```python
import torch

def _softmax(x, axis=-1):
    return torch.softmax(x, dim=axis)
def _gelu(x):
    return torch.nn.functional.gelu(x, approximate="tanh")
def _silu(x):
    return torch.nn.functional.silu(x)
def _sigmoid(x):
    return torch.sigmoid(x)
def _layernorm(x, axis=-1, eps=1e-5):
    m = x.mean(dim=axis, keepdim=True)
    v = x.var(dim=axis, keepdim=True, unbiased=False)
    return (x - m) / torch.sqrt(v + eps)
def _scatter_add(tgt, idx, src, axis=0):
    return tgt.clone().index_add_(axis, idx, src)
def _segment_sum(src, seg, n):
    out = torch.zeros((n,) + src.shape[1:], dtype=src.dtype)
    return out.index_add_(0, seg, src)
def _pad(x, pw):
    flat = tuple(v for pair in reversed(pw) for v in pair)
    return torch.nn.functional.pad(x, flat)

kernel_name = 'standalone__mha_softmax__near_ridge'

def setup_inputs():

    _w = (lambda a: (lambda t: t.to(torch.bfloat16) if t.is_floating_point() else t)(torch.as_tensor(a)))
    B, H, Sq, Sk, D = 8, 32, 1024, 512, 128
    return {
        "q": _w((lambda *s: torch.randn(*s, dtype=torch.bfloat16) * 0.8)(B, H, Sq, D)),
        "k": _w((lambda *s: torch.randn(*s, dtype=torch.bfloat16) * 0.8)(B, H, Sk, D)),
        "v": _w((lambda *s: torch.randn(*s, dtype=torch.bfloat16) * 0.05)(B, H, Sk, D)),
    }

def reference(q, k, v):
    scale = q.shape[-1] ** -0.5
    scores = torch.einsum("bhqd,bhkd->bhqk", q, k) * scale
    p = _softmax(scores, axis=-1)
    return torch.einsum("bhqk,bhkd->bhqd", p, v)
```

```asm
; @launch grid=(256,1,1) block=(256,1,1) lds=157824
.amdgcn_target "amdgcn-amd-amdhsa--gfx950"
.text
.globl standalone__mha_softmax__near_ridge_kernel
.p2align 8
.type standalone__mha_softmax__near_ridge_kernel,@function
standalone__mha_softmax__near_ridge_kernel:
    s_load_dwordx2 s[12:13], s[0:1], 8
    s_load_dwordx2 s[8:9], s[0:1], 0
    s_load_dwordx2 s[16:17], s[0:1], 16
    s_load_dwordx2 s[20:21], s[0:1], 24
    s_cmp_ge_u32 s2, 256
    s_cbranch_scc1 L_end
    s_getpc_b64 s[60:61]
L_pc:
    s_lshr_b32 s63, s2, 3
    s_lshl_b32 s63, s63, 12
    v_lshl_add_u32 v209, v0, 4, s63
    v_min_u32 v209, L_slow-L_pc, v209
    global_load_dword v208, v209, s[60:61]
    v_lshrrev_b32 v1, 6, v0
    v_and_b32 v0, 63, v0
    s_and_b32 s62, s2, 7
    v_readfirstlane_b32 s3, v1
    s_lshr_b32 s63, s2, 5
    s_lshl3_add_u32 s62, s63, s62
    s_bfe_u32 s63, s2, 0x20003
    s_lshl_b32 s30, s62, 17
    s_and_b32 s64, s62, 15
    s_lshl2_add_u32 s62, s62, s63
    s_bcnt1_i32_b32 s65, s62
    s_lshl2_add_u32 s62, s62, s3
    s_and_b32 s65, s65, 1
    s_lshl1_add_u32 s62, s62, s65
    s_lshl_b32 s28, s62, 13
    s_lshl2_add_u32 s64, s64, s3
    s_lshl_b32 s64, s64, 11
    s_add_u32 s29, s30, s64
    s_mul_i32 s62, s3, 2080
    s_add_u32 s31, s62, 33280
    s_mul_i32 s33, s3, 8320
    s_lshl2_add_u32 s66, s62, 124544
    v_bfe_u32 v1, v0, 2, 2
    v_lshrrev_b32 v2, 4, v0
    v_and_b32 v3, 3, v0
    v_lshlrev_b32 v4, 8, v1
    v_lshl_add_u32 v4, v2, 6, v4
    v_lshl_add_u32 v243, v3, 4, v4
    s_getreg_b32 s67, hwreg(HW_REG_XCC_ID, 0, 4)
    s_brev_b32 s10, 32
    s_mov_b32 s11, 0x20000
    s_brev_b32 s14, 64
    s_mov_b32 s15, 0x20000
    s_waitcnt lgkmcnt(0)
s_bitcmp0_b32 s67, 0
s_cbranch_scc1 L_skip_a
s_xor_b32 s38, s29, 0x0
s_add_u32 m0, s31, 0x0
s_nop 0
buffer_load_dwordx4 v243, s[12:15], s38 offen nt lds
buffer_load_dwordx4 v243, s[12:15], s38 offen offset:1024 nt lds
s_xor_b32 s56, s28, 0x0
s_add_u32 m0, s33, 0x0
s_nop 0
buffer_load_dwordx4 v243, s[8:11], s56 offen nt lds
buffer_load_dwordx4 v243, s[8:11], s56 offen offset:1024 nt lds
s_add_u32 m0, s33, 0x20
s_nop 0
buffer_load_dwordx4 v243, s[8:11], s56 offen offset:2048 nt lds
buffer_load_dwordx4 v243, s[8:11], s56 offen offset:3072 nt lds
s_xor_b32 s56, s28, 0x1000
s_add_u32 m0, s33, 0x1040
s_nop 0
buffer_load_dwordx4 v243, s[8:11], s56 offen nt lds
buffer_load_dwordx4 v243, s[8:11], s56 offen offset:1024 nt lds
s_add_u32 m0, s33, 0x1060
s_nop 0
buffer_load_dwordx4 v243, s[8:11], s56 offen offset:2048 nt lds
buffer_load_dwordx4 v243, s[8:11], s56 offen offset:3072 nt lds
s_xor_b32 s38, s29, 0x2000
s_add_u32 m0, s31, 0x2080
s_nop 0
buffer_load_dwordx4 v243, s[12:15], s38 offen nt lds
buffer_load_dwordx4 v243, s[12:15], s38 offen offset:1024 nt lds
L_skip_a:
    s_mul_i32 s63, s3, 2064
    s_add_u32 s32, s63, 91520
    s_mov_b32 s36, 0x35800000
    s_mov_b32 s37, 0x12000000
    s_mov_b32 s18, 0x2000000
    s_mov_b32 s19, 0x20000
    s_sub_u32 s24, s16, 8
    s_subb_u32 s25, s17, 0
    s_mov_b32 s26, 0x2000008
    s_mov_b32 s27, 0x20000
    s_mov_b32 s22, 0x4000000
    s_mov_b32 s23, 0x20000
    v_bfe_u32 v6, v0, 3, 1
    v_mul_u32_u24 v6, 2080, v6
    v_and_b32 v7, 1, v1
    v_lshl_add_u32 v6, v7, 10, v6
    v_lshl_add_u32 v6, v3, 6, v6
    v_lshl_add_u32 v6, v2, 4, v6
    v_add_u32 v240, 33280, v6
    v_add_u32 v242, s33, v6
    v_add_u32 v249, s66, v6
    v_and_b32 v5, 1, v0
    v_lshlrev_b32 v6, 4, v5
    v_mov_b32 v7, 0x3e03
    v_mov_b32 v8, 0xb9d8
    v_lshlrev_b32 v7, v6, v7
    v_lshlrev_b32 v8, v6, v8
    v_bfe_u32 v6, v0, 1, 3
    v_lshlrev_b32 v9, 1, v2
    v_sub_u32 v6, v6, v9
    v_cmp_eq_u32 vcc, 0, v6
    v_cmp_eq_u32 s[64:65], 1, v6
    v_mul_u32_u24 v5, 0xaaaa, v5
    v_add_u32 v248, 0x4444, v5
    v_cndmask_b32 v236, 0, v7, vcc
    v_cndmask_b32 v237, 0, v7, s[64:65]
    v_cndmask_b32 v238, 0, v8, vcc
    v_cndmask_b32 v239, 0, v8, s[64:65]
    v_xor_b32 v6, v2, v0
    v_and_b32 v5, 2, v6
    v_cmp_eq_u32 vcc, 0, v5
    v_mov_b32 v7, 0x3f803f80
    v_and_b32 v6, 7, v6
    v_cndmask_b32 v224, 0, v7, vcc
    v_cndmask_b32 v225, 0, v7, vcc
    v_cndmask_b32 v226, 0, v7, vcc
    v_cndmask_b32 v227, 0, v7, vcc
    v_and_b32 v5, 15, v0
    v_lshlrev_b32 v5, 7, v5
    v_lshl_add_u32 v5, v6, 4, v5
    v_add_u32 v244, s33, v5
    v_xor_b32 v247, 64, v244
    v_lshrrev_b32 v6, 3, v0
    v_and_b32 v7, 7, v0
    v_lshlrev_b32 v8, 8, v6
    v_lshl_add_u32 v246, v7, 4, v8
    v_xor_b32 v8, v6, v7
    v_lshlrev_b32 v8, 4, v8
    v_lshl_add_u32 v8, v6, 7, v8
    v_add_u32 v245, s33, v8
    v_mul_u32_u24 v6, 1032, v2
    v_lshl_add_u32 v6, v1, 6, v6
    v_lshl_add_u32 v6, v3, 4, v6
    v_add_u32 v241, 91520, v6
    v_mov_b64 v[216:217], 0
    v_mov_b64 v[218:219], 0
    v_mov_b64 v[220:221], 0
    v_mov_b64 v[222:223], 0
s_mov_b64 vcc, -1
s_cmp_eq_u32 s3, 0
s_cbranch_scc1 L_pad0
s_cmp_eq_u32 s3, 1
s_cbranch_scc1 L_pad1
s_cmp_eq_u32 s3, 2
s_cbranch_scc1 L_pad2
s_cmp_eq_u32 s3, 3
s_cbranch_scc1 L_pad3
s_branch L_main
.p2align 12
L_main:
s_mov_b64 vcc, 0
s_bitcmp0_b32 s67, 0
s_cbranch_scc0 L_skip_b
s_xor_b32 s38, s29, 0x0
s_add_u32 m0, s31, 0x0
s_nop 0
buffer_load_dwordx4 v243, s[12:15], s38 offen nt lds
buffer_load_dwordx4 v243, s[12:15], s38 offen offset:1024 nt lds
s_xor_b32 s56, s28, 0x0
s_add_u32 m0, s33, 0x0
s_nop 0
buffer_load_dwordx4 v243, s[8:11], s56 offen nt lds
buffer_load_dwordx4 v243, s[8:11], s56 offen offset:1024 nt lds
s_add_u32 m0, s33, 0x20
s_nop 0
buffer_load_dwordx4 v243, s[8:11], s56 offen offset:2048 nt lds
buffer_load_dwordx4 v243, s[8:11], s56 offen offset:3072 nt lds
s_xor_b32 s56, s28, 0x1000
s_add_u32 m0, s33, 0x1040
s_nop 0
buffer_load_dwordx4 v243, s[8:11], s56 offen nt lds
buffer_load_dwordx4 v243, s[8:11], s56 offen offset:1024 nt lds
s_add_u32 m0, s33, 0x1060
s_nop 0
buffer_load_dwordx4 v243, s[8:11], s56 offen offset:2048 nt lds
buffer_load_dwordx4 v243, s[8:11], s56 offen offset:3072 nt lds
s_xor_b32 s38, s29, 0x2000
s_add_u32 m0, s31, 0x2080
s_nop 0
buffer_load_dwordx4 v243, s[12:15], s38 offen nt lds
buffer_load_dwordx4 v243, s[12:15], s38 offen offset:1024 nt lds
L_skip_b:
s_xor_b32 s56, s28, 0x2000
s_add_u32 m0, s66, 0x0
s_nop 0
buffer_load_dwordx4 v243, s[8:11], s56 offen nt lds
buffer_load_dwordx4 v243, s[8:11], s56 offen offset:1024 nt lds
s_add_u32 m0, s66, 0x20
s_nop 0
buffer_load_dwordx4 v243, s[8:11], s56 offen offset:2048 nt lds
buffer_load_dwordx4 v243, s[8:11], s56 offen offset:3072 nt lds
s_xor_b32 s39, s29, 0x0
s_add_u32 m0, s32, 0x0
s_nop 0
buffer_load_dwordx4 v243, s[16:19], s39 offen nt lds
buffer_load_dwordx4 v243, s[24:27], s39 offen offset:1032 nt lds
s_xor_b32 s56, s28, 0x3000
s_add_u32 m0, s66, 0x1040
s_nop 0
buffer_load_dwordx4 v243, s[8:11], s56 offen nt lds
buffer_load_dwordx4 v243, s[8:11], s56 offen offset:1024 nt lds
s_add_u32 m0, s66, 0x1060
s_nop 0
buffer_load_dwordx4 v243, s[8:11], s56 offen offset:2048 nt lds
buffer_load_dwordx4 v243, s[8:11], s56 offen offset:3072 nt lds
s_waitcnt vmcnt(12) lgkmcnt(0)
ds_read_b128 v[2:5], v242
ds_read_b128 v[10:13], v242 offset:256
ds_read_b128 v[18:21], v242 offset:512
ds_read_b128 v[26:29], v242 offset:768
ds_read_b128 v[34:37], v242 offset:4160
ds_read_b128 v[42:45], v242 offset:4416
ds_read_b128 v[50:53], v242 offset:4672
ds_read_b128 v[58:61], v242 offset:4928
s_barrier
ds_read_b128 a[192:195], v240
ds_read_b128 a[196:199], v240 offset:256
ds_read_b128 a[200:203], v240 offset:512
ds_read_b128 a[204:207], v240 offset:768
s_waitcnt lgkmcnt(11)
v_mov_b64 v[0:1], v[2:3]
v_mov_b64 v[6:7], v[4:5]
s_waitcnt lgkmcnt(10)
v_mov_b64 v[8:9], v[10:11]
v_mov_b64 v[14:15], v[12:13]
v_mfma_f32_16x16x32_bf16 v[0:3], v[236:239], v[0:3], 0
ds_read_b128 a[208:211], v240 offset:4160
s_waitcnt lgkmcnt(10)
v_mov_b64 v[16:17], v[18:19]
v_mfma_f32_16x16x32_bf16 v[4:7], v[236:239], v[4:7], 0
ds_read_b128 a[212:215], v240 offset:4416
v_mov_b64 v[22:23], v[20:21]
v_mfma_f32_16x16x32_bf16 v[8:11], v[236:239], v[8:11], 0
ds_read_b128 a[216:219], v240 offset:4672
s_waitcnt lgkmcnt(11)
v_mov_b64 v[24:25], v[26:27]
v_cvt_pk_bf16_f32 v64, v0, v1
v_cvt_pk_bf16_f32 v65, v2, v3
v_mfma_f32_16x16x32_bf16 v[12:15], v[236:239], v[12:15], 0
ds_read_b128 a[220:223], v240 offset:4928
v_mov_b64_e64 v[30:31], v[28:29]
v_cvt_pk_bf16_f32 v66, v4, v5
v_cvt_pk_bf16_f32 v67, v6, v7
v_mfma_f32_16x16x32_bf16 v[16:19], v[236:239], v[16:19], 0
s_waitcnt lgkmcnt(11)
v_mov_b64 v[32:33], v[34:35]
v_cvt_pk_bf16_f32 v68, v8, v9
v_cvt_pk_bf16_f32 v69, v10, v11
v_mfma_f32_16x16x32_bf16 v[20:23], v[236:239], v[20:23], 0
v_mov_b64_e64 v[38:39], v[36:37]
v_cvt_pk_bf16_f32 v70, v12, v13
v_cvt_pk_bf16_f32 v71, v14, v15
v_mfma_f32_16x16x32_bf16 v[24:27], v[236:239], v[24:27], 0
s_waitcnt lgkmcnt(10)
v_mov_b64 v[40:41], v[42:43]
v_cvt_pk_bf16_f32 v72, v16, v17
v_cvt_pk_bf16_f32 v73, v18, v19
v_mfma_f32_16x16x32_bf16 v[28:31], v[236:239], v[28:31], 0
v_mov_b64_e64 v[46:47], v[44:45]
v_cvt_pk_bf16_f32 v74, v20, v21
v_cvt_pk_bf16_f32 v75, v22, v23
v_mfma_f32_16x16x32_bf16 v[32:35], v[236:239], v[32:35], 0
s_waitcnt lgkmcnt(9)
v_mov_b64 v[48:49], v[50:51]
v_cvt_pk_bf16_f32 v76, v24, v25
v_cvt_pk_bf16_f32 v77, v26, v27
v_mfma_f32_16x16x32_bf16 v[36:39], v[236:239], v[36:39], 0
v_mov_b64_e64 v[54:55], v[52:53]
v_cvt_pk_bf16_f32 v78, v28, v29
v_cvt_pk_bf16_f32 v79, v30, v31
v_mfma_f32_16x16x32_bf16 v[40:43], v[236:239], v[40:43], 0
s_waitcnt lgkmcnt(8)
v_mov_b64 v[56:57], v[58:59]
v_cvt_pk_bf16_f32 v80, v32, v33
v_cvt_pk_bf16_f32 v81, v34, v35
v_mfma_f32_16x16x32_bf16 v[44:47], v[236:239], v[44:47], 0
v_mov_b64 v[62:63], v[60:61]
v_cvt_pk_bf16_f32 v82, v36, v37
v_cvt_pk_bf16_f32 v83, v38, v39
v_mfma_f32_16x16x32_bf16 v[48:51], v[236:239], v[48:51], 0
v_cvt_pk_bf16_f32 v84, v40, v41
v_cvt_pk_bf16_f32 v85, v42, v43
v_mfma_f32_16x16x32_bf16 v[52:55], v[236:239], v[52:55], 0
v_mfma_f32_16x16x32_bf16 v[56:59], v[236:239], v[56:59], 0
v_cvt_pk_bf16_f32 v86, v44, v45
v_cvt_pk_bf16_f32 v87, v46, v47
v_mfma_f32_16x16x32_bf16 v[60:63], v[236:239], v[60:63], 0
s_waitcnt lgkmcnt(7)
v_mfma_f32_16x16x32_bf16 v[128:131], a[192:195], v[64:67], -4.0
s_waitcnt lgkmcnt(6)
v_cvt_pk_bf16_f32 v88, v48, v49
v_cvt_pk_bf16_f32 v89, v50, v51
v_mfma_f32_16x16x32_bf16 v[128:131], a[196:199], v[68:71], v[128:131]
s_waitcnt lgkmcnt(5)
v_cvt_pk_bf16_f32 v90, v52, v53
v_cvt_pk_bf16_f32 v91, v54, v55
v_mfma_f32_16x16x32_bf16 v[128:131], a[200:203], v[72:75], v[128:131]
s_waitcnt lgkmcnt(4)
v_cvt_pk_bf16_f32 v92, v56, v57
v_cvt_pk_bf16_f32 v93, v58, v59
v_mfma_f32_16x16x32_bf16 v[128:131], a[204:207], v[76:79], v[128:131]
s_waitcnt lgkmcnt(3)
v_cvt_pk_bf16_f32 v94, v60, v61
v_cvt_pk_bf16_f32 v95, v62, v63
v_mfma_f32_16x16x32_bf16 v[132:135], a[208:211], v[64:67], -4.0
s_waitcnt lgkmcnt(2)
v_mfma_f32_16x16x32_bf16 v[132:135], a[212:215], v[68:71], v[132:135]
s_waitcnt lgkmcnt(1)
v_mfma_f32_16x16x32_bf16 v[132:135], a[216:219], v[72:75], v[132:135]
s_waitcnt vmcnt(10) lgkmcnt(0)
v_exp_f32_e64 v128, v128
v_mfma_f32_16x16x32_bf16 v[132:135], a[220:223], v[76:79], v[132:135]
s_barrier
v_mfma_f32_16x16x32_bf16 v[136:139], a[192:195], v[80:83], -4.0
s_xor_b32 s39, s29, 0x2000
ds_read_b128 a[192:195], v240 offset:8320
v_exp_f32 v129, v129
v_mfma_f32_16x16x32_bf16 v[136:139], a[196:199], v[84:87], v[136:139]
s_add_u32 m0, s32, 0x2040
ds_read_b128 a[196:199], v240 offset:8576
v_exp_f32 v130, v130
v_mfma_f32_16x16x32_bf16 v[136:139], a[200:203], v[88:91], v[136:139]
s_xor_b32 s38, s29, 0x4000
ds_read_b128 a[200:203], v240 offset:8832
v_cvt_pk_bf16_f32 v160, v128, v129
v_mfma_f32_16x16x32_bf16 v[136:139], a[204:207], v[92:95], v[136:139]
s_xor_b32 s56, s28, 0x1000000
ds_read_b128 a[204:207], v240 offset:9088
v_exp_f32 v131, v131
v_mfma_f32_16x16x32_bf16 v[140:143], a[208:211], v[80:83], -4.0
s_xor_b32 s57, s28, 0x0
ds_read_b128 a[208:211], v240 offset:12480
v_exp_f32 v132, v132
v_mfma_f32_16x16x32_bf16 v[140:143], a[212:215], v[84:87], v[140:143]
s_xor_b32 s58, s28, 0x1000
ds_read_b128 a[212:215], v240 offset:12736
v_cvt_pk_bf16_f32 v161, v130, v131
v_mfma_f32_16x16x32_bf16 v[140:143], a[216:219], v[88:91], v[140:143]
ds_read_b128 a[216:219], v240 offset:12992
v_exp_f32 v133, v133
v_mfma_f32_16x16x32_bf16 v[140:143], a[220:223], v[92:95], v[140:143]
buffer_load_dwordx4 v243, s[16:19], s39 offen nt lds
buffer_load_dwordx4 v243, s[24:27], s39 offen offset:1032 nt lds
s_add_u32 m0, s31, 0x4100
s_nop 0
buffer_load_dwordx4 v243, s[12:15], s38 offen nt lds
buffer_load_dwordx4 v243, s[12:15], s38 offen offset:1024 nt lds
s_waitcnt lgkmcnt(6)
ds_read_b128 a[220:223], v240 offset:13248
v_mfma_f32_16x16x32_bf16 v[144:147], a[192:195], v[64:67], -4.0
s_waitcnt lgkmcnt(6)
v_exp_f32 v134, v134
v_mfma_f32_16x16x32_bf16 v[144:147], a[196:199], v[68:71], v[144:147]
s_waitcnt lgkmcnt(5)
v_cvt_pk_bf16_f32 v162, v132, v133
v_exp_f32 v135, v135
v_mfma_f32_16x16x32_bf16 v[144:147], a[200:203], v[72:75], v[144:147]
s_waitcnt lgkmcnt(4)
v_exp_f32_e64 v136, v136
v_mfma_f32_16x16x32_bf16 v[144:147], a[204:207], v[76:79], v[144:147]
s_waitcnt lgkmcnt(3)
v_cvt_pk_bf16_f32 v163, v134, v135
v_exp_f32 v137, v137
v_mfma_f32_16x16x32_bf16 v[148:151], a[208:211], v[64:67], -4.0
s_waitcnt lgkmcnt(2)
v_exp_f32 v138, v138
v_mfma_f32_16x16x32_bf16 v[148:151], a[212:215], v[68:71], v[148:151]
s_waitcnt lgkmcnt(1)
v_cvt_pk_bf16_f32 v164, v136, v137
v_exp_f32 v139, v139
v_mfma_f32_16x16x32_bf16 v[148:151], a[216:219], v[72:75], v[148:151]
s_waitcnt lgkmcnt(0)
v_exp_f32 v140, v140
v_mfma_f32_16x16x32_bf16 v[148:151], a[220:223], v[76:79], v[148:151]
s_xor_b32 s38, s29, 0x6000
v_cvt_pk_bf16_f32 v165, v138, v139
v_exp_f32 v141, v141
v_mfma_f32_16x16x32_bf16 v[152:155], a[192:195], v[80:83], -4.0
s_add_u32 m0, s31, 0x6180
ds_read_b128 a[192:195], v240
v_exp_f32_e64 v142, v142
v_mfma_f32_16x16x32_bf16 v[152:155], a[196:199], v[84:87], v[152:155]
s_xor_b32 s39, s29, 0x4000
ds_read_b128 a[196:199], v240 offset:256
v_cvt_pk_bf16_f32 v166, v140, v141
v_mfma_f32_16x16x32_bf16 v[152:155], a[200:203], v[88:91], v[152:155]
ds_read_b128 a[200:203], v240 offset:512
v_exp_f32_e64 v143, v143
v_mfma_f32_16x16x32_bf16 v[152:155], a[204:207], v[92:95], v[152:155]
ds_read_b128 a[204:207], v240 offset:768
v_cvt_pk_bf16_f32 v167, v142, v143
v_mfma_f32_16x16x32_bf16 v[156:159], a[208:211], v[80:83], -4.0
ds_read_b128 a[208:211], v240 offset:4160
v_exp_f32 v144, v144
v_mfma_f32_16x16x32_bf16 v[156:159], a[212:215], v[84:87], v[156:159]
ds_read_b128 a[212:215], v240 offset:4416
v_exp_f32 v145, v145
v_mfma_f32_16x16x32_bf16 v[156:159], a[216:219], v[88:91], v[156:159]
ds_read_b128 a[216:219], v240 offset:4672
v_exp_f32 v146, v146
v_mfma_f32_16x16x32_bf16 v[156:159], a[220:223], v[92:95], v[156:159]
ds_read_b128 a[220:223], v240 offset:4928
v_cvt_pk_bf16_f32 v168, v144, v145
v_exp_f32 v147, v147
v_exp_f32 v148, v148
v_cvt_pk_bf16_f32 v169, v146, v147
v_exp_f32 v149, v149
v_exp_f32_e64 v150, v150
v_cvt_pk_bf16_f32 v170, v148, v149
v_exp_f32 v151, v151
v_exp_f32 v152, v152
v_cvt_pk_bf16_f32 v171, v150, v151
v_exp_f32 v153, v153
v_exp_f32 v154, v154
v_cvt_pk_bf16_f32 v172, v152, v153
v_exp_f32 v155, v155
v_exp_f32 v156, v156
v_cvt_pk_bf16_f32 v173, v154, v155
v_exp_f32 v157, v157
v_exp_f32 v158, v158
v_cvt_pk_bf16_f32 v174, v156, v157
v_exp_f32 v159, v159
s_nop 0
v_cvt_pk_bf16_f32 v175, v158, v159
buffer_load_dwordx4 v243, s[12:15], s38 offen nt lds
s_add_u32 m0, s31, 0x6180
s_nop 0
buffer_load_dwordx4 v243, s[12:15], s38 offen offset:1024 nt lds
s_add_u32 m0, s32, 0x4080
s_nop 0
buffer_load_dwordx4 v243, s[16:19], s39 offen nt lds
buffer_load_dwordx4 v243, s[24:27], s39 offen offset:1032 nt lds
s_mov_b64 vcc, -1
s_cmp_eq_u32 s3, 0
s_cbranch_scc1 L_pad12
s_cmp_eq_u32 s3, 1
s_cbranch_scc1 L_pad13
s_cmp_eq_u32 s3, 2
s_cbranch_scc1 L_pad14
s_cmp_eq_u32 s3, 3
s_cbranch_scc1 L_pad15
L_back0:
s_cbranch_scc0 L_back
s_mov_b64 vcc, 0
s_waitcnt vmcnt(14)
ds_read_b128 v[2:5], v249
ds_read_b128 v[10:13], v249 offset:256
ds_read_b128 v[18:21], v249 offset:512
ds_read_b128 v[26:29], v249 offset:768
s_waitcnt lgkmcnt(3)
v_mov_b64 v[0:1], v[2:3]
v_mov_b64 v[6:7], v[4:5]
s_waitcnt lgkmcnt(2)
v_mov_b64 v[8:9], v[10:11]
v_mov_b64 v[14:15], v[12:13]
v_mfma_f32_16x16x32_bf16 v[0:3], v[236:239], v[0:3], 0
s_waitcnt lgkmcnt(1)
v_mov_b64 v[16:17], v[18:19]
v_mfma_f32_16x16x32_bf16 v[4:7], v[236:239], v[4:7], 0
v_mov_b64 v[22:23], v[20:21]
v_mfma_f32_16x16x32_bf16 v[8:11], v[236:239], v[8:11], 0
s_waitcnt lgkmcnt(0)
v_mov_b64_e64 v[24:25], v[26:27]
v_mfma_f32_16x16x32_bf16 v[12:15], v[236:239], v[12:15], 0
v_mov_b64_e64 v[30:31], v[28:29]
v_cvt_pk_bf16_f32 v96, v0, v1
v_cvt_pk_bf16_f32 v97, v2, v3
v_mfma_f32_16x16x32_bf16 v[16:19], v[236:239], v[16:19], 0
v_cvt_pk_bf16_f32 v98, v4, v5
v_cvt_pk_bf16_f32 v99, v6, v7
v_mfma_f32_16x16x32_bf16 v[20:23], v[236:239], v[20:23], 0
v_cvt_pk_bf16_f32 v100, v8, v9
v_cvt_pk_bf16_f32 v101, v10, v11
v_mfma_f32_16x16x32_bf16 v[24:27], v[236:239], v[24:27], 0
v_cvt_pk_bf16_f32 v102, v12, v13
v_cvt_pk_bf16_f32 v103, v14, v15
v_mfma_f32_16x16x32_bf16 v[28:31], v[236:239], v[28:31], 0
v_cvt_pk_bf16_f32 v104, v16, v17
v_cvt_pk_bf16_f32 v105, v18, v19
v_mfma_f32_16x16x32_bf16 v[128:131], a[192:195], v[96:99], -4.0
s_xor_b32 s39, s29, 0x6000
v_cvt_pk_bf16_f32 v106, v20, v21
v_cvt_pk_bf16_f32 v107, v22, v23
v_mfma_f32_16x16x32_bf16 v[128:131], a[196:199], v[100:103], v[128:131]
s_xor_b32 s38, s29, 0x8000
v_cvt_pk_bf16_f32 v108, v24, v25
v_cvt_pk_bf16_f32 v109, v26, v27
v_mfma_f32_16x16x32_bf16 v[128:131], a[200:203], v[104:107], v[128:131]
v_cvt_pk_bf16_f32 v110, v28, v29
v_cvt_pk_bf16_f32 v111, v30, v31
s_nop 1
v_mfma_f32_16x16x32_bf16 v[128:131], a[204:207], v[108:111], v[128:131]
v_mfma_f32_16x16x32_bf16 v[132:135], a[208:211], v[96:99], -4.0
v_mfma_f32_16x16x32_bf16 v[132:135], a[212:215], v[100:103], v[132:135]
v_mfma_f32_16x16x32_bf16 v[132:135], a[216:219], v[104:107], v[132:135]
v_mfma_f32_16x16x32_bf16 v[132:135], a[220:223], v[108:111], v[132:135]
s_waitcnt vmcnt(8)
ds_read_b128 v[34:37], v249 offset:4160
ds_read_b128 v[42:45], v249 offset:4416
ds_read_b128 v[50:53], v249 offset:4672
ds_read_b128 v[58:61], v249 offset:4928
s_waitcnt lgkmcnt(3)
v_mov_b64 v[32:33], v[34:35]
v_mov_b64 v[38:39], v[36:37]
s_waitcnt lgkmcnt(2)
v_mov_b64 v[40:41], v[42:43]
v_mov_b64 v[46:47], v[44:45]
v_mfma_f32_16x16x32_bf16 v[32:35], v[236:239], v[32:35], 0
s_waitcnt lgkmcnt(1)
v_mov_b64 v[48:49], v[50:51]
v_mfma_f32_16x16x32_bf16 v[36:39], v[236:239], v[36:39], 0
v_mov_b64 v[54:55], v[52:53]
v_mfma_f32_16x16x32_bf16 v[40:43], v[236:239], v[40:43], 0
s_waitcnt lgkmcnt(0)
v_mov_b64 v[56:57], v[58:59]
v_mfma_f32_16x16x32_bf16 v[44:47], v[236:239], v[44:47], 0
v_mov_b64 v[62:63], v[60:61]
v_cvt_pk_bf16_f32 v112, v32, v33
v_cvt_pk_bf16_f32 v113, v34, v35
v_mfma_f32_16x16x32_bf16 v[48:51], v[236:239], v[48:51], 0
v_cvt_pk_bf16_f32 v114, v36, v37
v_cvt_pk_bf16_f32 v115, v38, v39
v_mfma_f32_16x16x32_bf16 v[52:55], v[236:239], v[52:55], 0
v_cvt_pk_bf16_f32 v116, v40, v41
v_cvt_pk_bf16_f32 v117, v42, v43
v_mfma_f32_16x16x32_bf16 v[56:59], v[236:239], v[56:59], 0
v_cvt_pk_bf16_f32 v118, v44, v45
v_cvt_pk_bf16_f32 v119, v46, v47
v_mfma_f32_16x16x32_bf16 v[60:63], v[236:239], v[60:63], 0
v_cvt_pk_bf16_f32 v120, v48, v49
v_cvt_pk_bf16_f32 v121, v50, v51
v_mfma_f32_16x16x32_bf16 v[136:139], a[192:195], v[112:115], -4.0
s_add_u32 m0, s32, 0x60c0
ds_read_b128 a[192:195], v240 offset:8320
v_cvt_pk_bf16_f32 v122, v52, v53
v_mfma_f32_16x16x32_bf16 v[136:139], a[196:199], v[116:119], v[136:139]
ds_read_b128 a[196:199], v240 offset:8576
v_cvt_pk_bf16_f32 v123, v54, v55
s_nop 1
v_mfma_f32_16x16x32_bf16 v[136:139], a[200:203], v[120:123], v[136:139]
ds_read_b128 a[200:203], v240 offset:8832
v_cvt_pk_bf16_f32 v124, v56, v57
v_cvt_pk_bf16_f32 v125, v58, v59
v_cvt_pk_bf16_f32 v126, v60, v61
v_cvt_pk_bf16_f32 v127, v62, v63
s_nop 1
v_mfma_f32_16x16x32_bf16 v[136:139], a[204:207], v[124:127], v[136:139]
ds_read_b128 a[204:207], v240 offset:9088
v_mbcnt_lo_u32_b32 v249, -1, 0
v_mfma_f32_16x16x32_bf16 v[140:143], a[208:211], v[112:115], -4.0
ds_read_b128 a[208:211], v240 offset:12480
v_mbcnt_hi_u32_b32 v249, -1, v249
v_mfma_f32_16x16x32_bf16 v[140:143], a[212:215], v[116:119], v[140:143]
ds_read_b128 a[212:215], v240 offset:12736
v_and_b32 v200, 48, v249
v_mfma_f32_16x16x32_bf16 v[140:143], a[216:219], v[120:123], v[140:143]
s_waitcnt vmcnt(6)
ds_read_b128 a[216:219], v240 offset:12992
v_and_b32 v201, 8, v249
v_mfma_f32_16x16x32_bf16 v[140:143], a[220:223], v[124:127], v[140:143]
s_waitcnt lgkmcnt(6)
s_barrier
v_mfma_f32_16x16x32_bf16 v[144:147], a[192:195], v[96:99], -4.0
s_waitcnt lgkmcnt(5)
ds_read_b128 a[220:223], v240 offset:13248
ds_read_b64_tr_b16 a[224:225], v241
v_mfma_f32_16x16x32_bf16 v[144:147], a[196:199], v[100:103], v[144:147]
s_waitcnt lgkmcnt(6)
buffer_load_dwordx4 v243, s[16:19], s39 offen nt lds
v_mfma_f32_16x16x32_bf16 v[144:147], a[200:203], v[104:107], v[144:147]
s_waitcnt lgkmcnt(5)
ds_read_b64_tr_b16 a[226:227], v241 offset:4128
ds_read_b64_tr_b16 a[228:229], v241 offset:8256
v_mfma_f32_16x16x32_bf16 v[144:147], a[204:207], v[108:111], v[144:147]
s_waitcnt lgkmcnt(3)
ds_read_b64_tr_b16 a[230:231], v241 offset:12384
ds_read_b64_tr_b16 a[232:233], v241 offset:8
v_mfma_f32_16x16x32_bf16 v[148:151], a[220:223], v[108:111], -4.0
ds_read_b64_tr_b16 a[234:235], v241 offset:4136
ds_read_b64_tr_b16 a[236:237], v241 offset:8264
v_mfma_f32_16x16x32_bf16 v[148:151], a[216:219], v[104:107], v[148:151]
ds_read_b64_tr_b16 a[238:239], v241 offset:12392
ds_read_b64_tr_b16 a[240:241], v241 offset:256
v_mfma_f32_16x16x32_bf16 v[148:151], a[212:215], v[100:103], v[148:151]
ds_read_b64_tr_b16 a[242:243], v241 offset:4384
ds_read_b64_tr_b16 a[244:245], v241 offset:8512
v_mfma_f32_16x16x32_bf16 v[148:151], a[208:211], v[96:99], v[148:151]
ds_read_b64_tr_b16 a[246:247], v241 offset:12640
ds_read_b64_tr_b16 a[248:249], v241 offset:264
v_exp_f32 v128, v128
v_mfma_f32_16x16x32_bf16 v[156:159], a[208:211], v[112:115], -4.0
ds_read_b64_tr_b16 a[250:251], v241 offset:4392
ds_read_b64_tr_b16 a[252:253], v241 offset:8520
v_mfma_f32_16x16x32_bf16 v[156:159], a[212:215], v[116:119], v[156:159]
ds_read_b64_tr_b16 a[254:255], v241 offset:12648
v_lshl_add_u32 v200, v201, 3, v200
v_mfma_f32_16x16x32_bf16 v[156:159], a[216:219], v[120:123], v[156:159]
s_add_u32 m0, s32, 0x60c0
v_exp_f32_e64 v129, v129
v_mfma_f32_16x16x32_bf16 v[156:159], a[220:223], v[124:127], v[156:159]
buffer_load_dwordx4 v243, s[24:27], s39 offen offset:1032 nt lds
v_mfma_f32_16x16x32_bf16 v[152:155], a[204:207], v[124:127], -4.0
v_exp_f32 v130, v130
v_cvt_pk_bf16_f32 v176, v128, v129
v_mfma_f32_16x16x32_bf16 v[152:155], a[200:203], v[120:123], v[152:155]
v_exp_f32 v131, v131
v_mfma_f32_16x16x32_bf16 v[152:155], a[196:199], v[116:119], v[152:155]
s_waitcnt vmcnt(6) lgkmcnt(3)
v_exp_f32 v132, v132
v_mfma_f32_16x16x32_bf16 v[152:155], a[192:195], v[112:115], v[152:155]
s_barrier
v_smfmac_f32_16x16x64_bf16 v[216:219], v[224:227], v[160:167], v248
ds_read_b128 a[208:211], v240 offset:20800
v_cvt_pk_bf16_f32 v177, v130, v131
v_mfma_f32_16x16x32_bf16 v[0:3], a[224:227], v[160:163], 0
v_exp_f32 v133, v133
v_mfma_f32_16x16x32_bf16 v[0:3], a[228:231], v[168:171], v[0:3]
ds_read_b128 a[212:215], v240 offset:21056
ds_read_b128 a[216:219], v240 offset:21312
v_mfma_f32_16x16x32_bf16 v[32:35], a[228:231], v[172:175], 0
v_exp_f32_e64 v134, v134
v_mfma_f32_16x16x32_bf16 v[32:35], a[224:227], v[164:167], v[32:35]
s_add_u32 m0, s31, 0x8200
ds_read_b128 a[220:223], v240 offset:21568
ds_read_b128 a[204:207], v240 offset:17408
v_cvt_pk_bf16_f32 v178, v132, v133
v_mfma_f32_16x16x32_bf16 v[36:39], a[232:235], v[164:167], 0
v_exp_f32 v135, v135
v_mfma_f32_16x16x32_bf16 v[36:39], a[236:239], v[172:175], v[36:39]
buffer_load_dwordx4 v243, s[12:15], s38 offen nt lds
v_mfma_f32_16x16x32_bf16 v[4:7], a[236:239], v[168:171], 0
ds_read_b128 a[200:203], v240 offset:17152
v_and_b32 v249, 7, v249
v_mfma_f32_16x16x32_bf16 v[4:7], a[232:235], v[160:163], v[4:7]
ds_read_b128 a[196:199], v240 offset:16896
v_lshl_add_u32 v249, v249, 8, v200
v_exp_f32 v136, v136
v_mfma_f32_16x16x32_bf16 v[8:11], a[240:243], v[160:163], 0
ds_read_b128 a[192:195], v240 offset:16640
v_cvt_pk_bf16_f32 v179, v134, v135
v_mfma_f32_16x16x32_bf16 v[8:11], a[244:247], v[168:171], v[8:11]
v_exp_f32 v137, v137
v_mfma_f32_16x16x32_bf16 v[40:43], a[244:247], v[172:175], 0
v_exp_f32_e64 v138, v138
v_mfma_f32_16x16x32_bf16 v[40:43], a[240:243], v[164:167], v[40:43]
s_waitcnt lgkmcnt(3)
v_exp_f32 v139, v139
v_cvt_pk_bf16_f32 v180, v136, v137
v_mfma_f32_16x16x32_bf16 v[44:47], a[248:251], v[164:167], 0
v_exp_f32 v140, v140
v_mfma_f32_16x16x32_bf16 v[44:47], a[252:255], v[172:175], v[44:47]
v_exp_f32 v141, v141
v_mfma_f32_16x16x32_bf16 v[12:15], a[252:255], v[168:171], 0
s_add_u32 m0, s31, 0x8200
v_exp_f32 v142, v142
v_mfma_f32_16x16x32_bf16 v[12:15], a[248:251], v[160:163], v[12:15]
s_waitcnt lgkmcnt(0)
buffer_load_dwordx4 v243, s[12:15], s38 offen offset:1024 nt lds
v_mfma_f32_16x16x32_bf16 v[128:131], a[192:195], v[64:67], -4.0
s_xor_b32 s38, s29, 0xa000
v_cvt_pk_bf16_f32 v181, v138, v139
v_cvt_pk_bf16_f32 v182, v140, v141
v_mfma_f32_16x16x32_bf16 v[128:131], a[196:199], v[68:71], v[128:131]
s_xor_b32 s39, s29, 0x8000
v_exp_f32 v143, v143
v_mfma_f32_16x16x32_bf16 v[128:131], a[200:203], v[72:75], v[128:131]
v_exp_f32 v144, v144
v_mfma_f32_16x16x32_bf16 v[128:131], a[204:207], v[76:79], v[128:131]
v_exp_f32 v145, v145
v_mfma_f32_16x16x32_bf16 v[132:135], a[220:223], v[76:79], -4.0
v_exp_f32 v146, v146
v_mfma_f32_16x16x32_bf16 v[132:135], a[216:219], v[72:75], v[132:135]
v_cvt_pk_bf16_f32 v183, v142, v143
v_cvt_pk_bf16_f32 v184, v144, v145
v_mfma_f32_16x16x32_bf16 v[132:135], a[212:215], v[68:71], v[132:135]
v_exp_f32 v147, v147
v_mfma_f32_16x16x32_bf16 v[132:135], a[208:211], v[64:67], v[132:135]
v_exp_f32 v148, v148
v_cvt_pk_bf16_f32 v185, v146, v147
v_mfma_f32_16x16x32_bf16 v[140:143], a[208:211], v[80:83], -4.0
s_add_u32 m0, s31, 0xa280
v_exp_f32_e64 v149, v149
v_mfma_f32_16x16x32_bf16 v[140:143], a[212:215], v[84:87], v[140:143]
v_exp_f32 v150, v150
v_mfma_f32_16x16x32_bf16 v[140:143], a[216:219], v[88:91], v[140:143]
v_cvt_pk_bf16_f32 v186, v148, v149
v_mfma_f32_16x16x32_bf16 v[140:143], a[220:223], v[92:95], v[140:143]
buffer_load_dwordx4 v243, s[12:15], s38 offen nt lds
v_mfma_f32_16x16x32_bf16 v[136:139], a[204:207], v[92:95], -4.0
v_exp_f32 v151, v151
v_mfma_f32_16x16x32_bf16 v[136:139], a[200:203], v[88:91], v[136:139]
v_exp_f32 v156, v156
v_mfma_f32_16x16x32_bf16 v[136:139], a[196:199], v[84:87], v[136:139]
v_cvt_pk_bf16_f32 v187, v150, v151
v_mfma_f32_16x16x32_bf16 v[136:139], a[192:195], v[80:83], v[136:139]
v_exp_f32 v157, v157
v_smfmac_f32_16x16x64_bf16 v[220:223], v[224:227], v[176:183], v248
v_exp_f32 v158, v158
v_cvt_pk_bf16_f32 v190, v156, v157
v_mfma_f32_16x16x32_bf16 a[0:3], a[224:227], v[176:179], 0
v_exp_f32 v159, v159
v_mfma_f32_16x16x32_bf16 a[0:3], a[228:231], v[184:187], a[0:3]
v_exp_f32 v152, v152
v_cvt_pk_bf16_f32 v191, v158, v159
v_exp_f32 v153, v153
v_exp_f32 v154, v154
v_cvt_pk_bf16_f32 v188, v152, v153
v_exp_f32 v155, v155
s_nop 0
v_cvt_pk_bf16_f32 v189, v154, v155
s_nop 1
v_mfma_f32_16x16x32_bf16 a[32:35], a[228:231], v[188:191], 0
v_exp_f32 v128, v128
v_mfma_f32_16x16x32_bf16 a[32:35], a[224:227], v[180:183], a[32:35]
s_add_u32 m0, s31, 0xa280
ds_read_b64_tr_b16 a[224:225], v241 offset:512
ds_read_b64_tr_b16 a[226:227], v241 offset:4640
v_mfma_f32_16x16x32_bf16 a[36:39], a[232:235], v[180:183], 0
v_exp_f32 v129, v129
v_mfma_f32_16x16x32_bf16 a[36:39], a[236:239], v[188:191], a[36:39]
buffer_load_dwordx4 v243, s[12:15], s38 offen offset:1024 nt lds
v_mfma_f32_16x16x32_bf16 a[4:7], a[236:239], v[184:187], 0
v_exp_f32 v130, v130
v_mfma_f32_16x16x32_bf16 a[4:7], a[232:235], v[176:179], a[4:7]
ds_read_b64_tr_b16 a[228:229], v241 offset:8768
ds_read_b64_tr_b16 a[230:231], v241 offset:12896
v_mfma_f32_16x16x32_bf16 a[8:11], a[240:243], v[176:179], 0
v_exp_f32 v131, v131
v_mfma_f32_16x16x32_bf16 a[8:11], a[244:247], v[184:187], a[8:11]
ds_read_b64_tr_b16 a[232:233], v241 offset:520
ds_read_b64_tr_b16 a[234:235], v241 offset:4648
v_mfma_f32_16x16x32_bf16 a[40:43], a[244:247], v[188:191], 0
v_exp_f32 v132, v132
v_mfma_f32_16x16x32_bf16 a[40:43], a[240:243], v[180:183], a[40:43]
ds_read_b64_tr_b16 a[236:237], v241 offset:8776
ds_read_b64_tr_b16 a[238:239], v241 offset:12904
v_cvt_pk_bf16_f32 v192, v128, v129
v_mfma_f32_16x16x32_bf16 a[44:47], a[248:251], v[180:183], 0
v_exp_f32 v133, v133
v_mfma_f32_16x16x32_bf16 a[44:47], a[252:255], v[188:191], a[44:47]
ds_read_b64_tr_b16 a[240:241], v241 offset:768
ds_read_b64_tr_b16 a[242:243], v241 offset:4896
v_mfma_f32_16x16x32_bf16 a[12:15], a[252:255], v[184:187], 0
s_add_u32 m0, s32, 0x8100
v_exp_f32_e64 v134, v134
v_mfma_f32_16x16x32_bf16 a[12:15], a[248:251], v[176:179], a[12:15]
buffer_load_dwordx4 v243, s[16:19], s39 offen nt lds
v_mfma_f32_16x16x32_bf16 v[144:147], a[192:195], v[96:99], -4.0
v_cvt_pk_bf16_f32 v193, v130, v131
v_cvt_pk_bf16_f32 v194, v132, v133
v_mfma_f32_16x16x32_bf16 v[144:147], a[196:199], v[100:103], v[144:147]
v_exp_f32 v135, v135
v_mfma_f32_16x16x32_bf16 v[144:147], a[200:203], v[104:107], v[144:147]
v_exp_f32 v140, v140
v_mfma_f32_16x16x32_bf16 v[144:147], a[204:207], v[108:111], v[144:147]
ds_read_b64_tr_b16 a[244:245], v241 offset:9024
ds_read_b64_tr_b16 a[246:247], v241 offset:13152
v_mfma_f32_16x16x32_bf16 v[148:151], a[220:223], v[108:111], -4.0
L_pad0:
s_cbranch_vccnz L_pad4
v_exp_f32 v141, v141
v_mfma_f32_16x16x32_bf16 v[148:151], a[216:219], v[104:107], v[148:151]
v_exp_f32 v142, v142
v_mfma_f32_16x16x32_bf16 v[148:151], a[212:215], v[100:103], v[148:151]
s_waitcnt vmcnt(9) lgkmcnt(2)
v_cvt_pk_bf16_f32 v195, v134, v135
v_cvt_pk_bf16_f32 v198, v140, v141
v_mfma_f32_16x16x32_bf16 v[148:151], a[208:211], v[96:99], v[148:151]
s_barrier
v_mfma_f32_16x16x32_bf16 v[156:159], a[208:211], v[112:115], -4.0
s_add_u32 m0, s32, 0x8100
v_exp_f32 v143, v143
v_mfma_f32_16x16x32_bf16 v[156:159], a[212:215], v[116:119], v[156:159]
v_exp_f32 v136, v136
v_mfma_f32_16x16x32_bf16 v[156:159], a[216:219], v[120:123], v[156:159]
v_exp_f32 v137, v137
v_mfma_f32_16x16x32_bf16 v[156:159], a[220:223], v[124:127], v[156:159]
buffer_load_dwordx4 v243, s[24:27], s39 offen offset:1032 nt lds
v_mfma_f32_16x16x32_bf16 v[152:155], a[204:207], v[124:127], -4.0
s_xor_b32 s39, s29, 0xa000
v_exp_f32_e64 v138, v138
v_mfma_f32_16x16x32_bf16 v[152:155], a[200:203], v[120:123], v[152:155]
s_xor_b32 s38, s29, 0xc000
v_cvt_pk_bf16_f32 v199, v142, v143
v_cvt_pk_bf16_f32 v196, v136, v137
v_mfma_f32_16x16x32_bf16 v[152:155], a[196:199], v[116:119], v[152:155]
ds_read_b64_tr_b16 a[248:249], v241 offset:776
ds_read_b64_tr_b16 a[250:251], v241 offset:4904
v_mfma_f32_16x16x32_bf16 v[152:155], a[192:195], v[112:115], v[152:155]
ds_read_b64_tr_b16 a[252:253], v241 offset:9032
ds_read_b64_tr_b16 a[254:255], v241 offset:13160
v_smfmac_f32_16x16x64_bf16 v[216:219], v[224:227], v[168:175], v248
ds_read_b128 a[208:211], v240 offset:29120
v_mfma_f32_16x16x32_bf16 v[16:19], a[224:227], v[160:163], 0
v_exp_f32 v139, v139
v_mfma_f32_16x16x32_bf16 v[16:19], a[228:231], v[168:171], v[16:19]
ds_read_b128 a[212:215], v240 offset:29376
ds_read_b128 a[216:219], v240 offset:29632
v_mfma_f32_16x16x32_bf16 v[48:51], a[228:231], v[172:175], 0
v_exp_f32 v144, v144
v_mfma_f32_16x16x32_bf16 v[48:51], a[224:227], v[164:167], v[48:51]
s_add_u32 m0, s32, 0xa140
ds_read_b128 a[220:223], v240 offset:29888
ds_read_b128 a[204:207], v240 offset:25728
v_mfma_f32_16x16x32_bf16 v[52:55], a[232:235], v[164:167], 0
v_exp_f32_e64 v145, v145
v_mfma_f32_16x16x32_bf16 v[52:55], a[236:239], v[172:175], v[52:55]
buffer_load_dwordx4 v243, s[16:19], s39 offen nt lds
v_mfma_f32_16x16x32_bf16 v[20:23], a[236:239], v[168:171], 0
ds_read_b128 a[200:203], v240 offset:25472
v_cvt_pk_bf16_f32 v197, v138, v139
v_mfma_f32_16x16x32_bf16 v[20:23], a[232:235], v[160:163], v[20:23]
ds_read_b128 a[196:199], v240 offset:25216
ds_read_b128 a[192:195], v240 offset:24960
v_mfma_f32_16x16x32_bf16 v[24:27], a[240:243], v[160:163], 0
s_waitcnt lgkmcnt(5)
v_exp_f32 v146, v146
v_mfma_f32_16x16x32_bf16 v[24:27], a[244:247], v[168:171], v[24:27]
v_exp_f32_e64 v147, v147
v_mfma_f32_16x16x32_bf16 v[56:59], a[244:247], v[172:175], 0
v_exp_f32 v148, v148
v_mfma_f32_16x16x32_bf16 v[56:59], a[240:243], v[164:167], v[56:59]
v_cvt_pk_bf16_f32 v228, v144, v145
v_cvt_pk_bf16_f32 v229, v146, v147
v_mfma_f32_16x16x32_bf16 v[60:63], a[248:251], v[164:167], 0
v_exp_f32 v149, v149
v_mfma_f32_16x16x32_bf16 v[60:63], a[252:255], v[172:175], v[60:63]
v_exp_f32_e64 v150, v150
v_mfma_f32_16x16x32_bf16 v[28:31], a[252:255], v[168:171], 0
s_add_u32 m0, s32, 0xa140
v_exp_f32 v151, v151
v_mfma_f32_16x16x32_bf16 v[28:31], a[248:251], v[160:163], v[28:31]
s_waitcnt lgkmcnt(0)
buffer_load_dwordx4 v243, s[24:27], s39 offen offset:1032 nt lds
v_mfma_f32_16x16x32_bf16 v[128:131], a[192:195], v[64:67], -4.0
s_xor_b32 s39, s29, 0xc000
v_exp_f32_e64 v156, v156
v_mfma_f32_16x16x32_bf16 v[128:131], a[196:199], v[68:71], v[128:131]
v_cvt_pk_bf16_f32 v230, v148, v149
v_cvt_pk_bf16_f32 v231, v150, v151
v_mfma_f32_16x16x32_bf16 v[128:131], a[200:203], v[72:75], v[128:131]
v_exp_f32 v157, v157
v_mfma_f32_16x16x32_bf16 v[128:131], a[204:207], v[76:79], v[128:131]
s_add_u32 m0, s33, 0x0
v_exp_f32 v158, v158
v_mfma_f32_16x16x32_bf16 v[132:135], a[220:223], v[76:79], -4.0
v_exp_f32 v159, v159
v_mfma_f32_16x16x32_bf16 v[132:135], a[216:219], v[72:75], v[132:135]
v_exp_f32_e64 v152, v152
v_mfma_f32_16x16x32_bf16 v[132:135], a[212:215], v[68:71], v[132:135]
v_cvt_pk_bf16_f32 v234, v156, v157
v_cvt_pk_bf16_f32 v235, v158, v159
v_mfma_f32_16x16x32_bf16 v[132:135], a[208:211], v[64:67], v[132:135]
buffer_load_dwordx4 v243, s[8:11], s56 offen nt lds
v_mfma_f32_16x16x32_bf16 v[140:143], a[208:211], v[80:83], -4.0
s_add_u32 m0, s31, 0xc300
v_exp_f32 v153, v153
v_mfma_f32_16x16x32_bf16 v[140:143], a[212:215], v[84:87], v[140:143]
v_exp_f32 v154, v154
v_mfma_f32_16x16x32_bf16 v[140:143], a[216:219], v[88:91], v[140:143]
v_exp_f32_e64 v155, v155
v_mfma_f32_16x16x32_bf16 v[140:143], a[220:223], v[92:95], v[140:143]
v_cvt_pk_bf16_f32 v232, v152, v153
v_cvt_pk_bf16_f32 v233, v154, v155
v_mfma_f32_16x16x32_bf16 v[136:139], a[204:207], v[92:95], -4.0
v_exp_f32 v128, v128
v_mfma_f32_16x16x32_bf16 v[136:139], a[200:203], v[88:91], v[136:139]
v_exp_f32 v129, v129
v_mfma_f32_16x16x32_bf16 v[136:139], a[196:199], v[84:87], v[136:139]
s_waitcnt vmcnt(9)
v_exp_f32_e64 v130, v130
v_mfma_f32_16x16x32_bf16 v[136:139], a[192:195], v[80:83], v[136:139]
s_barrier
v_smfmac_f32_16x16x64_bf16 v[220:223], v[224:227], v[184:191], v248
buffer_load_dwordx4 v243, s[12:15], s38 offen nt lds
v_mfma_f32_16x16x32_bf16 a[16:19], a[224:227], v[176:179], 0
v_exp_f32 v131, v131
v_mfma_f32_16x16x32_bf16 a[16:19], a[228:231], v[184:187], a[16:19]
v_exp_f32 v132, v132
v_mfma_f32_16x16x32_bf16 a[48:51], a[228:231], v[188:191], 0
v_cvt_pk_bf16_f32 v160, v128, v129
v_cvt_pk_bf16_f32 v161, v130, v131
v_mfma_f32_16x16x32_bf16 a[48:51], a[224:227], v[180:183], a[48:51]
ds_read_b64_tr_b16 a[224:225], v241 offset:16512
ds_read_b64_tr_b16 a[226:227], v241 offset:20640
v_mfma_f32_16x16x32_bf16 a[52:55], a[232:235], v[180:183], 0
v_exp_f32 v133, v133
v_mfma_f32_16x16x32_bf16 a[52:55], a[236:239], v[188:191], a[52:55]
ds_read_b64_tr_b16 a[228:229], v241 offset:24768
ds_read_b64_tr_b16 a[230:231], v241 offset:28896
v_mfma_f32_16x16x32_bf16 a[20:23], a[236:239], v[184:187], 0
v_exp_f32 v134, v134
v_mfma_f32_16x16x32_bf16 a[20:23], a[232:235], v[176:179], a[20:23]
ds_read_b64_tr_b16 a[232:233], v241 offset:16520
ds_read_b64_tr_b16 a[234:235], v241 offset:20648
v_mfma_f32_16x16x32_bf16 a[24:27], a[240:243], v[176:179], 0
s_add_u32 m0, s31, 0xc300
v_exp_f32_e64 v135, v135
v_mfma_f32_16x16x32_bf16 a[24:27], a[244:247], v[184:187], a[24:27]
buffer_load_dwordx4 v243, s[12:15], s38 offen offset:1024 nt lds
v_mfma_f32_16x16x32_bf16 a[56:59], a[244:247], v[188:191], 0
v_exp_f32 v140, v140
v_mfma_f32_16x16x32_bf16 a[56:59], a[240:243], v[180:183], a[56:59]
s_add_u32 m0, s33, 0x0
ds_read_b64_tr_b16 a[236:237], v241 offset:24776
ds_read_b64_tr_b16 a[238:239], v241 offset:28904
v_mfma_f32_16x16x32_bf16 a[60:63], a[248:251], v[180:183], 0
v_cvt_pk_bf16_f32 v162, v132, v133
v_cvt_pk_bf16_f32 v163, v134, v135
v_mfma_f32_16x16x32_bf16 a[60:63], a[252:255], v[188:191], a[60:63]
ds_read_b64_tr_b16 a[240:241], v241 offset:16768
ds_read_b64_tr_b16 a[242:243], v241 offset:20896
v_mfma_f32_16x16x32_bf16 a[28:31], a[252:255], v[184:187], 0
v_exp_f32 v141, v141
v_mfma_f32_16x16x32_bf16 a[28:31], a[248:251], v[176:179], a[28:31]
buffer_load_dwordx4 v243, s[8:11], s56 offen offset:1024 nt lds
v_mfma_f32_16x16x32_bf16 v[144:147], a[192:195], v[96:99], -4.0
v_exp_f32 v142, v142
v_mfma_f32_16x16x32_bf16 v[144:147], a[196:199], v[100:103], v[144:147]
v_exp_f32 v143, v143
v_mfma_f32_16x16x32_bf16 v[144:147], a[200:203], v[104:107], v[144:147]
s_add_u32 m0, s32, 0xc180
v_exp_f32 v136, v136
v_mfma_f32_16x16x32_bf16 v[144:147], a[204:207], v[108:111], v[144:147]
ds_read_b64_tr_b16 a[244:245], v241 offset:25024
ds_read_b64_tr_b16 a[246:247], v241 offset:29152
v_mfma_f32_16x16x32_bf16 v[148:151], a[220:223], v[108:111], -4.0
v_cvt_pk_bf16_f32 v166, v140, v141
v_cvt_pk_bf16_f32 v167, v142, v143
v_mfma_f32_16x16x32_bf16 v[148:151], a[216:219], v[104:107], v[148:151]
v_exp_f32 v137, v137
v_mfma_f32_16x16x32_bf16 v[148:151], a[212:215], v[100:103], v[148:151]
s_waitcnt vmcnt(10) lgkmcnt(2)
v_exp_f32 v138, v138
v_mfma_f32_16x16x32_bf16 v[148:151], a[208:211], v[96:99], v[148:151]
s_barrier
v_mfma_f32_16x16x32_bf16 v[156:159], a[208:211], v[112:115], -4.0
v_exp_f32 v139, v139
v_mfma_f32_16x16x32_bf16 v[156:159], a[212:215], v[116:119], v[156:159]
v_cvt_pk_bf16_f32 v164, v136, v137
v_cvt_pk_bf16_f32 v165, v138, v139
v_mfma_f32_16x16x32_bf16 v[156:159], a[216:219], v[120:123], v[156:159]
v_exp_f32 v144, v144
v_mfma_f32_16x16x32_bf16 v[156:159], a[220:223], v[124:127], v[156:159]
buffer_load_dwordx4 v243, s[16:19], s39 offen nt lds
v_mfma_f32_16x16x32_bf16 v[152:155], a[204:207], v[124:127], -4.0
v_exp_f32 v145, v145
v_mfma_f32_16x16x32_bf16 v[152:155], a[200:203], v[120:123], v[152:155]
v_exp_f32 v146, v146
v_mfma_f32_16x16x32_bf16 v[152:155], a[196:199], v[116:119], v[152:155]
ds_read_b64_tr_b16 a[248:249], v241 offset:16776
v_cvt_pk_bf16_f32 v168, v144, v145
v_mfma_f32_16x16x32_bf16 v[152:155], a[192:195], v[112:115], v[152:155]
ds_read_b64_tr_b16 a[250:251], v241 offset:20904
ds_read_b64_tr_b16 a[252:253], v241 offset:25032
v_smfmac_f32_16x16x64_bf16 v[216:219], v[224:227], v[192:199], v248
ds_read_b64_tr_b16 a[254:255], v241 offset:29160
v_mfma_f32_16x16x32_bf16 v[0:3], a[224:227], v[192:195], v[0:3]
v_exp_f32 v147, v147
v_mfma_f32_16x16x32_bf16 v[0:3], a[228:231], v[160:163], v[0:3]
ds_read_b128 a[208:211], v240 offset:37440
ds_read_b128 a[212:215], v240 offset:37696
v_mfma_f32_16x16x32_bf16 v[32:35], a[228:231], v[164:167], v[32:35]
v_exp_f32 v148, v148
v_mfma_f32_16x16x32_bf16 v[32:35], a[224:227], v[196:199], v[32:35]
s_add_u32 m0, s32, 0xc180
ds_read_b128 a[216:219], v240 offset:37952
ds_read_b128 a[220:223], v240 offset:38208
v_mfma_f32_16x16x32_bf16 v[36:39], a[232:235], v[196:199], v[36:39]
v_exp_f32_e64 v149, v149
v_mfma_f32_16x16x32_bf16 v[36:39], a[236:239], v[164:167], v[36:39]
ds_read_b128 a[204:207], v240 offset:34048
ds_read_b128 a[200:203], v240 offset:33792
v_mfma_f32_16x16x32_bf16 v[4:7], a[236:239], v[160:163], v[4:7]
v_exp_f32 v150, v150
v_mfma_f32_16x16x32_bf16 v[4:7], a[232:235], v[192:195], v[4:7]
ds_read_b128 a[196:199], v240 offset:33536
v_cvt_pk_bf16_f32 v169, v146, v147
v_mfma_f32_16x16x32_bf16 v[8:11], a[240:243], v[192:195], v[8:11]
s_waitcnt lgkmcnt(5)
ds_read_b128 a[192:195], v240 offset:33280
v_cvt_pk_bf16_f32 v170, v148, v149
v_mfma_f32_16x16x32_bf16 v[8:11], a[244:247], v[160:163], v[8:11]
buffer_load_dwordx4 v243, s[24:27], s39 offen offset:1032 nt lds
v_mfma_f32_16x16x32_bf16 v[40:43], a[244:247], v[164:167], v[40:43]
s_add_u32 m0, s33, 0x20
v_exp_f32 v151, v151
v_mfma_f32_16x16x32_bf16 v[40:43], a[240:243], v[196:199], v[40:43]
s_xor_b32 s39, s29, 0xe000
v_exp_f32_e64 v156, v156
v_mfma_f32_16x16x32_bf16 v[44:47], a[248:251], v[196:199], v[44:47]
s_xor_b32 s38, s29, 0xe000
v_exp_f32 v157, v157
v_mfma_f32_16x16x32_bf16 v[44:47], a[252:255], v[164:167], v[44:47]
v_exp_f32 v158, v158
v_mfma_f32_16x16x32_bf16 v[12:15], a[252:255], v[160:163], v[12:15]
v_cvt_pk_bf16_f32 v171, v150, v151
v_cvt_pk_bf16_f32 v174, v156, v157
v_mfma_f32_16x16x32_bf16 v[12:15], a[248:251], v[192:195], v[12:15]
s_waitcnt lgkmcnt(0)
buffer_load_dwordx4 v243, s[8:11], s56 offen offset:2048 nt lds
v_mfma_f32_16x16x32_bf16 v[128:131], a[192:195], v[64:67], -4.0
v_exp_f32 v159, v159
v_mfma_f32_16x16x32_bf16 v[128:131], a[196:199], v[68:71], v[128:131]
v_exp_f32 v152, v152
v_mfma_f32_16x16x32_bf16 v[128:131], a[200:203], v[72:75], v[128:131]
s_add_u32 m0, s32, 0xe1c0
v_exp_f32 v153, v153
v_mfma_f32_16x16x32_bf16 v[128:131], a[204:207], v[76:79], v[128:131]
v_exp_f32 v154, v154
v_mfma_f32_16x16x32_bf16 v[132:135], a[220:223], v[76:79], -4.0
v_cvt_pk_bf16_f32 v175, v158, v159
v_cvt_pk_bf16_f32 v172, v152, v153
v_mfma_f32_16x16x32_bf16 v[132:135], a[216:219], v[72:75], v[132:135]
v_exp_f32 v155, v155
v_mfma_f32_16x16x32_bf16 v[132:135], a[212:215], v[68:71], v[132:135]
v_cvt_pk_bf16_f32 v173, v154, v155
v_mfma_f32_16x16x32_bf16 v[132:135], a[208:211], v[64:67], v[132:135]
buffer_load_dwordx4 v243, s[16:19], s39 offen nt lds
v_mfma_f32_16x16x32_bf16 v[140:143], a[208:211], v[80:83], -4.0
v_exp_f32 v128, v128
v_mfma_f32_16x16x32_bf16 v[140:143], a[212:215], v[84:87], v[140:143]
v_exp_f32 v129, v129
v_mfma_f32_16x16x32_bf16 v[140:143], a[216:219], v[88:91], v[140:143]
v_exp_f32 v130, v130
v_mfma_f32_16x16x32_bf16 v[140:143], a[220:223], v[92:95], v[140:143]
v_exp_f32 v131, v131
v_mfma_f32_16x16x32_bf16 v[136:139], a[204:207], v[92:95], -4.0
v_exp_f32 v132, v132
v_mfma_f32_16x16x32_bf16 v[136:139], a[200:203], v[88:91], v[136:139]
v_cvt_pk_bf16_f32 v176, v128, v129
v_cvt_pk_bf16_f32 v177, v130, v131
v_mfma_f32_16x16x32_bf16 v[136:139], a[196:199], v[84:87], v[136:139]
v_exp_f32 v133, v133
v_mfma_f32_16x16x32_bf16 v[136:139], a[192:195], v[80:83], v[136:139]
v_exp_f32_e64 v134, v134
v_smfmac_f32_16x16x64_bf16 v[220:223], v[224:227], v[228:235], v248
s_add_u32 m0, s32, 0xe1c0
v_cvt_pk_bf16_f32 v178, v132, v133
v_mfma_f32_16x16x32_bf16 a[0:3], a[224:227], v[228:231], a[0:3]
v_exp_f32 v135, v135
v_mfma_f32_16x16x32_bf16 a[0:3], a[228:231], v[168:171], a[0:3]
buffer_load_dwordx4 v243, s[24:27], s39 offen offset:1032 nt lds
v_mfma_f32_16x16x32_bf16 a[32:35], a[228:231], v[172:175], a[32:35]
v_exp_f32 v140, v140
v_mfma_f32_16x16x32_bf16 a[32:35], a[224:227], v[232:235], a[32:35]
s_add_u32 m0, s33, 0x20
ds_read_b64_tr_b16 a[224:225], v241 offset:17024
ds_read_b64_tr_b16 a[226:227], v241 offset:21152
v_mfma_f32_16x16x32_bf16 a[36:39], a[232:235], v[232:235], a[36:39]
v_exp_f32 v141, v141
v_mfma_f32_16x16x32_bf16 a[36:39], a[236:239], v[172:175], a[36:39]
ds_read_b64_tr_b16 a[228:229], v241 offset:25280
ds_read_b64_tr_b16 a[230:231], v241 offset:29408
v_mfma_f32_16x16x32_bf16 a[4:7], a[236:239], v[168:171], a[4:7]
v_exp_f32_e64 v142, v142
v_mfma_f32_16x16x32_bf16 a[4:7], a[232:235], v[228:231], a[4:7]
buffer_load_dwordx4 v243, s[8:11], s56 offen offset:3072 nt lds
v_mfma_f32_16x16x32_bf16 a[8:11], a[240:243], v[228:231], a[8:11]
s_xor_b32 s56, s28, 0x1001000
v_cvt_pk_bf16_f32 v179, v134, v135
v_cvt_pk_bf16_f32 v182, v140, v141
v_mfma_f32_16x16x32_bf16 a[8:11], a[244:247], v[168:171], a[8:11]
ds_read_b64_tr_b16 a[232:233], v241 offset:17032
ds_read_b64_tr_b16 a[234:235], v241 offset:21160
v_mfma_f32_16x16x32_bf16 a[40:43], a[244:247], v[172:175], a[40:43]
s_add_u32 m0, s31, 0x0
v_exp_f32 v143, v143
v_mfma_f32_16x16x32_bf16 a[40:43], a[240:243], v[232:235], a[40:43]
ds_read_b64_tr_b16 a[236:237], v241 offset:25288
ds_read_b64_tr_b16 a[238:239], v241 offset:29416
v_mfma_f32_16x16x32_bf16 a[44:47], a[248:251], v[232:235], a[44:47]
v_exp_f32 v136, v136
v_mfma_f32_16x16x32_bf16 a[44:47], a[252:255], v[172:175], a[44:47]
buffer_load_dwordx4 v243, s[12:15], s38 offen nt lds
v_mfma_f32_16x16x32_bf16 a[12:15], a[252:255], v[168:171], a[12:15]
v_exp_f32 v137, v137
v_mfma_f32_16x16x32_bf16 a[12:15], a[248:251], v[228:231], a[12:15]
ds_read_b64_tr_b16 a[240:241], v241 offset:17280
ds_read_b64_tr_b16 a[242:243], v241 offset:21408
v_mfma_f32_16x16x32_bf16 v[144:147], a[192:195], v[96:99], -4.0
v_exp_f32 v138, v138
v_mfma_f32_16x16x32_bf16 v[144:147], a[196:199], v[100:103], v[144:147]
v_cvt_pk_bf16_f32 v183, v142, v143
v_cvt_pk_bf16_f32 v180, v136, v137
v_mfma_f32_16x16x32_bf16 v[144:147], a[200:203], v[104:107], v[144:147]
v_exp_f32 v139, v139
v_mfma_f32_16x16x32_bf16 v[144:147], a[204:207], v[108:111], v[144:147]
ds_read_b64_tr_b16 a[244:245], v241 offset:25536
ds_read_b64_tr_b16 a[246:247], v241 offset:29664
v_mfma_f32_16x16x32_bf16 v[148:151], a[220:223], v[108:111], -4.0
v_cvt_pk_bf16_f32 v181, v138, v139
v_mfma_f32_16x16x32_bf16 v[148:151], a[216:219], v[104:107], v[148:151]
ds_read_b64_tr_b16 a[248:249], v241 offset:17288
ds_read_b64_tr_b16 a[250:251], v241 offset:21416
v_mfma_f32_16x16x32_bf16 v[148:151], a[212:215], v[100:103], v[148:151]
s_waitcnt vmcnt(15) lgkmcnt(4)
v_exp_f32 v144, v144
v_mfma_f32_16x16x32_bf16 v[148:151], a[208:211], v[96:99], v[148:151]
s_barrier
v_mfma_f32_16x16x32_bf16 v[156:159], a[208:211], v[112:115], -4.0
s_add_u32 m0, s31, 0x0
v_exp_f32 v145, v145
v_mfma_f32_16x16x32_bf16 v[156:159], a[212:215], v[116:119], v[156:159]
v_exp_f32 v146, v146
v_mfma_f32_16x16x32_bf16 v[156:159], a[216:219], v[120:123], v[156:159]
v_exp_f32_e64 v147, v147
v_mfma_f32_16x16x32_bf16 v[156:159], a[220:223], v[124:127], v[156:159]
buffer_load_dwordx4 v243, s[12:15], s38 offen offset:1024 nt lds
v_mfma_f32_16x16x32_bf16 v[152:155], a[204:207], v[124:127], -4.0
s_add_u32 m0, s33, 0x1040
v_exp_f32 v148, v148
v_mfma_f32_16x16x32_bf16 v[152:155], a[200:203], v[120:123], v[152:155]
s_xor_b32 s38, s29, 0x10000
v_cvt_pk_bf16_f32 v184, v144, v145
v_cvt_pk_bf16_f32 v185, v146, v147
v_mfma_f32_16x16x32_bf16 v[152:155], a[196:199], v[116:119], v[152:155]
v_exp_f32 v149, v149
v_mfma_f32_16x16x32_bf16 v[152:155], a[192:195], v[112:115], v[152:155]
ds_read_b64_tr_b16 a[252:253], v241 offset:25544
ds_read_b64_tr_b16 a[254:255], v241 offset:29672
v_smfmac_f32_16x16x64_bf16 v[216:219], v[224:227], v[160:167], v248
buffer_load_dwordx4 v243, s[8:11], s56 offen nt lds
v_mfma_f32_16x16x32_bf16 v[16:19], a[224:227], v[192:195], v[16:19]
v_exp_f32_e64 v150, v150
v_mfma_f32_16x16x32_bf16 v[16:19], a[228:231], v[160:163], v[16:19]
ds_read_b128 a[208:211], v240 offset:45760
ds_read_b128 a[212:215], v240 offset:46016
v_mfma_f32_16x16x32_bf16 v[48:51], a[228:231], v[164:167], v[48:51]
v_exp_f32_e64 v151, v151
v_mfma_f32_16x16x32_bf16 v[48:51], a[224:227], v[196:199], v[48:51]
s_add_u32 m0, s31, 0x2080
ds_read_b128 a[216:219], v240 offset:46272
ds_read_b128 a[220:223], v240 offset:46528
v_mfma_f32_16x16x32_bf16 v[52:55], a[232:235], v[196:199], v[52:55]
v_exp_f32_e64 v156, v156
v_mfma_f32_16x16x32_bf16 v[52:55], a[236:239], v[164:167], v[52:55]
ds_read_b128 a[204:207], v240 offset:42368
ds_read_b128 a[200:203], v240 offset:42112
v_mfma_f32_16x16x32_bf16 v[20:23], a[236:239], v[160:163], v[20:23]
v_cvt_pk_bf16_f32 v186, v148, v149
v_cvt_pk_bf16_f32 v187, v150, v151
v_mfma_f32_16x16x32_bf16 v[20:23], a[232:235], v[192:195], v[20:23]
ds_read_b128 a[196:199], v240 offset:41856
ds_read_b128 a[192:195], v240 offset:41600
v_mfma_f32_16x16x32_bf16 v[24:27], a[240:243], v[192:195], v[24:27]
s_waitcnt lgkmcnt(6)
v_exp_f32 v157, v157
v_mfma_f32_16x16x32_bf16 v[24:27], a[244:247], v[160:163], v[24:27]
buffer_load_dwordx4 v243, s[12:15], s38 offen nt lds
v_mfma_f32_16x16x32_bf16 v[56:59], a[244:247], v[164:167], v[56:59]
v_exp_f32 v158, v158
v_mfma_f32_16x16x32_bf16 v[56:59], a[240:243], v[196:199], v[56:59]
v_exp_f32 v159, v159
v_mfma_f32_16x16x32_bf16 v[60:63], a[248:251], v[196:199], v[60:63]
v_exp_f32 v152, v152
v_mfma_f32_16x16x32_bf16 v[60:63], a[252:255], v[164:167], v[60:63]
v_cvt_pk_bf16_f32 v190, v156, v157
v_cvt_pk_bf16_f32 v191, v158, v159
v_mfma_f32_16x16x32_bf16 v[28:31], a[252:255], v[160:163], v[28:31]
v_exp_f32 v153, v153
v_mfma_f32_16x16x32_bf16 v[28:31], a[248:251], v[192:195], v[28:31]
s_waitcnt lgkmcnt(0)
v_exp_f32 v154, v154
v_mfma_f32_16x16x32_bf16 v[128:131], a[192:195], v[64:67], -4.0
v_exp_f32_e64 v155, v155
v_mfma_f32_16x16x32_bf16 v[128:131], a[196:199], v[68:71], v[128:131]
v_cvt_pk_bf16_f32 v188, v152, v153
v_cvt_pk_bf16_f32 v189, v154, v155
v_mfma_f32_16x16x32_bf16 v[128:131], a[200:203], v[72:75], v[128:131]
s_add_u32 m0, s31, 0x2080
v_mfma_f32_16x16x32_bf16 v[128:131], a[204:207], v[76:79], v[128:131]
buffer_load_dwordx4 v243, s[12:15], s38 offen offset:1024 nt lds
v_mfma_f32_16x16x32_bf16 v[132:135], a[220:223], v[76:79], -4.0
s_add_u32 m0, s33, 0x1040
v_mfma_f32_16x16x32_bf16 v[132:135], a[216:219], v[72:75], v[132:135]
s_xor_b32 s38, s29, 0x12000
v_mfma_f32_16x16x32_bf16 v[132:135], a[212:215], v[68:71], v[132:135]
v_mfma_f32_16x16x32_bf16 v[132:135], a[208:211], v[64:67], v[132:135]
v_mfma_f32_16x16x32_bf16 v[140:143], a[208:211], v[80:83], -4.0
v_exp_f32 v128, v128
v_mfma_f32_16x16x32_bf16 v[140:143], a[212:215], v[84:87], v[140:143]
v_exp_f32 v129, v129
v_mfma_f32_16x16x32_bf16 v[140:143], a[216:219], v[88:91], v[140:143]
v_exp_f32_e64 v130, v130
v_mfma_f32_16x16x32_bf16 v[140:143], a[220:223], v[92:95], v[140:143]
buffer_load_dwordx4 v243, s[8:11], s56 offen offset:1024 nt lds
v_mfma_f32_16x16x32_bf16 v[136:139], a[204:207], v[92:95], -4.0
s_add_u32 m0, s31, 0x4100
v_exp_f32 v131, v131
v_mfma_f32_16x16x32_bf16 v[136:139], a[200:203], v[88:91], v[136:139]
v_exp_f32_e64 v132, v132
v_mfma_f32_16x16x32_bf16 v[136:139], a[196:199], v[84:87], v[136:139]
s_waitcnt vmcnt(16)
v_cvt_pk_bf16_f32 v160, v128, v129
v_cvt_pk_bf16_f32 v161, v130, v131
v_mfma_f32_16x16x32_bf16 v[136:139], a[192:195], v[80:83], v[136:139]
s_barrier
v_smfmac_f32_16x16x64_bf16 v[220:223], v[224:227], v[168:175], v248
buffer_load_dwordx4 v243, s[12:15], s38 offen nt lds
v_mfma_f32_16x16x32_bf16 a[16:19], a[224:227], v[228:231], a[16:19]
v_exp_f32 v133, v133
v_mfma_f32_16x16x32_bf16 a[16:19], a[228:231], v[168:171], a[16:19]
v_exp_f32 v134, v134
v_mfma_f32_16x16x32_bf16 a[48:51], a[228:231], v[172:175], a[48:51]
v_exp_f32 v135, v135
v_mfma_f32_16x16x32_bf16 a[48:51], a[224:227], v[232:235], a[48:51]
ds_read_b64_tr_b16 a[224:225], v241 offset:33024
ds_read_b64_tr_b16 a[226:227], v241 offset:37152
v_mfma_f32_16x16x32_bf16 a[52:55], a[232:235], v[232:235], a[52:55]
v_exp_f32_e64 v140, v140
v_mfma_f32_16x16x32_bf16 a[52:55], a[236:239], v[172:175], a[52:55]
ds_read_b64_tr_b16 a[228:229], v241 offset:41280
ds_read_b64_tr_b16 a[230:231], v241 offset:45408
v_mfma_f32_16x16x32_bf16 a[20:23], a[236:239], v[168:171], a[20:23]
v_cvt_pk_bf16_f32 v162, v132, v133
v_cvt_pk_bf16_f32 v163, v134, v135
v_mfma_f32_16x16x32_bf16 a[20:23], a[232:235], v[228:231], a[20:23]
ds_read_b64_tr_b16 a[232:233], v241 offset:33032
ds_read_b64_tr_b16 a[234:235], v241 offset:37160
v_mfma_f32_16x16x32_bf16 a[24:27], a[240:243], v[228:231], a[24:27]
s_add_u32 m0, s31, 0x4100
v_exp_f32 v141, v141
v_mfma_f32_16x16x32_bf16 a[24:27], a[244:247], v[168:171], a[24:27]
buffer_load_dwordx4 v243, s[12:15], s38 offen offset:1024 nt lds
v_mfma_f32_16x16x32_bf16 a[56:59], a[244:247], v[172:175], a[56:59]
s_xor_b32 s38, s29, 0x14000
v_exp_f32 v142, v142
v_mfma_f32_16x16x32_bf16 a[56:59], a[240:243], v[232:235], a[56:59]
s_xor_b32 s39, s29, 0x10000
ds_read_b64_tr_b16 a[236:237], v241 offset:41288
ds_read_b64_tr_b16 a[238:239], v241 offset:45416
v_mfma_f32_16x16x32_bf16 a[60:63], a[248:251], v[232:235], a[60:63]
v_exp_f32 v143, v143
v_mfma_f32_16x16x32_bf16 a[60:63], a[252:255], v[172:175], a[60:63]
ds_read_b64_tr_b16 a[240:241], v241 offset:33280
ds_read_b64_tr_b16 a[242:243], v241 offset:37408
v_mfma_f32_16x16x32_bf16 a[28:31], a[252:255], v[168:171], a[28:31]
v_exp_f32 v136, v136
v_mfma_f32_16x16x32_bf16 a[28:31], a[248:251], v[228:231], a[28:31]
s_add_u32 m0, s33, 0x1060
ds_read_b64_tr_b16 a[244:245], v241 offset:41536
v_cvt_pk_bf16_f32 v166, v140, v141
v_mfma_f32_16x16x32_bf16 v[144:147], a[192:195], v[96:99], -4.0
v_exp_f32 v137, v137
v_mfma_f32_16x16x32_bf16 v[144:147], a[196:199], v[100:103], v[144:147]
v_exp_f32 v138, v138
v_mfma_f32_16x16x32_bf16 v[144:147], a[200:203], v[104:107], v[144:147]
v_cvt_pk_bf16_f32 v167, v142, v143
v_cvt_pk_bf16_f32 v164, v136, v137
v_mfma_f32_16x16x32_bf16 v[144:147], a[204:207], v[108:111], v[144:147]
buffer_load_dwordx4 v243, s[8:11], s56 offen offset:2048 nt lds
v_mfma_f32_16x16x32_bf16 v[148:151], a[220:223], v[108:111], -4.0
s_add_u32 m0, s31, 0x6180
v_exp_f32_e64 v139, v139
v_mfma_f32_16x16x32_bf16 v[148:151], a[216:219], v[104:107], v[148:151]
v_cvt_pk_bf16_f32 v165, v138, v139
v_mfma_f32_16x16x32_bf16 v[148:151], a[212:215], v[100:103], v[148:151]
s_waitcnt vmcnt(16) lgkmcnt(0)
v_exp_f32 v144, v144
v_mfma_f32_16x16x32_bf16 v[148:151], a[208:211], v[96:99], v[148:151]
s_barrier
v_mfma_f32_16x16x32_bf16 v[156:159], a[208:211], v[112:115], -4.0
v_exp_f32 v145, v145
v_mfma_f32_16x16x32_bf16 v[156:159], a[212:215], v[116:119], v[156:159]
v_exp_f32 v146, v146
v_mfma_f32_16x16x32_bf16 v[156:159], a[216:219], v[120:123], v[156:159]
v_exp_f32 v147, v147
v_mfma_f32_16x16x32_bf16 v[156:159], a[220:223], v[124:127], v[156:159]
buffer_load_dwordx4 v243, s[12:15], s38 offen nt lds
v_mfma_f32_16x16x32_bf16 v[152:155], a[204:207], v[124:127], -4.0
v_exp_f32_e64 v148, v148
v_mfma_f32_16x16x32_bf16 v[152:155], a[200:203], v[120:123], v[152:155]
ds_read_b64_tr_b16 a[246:247], v241 offset:45664
v_cvt_pk_bf16_f32 v192, v144, v145
v_mfma_f32_16x16x32_bf16 v[152:155], a[196:199], v[116:119], v[152:155]
ds_read_b64_tr_b16 a[248:249], v241 offset:33288
v_cvt_pk_bf16_f32 v193, v146, v147
v_mfma_f32_16x16x32_bf16 v[152:155], a[192:195], v[112:115], v[152:155]
ds_read_b64_tr_b16 a[250:251], v241 offset:37416
ds_read_b64_tr_b16 a[252:253], v241 offset:41544
v_smfmac_f32_16x16x64_bf16 v[216:219], v[224:227], v[176:183], v248
ds_read_b64_tr_b16 a[254:255], v241 offset:45672
v_mfma_f32_16x16x32_bf16 v[0:3], a[224:227], v[176:179], v[0:3]
v_exp_f32_e64 v149, v149
v_mfma_f32_16x16x32_bf16 v[0:3], a[228:231], v[160:163], v[0:3]
ds_read_b128 a[208:211], v240 offset:54080
ds_read_b128 a[212:215], v240 offset:54336
v_mfma_f32_16x16x32_bf16 v[32:35], a[228:231], v[164:167], v[32:35]
v_exp_f32_e64 v150, v150
v_mfma_f32_16x16x32_bf16 v[32:35], a[224:227], v[180:183], v[32:35]
s_add_u32 m0, s31, 0x6180
ds_read_b128 a[216:219], v240 offset:54592
ds_read_b128 a[220:223], v240 offset:54848
v_mfma_f32_16x16x32_bf16 v[36:39], a[232:235], v[180:183], v[36:39]
v_exp_f32_e64 v151, v151
v_mfma_f32_16x16x32_bf16 v[36:39], a[236:239], v[164:167], v[36:39]
ds_read_b128 a[204:207], v240 offset:50688
ds_read_b128 a[200:203], v240 offset:50432
v_mfma_f32_16x16x32_bf16 v[4:7], a[236:239], v[160:163], v[4:7]
v_exp_f32 v156, v156
v_mfma_f32_16x16x32_bf16 v[4:7], a[232:235], v[176:179], v[4:7]
ds_read_b128 a[196:199], v240 offset:50176
v_cvt_pk_bf16_f32 v194, v148, v149
v_mfma_f32_16x16x32_bf16 v[8:11], a[240:243], v[176:179], v[8:11]
s_waitcnt lgkmcnt(5)
ds_read_b128 a[192:195], v240 offset:49920
v_cvt_pk_bf16_f32 v195, v150, v151
v_mfma_f32_16x16x32_bf16 v[8:11], a[244:247], v[160:163], v[8:11]
buffer_load_dwordx4 v243, s[12:15], s38 offen offset:1024 nt lds
v_mfma_f32_16x16x32_bf16 v[40:43], a[244:247], v[164:167], v[40:43]
s_add_u32 m0, s33, 0x1060
v_exp_f32 v157, v157
v_mfma_f32_16x16x32_bf16 v[40:43], a[240:243], v[180:183], v[40:43]
v_exp_f32 v158, v158
v_mfma_f32_16x16x32_bf16 v[44:47], a[248:251], v[180:183], v[44:47]
v_exp_f32 v159, v159
v_mfma_f32_16x16x32_bf16 v[44:47], a[252:255], v[164:167], v[44:47]
v_exp_f32 v152, v152
v_mfma_f32_16x16x32_bf16 v[12:15], a[252:255], v[160:163], v[12:15]
v_cvt_pk_bf16_f32 v198, v156, v157
v_cvt_pk_bf16_f32 v199, v158, v159
v_mfma_f32_16x16x32_bf16 v[12:15], a[248:251], v[176:179], v[12:15]
s_waitcnt lgkmcnt(0)
buffer_load_dwordx4 v243, s[8:11], s56 offen offset:3072 nt lds
v_mfma_f32_16x16x32_bf16 v[128:131], a[192:195], v[64:67], -4.0
s_xor_b32 s56, s28, 0x1002000
v_exp_f32 v153, v153
v_mfma_f32_16x16x32_bf16 v[128:131], a[196:199], v[68:71], v[128:131]
L_pad1:
s_cbranch_vccnz L_pad5
v_exp_f32 v154, v154
v_mfma_f32_16x16x32_bf16 v[128:131], a[200:203], v[72:75], v[128:131]
s_add_u32 m0, s32, 0x0
v_exp_f32 v155, v155
v_mfma_f32_16x16x32_bf16 v[128:131], a[204:207], v[76:79], v[128:131]
v_cvt_pk_bf16_f32 v196, v152, v153
v_cvt_pk_bf16_f32 v197, v154, v155
v_mfma_f32_16x16x32_bf16 v[132:135], a[220:223], v[76:79], -4.0
v_mfma_f32_16x16x32_bf16 v[132:135], a[216:219], v[72:75], v[132:135]
v_mfma_f32_16x16x32_bf16 v[132:135], a[212:215], v[68:71], v[132:135]
v_mfma_f32_16x16x32_bf16 v[132:135], a[208:211], v[64:67], v[132:135]
buffer_load_dwordx4 v243, s[16:19], s39 offen nt lds
v_mfma_f32_16x16x32_bf16 v[140:143], a[208:211], v[80:83], -4.0
v_exp_f32 v128, v128
v_mfma_f32_16x16x32_bf16 v[140:143], a[212:215], v[84:87], v[140:143]
v_exp_f32 v129, v129
v_mfma_f32_16x16x32_bf16 v[140:143], a[216:219], v[88:91], v[140:143]
v_exp_f32 v130, v130
v_mfma_f32_16x16x32_bf16 v[140:143], a[220:223], v[92:95], v[140:143]
v_exp_f32 v131, v131
v_mfma_f32_16x16x32_bf16 v[136:139], a[204:207], v[92:95], -4.0
v_exp_f32 v132, v132
v_mfma_f32_16x16x32_bf16 v[136:139], a[200:203], v[88:91], v[136:139]
v_cvt_pk_bf16_f32 v168, v128, v129
v_cvt_pk_bf16_f32 v169, v130, v131
v_mfma_f32_16x16x32_bf16 v[136:139], a[196:199], v[84:87], v[136:139]
v_exp_f32 v133, v133
v_mfma_f32_16x16x32_bf16 v[136:139], a[192:195], v[80:83], v[136:139]
v_exp_f32 v134, v134
v_smfmac_f32_16x16x64_bf16 v[220:223], v[224:227], v[184:191], v248
s_add_u32 m0, s32, 0x0
v_cvt_pk_bf16_f32 v170, v132, v133
v_mfma_f32_16x16x32_bf16 a[0:3], a[224:227], v[184:187], a[0:3]
v_exp_f32_e64 v135, v135
v_mfma_f32_16x16x32_bf16 a[0:3], a[228:231], v[192:195], a[0:3]
buffer_load_dwordx4 v243, s[24:27], s39 offen offset:1032 nt lds
v_mfma_f32_16x16x32_bf16 a[32:35], a[228:231], v[196:199], a[32:35]
s_xor_b32 s39, s29, 0x12000
v_exp_f32 v140, v140
v_mfma_f32_16x16x32_bf16 a[32:35], a[224:227], v[188:191], a[32:35]
s_xor_b32 s38, s29, 0x16000
ds_read_b64_tr_b16 a[224:225], v241 offset:33536
ds_read_b64_tr_b16 a[226:227], v241 offset:37664
v_mfma_f32_16x16x32_bf16 a[36:39], a[232:235], v[188:191], a[36:39]
v_exp_f32 v141, v141
v_mfma_f32_16x16x32_bf16 a[36:39], a[236:239], v[196:199], a[36:39]
ds_read_b64_tr_b16 a[228:229], v241 offset:41792
ds_read_b64_tr_b16 a[230:231], v241 offset:45920
v_mfma_f32_16x16x32_bf16 a[4:7], a[236:239], v[192:195], a[4:7]
v_exp_f32_e64 v142, v142
v_mfma_f32_16x16x32_bf16 a[4:7], a[232:235], v[184:187], a[4:7]
ds_read_b64_tr_b16 a[232:233], v241 offset:33544
ds_read_b64_tr_b16 a[234:235], v241 offset:37672
v_mfma_f32_16x16x32_bf16 a[8:11], a[240:243], v[184:187], a[8:11]
v_cvt_pk_bf16_f32 v171, v134, v135
v_cvt_pk_bf16_f32 v174, v140, v141
v_mfma_f32_16x16x32_bf16 a[8:11], a[244:247], v[192:195], a[8:11]
ds_read_b64_tr_b16 a[236:237], v241 offset:41800
ds_read_b64_tr_b16 a[238:239], v241 offset:45928
v_mfma_f32_16x16x32_bf16 a[40:43], a[244:247], v[196:199], a[40:43]
s_add_u32 m0, s32, 0x2040
v_exp_f32 v143, v143
v_mfma_f32_16x16x32_bf16 a[40:43], a[240:243], v[188:191], a[40:43]
buffer_load_dwordx4 v243, s[16:19], s39 offen nt lds
v_mfma_f32_16x16x32_bf16 a[44:47], a[248:251], v[188:191], a[44:47]
v_exp_f32 v136, v136
v_mfma_f32_16x16x32_bf16 a[44:47], a[252:255], v[196:199], a[44:47]
ds_read_b64_tr_b16 a[240:241], v241 offset:33792
ds_read_b64_tr_b16 a[242:243], v241 offset:37920
v_mfma_f32_16x16x32_bf16 a[12:15], a[252:255], v[192:195], a[12:15]
v_exp_f32 v137, v137
v_mfma_f32_16x16x32_bf16 a[12:15], a[248:251], v[184:187], a[12:15]
ds_read_b64_tr_b16 a[244:245], v241 offset:42048
v_cvt_pk_bf16_f32 v175, v142, v143
v_mfma_f32_16x16x32_bf16 v[144:147], a[192:195], v[96:99], -4.0
v_exp_f32 v138, v138
v_mfma_f32_16x16x32_bf16 v[144:147], a[196:199], v[100:103], v[144:147]
v_exp_f32_e64 v139, v139
v_mfma_f32_16x16x32_bf16 v[144:147], a[200:203], v[104:107], v[144:147]
v_cvt_pk_bf16_f32 v172, v136, v137
v_cvt_pk_bf16_f32 v173, v138, v139
v_mfma_f32_16x16x32_bf16 v[144:147], a[204:207], v[108:111], v[144:147]
ds_read_b64_tr_b16 a[246:247], v241 offset:46176
ds_read_b64_tr_b16 a[248:249], v241 offset:33800
v_mfma_f32_16x16x32_bf16 v[148:151], a[220:223], v[108:111], -4.0
s_add_u32 m0, s32, 0x2040
ds_read_b64_tr_b16 a[250:251], v241 offset:37928
ds_read_b64_tr_b16 a[252:253], v241 offset:42056
v_mfma_f32_16x16x32_bf16 v[148:151], a[216:219], v[104:107], v[148:151]
ds_read_b64_tr_b16 a[254:255], v241 offset:46184
v_mfma_f32_16x16x32_bf16 v[148:151], a[212:215], v[100:103], v[148:151]
s_waitcnt vmcnt(13) lgkmcnt(5)
v_exp_f32 v144, v144
v_mfma_f32_16x16x32_bf16 v[148:151], a[208:211], v[96:99], v[148:151]
s_barrier
v_mfma_f32_16x16x32_bf16 v[156:159], a[208:211], v[112:115], -4.0
v_exp_f32 v145, v145
v_mfma_f32_16x16x32_bf16 v[156:159], a[212:215], v[116:119], v[156:159]
v_exp_f32 v146, v146
v_mfma_f32_16x16x32_bf16 v[156:159], a[216:219], v[120:123], v[156:159]
v_exp_f32 v147, v147
v_mfma_f32_16x16x32_bf16 v[156:159], a[220:223], v[124:127], v[156:159]
buffer_load_dwordx4 v243, s[24:27], s39 offen offset:1032 nt lds
v_mfma_f32_16x16x32_bf16 v[152:155], a[204:207], v[124:127], -4.0
v_exp_f32 v148, v148
v_mfma_f32_16x16x32_bf16 v[152:155], a[200:203], v[120:123], v[152:155]
v_cvt_pk_bf16_f32 v228, v144, v145
v_cvt_pk_bf16_f32 v229, v146, v147
v_mfma_f32_16x16x32_bf16 v[152:155], a[196:199], v[116:119], v[152:155]
v_exp_f32 v149, v149
v_mfma_f32_16x16x32_bf16 v[152:155], a[192:195], v[112:115], v[152:155]
ds_read_b128 a[208:211], v240 offset:4160
ds_read_b128 a[212:215], v240 offset:4416
v_smfmac_f32_16x16x64_bf16 v[216:219], v[224:227], v[160:167], v248
ds_read_b128 a[216:219], v240 offset:4672
v_mfma_f32_16x16x32_bf16 v[16:19], a[224:227], v[176:179], v[16:19]
v_exp_f32 v150, v150
v_mfma_f32_16x16x32_bf16 v[16:19], a[228:231], v[160:163], v[16:19]
ds_read_b128 a[220:223], v240 offset:4928
v_cvt_pk_bf16_f32 v230, v148, v149
v_mfma_f32_16x16x32_bf16 v[48:51], a[228:231], v[164:167], v[48:51]
v_exp_f32 v151, v151
v_mfma_f32_16x16x32_bf16 v[48:51], a[224:227], v[180:183], v[48:51]
s_add_u32 m0, s31, 0x8200
ds_read_b128 a[204:207], v240 offset:768
ds_read_b128 v[202:205], v242
v_mfma_f32_16x16x32_bf16 v[52:55], a[232:235], v[180:183], v[52:55]
v_exp_f32_e64 v156, v156
v_mfma_f32_16x16x32_bf16 v[52:55], a[236:239], v[164:167], v[52:55]
buffer_load_dwordx4 v243, s[12:15], s38 offen nt lds
v_mfma_f32_16x16x32_bf16 v[20:23], a[236:239], v[160:163], v[20:23]
ds_read_b128 a[200:203], v240 offset:512
v_cvt_pk_bf16_f32 v231, v150, v151
v_mfma_f32_16x16x32_bf16 v[20:23], a[232:235], v[176:179], v[20:23]
ds_read_b128 a[196:199], v240 offset:256
ds_read_b128 v[210:213], v242 offset:256
v_mfma_f32_16x16x32_bf16 v[24:27], a[240:243], v[176:179], v[24:27]
s_waitcnt lgkmcnt(5)
ds_read_b128 a[192:195], v240
v_mfma_f32_16x16x32_bf16 v[24:27], a[244:247], v[160:163], v[24:27]
v_exp_f32 v157, v157
v_mfma_f32_16x16x32_bf16 v[56:59], a[244:247], v[164:167], v[56:59]
s_waitcnt lgkmcnt(4)
v_exp_f32 v158, v158
v_mfma_f32_16x16x32_bf16 v[56:59], a[240:243], v[180:183], v[56:59]
v_cvt_pk_bf16_f32 v234, v156, v157
v_mov_b64 v[200:201], v[202:203]
v_mfma_f32_16x16x32_bf16 v[60:63], a[248:251], v[180:183], v[60:63]
v_exp_f32 v159, v159
v_mfma_f32_16x16x32_bf16 v[60:63], a[252:255], v[164:167], v[60:63]
v_exp_f32_e64 v152, v152
v_mfma_f32_16x16x32_bf16 v[28:31], a[252:255], v[160:163], v[28:31]
s_add_u32 m0, s31, 0x8200
v_cvt_pk_bf16_f32 v235, v158, v159
v_mov_b64 v[206:207], v[204:205]
v_mfma_f32_16x16x32_bf16 v[28:31], a[248:251], v[176:179], v[28:31]
s_waitcnt lgkmcnt(0)
buffer_load_dwordx4 v243, s[12:15], s38 offen offset:1024 nt lds
v_mfma_f32_16x16x32_bf16 v[200:203], v[236:239], v[200:203], 0
s_xor_b32 s38, s29, 0x18000
v_exp_f32 v153, v153
v_mfma_f32_16x16x32_bf16 v[204:207], v[236:239], v[204:207], 0
s_xor_b32 s39, s29, 0x14000
v_exp_f32 v154, v154
v_mfma_f32_16x16x32_bf16 v[128:131], a[192:195], v[64:67], -4.0
v_cvt_pk_bf16_f32 v232, v152, v153
v_mov_b64 v[208:209], v[210:211]
v_mfma_f32_16x16x32_bf16 v[128:131], a[196:199], v[68:71], v[128:131]
v_exp_f32 v155, v155
v_mfma_f32_16x16x32_bf16 v[128:131], a[200:203], v[72:75], v[128:131]
v_cvt_pk_bf16_f32 v233, v154, v155
v_mov_b64_e64 v[214:215], v[212:213]
v_mfma_f32_16x16x32_bf16 v[128:131], a[204:207], v[76:79], v[128:131]
v_cvt_pk_bf16_f32 v200, v200, v201
v_cvt_pk_bf16_f32 v201, v202, v203
v_mfma_f32_16x16x32_bf16 v[132:135], a[220:223], v[76:79], -4.0
v_accvgpr_write_b32 a64, v200
v_accvgpr_write_b32 a65, v201
v_mfma_f32_16x16x32_bf16 v[132:135], a[216:219], v[72:75], v[132:135]
v_cvt_pk_bf16_f32 v204, v204, v205
v_cvt_pk_bf16_f32 v205, v206, v207
v_mfma_f32_16x16x32_bf16 v[132:135], a[212:215], v[68:71], v[132:135]
v_exp_f32 v128, v128
v_mfma_f32_16x16x32_bf16 v[132:135], a[208:211], v[64:67], v[132:135]
v_exp_f32 v129, v129
v_mfma_f32_16x16x32_bf16 v[140:143], a[208:211], v[80:83], -4.0
s_add_u32 m0, s31, 0xa280
v_exp_f32 v130, v130
v_mfma_f32_16x16x32_bf16 v[140:143], a[212:215], v[84:87], v[140:143]
v_cvt_pk_bf16_f32 v160, v128, v129
v_accvgpr_write_b32 a66, v204
v_mfma_f32_16x16x32_bf16 v[140:143], a[216:219], v[88:91], v[140:143]
v_exp_f32 v131, v131
v_mfma_f32_16x16x32_bf16 v[140:143], a[220:223], v[92:95], v[140:143]
buffer_load_dwordx4 v243, s[12:15], s38 offen nt lds
v_mfma_f32_16x16x32_bf16 v[136:139], a[204:207], v[92:95], -4.0
v_exp_f32 v132, v132
v_mfma_f32_16x16x32_bf16 v[136:139], a[200:203], v[88:91], v[136:139]
v_cvt_pk_bf16_f32 v161, v130, v131
v_accvgpr_write_b32 a67, v205
v_mfma_f32_16x16x32_bf16 v[136:139], a[196:199], v[84:87], v[136:139]
s_waitcnt vmcnt(14)
v_exp_f32 v133, v133
v_mfma_f32_16x16x32_bf16 v[136:139], a[192:195], v[80:83], v[136:139]
s_barrier
v_smfmac_f32_16x16x64_bf16 v[220:223], v[224:227], v[192:199], v248
ds_read_b128 v[202:205], v242 offset:512
v_mfma_f32_16x16x32_bf16 v[208:211], v[236:239], v[208:211], 0
v_exp_f32 v134, v134
v_mfma_f32_16x16x32_bf16 v[212:215], v[236:239], v[212:215], 0
v_exp_f32 v135, v135
v_mfma_f32_16x16x32_bf16 a[16:19], a[224:227], v[184:187], a[16:19]
v_exp_f32_e64 v140, v140
v_mfma_f32_16x16x32_bf16 a[16:19], a[228:231], v[192:195], a[16:19]
v_cvt_pk_bf16_f32 v162, v132, v133
v_cvt_pk_bf16_f32 v163, v134, v135
v_mfma_f32_16x16x32_bf16 a[48:51], a[228:231], v[196:199], a[48:51]
v_exp_f32 v141, v141
v_mfma_f32_16x16x32_bf16 a[48:51], a[224:227], v[188:191], a[48:51]
s_add_u32 m0, s31, 0xa280
ds_read_b64_tr_b16 a[224:225], v241 offset:49536
ds_read_b64_tr_b16 a[226:227], v241 offset:53664
v_mfma_f32_16x16x32_bf16 a[52:55], a[232:235], v[188:191], a[52:55]
v_exp_f32 v142, v142
v_mfma_f32_16x16x32_bf16 a[52:55], a[236:239], v[196:199], a[52:55]
buffer_load_dwordx4 v243, s[12:15], s38 offen offset:1024 nt lds
v_mfma_f32_16x16x32_bf16 a[20:23], a[236:239], v[192:195], a[20:23]
s_waitcnt lgkmcnt(2)
v_cvt_pk_bf16_f32 v166, v140, v141
v_mov_b64 v[200:201], v[202:203]
v_mfma_f32_16x16x32_bf16 a[20:23], a[232:235], v[184:187], a[20:23]
ds_read_b64_tr_b16 a[228:229], v241 offset:57792
ds_read_b64_tr_b16 a[230:231], v241 offset:61920
v_mfma_f32_16x16x32_bf16 a[24:27], a[240:243], v[184:187], a[24:27]
v_exp_f32 v143, v143
v_mfma_f32_16x16x32_bf16 a[24:27], a[244:247], v[192:195], a[24:27]
ds_read_b64_tr_b16 a[232:233], v241 offset:49544
ds_read_b64_tr_b16 a[234:235], v241 offset:53672
v_mfma_f32_16x16x32_bf16 a[56:59], a[244:247], v[196:199], a[56:59]
v_exp_f32 v136, v136
v_mfma_f32_16x16x32_bf16 a[56:59], a[240:243], v[188:191], a[56:59]
ds_read_b64_tr_b16 a[236:237], v241 offset:57800
ds_read_b64_tr_b16 a[238:239], v241 offset:61928
v_mfma_f32_16x16x32_bf16 a[60:63], a[248:251], v[188:191], a[60:63]
v_cvt_pk_bf16_f32 v167, v142, v143
v_mov_b64_e64 v[206:207], v[204:205]
v_mfma_f32_16x16x32_bf16 a[60:63], a[252:255], v[196:199], a[60:63]
ds_read_b64_tr_b16 a[240:241], v241 offset:49792
ds_read_b64_tr_b16 a[242:243], v241 offset:53920
v_mfma_f32_16x16x32_bf16 a[28:31], a[252:255], v[192:195], a[28:31]
s_add_u32 m0, s32, 0x4080
v_exp_f32_e64 v137, v137
v_mfma_f32_16x16x32_bf16 a[28:31], a[248:251], v[184:187], a[28:31]
buffer_load_dwordx4 v243, s[16:19], s39 offen nt lds
v_mfma_f32_16x16x32_bf16 v[200:203], v[236:239], v[200:203], 0
ds_read_b64_tr_b16 a[244:245], v241 offset:58048
v_cvt_pk_bf16_f32 v208, v208, v209
v_mfma_f32_16x16x32_bf16 v[204:207], v[236:239], v[204:207], 0
ds_read_b64_tr_b16 a[246:247], v241 offset:62176
v_cvt_pk_bf16_f32 v209, v210, v211
v_mfma_f32_16x16x32_bf16 v[144:147], a[192:195], v[96:99], -4.0
v_exp_f32 v138, v138
v_mfma_f32_16x16x32_bf16 v[144:147], a[196:199], v[100:103], v[144:147]
v_cvt_pk_bf16_f32 v164, v136, v137
v_accvgpr_write_b32 a68, v208
v_mfma_f32_16x16x32_bf16 v[144:147], a[200:203], v[104:107], v[144:147]
v_exp_f32 v139, v139
v_mfma_f32_16x16x32_bf16 v[144:147], a[204:207], v[108:111], v[144:147]
ds_read_b64_tr_b16 a[248:249], v241 offset:49800
v_cvt_pk_bf16_f32 v165, v138, v139
v_mfma_f32_16x16x32_bf16 v[148:151], a[220:223], v[108:111], -4.0
v_accvgpr_write_b32 a69, v209
v_cvt_pk_bf16_f32 v212, v212, v213
v_mfma_f32_16x16x32_bf16 v[148:151], a[216:219], v[104:107], v[148:151]
v_cvt_pk_bf16_f32 v213, v214, v215
v_accvgpr_write_b32 a70, v212
v_mfma_f32_16x16x32_bf16 v[148:151], a[212:215], v[100:103], v[148:151]
v_exp_f32 v144, v144
v_mfma_f32_16x16x32_bf16 v[148:151], a[208:211], v[96:99], v[148:151]
ds_read_b64_tr_b16 a[250:251], v241 offset:53928
ds_read_b64_tr_b16 a[252:253], v241 offset:58056
v_mfma_f32_16x16x32_bf16 v[156:159], a[208:211], v[112:115], -4.0
s_add_u32 m0, s32, 0x4080
v_exp_f32 v145, v145
v_mfma_f32_16x16x32_bf16 v[156:159], a[212:215], v[116:119], v[156:159]
v_exp_f32_e64 v146, v146
v_mfma_f32_16x16x32_bf16 v[156:159], a[216:219], v[120:123], v[156:159]
v_cvt_pk_bf16_f32 v176, v144, v145
v_accvgpr_write_b32 a71, v213
v_mfma_f32_16x16x32_bf16 v[156:159], a[220:223], v[124:127], v[156:159]
buffer_load_dwordx4 v243, s[24:27], s39 offen offset:1032 nt lds
v_mfma_f32_16x16x32_bf16 v[152:155], a[204:207], v[124:127], -4.0
s_xor_b32 s39, s29, 0x16000
v_exp_f32 v147, v147
v_mfma_f32_16x16x32_bf16 v[152:155], a[200:203], v[120:123], v[152:155]
s_xor_b32 s38, s29, 0x1a000
v_exp_f32 v148, v148
v_mfma_f32_16x16x32_bf16 v[152:155], a[196:199], v[116:119], v[152:155]
v_cvt_pk_bf16_f32 v177, v146, v147
v_cvt_pk_bf16_f32 v200, v200, v201
v_mfma_f32_16x16x32_bf16 v[152:155], a[192:195], v[112:115], v[152:155]
ds_read_b64_tr_b16 a[254:255], v241 offset:62184
ds_read_b128 a[208:211], v240 offset:12480
v_smfmac_f32_16x16x64_bf16 v[216:219], v[224:227], v[168:175], v248
s_waitcnt lgkmcnt(2)
ds_read_b128 a[212:215], v240 offset:12736
v_mfma_f32_16x16x32_bf16 v[0:3], a[224:227], v[168:171], v[0:3]
v_exp_f32 v149, v149
v_mfma_f32_16x16x32_bf16 v[0:3], a[228:231], v[160:163], v[0:3]
ds_read_b128 a[216:219], v240 offset:12992
ds_read_b128 a[220:223], v240 offset:13248
v_mfma_f32_16x16x32_bf16 v[32:35], a[228:231], v[164:167], v[32:35]
v_exp_f32 v150, v150
v_mfma_f32_16x16x32_bf16 v[32:35], a[224:227], v[172:175], v[32:35]
s_add_u32 m0, s32, 0x60c0
ds_read_b128 a[204:207], v240 offset:9088
v_cvt_pk_bf16_f32 v178, v148, v149
v_mfma_f32_16x16x32_bf16 v[36:39], a[232:235], v[172:175], v[36:39]
v_exp_f32 v151, v151
v_mfma_f32_16x16x32_bf16 v[36:39], a[236:239], v[164:167], v[36:39]
buffer_load_dwordx4 v243, s[16:19], s39 offen nt lds
v_mfma_f32_16x16x32_bf16 v[4:7], a[236:239], v[160:163], v[4:7]
ds_read_b128 a[200:203], v240 offset:8832
v_cvt_pk_bf16_f32 v201, v202, v203
v_mfma_f32_16x16x32_bf16 v[4:7], a[232:235], v[168:171], v[4:7]
ds_read_b128 a[196:199], v240 offset:8576
v_accvgpr_write_b32 a72, v200
v_mfma_f32_16x16x32_bf16 v[8:11], a[240:243], v[168:171], v[8:11]
ds_read_b128 a[192:195], v240 offset:8320
v_accvgpr_write_b32 a73, v201
v_mfma_f32_16x16x32_bf16 v[8:11], a[244:247], v[160:163], v[8:11]
ds_read_b128 v[210:213], v242 offset:768
v_cvt_pk_bf16_f32 v204, v204, v205
v_mfma_f32_16x16x32_bf16 v[40:43], a[244:247], v[164:167], v[40:43]
v_exp_f32_e64 v156, v156
v_mfma_f32_16x16x32_bf16 v[40:43], a[240:243], v[172:175], v[40:43]
v_cvt_pk_bf16_f32 v179, v150, v151
v_cvt_pk_bf16_f32 v205, v206, v207
v_mfma_f32_16x16x32_bf16 v[44:47], a[248:251], v[172:175], v[44:47]
s_waitcnt lgkmcnt(4)
v_exp_f32 v157, v157
v_mfma_f32_16x16x32_bf16 v[44:47], a[252:255], v[164:167], v[44:47]
v_exp_f32_e64 v158, v158
v_mfma_f32_16x16x32_bf16 v[12:15], a[252:255], v[160:163], v[12:15]
s_add_u32 m0, s32, 0x60c0
v_cvt_pk_bf16_f32 v182, v156, v157
v_accvgpr_write_b32 a74, v204
v_mfma_f32_16x16x32_bf16 v[12:15], a[248:251], v[168:171], v[12:15]
s_waitcnt lgkmcnt(1)
buffer_load_dwordx4 v243, s[24:27], s39 offen offset:1032 nt lds
v_mfma_f32_16x16x32_bf16 v[128:131], a[192:195], v[64:67], -4.0
s_waitcnt lgkmcnt(0)
v_exp_f32_e64 v159, v159
v_mfma_f32_16x16x32_bf16 v[128:131], a[196:199], v[68:71], v[128:131]
s_add_u32 m0, s33, 0x0
v_exp_f32 v152, v152
v_mfma_f32_16x16x32_bf16 v[128:131], a[200:203], v[72:75], v[128:131]
v_cvt_pk_bf16_f32 v183, v158, v159
v_mov_b64 v[208:209], v[210:211]
v_mfma_f32_16x16x32_bf16 v[128:131], a[204:207], v[76:79], v[128:131]
v_exp_f32 v153, v153
v_mfma_f32_16x16x32_bf16 v[132:135], a[220:223], v[76:79], -4.0
v_exp_f32_e64 v154, v154
v_mfma_f32_16x16x32_bf16 v[132:135], a[216:219], v[72:75], v[132:135]
v_cvt_pk_bf16_f32 v180, v152, v153
v_mov_b64 v[214:215], v[212:213]
v_mfma_f32_16x16x32_bf16 v[132:135], a[212:215], v[68:71], v[132:135]
v_exp_f32 v155, v155
v_mfma_f32_16x16x32_bf16 v[132:135], a[208:211], v[64:67], v[132:135]
buffer_load_dwordx4 v243, s[8:11], s56 offen nt lds
v_mfma_f32_16x16x32_bf16 v[140:143], a[208:211], v[80:83], -4.0
s_add_u32 m0, s31, 0xc300
v_cvt_pk_bf16_f32 v181, v154, v155
v_accvgpr_write_b32 a75, v205
v_mfma_f32_16x16x32_bf16 v[140:143], a[212:215], v[84:87], v[140:143]
v_exp_f32 v128, v128
v_mfma_f32_16x16x32_bf16 v[140:143], a[216:219], v[88:91], v[140:143]
v_exp_f32 v129, v129
v_mfma_f32_16x16x32_bf16 v[140:143], a[220:223], v[92:95], v[140:143]
v_exp_f32 v130, v130
v_mfma_f32_16x16x32_bf16 v[136:139], a[204:207], v[92:95], -4.0
v_exp_f32 v131, v131
v_mfma_f32_16x16x32_bf16 v[136:139], a[200:203], v[88:91], v[136:139]
v_exp_f32_e64 v132, v132
v_mfma_f32_16x16x32_bf16 v[136:139], a[196:199], v[84:87], v[136:139]
s_waitcnt vmcnt(17)
v_cvt_pk_bf16_f32 v184, v128, v129
v_cvt_pk_bf16_f32 v185, v130, v131
v_mfma_f32_16x16x32_bf16 v[136:139], a[192:195], v[80:83], v[136:139]
s_barrier
v_smfmac_f32_16x16x64_bf16 v[220:223], v[224:227], v[228:235], v248
buffer_load_dwordx4 v243, s[12:15], s38 offen nt lds
v_mfma_f32_16x16x32_bf16 v[208:211], v[236:239], v[208:211], 0
v_exp_f32 v133, v133
v_mfma_f32_16x16x32_bf16 v[212:215], v[236:239], v[212:215], 0
v_exp_f32 v134, v134
v_mfma_f32_16x16x32_bf16 a[0:3], a[224:227], v[228:231], a[0:3]
v_exp_f32 v135, v135
v_mfma_f32_16x16x32_bf16 a[0:3], a[228:231], v[176:179], a[0:3]
v_exp_f32 v140, v140
v_mfma_f32_16x16x32_bf16 a[32:35], a[228:231], v[180:183], a[32:35]
v_cvt_pk_bf16_f32 v186, v132, v133
v_cvt_pk_bf16_f32 v187, v134, v135
v_mfma_f32_16x16x32_bf16 a[32:35], a[224:227], v[232:235], a[32:35]
ds_read_b64_tr_b16 a[224:225], v241 offset:50048
ds_read_b64_tr_b16 a[226:227], v241 offset:54176
v_mfma_f32_16x16x32_bf16 a[36:39], a[232:235], v[232:235], a[36:39]
v_exp_f32_e64 v141, v141
v_mfma_f32_16x16x32_bf16 a[36:39], a[236:239], v[180:183], a[36:39]
ds_read_b64_tr_b16 a[228:229], v241 offset:58304
ds_read_b64_tr_b16 a[230:231], v241 offset:62432
v_mfma_f32_16x16x32_bf16 a[4:7], a[236:239], v[176:179], a[4:7]
v_exp_f32_e64 v142, v142
v_mfma_f32_16x16x32_bf16 a[4:7], a[232:235], v[228:231], a[4:7]
ds_read_b64_tr_b16 a[232:233], v241 offset:50056
ds_read_b64_tr_b16 a[234:235], v241 offset:54184
v_mfma_f32_16x16x32_bf16 a[8:11], a[240:243], v[228:231], a[8:11]
s_add_u32 m0, s31, 0xc300
v_cvt_pk_bf16_f32 v190, v140, v141
v_cvt_pk_bf16_f32 v208, v208, v209
v_mfma_f32_16x16x32_bf16 a[8:11], a[244:247], v[176:179], a[8:11]
buffer_load_dwordx4 v243, s[12:15], s38 offen offset:1024 nt lds
v_mfma_f32_16x16x32_bf16 a[40:43], a[244:247], v[180:183], a[40:43]
s_xor_b32 s38, s29, 0x1c000
v_exp_f32_e64 v143, v143
v_mfma_f32_16x16x32_bf16 a[40:43], a[240:243], v[232:235], a[40:43]
s_add_u32 m0, s33, 0x0
ds_read_b64_tr_b16 a[236:237], v241 offset:58312
ds_read_b64_tr_b16 a[238:239], v241 offset:62440
v_mfma_f32_16x16x32_bf16 a[44:47], a[248:251], v[232:235], a[44:47]
s_xor_b32 s39, s29, 0x18000
v_exp_f32 v136, v136
v_mfma_f32_16x16x32_bf16 a[44:47], a[252:255], v[180:183], a[44:47]
ds_read_b64_tr_b16 a[240:241], v241 offset:50304
ds_read_b64_tr_b16 a[242:243], v241 offset:54432
v_mfma_f32_16x16x32_bf16 a[12:15], a[252:255], v[176:179], a[12:15]
v_cvt_pk_bf16_f32 v191, v142, v143
v_cvt_pk_bf16_f32 v209, v210, v211
v_mfma_f32_16x16x32_bf16 a[12:15], a[248:251], v[228:231], a[12:15]
buffer_load_dwordx4 v243, s[8:11], s56 offen offset:1024 nt lds
v_mfma_f32_16x16x32_bf16 v[144:147], a[192:195], v[96:99], -4.0
v_exp_f32_e64 v137, v137
v_mfma_f32_16x16x32_bf16 v[144:147], a[196:199], v[100:103], v[144:147]
v_exp_f32 v138, v138
v_mfma_f32_16x16x32_bf16 v[144:147], a[200:203], v[104:107], v[144:147]
s_add_u32 m0, s31, 0x0
v_cvt_pk_bf16_f32 v188, v136, v137
v_accvgpr_write_b32 a76, v208
v_mfma_f32_16x16x32_bf16 v[144:147], a[204:207], v[108:111], v[144:147]
ds_read_b64_tr_b16 a[244:245], v241 offset:58560
ds_read_b64_tr_b16 a[246:247], v241 offset:62688
v_mfma_f32_16x16x32_bf16 v[148:151], a[220:223], v[108:111], -4.0
v_exp_f32 v139, v139
v_mfma_f32_16x16x32_bf16 v[148:151], a[216:219], v[104:107], v[148:151]
v_cvt_pk_bf16_f32 v189, v138, v139
v_accvgpr_write_b32 a77, v209
v_mfma_f32_16x16x32_bf16 v[148:151], a[212:215], v[100:103], v[148:151]
v_exp_f32 v144, v144
v_mfma_f32_16x16x32_bf16 v[148:151], a[208:211], v[96:99], v[148:151]
buffer_load_dwordx4 v243, s[12:15], s38 offen nt lds
v_mfma_f32_16x16x32_bf16 v[156:159], a[208:211], v[112:115], -4.0
v_exp_f32_e64 v145, v145
v_mfma_f32_16x16x32_bf16 v[156:159], a[212:215], v[116:119], v[156:159]
v_exp_f32_e64 v146, v146
v_mfma_f32_16x16x32_bf16 v[156:159], a[216:219], v[120:123], v[156:159]
v_cvt_pk_bf16_f32 v192, v144, v145
v_cvt_pk_bf16_f32 v212, v212, v213
v_mfma_f32_16x16x32_bf16 v[156:159], a[220:223], v[124:127], v[156:159]
ds_read_b64_tr_b16 a[248:249], v241 offset:50312
ds_read_b64_tr_b16 a[250:251], v241 offset:54440
v_mfma_f32_16x16x32_bf16 v[152:155], a[204:207], v[124:127], -4.0
v_exp_f32_e64 v147, v147
v_mfma_f32_16x16x32_bf16 v[152:155], a[200:203], v[120:123], v[152:155]
v_exp_f32_e64 v148, v148
v_mfma_f32_16x16x32_bf16 v[152:155], a[196:199], v[116:119], v[152:155]
v_cvt_pk_bf16_f32 v193, v146, v147
v_cvt_pk_bf16_f32 v213, v214, v215
v_mfma_f32_16x16x32_bf16 v[152:155], a[192:195], v[112:115], v[152:155]
ds_read_b64_tr_b16 a[252:253], v241 offset:58568
ds_read_b64_tr_b16 a[254:255], v241 offset:62696
v_smfmac_f32_16x16x64_bf16 v[216:219], v[224:227], v[160:167], v248
s_waitcnt lgkmcnt(4)
ds_read_b128 a[208:211], v240 offset:20800
v_mfma_f32_16x16x32_bf16 v[16:19], a[224:227], v[168:171], v[16:19]
s_add_u32 m0, s31, 0x0
v_exp_f32 v149, v149
v_mfma_f32_16x16x32_bf16 v[16:19], a[228:231], v[160:163], v[16:19]
buffer_load_dwordx4 v243, s[12:15], s38 offen offset:1024 nt lds
v_mfma_f32_16x16x32_bf16 v[48:51], a[228:231], v[164:167], v[48:51]
ds_read_b128 a[212:215], v240 offset:21056
v_accvgpr_write_b32 a78, v212
v_mfma_f32_16x16x32_bf16 v[48:51], a[224:227], v[172:175], v[48:51]
s_add_u32 m0, s33, 0x20
ds_read_b128 a[216:219], v240 offset:21312
ds_read_b128 a[220:223], v240 offset:21568
v_mfma_f32_16x16x32_bf16 v[52:55], a[232:235], v[172:175], v[52:55]
v_exp_f32_e64 v150, v150
v_mfma_f32_16x16x32_bf16 v[52:55], a[236:239], v[164:167], v[52:55]
ds_read_b128 a[204:207], v240 offset:17408
ds_read_b128 a[200:203], v240 offset:17152
v_mfma_f32_16x16x32_bf16 v[20:23], a[236:239], v[160:163], v[20:23]
v_cvt_pk_bf16_f32 v194, v148, v149
v_accvgpr_write_b32 a79, v213
v_mfma_f32_16x16x32_bf16 v[20:23], a[232:235], v[168:171], v[20:23]
ds_read_b128 a[196:199], v240 offset:16896
ds_read_b128 a[192:195], v240 offset:16640
v_mfma_f32_16x16x32_bf16 v[24:27], a[240:243], v[168:171], v[24:27]
v_exp_f32_e64 v151, v151
v_mfma_f32_16x16x32_bf16 v[24:27], a[244:247], v[160:163], v[24:27]
buffer_load_dwordx4 v243, s[8:11], s56 offen offset:2048 nt lds
v_mfma_f32_16x16x32_bf16 v[56:59], a[244:247], v[164:167], v[56:59]
s_add_u32 m0, s32, 0x8100
v_exp_f32 v156, v156
v_mfma_f32_16x16x32_bf16 v[56:59], a[240:243], v[172:175], v[56:59]
s_waitcnt lgkmcnt(4)
v_exp_f32 v157, v157
v_mfma_f32_16x16x32_bf16 v[60:63], a[248:251], v[172:175], v[60:63]
v_exp_f32 v158, v158
v_mfma_f32_16x16x32_bf16 v[60:63], a[252:255], v[164:167], v[60:63]
v_cvt_pk_bf16_f32 v195, v150, v151
v_cvt_pk_bf16_f32 v198, v156, v157
v_mfma_f32_16x16x32_bf16 v[28:31], a[252:255], v[160:163], v[28:31]
v_exp_f32 v159, v159
v_mfma_f32_16x16x32_bf16 v[28:31], a[248:251], v[168:171], v[28:31]
s_waitcnt lgkmcnt(0)
buffer_load_dwordx4 v243, s[16:19], s39 offen nt lds
v_mfma_f32_16x16x32_bf16 v[128:131], a[192:195], v[64:67], -4.0
v_exp_f32 v152, v152
v_mfma_f32_16x16x32_bf16 v[128:131], a[196:199], v[68:71], v[128:131]
s_waitcnt vmcnt(20)
v_exp_f32 v153, v153
v_mfma_f32_16x16x32_bf16 v[128:131], a[200:203], v[72:75], v[128:131]
v_exp_f32 v154, v154
v_mfma_f32_16x16x32_bf16 v[128:131], a[204:207], v[76:79], v[128:131]
ds_read_b128 v[202:205], v242 offset:4160
v_cvt_pk_bf16_f32 v199, v158, v159
v_mfma_f32_16x16x32_bf16 v[132:135], a[220:223], v[76:79], -4.0
v_exp_f32_e64 v155, v155
v_mfma_f32_16x16x32_bf16 v[132:135], a[216:219], v[72:75], v[132:135]
v_cvt_pk_bf16_f32 v196, v152, v153
v_cvt_pk_bf16_f32 v197, v154, v155
v_mfma_f32_16x16x32_bf16 v[132:135], a[212:215], v[68:71], v[132:135]
v_exp_f32 v128, v128
v_mfma_f32_16x16x32_bf16 v[132:135], a[208:211], v[64:67], v[132:135]
ds_read_b128 v[210:213], v242 offset:4416
v_mfma_f32_16x16x32_bf16 v[140:143], a[208:211], v[80:83], -4.0
s_add_u32 m0, s32, 0x8100
v_exp_f32 v129, v129
v_mfma_f32_16x16x32_bf16 v[140:143], a[212:215], v[84:87], v[140:143]
v_exp_f32 v130, v130
v_mfma_f32_16x16x32_bf16 v[140:143], a[216:219], v[88:91], v[140:143]
s_waitcnt lgkmcnt(1)
v_cvt_pk_bf16_f32 v160, v128, v129
v_mov_b64_e64 v[200:201], v[202:203]
v_mfma_f32_16x16x32_bf16 v[140:143], a[220:223], v[92:95], v[140:143]
buffer_load_dwordx4 v243, s[24:27], s39 offen offset:1032 nt lds
v_mfma_f32_16x16x32_bf16 v[136:139], a[204:207], v[92:95], -4.0
s_xor_b32 s39, s29, 0x1a000
v_exp_f32 v131, v131
v_mfma_f32_16x16x32_bf16 v[136:139], a[200:203], v[88:91], v[136:139]
s_xor_b32 s38, s29, 0x1e000
v_exp_f32 v132, v132
v_mfma_f32_16x16x32_bf16 v[136:139], a[196:199], v[84:87], v[136:139]
s_waitcnt vmcnt(15) lgkmcnt(0)
v_cvt_pk_bf16_f32 v161, v130, v131
v_mov_b64 v[206:207], v[204:205]
v_mfma_f32_16x16x32_bf16 v[136:139], a[192:195], v[80:83], v[136:139]
L_pad2:
s_cbranch_vccnz L_pad6
s_barrier
v_smfmac_f32_16x16x64_bf16 v[220:223], v[224:227], v[176:183], v248
s_add_u32 m0, s33, 0x20
v_mov_b64 v[208:209], v[210:211]
v_mfma_f32_16x16x32_bf16 v[200:203], v[236:239], v[200:203], 0
buffer_load_dwordx4 v243, s[8:11], s56 offen offset:3072 nt lds
v_mfma_f32_16x16x32_bf16 v[204:207], v[236:239], v[204:207], 0
s_xor_b32 s56, s28, 0x1003000
v_exp_f32_e64 v133, v133
v_mfma_f32_16x16x32_bf16 a[16:19], a[224:227], v[228:231], a[16:19]
v_exp_f32 v134, v134
v_mfma_f32_16x16x32_bf16 a[16:19], a[228:231], v[176:179], a[16:19]
v_cvt_pk_bf16_f32 v162, v132, v133
v_mov_b64 v[214:215], v[212:213]
v_mfma_f32_16x16x32_bf16 a[48:51], a[228:231], v[180:183], a[48:51]
v_exp_f32_e64 v135, v135
v_mfma_f32_16x16x32_bf16 a[48:51], a[224:227], v[232:235], a[48:51]
s_add_u32 m0, s32, 0xa140
ds_read_b64_tr_b16 a[224:225], v241
ds_read_b64_tr_b16 a[226:227], v241 offset:4128
v_mfma_f32_16x16x32_bf16 a[52:55], a[232:235], v[232:235], a[52:55]
v_exp_f32_e64 v140, v140
v_mfma_f32_16x16x32_bf16 a[52:55], a[236:239], v[180:183], a[52:55]
buffer_load_dwordx4 v243, s[16:19], s39 offen nt lds
v_mfma_f32_16x16x32_bf16 a[20:23], a[236:239], v[176:179], a[20:23]
v_cvt_pk_bf16_f32 v163, v134, v135
v_cvt_pk_bf16_f32 v200, v200, v201
v_mfma_f32_16x16x32_bf16 a[20:23], a[232:235], v[228:231], a[20:23]
ds_read_b64_tr_b16 a[228:229], v241 offset:8256
ds_read_b64_tr_b16 a[230:231], v241 offset:12384
v_mfma_f32_16x16x32_bf16 a[24:27], a[240:243], v[228:231], a[24:27]
v_exp_f32_e64 v141, v141
v_mfma_f32_16x16x32_bf16 a[24:27], a[244:247], v[176:179], a[24:27]
ds_read_b64_tr_b16 a[232:233], v241 offset:8
ds_read_b64_tr_b16 a[234:235], v241 offset:4136
v_mfma_f32_16x16x32_bf16 a[56:59], a[244:247], v[180:183], a[56:59]
v_exp_f32_e64 v142, v142
v_mfma_f32_16x16x32_bf16 a[56:59], a[240:243], v[232:235], a[56:59]
ds_read_b64_tr_b16 a[236:237], v241 offset:8264
ds_read_b64_tr_b16 a[238:239], v241 offset:12392
v_mfma_f32_16x16x32_bf16 a[60:63], a[248:251], v[232:235], a[60:63]
v_cvt_pk_bf16_f32 v166, v140, v141
v_cvt_pk_bf16_f32 v201, v202, v203
v_mfma_f32_16x16x32_bf16 a[60:63], a[252:255], v[180:183], a[60:63]
ds_read_b64_tr_b16 a[240:241], v241 offset:256
ds_read_b64_tr_b16 a[242:243], v241 offset:4384
v_mfma_f32_16x16x32_bf16 a[28:31], a[252:255], v[176:179], a[28:31]
s_add_u32 m0, s32, 0xa140
v_exp_f32_e64 v143, v143
v_mfma_f32_16x16x32_bf16 a[28:31], a[248:251], v[228:231], a[28:31]
buffer_load_dwordx4 v243, s[24:27], s39 offen offset:1032 nt lds
v_mfma_f32_16x16x32_bf16 v[208:211], v[236:239], v[208:211], 0
ds_read_b64_tr_b16 a[244:245], v241 offset:8512
v_accvgpr_write_b32 a80, v200
v_mfma_f32_16x16x32_bf16 v[212:215], v[236:239], v[212:215], 0
ds_read_b64_tr_b16 a[246:247], v241 offset:12640
v_accvgpr_write_b32 a81, v201
v_mfma_f32_16x16x32_bf16 v[144:147], a[192:195], v[96:99], -4.0
v_exp_f32 v136, v136
v_mfma_f32_16x16x32_bf16 v[144:147], a[196:199], v[100:103], v[144:147]
v_cvt_pk_bf16_f32 v167, v142, v143
v_cvt_pk_bf16_f32 v204, v204, v205
v_mfma_f32_16x16x32_bf16 v[144:147], a[200:203], v[104:107], v[144:147]
v_exp_f32 v137, v137
v_mfma_f32_16x16x32_bf16 v[144:147], a[204:207], v[108:111], v[144:147]
ds_read_b64_tr_b16 a[248:249], v241 offset:264
v_cvt_pk_bf16_f32 v205, v206, v207
v_mfma_f32_16x16x32_bf16 v[148:151], a[220:223], v[108:111], -4.0
v_exp_f32 v138, v138
v_mfma_f32_16x16x32_bf16 v[148:151], a[216:219], v[104:107], v[148:151]
v_cvt_pk_bf16_f32 v164, v136, v137
v_accvgpr_write_b32 a82, v204
v_mfma_f32_16x16x32_bf16 v[148:151], a[212:215], v[100:103], v[148:151]
v_exp_f32 v139, v139
v_mfma_f32_16x16x32_bf16 v[148:151], a[208:211], v[96:99], v[148:151]
ds_read_b64_tr_b16 a[250:251], v241 offset:4392
ds_read_b64_tr_b16 a[252:253], v241 offset:8520
v_mfma_f32_16x16x32_bf16 v[156:159], a[208:211], v[112:115], -4.0
s_add_u32 m0, s31, 0x2080
v_cvt_pk_bf16_f32 v165, v138, v139
v_accvgpr_write_b32 a83, v205
v_mfma_f32_16x16x32_bf16 v[156:159], a[212:215], v[116:119], v[156:159]
v_exp_f32 v144, v144
v_mfma_f32_16x16x32_bf16 v[156:159], a[216:219], v[120:123], v[156:159]
v_exp_f32 v145, v145
v_mfma_f32_16x16x32_bf16 v[156:159], a[220:223], v[124:127], v[156:159]
buffer_load_dwordx4 v243, s[12:15], s38 offen nt lds
v_mfma_f32_16x16x32_bf16 v[152:155], a[204:207], v[124:127], -4.0
v_exp_f32 v146, v146
v_mfma_f32_16x16x32_bf16 v[152:155], a[200:203], v[120:123], v[152:155]
v_cvt_pk_bf16_f32 v168, v144, v145
v_cvt_pk_bf16_f32 v208, v208, v209
v_mfma_f32_16x16x32_bf16 v[152:155], a[196:199], v[116:119], v[152:155]
v_exp_f32 v147, v147
v_mfma_f32_16x16x32_bf16 v[152:155], a[192:195], v[112:115], v[152:155]
ds_read_b64_tr_b16 a[254:255], v241 offset:12648
ds_read_b128 a[208:211], v240 offset:29120
v_smfmac_f32_16x16x64_bf16 v[216:219], v[224:227], v[184:191], v248
s_waitcnt lgkmcnt(2)
ds_read_b128 a[212:215], v240 offset:29376
v_mfma_f32_16x16x32_bf16 v[0:3], a[224:227], v[184:187], v[0:3]
v_exp_f32 v148, v148
v_mfma_f32_16x16x32_bf16 v[0:3], a[228:231], v[160:163], v[0:3]
ds_read_b128 a[216:219], v240 offset:29632
ds_read_b128 a[220:223], v240 offset:29888
v_mfma_f32_16x16x32_bf16 v[32:35], a[228:231], v[164:167], v[32:35]
v_cvt_pk_bf16_f32 v169, v146, v147
v_cvt_pk_bf16_f32 v209, v210, v211
v_mfma_f32_16x16x32_bf16 v[32:35], a[224:227], v[188:191], v[32:35]
s_add_u32 m0, s31, 0x2080
ds_read_b128 a[204:207], v240 offset:25728
v_accvgpr_write_b32 a84, v208
v_mfma_f32_16x16x32_bf16 v[36:39], a[232:235], v[188:191], v[36:39]
v_exp_f32_e64 v149, v149
v_mfma_f32_16x16x32_bf16 v[36:39], a[236:239], v[164:167], v[36:39]
buffer_load_dwordx4 v243, s[12:15], s38 offen offset:1024 nt lds
v_mfma_f32_16x16x32_bf16 v[4:7], a[236:239], v[160:163], v[4:7]
s_xor_b32 s38, s29, 0x800000
ds_read_b128 a[200:203], v240 offset:25472
v_accvgpr_write_b32 a85, v209
v_mfma_f32_16x16x32_bf16 v[4:7], a[232:235], v[184:187], v[4:7]
s_xor_b32 s39, s29, 0x1c000
ds_read_b128 a[196:199], v240 offset:25216
v_cvt_pk_bf16_f32 v212, v212, v213
v_mfma_f32_16x16x32_bf16 v[8:11], a[240:243], v[184:187], v[8:11]
ds_read_b128 a[192:195], v240 offset:24960
v_cvt_pk_bf16_f32 v213, v214, v215
v_mfma_f32_16x16x32_bf16 v[8:11], a[244:247], v[160:163], v[8:11]
ds_read_b128 v[202:205], v242 offset:4672
v_accvgpr_write_b32 a86, v212
v_mfma_f32_16x16x32_bf16 v[40:43], a[244:247], v[164:167], v[40:43]
v_exp_f32_e64 v150, v150
v_mfma_f32_16x16x32_bf16 v[40:43], a[240:243], v[188:191], v[40:43]
v_cvt_pk_bf16_f32 v170, v148, v149
v_accvgpr_write_b32 a87, v213
v_mfma_f32_16x16x32_bf16 v[44:47], a[248:251], v[188:191], v[44:47]
s_waitcnt lgkmcnt(4)
v_exp_f32 v151, v151
v_mfma_f32_16x16x32_bf16 v[44:47], a[252:255], v[164:167], v[44:47]
ds_read_b128 v[210:213], v242 offset:4928
v_mfma_f32_16x16x32_bf16 v[12:15], a[252:255], v[160:163], v[12:15]
s_add_u32 m0, s31, 0x4100
v_exp_f32 v156, v156
v_mfma_f32_16x16x32_bf16 v[12:15], a[248:251], v[184:187], v[12:15]
s_waitcnt lgkmcnt(2)
buffer_load_dwordx4 v243, s[12:15], s38 offen nt lds
v_mfma_f32_16x16x32_bf16 v[128:131], a[192:195], v[64:67], -4.0
s_waitcnt lgkmcnt(1)
v_cvt_pk_bf16_f32 v171, v150, v151
v_mov_b64 v[200:201], v[202:203]
v_mfma_f32_16x16x32_bf16 v[128:131], a[196:199], v[68:71], v[128:131]
v_exp_f32 v157, v157
v_mfma_f32_16x16x32_bf16 v[128:131], a[200:203], v[72:75], v[128:131]
v_exp_f32 v158, v158
v_mfma_f32_16x16x32_bf16 v[128:131], a[204:207], v[76:79], v[128:131]
v_cvt_pk_bf16_f32 v174, v156, v157
v_mov_b64 v[206:207], v[204:205]
v_mfma_f32_16x16x32_bf16 v[132:135], a[220:223], v[76:79], -4.0
s_waitcnt lgkmcnt(0)
v_exp_f32 v159, v159
v_mfma_f32_16x16x32_bf16 v[132:135], a[216:219], v[72:75], v[132:135]
s_add_u32 m0, s33, 0x1040
v_exp_f32 v152, v152
v_mfma_f32_16x16x32_bf16 v[132:135], a[212:215], v[68:71], v[132:135]
v_cvt_pk_bf16_f32 v175, v158, v159
v_mov_b64 v[208:209], v[210:211]
v_mfma_f32_16x16x32_bf16 v[132:135], a[208:211], v[64:67], v[132:135]
buffer_load_dwordx4 v243, s[8:11], s56 offen nt lds
v_mfma_f32_16x16x32_bf16 v[140:143], a[208:211], v[80:83], -4.0
s_add_u32 m0, s31, 0x4100
v_exp_f32 v153, v153
v_mfma_f32_16x16x32_bf16 v[140:143], a[212:215], v[84:87], v[140:143]
v_exp_f32_e64 v154, v154
v_mfma_f32_16x16x32_bf16 v[140:143], a[216:219], v[88:91], v[140:143]
v_cvt_pk_bf16_f32 v172, v152, v153
v_mov_b64 v[214:215], v[212:213]
v_mfma_f32_16x16x32_bf16 v[140:143], a[220:223], v[92:95], v[140:143]
v_exp_f32 v155, v155
v_mfma_f32_16x16x32_bf16 v[136:139], a[204:207], v[92:95], -4.0
v_exp_f32 v128, v128
v_mfma_f32_16x16x32_bf16 v[136:139], a[200:203], v[88:91], v[136:139]
v_exp_f32 v129, v129
v_mfma_f32_16x16x32_bf16 v[136:139], a[196:199], v[84:87], v[136:139]
v_exp_f32_e64 v130, v130
v_mfma_f32_16x16x32_bf16 v[136:139], a[192:195], v[80:83], v[136:139]
buffer_load_dwordx4 v243, s[12:15], s38 offen offset:1024 nt lds
v_mfma_f32_16x16x32_bf16 v[200:203], v[236:239], v[200:203], 0
v_cvt_pk_bf16_f32 v173, v154, v155
v_cvt_pk_bf16_f32 v176, v128, v129
v_mfma_f32_16x16x32_bf16 v[204:207], v[236:239], v[204:207], 0
v_exp_f32_e64 v131, v131
v_smfmac_f32_16x16x64_bf16 v[220:223], v[224:227], v[192:199], v248
v_mfma_f32_16x16x32_bf16 v[208:211], v[236:239], v[208:211], 0
v_exp_f32 v132, v132
v_mfma_f32_16x16x32_bf16 v[212:215], v[236:239], v[212:215], 0
v_cvt_pk_bf16_f32 v177, v130, v131
v_cvt_pk_bf16_f32 v200, v200, v201
v_mfma_f32_16x16x32_bf16 a[0:3], a[224:227], v[192:195], a[0:3]
v_exp_f32 v133, v133
v_mfma_f32_16x16x32_bf16 a[0:3], a[228:231], v[168:171], a[0:3]
v_exp_f32_e64 v134, v134
v_mfma_f32_16x16x32_bf16 a[32:35], a[228:231], v[172:175], a[32:35]
v_cvt_pk_bf16_f32 v178, v132, v133
v_cvt_pk_bf16_f32 v201, v202, v203
v_mfma_f32_16x16x32_bf16 a[32:35], a[224:227], v[196:199], a[32:35]
ds_read_b64_tr_b16 a[224:225], v241 offset:512
ds_read_b64_tr_b16 a[226:227], v241 offset:4640
v_mfma_f32_16x16x32_bf16 a[36:39], a[232:235], v[196:199], a[36:39]
v_exp_f32_e64 v135, v135
v_mfma_f32_16x16x32_bf16 a[36:39], a[236:239], v[172:175], a[36:39]
ds_read_b64_tr_b16 a[228:229], v241 offset:8768
ds_read_b64_tr_b16 a[230:231], v241 offset:12896
v_mfma_f32_16x16x32_bf16 a[4:7], a[236:239], v[168:171], a[4:7]
v_exp_f32_e64 v140, v140
v_mfma_f32_16x16x32_bf16 a[4:7], a[232:235], v[192:195], a[4:7]
s_add_u32 m0, s32, 0xc180
ds_read_b64_tr_b16 a[232:233], v241 offset:520
ds_read_b64_tr_b16 a[234:235], v241 offset:4648
v_mfma_f32_16x16x32_bf16 a[8:11], a[240:243], v[192:195], a[8:11]
v_cvt_pk_bf16_f32 v179, v134, v135
v_accvgpr_write_b32 a88, v200
v_mfma_f32_16x16x32_bf16 a[8:11], a[244:247], v[168:171], a[8:11]
buffer_load_dwordx4 v243, s[16:19], s39 offen nt lds
v_mfma_f32_16x16x32_bf16 a[40:43], a[244:247], v[172:175], a[40:43]
v_exp_f32_e64 v141, v141
v_mfma_f32_16x16x32_bf16 a[40:43], a[240:243], v[196:199], a[40:43]
s_add_u32 m0, s33, 0x1040
ds_read_b64_tr_b16 a[236:237], v241 offset:8776
ds_read_b64_tr_b16 a[238:239], v241 offset:12904
v_mfma_f32_16x16x32_bf16 a[44:47], a[248:251], v[196:199], a[44:47]
v_exp_f32_e64 v142, v142
v_mfma_f32_16x16x32_bf16 a[44:47], a[252:255], v[172:175], a[44:47]
ds_read_b64_tr_b16 a[240:241], v241 offset:768
ds_read_b64_tr_b16 a[242:243], v241 offset:4896
v_mfma_f32_16x16x32_bf16 a[12:15], a[252:255], v[168:171], a[12:15]
v_cvt_pk_bf16_f32 v182, v140, v141
v_accvgpr_write_b32 a89, v201
v_mfma_f32_16x16x32_bf16 a[12:15], a[248:251], v[192:195], a[12:15]
buffer_load_dwordx4 v243, s[8:11], s56 offen offset:1024 nt lds
v_mfma_f32_16x16x32_bf16 v[144:147], a[192:195], v[96:99], -4.0
v_exp_f32_e64 v143, v143
v_mfma_f32_16x16x32_bf16 v[144:147], a[196:199], v[100:103], v[144:147]
v_exp_f32_e64 v136, v136
v_mfma_f32_16x16x32_bf16 v[144:147], a[200:203], v[104:107], v[144:147]
s_add_u32 m0, s32, 0xc180
v_cvt_pk_bf16_f32 v183, v142, v143
v_cvt_pk_bf16_f32 v204, v204, v205
v_mfma_f32_16x16x32_bf16 v[144:147], a[204:207], v[108:111], v[144:147]
ds_read_b64_tr_b16 a[244:245], v241 offset:9024
ds_read_b64_tr_b16 a[246:247], v241 offset:13152
v_mfma_f32_16x16x32_bf16 v[148:151], a[220:223], v[108:111], -4.0
v_exp_f32 v137, v137
v_mfma_f32_16x16x32_bf16 v[148:151], a[216:219], v[104:107], v[148:151]
v_exp_f32 v138, v138
v_mfma_f32_16x16x32_bf16 v[148:151], a[212:215], v[100:103], v[148:151]
v_cvt_pk_bf16_f32 v180, v136, v137
v_cvt_pk_bf16_f32 v205, v206, v207
v_mfma_f32_16x16x32_bf16 v[148:151], a[208:211], v[96:99], v[148:151]
buffer_load_dwordx4 v243, s[24:27], s39 offen offset:1032 nt lds
v_mfma_f32_16x16x32_bf16 v[156:159], a[208:211], v[112:115], -4.0
s_xor_b32 s39, s29, 0x1e000
v_exp_f32_e64 v139, v139
v_mfma_f32_16x16x32_bf16 v[156:159], a[212:215], v[116:119], v[156:159]
s_xor_b32 s38, s29, 0x802000
v_cvt_pk_bf16_f32 v181, v138, v139
v_accvgpr_write_b32 a90, v204
v_mfma_f32_16x16x32_bf16 v[156:159], a[216:219], v[120:123], v[156:159]
v_exp_f32_e64 v144, v144
v_mfma_f32_16x16x32_bf16 v[156:159], a[220:223], v[124:127], v[156:159]
ds_read_b64_tr_b16 a[248:249], v241 offset:776
ds_read_b64_tr_b16 a[250:251], v241 offset:4904
v_mfma_f32_16x16x32_bf16 v[152:155], a[204:207], v[124:127], -4.0
v_exp_f32_e64 v145, v145
v_mfma_f32_16x16x32_bf16 v[152:155], a[200:203], v[120:123], v[152:155]
v_exp_f32 v146, v146
v_mfma_f32_16x16x32_bf16 v[152:155], a[196:199], v[116:119], v[152:155]
v_cvt_pk_bf16_f32 v228, v144, v145
v_accvgpr_write_b32 a91, v205
v_mfma_f32_16x16x32_bf16 v[152:155], a[192:195], v[112:115], v[152:155]
ds_read_b64_tr_b16 a[252:253], v241 offset:9032
ds_read_b64_tr_b16 a[254:255], v241 offset:13160
v_smfmac_f32_16x16x64_bf16 v[216:219], v[224:227], v[160:167], v248
s_waitcnt lgkmcnt(4)
ds_read_b128 a[208:211], v240 offset:37440
v_mfma_f32_16x16x32_bf16 v[16:19], a[224:227], v[184:187], v[16:19]
s_add_u32 m0, s32, 0xe1c0
v_exp_f32_e64 v147, v147
v_mfma_f32_16x16x32_bf16 v[16:19], a[228:231], v[160:163], v[16:19]
buffer_load_dwordx4 v243, s[16:19], s39 offen nt lds
v_mfma_f32_16x16x32_bf16 v[48:51], a[228:231], v[164:167], v[48:51]
ds_read_b128 a[212:215], v240 offset:37696
v_cvt_pk_bf16_f32 v208, v208, v209
v_mfma_f32_16x16x32_bf16 v[48:51], a[224:227], v[188:191], v[48:51]
s_add_u32 m0, s33, 0x1060
ds_read_b128 a[216:219], v240 offset:37952
ds_read_b128 a[220:223], v240 offset:38208
v_mfma_f32_16x16x32_bf16 v[52:55], a[232:235], v[188:191], v[52:55]
v_exp_f32_e64 v148, v148
v_mfma_f32_16x16x32_bf16 v[52:55], a[236:239], v[164:167], v[52:55]
ds_read_b128 a[204:207], v240 offset:34048
ds_read_b128 a[200:203], v240 offset:33792
v_mfma_f32_16x16x32_bf16 v[20:23], a[236:239], v[160:163], v[20:23]
v_cvt_pk_bf16_f32 v229, v146, v147
v_cvt_pk_bf16_f32 v209, v210, v211
v_mfma_f32_16x16x32_bf16 v[20:23], a[232:235], v[184:187], v[20:23]
ds_read_b128 a[196:199], v240 offset:33536
v_accvgpr_write_b32 a92, v208
v_mfma_f32_16x16x32_bf16 v[24:27], a[240:243], v[184:187], v[24:27]
ds_read_b128 a[192:195], v240 offset:33280
v_accvgpr_write_b32 a93, v209
v_mfma_f32_16x16x32_bf16 v[24:27], a[244:247], v[160:163], v[24:27]
buffer_load_dwordx4 v243, s[8:11], s56 offen offset:2048 nt lds
v_mfma_f32_16x16x32_bf16 v[56:59], a[244:247], v[164:167], v[56:59]
s_add_u32 m0, s32, 0xe1c0
v_exp_f32_e64 v149, v149
v_mfma_f32_16x16x32_bf16 v[56:59], a[240:243], v[188:191], v[56:59]
s_waitcnt lgkmcnt(4)
v_exp_f32 v150, v150
v_mfma_f32_16x16x32_bf16 v[60:63], a[248:251], v[188:191], v[60:63]
v_cvt_pk_bf16_f32 v230, v148, v149
v_cvt_pk_bf16_f32 v212, v212, v213
v_mfma_f32_16x16x32_bf16 v[60:63], a[252:255], v[164:167], v[60:63]
v_exp_f32 v151, v151
v_mfma_f32_16x16x32_bf16 v[28:31], a[252:255], v[160:163], v[28:31]
v_exp_f32 v156, v156
v_mfma_f32_16x16x32_bf16 v[28:31], a[248:251], v[184:187], v[28:31]
s_waitcnt lgkmcnt(0)
buffer_load_dwordx4 v243, s[24:27], s39 offen offset:1032 nt lds
v_mfma_f32_16x16x32_bf16 v[128:131], a[192:195], v[64:67], -4.0
v_cvt_pk_bf16_f32 v231, v150, v151
v_cvt_pk_bf16_f32 v213, v214, v215
v_mfma_f32_16x16x32_bf16 v[128:131], a[196:199], v[68:71], v[128:131]
v_exp_f32 v157, v157
v_mfma_f32_16x16x32_bf16 v[128:131], a[200:203], v[72:75], v[128:131]
v_exp_f32 v158, v158
v_mfma_f32_16x16x32_bf16 v[128:131], a[204:207], v[76:79], v[128:131]
v_cvt_pk_bf16_f32 v234, v156, v157
v_accvgpr_write_b32 a94, v212
v_mfma_f32_16x16x32_bf16 v[132:135], a[220:223], v[76:79], -4.0
v_exp_f32 v159, v159
v_mfma_f32_16x16x32_bf16 v[132:135], a[216:219], v[72:75], v[132:135]
v_exp_f32_e64 v152, v152
v_mfma_f32_16x16x32_bf16 v[132:135], a[212:215], v[68:71], v[132:135]
v_cvt_pk_bf16_f32 v235, v158, v159
v_accvgpr_write_b32 a95, v213
v_mfma_f32_16x16x32_bf16 v[132:135], a[208:211], v[64:67], v[132:135]
v_exp_f32 v153, v153
v_mfma_f32_16x16x32_bf16 v[140:143], a[208:211], v[80:83], -4.0
v_exp_f32 v154, v154
v_mfma_f32_16x16x32_bf16 v[140:143], a[212:215], v[84:87], v[140:143]
v_exp_f32_e64 v155, v155
v_mfma_f32_16x16x32_bf16 v[140:143], a[216:219], v[88:91], v[140:143]
v_cvt_pk_bf16_f32 v232, v152, v153
v_cvt_pk_bf16_f32 v233, v154, v155
v_mfma_f32_16x16x32_bf16 v[140:143], a[220:223], v[92:95], v[140:143]
s_add_u32 m0, s31, 0x6180
v_exp_f32 v128, v128
v_mfma_f32_16x16x32_bf16 v[136:139], a[204:207], v[92:95], -4.0
v_exp_f32 v129, v129
v_mfma_f32_16x16x32_bf16 v[136:139], a[200:203], v[88:91], v[136:139]
v_exp_f32_e64 v130, v130
v_mfma_f32_16x16x32_bf16 v[136:139], a[196:199], v[84:87], v[136:139]
s_waitcnt vmcnt(20)
v_exp_f32 v131, v131
v_mfma_f32_16x16x32_bf16 v[136:139], a[192:195], v[80:83], v[136:139]
s_barrier
v_smfmac_f32_16x16x64_bf16 v[220:223], v[224:227], v[168:175], v248
buffer_load_dwordx4 v243, s[12:15], s38 offen nt lds
v_mfma_f32_16x16x32_bf16 a[16:19], a[224:227], v[192:195], a[16:19]
s_add_u32 m0, s33, 0x1060
v_exp_f32 v132, v132
v_mfma_f32_16x16x32_bf16 a[16:19], a[228:231], v[168:171], a[16:19]
v_cvt_pk_bf16_f32 v160, v128, v129
v_cvt_pk_bf16_f32 v161, v130, v131
v_mfma_f32_16x16x32_bf16 a[48:51], a[228:231], v[172:175], a[48:51]
v_exp_f32_e64 v133, v133
v_mfma_f32_16x16x32_bf16 a[48:51], a[224:227], v[196:199], a[48:51]
ds_read_b64_tr_b16 a[224:225], v241 offset:16512
ds_read_b64_tr_b16 a[226:227], v241 offset:20640
v_mfma_f32_16x16x32_bf16 a[52:55], a[232:235], v[196:199], a[52:55]
v_exp_f32 v134, v134
v_mfma_f32_16x16x32_bf16 a[52:55], a[236:239], v[172:175], a[52:55]
buffer_load_dwordx4 v243, s[8:11], s56 offen offset:3072 nt lds
v_mfma_f32_16x16x32_bf16 a[20:23], a[236:239], v[168:171], a[20:23]
s_xor_b32 s56, s28, 0x2000000
v_exp_f32 v135, v135
v_mfma_f32_16x16x32_bf16 a[20:23], a[232:235], v[192:195], a[20:23]
ds_read_b64_tr_b16 a[228:229], v241 offset:24768
ds_read_b64_tr_b16 a[230:231], v241 offset:28896
v_mfma_f32_16x16x32_bf16 a[24:27], a[240:243], v[192:195], a[24:27]
s_add_u32 m0, s31, 0x6180
v_exp_f32_e64 v140, v140
v_mfma_f32_16x16x32_bf16 a[24:27], a[244:247], v[168:171], a[24:27]
ds_read_b64_tr_b16 a[232:233], v241 offset:16520
ds_read_b64_tr_b16 a[234:235], v241 offset:20648
v_mfma_f32_16x16x32_bf16 a[56:59], a[244:247], v[172:175], a[56:59]
v_cvt_pk_bf16_f32 v162, v132, v133
v_cvt_pk_bf16_f32 v163, v134, v135
v_mfma_f32_16x16x32_bf16 a[56:59], a[240:243], v[196:199], a[56:59]
buffer_load_dwordx4 v243, s[12:15], s38 offen offset:1024 nt lds
v_mfma_f32_16x16x32_bf16 a[60:63], a[248:251], v[196:199], a[60:63]
s_xor_b32 s38, s29, 0x804000
v_exp_f32_e64 v141, v141
v_mfma_f32_16x16x32_bf16 a[60:63], a[252:255], v[172:175], a[60:63]
s_xor_b32 s39, s29, 0x800000
ds_read_b64_tr_b16 a[236:237], v241 offset:24776
ds_read_b64_tr_b16 a[238:239], v241 offset:28904
v_mfma_f32_16x16x32_bf16 a[28:31], a[252:255], v[168:171], a[28:31]
v_exp_f32_e64 v142, v142
v_mfma_f32_16x16x32_bf16 a[28:31], a[248:251], v[192:195], a[28:31]
ds_read_b64_tr_b16 a[240:241], v241 offset:16768
ds_read_b64_tr_b16 a[242:243], v241 offset:20896
v_mfma_f32_16x16x32_bf16 v[144:147], a[192:195], v[96:99], -4.0
v_exp_f32 v143, v143
v_mfma_f32_16x16x32_bf16 v[144:147], a[196:199], v[100:103], v[144:147]
v_exp_f32 v136, v136
v_mfma_f32_16x16x32_bf16 v[144:147], a[200:203], v[104:107], v[144:147]
v_cvt_pk_bf16_f32 v166, v140, v141
v_cvt_pk_bf16_f32 v167, v142, v143
v_mfma_f32_16x16x32_bf16 v[144:147], a[204:207], v[108:111], v[144:147]
ds_read_b64_tr_b16 a[244:245], v241 offset:25024
ds_read_b64_tr_b16 a[246:247], v241 offset:29152
v_mfma_f32_16x16x32_bf16 v[148:151], a[220:223], v[108:111], -4.0
s_add_u32 m0, s31, 0x8200
v_exp_f32 v137, v137
v_mfma_f32_16x16x32_bf16 v[148:151], a[216:219], v[104:107], v[148:151]
v_exp_f32 v138, v138
v_mfma_f32_16x16x32_bf16 v[148:151], a[212:215], v[100:103], v[148:151]
v_exp_f32_e64 v139, v139
v_mfma_f32_16x16x32_bf16 v[148:151], a[208:211], v[96:99], v[148:151]
buffer_load_dwordx4 v243, s[12:15], s38 offen nt lds
v_mfma_f32_16x16x32_bf16 v[156:159], a[208:211], v[112:115], -4.0
v_cvt_pk_bf16_f32 v164, v136, v137
v_cvt_pk_bf16_f32 v165, v138, v139
v_mfma_f32_16x16x32_bf16 v[156:159], a[212:215], v[116:119], v[156:159]
v_exp_f32_e64 v144, v144
v_mfma_f32_16x16x32_bf16 v[156:159], a[216:219], v[120:123], v[156:159]
v_exp_f32_e64 v145, v145
v_mfma_f32_16x16x32_bf16 v[156:159], a[220:223], v[124:127], v[156:159]
ds_read_b64_tr_b16 a[248:249], v241 offset:16776
ds_read_b64_tr_b16 a[250:251], v241 offset:20904
v_mfma_f32_16x16x32_bf16 v[152:155], a[204:207], v[124:127], -4.0
v_exp_f32_e64 v146, v146
v_mfma_f32_16x16x32_bf16 v[152:155], a[200:203], v[120:123], v[152:155]
v_exp_f32_e64 v147, v147
v_mfma_f32_16x16x32_bf16 v[152:155], a[196:199], v[116:119], v[152:155]
v_exp_f32 v148, v148
v_mfma_f32_16x16x32_bf16 v[152:155], a[192:195], v[112:115], v[152:155]
ds_read_b64_tr_b16 a[252:253], v241 offset:25032
ds_read_b64_tr_b16 a[254:255], v241 offset:29160
v_smfmac_f32_16x16x64_bf16 v[216:219], v[224:227], v[176:183], v248
s_waitcnt lgkmcnt(4)
ds_read_b128 a[208:211], v240 offset:45760
v_mfma_f32_16x16x32_bf16 v[0:3], a[224:227], v[176:179], v[0:3]
s_add_u32 m0, s31, 0x8200
v_cvt_pk_bf16_f32 v184, v144, v145
v_cvt_pk_bf16_f32 v185, v146, v147
v_mfma_f32_16x16x32_bf16 v[0:3], a[228:231], v[160:163], v[0:3]
buffer_load_dwordx4 v243, s[12:15], s38 offen offset:1024 nt lds
v_mfma_f32_16x16x32_bf16 v[32:35], a[228:231], v[164:167], v[32:35]
ds_read_b128 a[212:215], v240 offset:46016
ds_read_b128 a[216:219], v240 offset:46272
v_mfma_f32_16x16x32_bf16 v[32:35], a[224:227], v[180:183], v[32:35]
ds_read_b128 a[220:223], v240 offset:46528
ds_read_b128 a[204:207], v240 offset:42368
v_mfma_f32_16x16x32_bf16 v[36:39], a[232:235], v[180:183], v[36:39]
v_exp_f32 v149, v149
v_mfma_f32_16x16x32_bf16 v[36:39], a[236:239], v[164:167], v[36:39]
ds_read_b128 a[200:203], v240 offset:42112
ds_read_b128 a[196:199], v240 offset:41856
v_mfma_f32_16x16x32_bf16 v[4:7], a[236:239], v[160:163], v[4:7]
v_exp_f32 v150, v150
v_mfma_f32_16x16x32_bf16 v[4:7], a[232:235], v[176:179], v[4:7]
ds_read_b128 a[192:195], v240 offset:41600
v_cvt_pk_bf16_f32 v186, v148, v149
v_mfma_f32_16x16x32_bf16 v[8:11], a[240:243], v[176:179], v[8:11]
v_exp_f32 v151, v151
v_mfma_f32_16x16x32_bf16 v[8:11], a[244:247], v[160:163], v[8:11]
v_exp_f32 v156, v156
v_mfma_f32_16x16x32_bf16 v[40:43], a[244:247], v[164:167], v[40:43]
s_add_u32 m0, s32, 0x0
v_exp_f32 v157, v157
v_mfma_f32_16x16x32_bf16 v[40:43], a[240:243], v[180:183], v[40:43]
s_waitcnt lgkmcnt(3)
buffer_load_dwordx4 v243, s[16:19], s39 offen nt lds
v_mfma_f32_16x16x32_bf16 v[44:47], a[248:251], v[180:183], v[44:47]
v_exp_f32 v158, v158
v_mfma_f32_16x16x32_bf16 v[44:47], a[252:255], v[164:167], v[44:47]
v_cvt_pk_bf16_f32 v187, v150, v151
v_cvt_pk_bf16_f32 v190, v156, v157
v_mfma_f32_16x16x32_bf16 v[12:15], a[252:255], v[160:163], v[12:15]
v_exp_f32 v159, v159
v_mfma_f32_16x16x32_bf16 v[12:15], a[248:251], v[176:179], v[12:15]
s_waitcnt lgkmcnt(0)
v_exp_f32 v152, v152
v_mfma_f32_16x16x32_bf16 v[128:131], a[192:195], v[64:67], -4.0
v_exp_f32 v153, v153
v_mfma_f32_16x16x32_bf16 v[128:131], a[196:199], v[68:71], v[128:131]
v_exp_f32_e64 v154, v154
v_mfma_f32_16x16x32_bf16 v[128:131], a[200:203], v[72:75], v[128:131]
v_cvt_pk_bf16_f32 v191, v158, v159
v_cvt_pk_bf16_f32 v188, v152, v153
v_mfma_f32_16x16x32_bf16 v[128:131], a[204:207], v[76:79], v[128:131]
v_exp_f32 v155, v155
v_mfma_f32_16x16x32_bf16 v[132:135], a[220:223], v[76:79], -4.0
s_add_u32 m0, s32, 0x0
v_cvt_pk_bf16_f32 v189, v154, v155
v_mfma_f32_16x16x32_bf16 v[132:135], a[216:219], v[72:75], v[132:135]
v_mfma_f32_16x16x32_bf16 v[132:135], a[212:215], v[68:71], v[132:135]
v_mfma_f32_16x16x32_bf16 v[132:135], a[208:211], v[64:67], v[132:135]
buffer_load_dwordx4 v243, s[24:27], s39 offen offset:1032 nt lds
v_mfma_f32_16x16x32_bf16 v[140:143], a[208:211], v[80:83], -4.0
s_xor_b32 s39, s29, 0x802000
v_exp_f32 v128, v128
v_mfma_f32_16x16x32_bf16 v[140:143], a[212:215], v[84:87], v[140:143]
s_xor_b32 s38, s29, 0x806000
v_exp_f32 v129, v129
v_mfma_f32_16x16x32_bf16 v[140:143], a[216:219], v[88:91], v[140:143]
v_exp_f32_e64 v130, v130
v_mfma_f32_16x16x32_bf16 v[140:143], a[220:223], v[92:95], v[140:143]
v_exp_f32 v131, v131
v_mfma_f32_16x16x32_bf16 v[136:139], a[204:207], v[92:95], -4.0
v_exp_f32 v132, v132
v_mfma_f32_16x16x32_bf16 v[136:139], a[200:203], v[88:91], v[136:139]
v_cvt_pk_bf16_f32 v168, v128, v129
v_cvt_pk_bf16_f32 v169, v130, v131
v_mfma_f32_16x16x32_bf16 v[136:139], a[196:199], v[84:87], v[136:139]
v_exp_f32_e64 v133, v133
v_mfma_f32_16x16x32_bf16 v[136:139], a[192:195], v[80:83], v[136:139]
v_exp_f32 v134, v134
v_smfmac_f32_16x16x64_bf16 v[220:223], v[224:227], v[228:235], v248
s_add_u32 m0, s32, 0x2040
v_cvt_pk_bf16_f32 v170, v132, v133
v_mfma_f32_16x16x32_bf16 a[0:3], a[224:227], v[228:231], a[0:3]
v_exp_f32_e64 v135, v135
v_mfma_f32_16x16x32_bf16 a[0:3], a[228:231], v[184:187], a[0:3]
s_waitcnt vmcnt(20)
buffer_load_dwordx4 v243, s[16:19], s39 offen nt lds
v_mfma_f32_16x16x32_bf16 a[32:35], a[228:231], v[188:191], a[32:35]
v_exp_f32 v140, v140
v_mfma_f32_16x16x32_bf16 a[32:35], a[224:227], v[232:235], a[32:35]
ds_read_b64_tr_b16 a[224:225], v241 offset:17024
ds_read_b64_tr_b16 a[226:227], v241 offset:21152
v_mfma_f32_16x16x32_bf16 a[36:39], a[232:235], v[232:235], a[36:39]
v_exp_f32 v141, v141
v_mfma_f32_16x16x32_bf16 a[36:39], a[236:239], v[188:191], a[36:39]
ds_read_b64_tr_b16 a[228:229], v241 offset:25280
ds_read_b64_tr_b16 a[230:231], v241 offset:29408
v_mfma_f32_16x16x32_bf16 a[4:7], a[236:239], v[184:187], a[4:7]
v_exp_f32_e64 v142, v142
v_mfma_f32_16x16x32_bf16 a[4:7], a[232:235], v[228:231], a[4:7]
ds_read_b64_tr_b16 a[232:233], v241 offset:17032
ds_read_b64_tr_b16 a[234:235], v241 offset:21160
v_mfma_f32_16x16x32_bf16 a[8:11], a[240:243], v[228:231], a[8:11]
L_pad3:
s_cbranch_vccnz L_pad7
v_cvt_pk_bf16_f32 v171, v134, v135
v_cvt_pk_bf16_f32 v174, v140, v141
v_mfma_f32_16x16x32_bf16 a[8:11], a[244:247], v[184:187], a[8:11]
ds_read_b64_tr_b16 a[236:237], v241 offset:25288
ds_read_b64_tr_b16 a[238:239], v241 offset:29416
v_mfma_f32_16x16x32_bf16 a[40:43], a[244:247], v[188:191], a[40:43]
s_add_u32 m0, s32, 0x2040
v_exp_f32 v143, v143
v_mfma_f32_16x16x32_bf16 a[40:43], a[240:243], v[232:235], a[40:43]
buffer_load_dwordx4 v243, s[24:27], s39 offen offset:1032 nt lds
v_mfma_f32_16x16x32_bf16 a[44:47], a[248:251], v[232:235], a[44:47]
v_exp_f32 v136, v136
v_mfma_f32_16x16x32_bf16 a[44:47], a[252:255], v[188:191], a[44:47]
ds_read_b64_tr_b16 a[240:241], v241 offset:17280
ds_read_b64_tr_b16 a[242:243], v241 offset:21408
v_mfma_f32_16x16x32_bf16 a[12:15], a[252:255], v[184:187], a[12:15]
v_exp_f32 v137, v137
v_mfma_f32_16x16x32_bf16 a[12:15], a[248:251], v[228:231], a[12:15]
ds_read_b64_tr_b16 a[244:245], v241 offset:25536
v_cvt_pk_bf16_f32 v175, v142, v143
v_mfma_f32_16x16x32_bf16 v[144:147], a[192:195], v[96:99], -4.0
v_exp_f32 v138, v138
v_mfma_f32_16x16x32_bf16 v[144:147], a[196:199], v[100:103], v[144:147]
v_exp_f32 v139, v139
v_mfma_f32_16x16x32_bf16 v[144:147], a[200:203], v[104:107], v[144:147]
v_cvt_pk_bf16_f32 v172, v136, v137
v_cvt_pk_bf16_f32 v173, v138, v139
v_mfma_f32_16x16x32_bf16 v[144:147], a[204:207], v[108:111], v[144:147]
ds_read_b64_tr_b16 a[246:247], v241 offset:29664
ds_read_b64_tr_b16 a[248:249], v241 offset:17288
v_mfma_f32_16x16x32_bf16 v[148:151], a[220:223], v[108:111], -4.0
ds_read_b64_tr_b16 a[250:251], v241 offset:21416
ds_read_b128 v[202:205], v242
v_mfma_f32_16x16x32_bf16 v[148:151], a[216:219], v[104:107], v[148:151]
ds_read_b64_tr_b16 a[252:253], v241 offset:25544
ds_read_b128 v[210:213], v242 offset:256
v_mfma_f32_16x16x32_bf16 v[148:151], a[212:215], v[100:103], v[148:151]
v_exp_f32 v144, v144
v_mfma_f32_16x16x32_bf16 v[148:151], a[208:211], v[96:99], v[148:151]
ds_read_b64_tr_b16 a[254:255], v241 offset:29672
v_exp_f32 v145, v145
v_mfma_f32_16x16x32_bf16 v[156:159], a[208:211], v[112:115], -4.0
v_exp_f32_e64 v146, v146
v_mfma_f32_16x16x32_bf16 v[156:159], a[212:215], v[116:119], v[156:159]
v_exp_f32 v147, v147
v_mfma_f32_16x16x32_bf16 v[156:159], a[216:219], v[120:123], v[156:159]
v_cvt_pk_bf16_f32 v192, v144, v145
v_mfma_f32_16x16x32_bf16 v[156:159], a[220:223], v[124:127], v[156:159]
s_waitcnt lgkmcnt(3)
ds_read_b128 a[208:211], v240 offset:54080
v_mov_b64 v[200:201], v[202:203]
v_mov_b64 v[206:207], v[204:205]
v_mfma_f32_16x16x32_bf16 v[152:155], a[204:207], v[124:127], -4.0
s_waitcnt lgkmcnt(2)
v_mov_b64 v[208:209], v[210:211]
v_mov_b64 v[214:215], v[212:213]
v_mfma_f32_16x16x32_bf16 v[152:155], a[200:203], v[120:123], v[152:155]
v_exp_f32 v148, v148
v_mfma_f32_16x16x32_bf16 v[152:155], a[196:199], v[116:119], v[152:155]
v_exp_f32_e64 v149, v149
v_mfma_f32_16x16x32_bf16 v[152:155], a[192:195], v[112:115], v[152:155]
ds_read_b128 a[212:215], v240 offset:54336
ds_read_b128 a[216:219], v240 offset:54592
v_mfma_f32_16x16x32_bf16 v[200:203], v[236:239], v[200:203], 0
ds_read_b128 a[220:223], v240 offset:54848
v_cvt_pk_bf16_f32 v193, v146, v147
v_mfma_f32_16x16x32_bf16 v[204:207], v[236:239], v[204:207], 0
ds_read_b128 a[204:207], v240 offset:50688
ds_read_b128 a[200:203], v240 offset:50432
v_smfmac_f32_16x16x64_bf16 v[216:219], v[224:227], v[160:167], v248
ds_read_b128 a[196:199], v240 offset:50176
v_mfma_f32_16x16x32_bf16 v[208:211], v[236:239], v[208:211], 0
ds_read_b128 a[192:195], v240 offset:49920
v_cvt_pk_bf16_f32 v200, v200, v201
v_cvt_pk_bf16_f32 v201, v202, v203
v_mfma_f32_16x16x32_bf16 v[212:215], v[236:239], v[212:215], 0
v_accvgpr_write_b32 a96, v200
v_accvgpr_write_b32 a97, v201
v_mfma_f32_16x16x32_bf16 v[16:19], a[224:227], v[176:179], v[16:19]
v_exp_f32 v150, v150
v_mfma_f32_16x16x32_bf16 v[16:19], a[228:231], v[160:163], v[16:19]
v_cvt_pk_bf16_f32 v194, v148, v149
v_cvt_pk_bf16_f32 v204, v204, v205
v_mfma_f32_16x16x32_bf16 v[48:51], a[228:231], v[164:167], v[48:51]
v_exp_f32 v151, v151
v_mfma_f32_16x16x32_bf16 v[48:51], a[224:227], v[180:183], v[48:51]
v_cvt_pk_bf16_f32 v205, v206, v207
v_accvgpr_write_b32 a98, v204
v_mfma_f32_16x16x32_bf16 v[52:55], a[232:235], v[180:183], v[52:55]
v_exp_f32 v156, v156
v_mfma_f32_16x16x32_bf16 v[52:55], a[236:239], v[164:167], v[52:55]
v_cvt_pk_bf16_f32 v195, v150, v151
v_accvgpr_write_b32 a99, v205
v_mfma_f32_16x16x32_bf16 v[20:23], a[236:239], v[160:163], v[20:23]
v_exp_f32 v157, v157
v_mfma_f32_16x16x32_bf16 v[20:23], a[232:235], v[176:179], v[20:23]
ds_read_b128 v[202:205], v242 offset:512
v_cvt_pk_bf16_f32 v208, v208, v209
v_mfma_f32_16x16x32_bf16 v[24:27], a[240:243], v[176:179], v[24:27]
v_exp_f32 v158, v158
v_mfma_f32_16x16x32_bf16 v[24:27], a[244:247], v[160:163], v[24:27]
v_cvt_pk_bf16_f32 v198, v156, v157
v_cvt_pk_bf16_f32 v209, v210, v211
v_mfma_f32_16x16x32_bf16 v[56:59], a[244:247], v[164:167], v[56:59]
v_exp_f32 v159, v159
v_mfma_f32_16x16x32_bf16 v[56:59], a[240:243], v[180:183], v[56:59]
v_exp_f32 v152, v152
v_mfma_f32_16x16x32_bf16 v[60:63], a[248:251], v[180:183], v[60:63]
s_waitcnt lgkmcnt(1)
v_cvt_pk_bf16_f32 v199, v158, v159
v_accvgpr_write_b32 a100, v208
v_mfma_f32_16x16x32_bf16 v[60:63], a[252:255], v[164:167], v[60:63]
v_exp_f32 v153, v153
v_mfma_f32_16x16x32_bf16 v[28:31], a[252:255], v[160:163], v[28:31]
s_waitcnt lgkmcnt(0)
v_exp_f32_e64 v154, v154
v_mfma_f32_16x16x32_bf16 v[28:31], a[248:251], v[176:179], v[28:31]
v_cvt_pk_bf16_f32 v196, v152, v153
v_mov_b64 v[200:201], v[202:203]
v_mfma_f32_16x16x32_bf16 v[128:131], a[192:195], v[64:67], -4.0
v_exp_f32 v155, v155
v_mfma_f32_16x16x32_bf16 v[128:131], a[196:199], v[68:71], v[128:131]
v_cvt_pk_bf16_f32 v197, v154, v155
v_mov_b64_e64 v[206:207], v[204:205]
v_mfma_f32_16x16x32_bf16 v[128:131], a[200:203], v[72:75], v[128:131]
v_accvgpr_write_b32 a101, v209
v_cvt_pk_bf16_f32 v212, v212, v213
v_mfma_f32_16x16x32_bf16 v[128:131], a[204:207], v[76:79], v[128:131]
v_cvt_pk_bf16_f32 v213, v214, v215
v_accvgpr_write_b32 a102, v212
v_mfma_f32_16x16x32_bf16 v[132:135], a[220:223], v[76:79], -4.0
v_accvgpr_write_b32 a103, v213
v_mfma_f32_16x16x32_bf16 v[132:135], a[216:219], v[72:75], v[132:135]
ds_read_b128 v[210:213], v242 offset:768
v_mfma_f32_16x16x32_bf16 v[132:135], a[212:215], v[68:71], v[132:135]
v_mfma_f32_16x16x32_bf16 v[132:135], a[208:211], v[64:67], v[132:135]
v_exp_f32 v128, v128
v_mfma_f32_16x16x32_bf16 v[140:143], a[208:211], v[80:83], -4.0
v_exp_f32 v129, v129
v_mfma_f32_16x16x32_bf16 v[140:143], a[212:215], v[84:87], v[140:143]
v_exp_f32 v130, v130
v_mfma_f32_16x16x32_bf16 v[140:143], a[216:219], v[88:91], v[140:143]
v_exp_f32 v131, v131
v_mfma_f32_16x16x32_bf16 v[140:143], a[220:223], v[92:95], v[140:143]
s_add_u32 m0, s31, 0xa280
v_exp_f32 v132, v132
v_mfma_f32_16x16x32_bf16 v[136:139], a[204:207], v[92:95], -4.0
s_waitcnt lgkmcnt(0)
v_cvt_pk_bf16_f32 v160, v128, v129
v_cvt_pk_bf16_f32 v161, v130, v131
v_mfma_f32_16x16x32_bf16 v[136:139], a[200:203], v[88:91], v[136:139]
v_exp_f32_e64 v133, v133
v_mfma_f32_16x16x32_bf16 v[136:139], a[196:199], v[84:87], v[136:139]
s_waitcnt vmcnt(18)
v_exp_f32 v134, v134
v_mfma_f32_16x16x32_bf16 v[136:139], a[192:195], v[80:83], v[136:139]
s_barrier
v_smfmac_f32_16x16x64_bf16 v[220:223], v[224:227], v[184:191], v248
buffer_load_dwordx4 v243, s[12:15], s38 offen nt lds
v_mfma_f32_16x16x32_bf16 v[200:203], v[236:239], v[200:203], 0
s_add_u32 m0, s33, 0x0
v_cvt_pk_bf16_f32 v162, v132, v133
v_mov_b64 v[208:209], v[210:211]
v_mfma_f32_16x16x32_bf16 v[204:207], v[236:239], v[204:207], 0
v_exp_f32 v135, v135
v_mfma_f32_16x16x32_bf16 a[16:19], a[224:227], v[228:231], a[16:19]
v_exp_f32 v140, v140
v_mfma_f32_16x16x32_bf16 a[16:19], a[228:231], v[184:187], a[16:19]
v_cvt_pk_bf16_f32 v163, v134, v135
v_mov_b64 v[214:215], v[212:213]
v_mfma_f32_16x16x32_bf16 a[48:51], a[228:231], v[188:191], a[48:51]
v_exp_f32_e64 v141, v141
v_mfma_f32_16x16x32_bf16 a[48:51], a[224:227], v[232:235], a[48:51]
ds_read_b64_tr_b16 a[224:225], v241 offset:33024
ds_read_b64_tr_b16 a[226:227], v241 offset:37152
v_mfma_f32_16x16x32_bf16 a[52:55], a[232:235], v[232:235], a[52:55]
v_exp_f32_e64 v142, v142
v_mfma_f32_16x16x32_bf16 a[52:55], a[236:239], v[188:191], a[52:55]
buffer_load_dwordx4 v243, s[8:11], s56 offen nt lds
v_mfma_f32_16x16x32_bf16 a[20:23], a[236:239], v[184:187], a[20:23]
v_cvt_pk_bf16_f32 v166, v140, v141
v_cvt_pk_bf16_f32 v200, v200, v201
v_mfma_f32_16x16x32_bf16 a[20:23], a[232:235], v[228:231], a[20:23]
ds_read_b64_tr_b16 a[228:229], v241 offset:41280
ds_read_b64_tr_b16 a[230:231], v241 offset:45408
v_mfma_f32_16x16x32_bf16 a[24:27], a[240:243], v[228:231], a[24:27]
s_add_u32 m0, s31, 0xa280
v_exp_f32_e64 v143, v143
v_mfma_f32_16x16x32_bf16 a[24:27], a[244:247], v[184:187], a[24:27]
ds_read_b64_tr_b16 a[232:233], v241 offset:33032
ds_read_b64_tr_b16 a[234:235], v241 offset:37160
v_mfma_f32_16x16x32_bf16 a[56:59], a[244:247], v[188:191], a[56:59]
v_exp_f32_e64 v136, v136
v_mfma_f32_16x16x32_bf16 a[56:59], a[240:243], v[232:235], a[56:59]
buffer_load_dwordx4 v243, s[12:15], s38 offen offset:1024 nt lds
v_mfma_f32_16x16x32_bf16 a[60:63], a[248:251], v[232:235], a[60:63]
s_xor_b32 s38, s29, 0x808000
v_cvt_pk_bf16_f32 v167, v142, v143
v_cvt_pk_bf16_f32 v201, v202, v203
v_mfma_f32_16x16x32_bf16 a[60:63], a[252:255], v[188:191], a[60:63]
s_xor_b32 s39, s29, 0x804000
ds_read_b64_tr_b16 a[236:237], v241 offset:41288
ds_read_b64_tr_b16 a[238:239], v241 offset:45416
v_mfma_f32_16x16x32_bf16 a[28:31], a[252:255], v[184:187], a[28:31]
v_exp_f32_e64 v137, v137
v_mfma_f32_16x16x32_bf16 a[28:31], a[248:251], v[228:231], a[28:31]
ds_read_b64_tr_b16 a[240:241], v241 offset:33280
ds_read_b64_tr_b16 a[242:243], v241 offset:37408
v_accvgpr_write_b32 a104, v200
v_mfma_f32_16x16x32_bf16 v[208:211], v[236:239], v[208:211], 0
ds_read_b64_tr_b16 a[244:245], v241 offset:41536
v_accvgpr_write_b32 a105, v201
v_mfma_f32_16x16x32_bf16 v[212:215], v[236:239], v[212:215], 0
ds_read_b64_tr_b16 a[246:247], v241 offset:45664
v_cvt_pk_bf16_f32 v204, v204, v205
v_mfma_f32_16x16x32_bf16 v[144:147], a[192:195], v[96:99], -4.0
v_exp_f32_e64 v138, v138
v_mfma_f32_16x16x32_bf16 v[144:147], a[196:199], v[100:103], v[144:147]
v_cvt_pk_bf16_f32 v164, v136, v137
v_cvt_pk_bf16_f32 v205, v206, v207
v_mfma_f32_16x16x32_bf16 v[144:147], a[200:203], v[104:107], v[144:147]
v_exp_f32_e64 v139, v139
v_mfma_f32_16x16x32_bf16 v[144:147], a[204:207], v[108:111], v[144:147]
ds_read_b64_tr_b16 a[248:249], v241 offset:33288
v_cvt_pk_bf16_f32 v165, v138, v139
v_mfma_f32_16x16x32_bf16 v[148:151], a[220:223], v[108:111], -4.0
s_add_u32 m0, s31, 0xc300
v_accvgpr_write_b32 a106, v204
v_accvgpr_write_b32 a107, v205
v_mfma_f32_16x16x32_bf16 v[148:151], a[216:219], v[104:107], v[148:151]
v_cvt_pk_bf16_f32 v208, v208, v209
v_cvt_pk_bf16_f32 v209, v210, v211
v_mfma_f32_16x16x32_bf16 v[148:151], a[212:215], v[100:103], v[148:151]
v_exp_f32_e64 v144, v144
v_mfma_f32_16x16x32_bf16 v[148:151], a[208:211], v[96:99], v[148:151]
buffer_load_dwordx4 v243, s[12:15], s38 offen nt lds
v_mfma_f32_16x16x32_bf16 v[156:159], a[208:211], v[112:115], -4.0
v_exp_f32 v145, v145
v_mfma_f32_16x16x32_bf16 v[156:159], a[212:215], v[116:119], v[156:159]
v_exp_f32_e64 v146, v146
v_mfma_f32_16x16x32_bf16 v[156:159], a[216:219], v[120:123], v[156:159]
s_add_u32 m0, s33, 0x0
v_cvt_pk_bf16_f32 v176, v144, v145
v_accvgpr_write_b32 a108, v208
v_mfma_f32_16x16x32_bf16 v[156:159], a[220:223], v[124:127], v[156:159]
ds_read_b64_tr_b16 a[250:251], v241 offset:37416
ds_read_b64_tr_b16 a[252:253], v241 offset:41544
v_mfma_f32_16x16x32_bf16 v[152:155], a[204:207], v[124:127], -4.0
v_exp_f32 v147, v147
v_mfma_f32_16x16x32_bf16 v[152:155], a[200:203], v[120:123], v[152:155]
v_exp_f32 v148, v148
v_mfma_f32_16x16x32_bf16 v[152:155], a[196:199], v[116:119], v[152:155]
v_cvt_pk_bf16_f32 v177, v146, v147
v_accvgpr_write_b32 a109, v209
v_mfma_f32_16x16x32_bf16 v[152:155], a[192:195], v[112:115], v[152:155]
buffer_load_dwordx4 v243, s[8:11], s56 offen offset:1024 nt lds
v_smfmac_f32_16x16x64_bf16 v[216:219], v[224:227], v[168:175], v248
s_waitcnt lgkmcnt(2)
ds_read_b64_tr_b16 a[254:255], v241 offset:45672
v_mfma_f32_16x16x32_bf16 v[0:3], a[224:227], v[168:171], v[0:3]
s_add_u32 m0, s31, 0xc300
v_exp_f32 v149, v149
v_mfma_f32_16x16x32_bf16 v[0:3], a[228:231], v[160:163], v[0:3]
ds_read_b128 a[208:211], v240 offset:4160
ds_read_b128 a[212:215], v240 offset:4416
v_mfma_f32_16x16x32_bf16 v[32:35], a[228:231], v[164:167], v[32:35]
v_exp_f32_e64 v150, v150
v_mfma_f32_16x16x32_bf16 v[32:35], a[224:227], v[172:175], v[32:35]
ds_read_b128 a[216:219], v240 offset:4672
ds_read_b128 a[220:223], v240 offset:4928
v_mfma_f32_16x16x32_bf16 v[36:39], a[232:235], v[172:175], v[36:39]
v_cvt_pk_bf16_f32 v178, v148, v149
v_cvt_pk_bf16_f32 v212, v212, v213
v_mfma_f32_16x16x32_bf16 v[36:39], a[236:239], v[164:167], v[36:39]
ds_read_b128 a[204:207], v240 offset:768
ds_read_b128 a[200:203], v240 offset:512
v_mfma_f32_16x16x32_bf16 v[4:7], a[236:239], v[160:163], v[4:7]
v_exp_f32_e64 v151, v151
v_mfma_f32_16x16x32_bf16 v[4:7], a[232:235], v[168:171], v[4:7]
ds_read_b128 a[196:199], v240 offset:256
v_cvt_pk_bf16_f32 v213, v214, v215
v_mfma_f32_16x16x32_bf16 v[8:11], a[240:243], v[168:171], v[8:11]
ds_read_b128 a[192:195], v240
v_accvgpr_write_b32 a110, v212
v_mfma_f32_16x16x32_bf16 v[8:11], a[244:247], v[160:163], v[8:11]
buffer_load_dwordx4 v243, s[12:15], s38 offen offset:1024 nt lds
v_mfma_f32_16x16x32_bf16 v[40:43], a[244:247], v[164:167], v[40:43]
v_exp_f32 v156, v156
v_mfma_f32_16x16x32_bf16 v[40:43], a[240:243], v[172:175], v[40:43]
s_waitcnt lgkmcnt(4)
v_cvt_pk_bf16_f32 v179, v150, v151
v_accvgpr_write_b32 a111, v213
v_mfma_f32_16x16x32_bf16 v[44:47], a[248:251], v[172:175], v[44:47]
v_exp_f32 v157, v157
v_mfma_f32_16x16x32_bf16 v[44:47], a[252:255], v[164:167], v[44:47]
v_exp_f32 v158, v158
v_mfma_f32_16x16x32_bf16 v[12:15], a[252:255], v[160:163], v[12:15]
v_exp_f32 v159, v159
v_mfma_f32_16x16x32_bf16 v[12:15], a[248:251], v[168:171], v[12:15]
s_waitcnt lgkmcnt(0)
v_exp_f32 v152, v152
v_mfma_f32_16x16x32_bf16 v[128:131], a[192:195], v[64:67], -4.0
v_cvt_pk_bf16_f32 v182, v156, v157
v_cvt_pk_bf16_f32 v183, v158, v159
v_mfma_f32_16x16x32_bf16 v[128:131], a[196:199], v[68:71], v[128:131]
v_exp_f32 v153, v153
v_mfma_f32_16x16x32_bf16 v[128:131], a[200:203], v[72:75], v[128:131]
s_add_u32 m0, s32, 0x4080
v_exp_f32 v154, v154
v_mfma_f32_16x16x32_bf16 v[128:131], a[204:207], v[76:79], v[128:131]
buffer_load_dwordx4 v243, s[16:19], s39 offen nt lds
v_mfma_f32_16x16x32_bf16 v[132:135], a[220:223], v[76:79], -4.0
s_add_u32 m0, s33, 0x20
v_exp_f32_e64 v155, v155
v_mfma_f32_16x16x32_bf16 v[132:135], a[216:219], v[72:75], v[132:135]
v_cvt_pk_bf16_f32 v180, v152, v153
v_cvt_pk_bf16_f32 v181, v154, v155
v_mfma_f32_16x16x32_bf16 v[132:135], a[212:215], v[68:71], v[132:135]
v_exp_f32 v128, v128
v_mfma_f32_16x16x32_bf16 v[132:135], a[208:211], v[64:67], v[132:135]
v_exp_f32 v129, v129
v_mfma_f32_16x16x32_bf16 v[140:143], a[208:211], v[80:83], -4.0
v_exp_f32 v130, v130
v_mfma_f32_16x16x32_bf16 v[140:143], a[212:215], v[84:87], v[140:143]
v_exp_f32 v131, v131
v_mfma_f32_16x16x32_bf16 v[140:143], a[216:219], v[88:91], v[140:143]
v_cvt_pk_bf16_f32 v184, v128, v129
v_mfma_f32_16x16x32_bf16 v[140:143], a[220:223], v[92:95], v[140:143]
buffer_load_dwordx4 v243, s[8:11], s56 offen offset:2048 nt lds
v_mfma_f32_16x16x32_bf16 v[136:139], a[204:207], v[92:95], -4.0
s_add_u32 m0, s32, 0x4080
v_exp_f32 v132, v132
v_mfma_f32_16x16x32_bf16 v[136:139], a[200:203], v[88:91], v[136:139]
v_exp_f32 v133, v133
v_mfma_f32_16x16x32_bf16 v[136:139], a[196:199], v[84:87], v[136:139]
v_exp_f32 v134, v134
v_mfma_f32_16x16x32_bf16 v[136:139], a[192:195], v[80:83], v[136:139]
v_cvt_pk_bf16_f32 v185, v130, v131
v_cvt_pk_bf16_f32 v186, v132, v133
v_smfmac_f32_16x16x64_bf16 v[220:223], v[224:227], v[192:199], v248
buffer_load_dwordx4 v243, s[24:27], s39 offen offset:1032 nt lds
v_mfma_f32_16x16x32_bf16 a[0:3], a[224:227], v[192:195], a[0:3]
s_xor_b32 s39, s29, 0x806000
v_exp_f32 v135, v135
v_mfma_f32_16x16x32_bf16 a[0:3], a[228:231], v[176:179], a[0:3]
s_xor_b32 s38, s29, 0x80a000
v_exp_f32 v140, v140
v_mfma_f32_16x16x32_bf16 a[32:35], a[228:231], v[180:183], a[32:35]
v_exp_f32 v141, v141
v_mfma_f32_16x16x32_bf16 a[32:35], a[224:227], v[196:199], a[32:35]
ds_read_b64_tr_b16 a[224:225], v241 offset:33536
ds_read_b64_tr_b16 a[226:227], v241 offset:37664
v_mfma_f32_16x16x32_bf16 a[36:39], a[232:235], v[196:199], a[36:39]
v_exp_f32 v142, v142
v_mfma_f32_16x16x32_bf16 a[36:39], a[236:239], v[180:183], a[36:39]
ds_read_b64_tr_b16 a[228:229], v241 offset:41792
ds_read_b64_tr_b16 a[230:231], v241 offset:45920
v_mfma_f32_16x16x32_bf16 a[4:7], a[236:239], v[176:179], a[4:7]
v_cvt_pk_bf16_f32 v187, v134, v135
v_cvt_pk_bf16_f32 v190, v140, v141
v_mfma_f32_16x16x32_bf16 a[4:7], a[232:235], v[192:195], a[4:7]
s_waitcnt vmcnt(16)
ds_read_b64_tr_b16 a[232:233], v241 offset:33544
ds_read_b64_tr_b16 a[234:235], v241 offset:37672
v_mfma_f32_16x16x32_bf16 a[8:11], a[240:243], v[192:195], a[8:11]
s_add_u32 m0, s32, 0x60c0
v_exp_f32 v143, v143
v_mfma_f32_16x16x32_bf16 a[8:11], a[244:247], v[176:179], a[8:11]
buffer_load_dwordx4 v243, s[16:19], s39 offen nt lds
v_mfma_f32_16x16x32_bf16 a[40:43], a[244:247], v[180:183], a[40:43]
v_exp_f32 v136, v136
v_mfma_f32_16x16x32_bf16 a[40:43], a[240:243], v[196:199], a[40:43]
ds_read_b64_tr_b16 a[236:237], v241 offset:41800
ds_read_b64_tr_b16 a[238:239], v241 offset:45928
v_mfma_f32_16x16x32_bf16 a[44:47], a[248:251], v[196:199], a[44:47]
v_exp_f32_e64 v137, v137
v_mfma_f32_16x16x32_bf16 a[44:47], a[252:255], v[180:183], a[44:47]
ds_read_b64_tr_b16 a[240:241], v241 offset:33792
ds_read_b64_tr_b16 a[242:243], v241 offset:37920
v_mfma_f32_16x16x32_bf16 a[12:15], a[252:255], v[176:179], a[12:15]
v_exp_f32 v138, v138
v_mfma_f32_16x16x32_bf16 a[12:15], a[248:251], v[192:195], a[12:15]
s_add_u32 m0, s33, 0x20
ds_read_b64_tr_b16 a[244:245], v241 offset:42048
ds_read_b128 v[202:205], v242 offset:4160
v_mfma_f32_16x16x32_bf16 v[144:147], a[192:195], v[96:99], -4.0
v_cvt_pk_bf16_f32 v191, v142, v143
v_cvt_pk_bf16_f32 v188, v136, v137
v_mfma_f32_16x16x32_bf16 v[144:147], a[196:199], v[100:103], v[144:147]
v_exp_f32_e64 v139, v139
v_mfma_f32_16x16x32_bf16 v[144:147], a[200:203], v[104:107], v[144:147]
v_cvt_pk_bf16_f32 v189, v138, v139
v_mfma_f32_16x16x32_bf16 v[144:147], a[204:207], v[108:111], v[144:147]
buffer_load_dwordx4 v243, s[8:11], s56 offen offset:3072 nt lds
v_mfma_f32_16x16x32_bf16 v[148:151], a[220:223], v[108:111], -4.0
s_add_u32 m0, s32, 0x60c0
ds_read_b64_tr_b16 a[246:247], v241 offset:46176
ds_read_b128 v[210:213], v242 offset:4416
v_mfma_f32_16x16x32_bf16 v[148:151], a[216:219], v[104:107], v[148:151]
s_xor_b32 s56, s28, 0x2001000
ds_read_b64_tr_b16 a[248:249], v241 offset:33800
ds_read_b64_tr_b16 a[250:251], v241 offset:37928
v_mfma_f32_16x16x32_bf16 v[148:151], a[212:215], v[100:103], v[148:151]
s_waitcnt lgkmcnt(4)
v_mov_b64 v[200:201], v[202:203]
v_mov_b64 v[206:207], v[204:205]
v_mfma_f32_16x16x32_bf16 v[148:151], a[208:211], v[96:99], v[148:151]
ds_read_b64_tr_b16 a[252:253], v241 offset:42056
ds_read_b64_tr_b16 a[254:255], v241 offset:46184
v_mfma_f32_16x16x32_bf16 v[156:159], a[208:211], v[112:115], -4.0
v_exp_f32 v144, v144
v_mfma_f32_16x16x32_bf16 v[156:159], a[212:215], v[116:119], v[156:159]
v_exp_f32 v145, v145
v_mfma_f32_16x16x32_bf16 v[156:159], a[216:219], v[120:123], v[156:159]
v_exp_f32 v146, v146
v_mfma_f32_16x16x32_bf16 v[156:159], a[220:223], v[124:127], v[156:159]
s_waitcnt lgkmcnt(4)
buffer_load_dwordx4 v243, s[24:27], s39 offen offset:1032 nt lds
v_mfma_f32_16x16x32_bf16 v[152:155], a[204:207], v[124:127], -4.0
v_cvt_pk_bf16_f32 v228, v144, v145
v_mov_b64 v[208:209], v[210:211]
v_mfma_f32_16x16x32_bf16 v[152:155], a[200:203], v[120:123], v[152:155]
v_mov_b64 v[214:215], v[212:213]
v_mfma_f32_16x16x32_bf16 v[152:155], a[196:199], v[116:119], v[152:155]
v_exp_f32 v147, v147
v_mfma_f32_16x16x32_bf16 v[152:155], a[192:195], v[112:115], v[152:155]
ds_read_b128 a[208:211], v240 offset:12480
ds_read_b128 a[212:215], v240 offset:12736
v_mfma_f32_16x16x32_bf16 v[200:203], v[236:239], v[200:203], 0
ds_read_b128 a[216:219], v240 offset:12992
ds_read_b128 a[220:223], v240 offset:13248
v_mfma_f32_16x16x32_bf16 v[204:207], v[236:239], v[204:207], 0
ds_read_b128 a[204:207], v240 offset:9088
ds_read_b128 a[200:203], v240 offset:8832
v_smfmac_f32_16x16x64_bf16 v[216:219], v[224:227], v[160:167], v248
ds_read_b128 a[196:199], v240 offset:8576
v_mfma_f32_16x16x32_bf16 v[208:211], v[236:239], v[208:211], 0
ds_read_b128 a[192:195], v240 offset:8320
v_cvt_pk_bf16_f32 v200, v200, v201
v_cvt_pk_bf16_f32 v201, v202, v203
v_mfma_f32_16x16x32_bf16 v[212:215], v[236:239], v[212:215], 0
v_accvgpr_write_b32 a112, v200
v_accvgpr_write_b32 a113, v201
v_cvt_pk_bf16_f32 v204, v204, v205
v_mfma_f32_16x16x32_bf16 v[16:19], a[224:227], v[168:171], v[16:19]
v_cvt_pk_bf16_f32 v205, v206, v207
v_accvgpr_write_b32 a114, v204
v_mfma_f32_16x16x32_bf16 v[16:19], a[228:231], v[160:163], v[16:19]
v_accvgpr_write_b32 a115, v205
v_cvt_pk_bf16_f32 v208, v208, v209
v_cvt_pk_bf16_f32 v209, v210, v211
v_mfma_f32_16x16x32_bf16 v[48:51], a[228:231], v[164:167], v[48:51]
v_accvgpr_write_b32 a116, v208
v_accvgpr_write_b32 a117, v209
v_mfma_f32_16x16x32_bf16 v[48:51], a[224:227], v[172:175], v[48:51]
ds_read_b128 v[202:205], v242 offset:4672
v_cvt_pk_bf16_f32 v212, v212, v213
v_mfma_f32_16x16x32_bf16 v[52:55], a[232:235], v[172:175], v[52:55]
v_exp_f32 v148, v148
v_mfma_f32_16x16x32_bf16 v[52:55], a[236:239], v[164:167], v[52:55]
v_cvt_pk_bf16_f32 v229, v146, v147
v_cvt_pk_bf16_f32 v213, v214, v215
v_mfma_f32_16x16x32_bf16 v[20:23], a[236:239], v[160:163], v[20:23]
v_exp_f32 v149, v149
v_mfma_f32_16x16x32_bf16 v[20:23], a[232:235], v[168:171], v[20:23]
v_exp_f32_e64 v150, v150
v_mfma_f32_16x16x32_bf16 v[24:27], a[240:243], v[168:171], v[24:27]
v_cvt_pk_bf16_f32 v230, v148, v149
v_accvgpr_write_b32 a118, v212
v_mfma_f32_16x16x32_bf16 v[24:27], a[244:247], v[160:163], v[24:27]
v_exp_f32 v151, v151
v_mfma_f32_16x16x32_bf16 v[56:59], a[244:247], v[164:167], v[56:59]
s_waitcnt lgkmcnt(0)
v_exp_f32_e64 v156, v156
v_mfma_f32_16x16x32_bf16 v[56:59], a[240:243], v[172:175], v[56:59]
v_cvt_pk_bf16_f32 v231, v150, v151
v_mov_b64 v[200:201], v[202:203]
v_mfma_f32_16x16x32_bf16 v[60:63], a[248:251], v[172:175], v[60:63]
v_exp_f32 v157, v157
v_mfma_f32_16x16x32_bf16 v[60:63], a[252:255], v[164:167], v[60:63]
v_exp_f32 v158, v158
v_mfma_f32_16x16x32_bf16 v[28:31], a[252:255], v[160:163], v[28:31]
v_cvt_pk_bf16_f32 v234, v156, v157
v_mov_b64 v[206:207], v[204:205]
v_mfma_f32_16x16x32_bf16 v[28:31], a[248:251], v[168:171], v[28:31]
v_exp_f32 v159, v159
v_mfma_f32_16x16x32_bf16 v[200:203], v[236:239], v[200:203], 0
v_exp_f32 v152, v152
v_mfma_f32_16x16x32_bf16 v[204:207], v[236:239], v[204:207], 0
v_cvt_pk_bf16_f32 v235, v158, v159
v_accvgpr_write_b32 a119, v213
v_mfma_f32_16x16x32_bf16 v[128:131], a[192:195], v[64:67], -4.0
v_exp_f32 v153, v153
v_mfma_f32_16x16x32_bf16 v[128:131], a[196:199], v[68:71], v[128:131]
v_exp_f32 v154, v154
v_mfma_f32_16x16x32_bf16 v[128:131], a[200:203], v[72:75], v[128:131]
v_cvt_pk_bf16_f32 v232, v152, v153
v_cvt_pk_bf16_f32 v200, v200, v201
v_mfma_f32_16x16x32_bf16 v[128:131], a[204:207], v[76:79], v[128:131]
ds_read_b128 v[210:213], v242 offset:4928
v_cvt_pk_bf16_f32 v201, v202, v203
v_mfma_f32_16x16x32_bf16 v[132:135], a[220:223], v[76:79], -4.0
v_exp_f32_e64 v155, v155
v_mfma_f32_16x16x32_bf16 v[132:135], a[216:219], v[72:75], v[132:135]
v_cvt_pk_bf16_f32 v233, v154, v155
v_accvgpr_write_b32 a120, v200
v_mfma_f32_16x16x32_bf16 v[132:135], a[212:215], v[68:71], v[132:135]
v_exp_f32 v128, v128
v_mfma_f32_16x16x32_bf16 v[132:135], a[208:211], v[64:67], v[132:135]
v_exp_f32 v129, v129
v_mfma_f32_16x16x32_bf16 v[140:143], a[208:211], v[80:83], -4.0
v_exp_f32_e64 v130, v130
v_mfma_f32_16x16x32_bf16 v[140:143], a[212:215], v[84:87], v[140:143]
v_cvt_pk_bf16_f32 v160, v128, v129
v_accvgpr_write_b32 a121, v201
v_mfma_f32_16x16x32_bf16 v[140:143], a[216:219], v[88:91], v[140:143]
s_waitcnt lgkmcnt(0)
v_exp_f32 v131, v131
v_mfma_f32_16x16x32_bf16 v[140:143], a[220:223], v[92:95], v[140:143]
s_add_u32 m0, s31, 0x0
v_exp_f32 v132, v132
v_mfma_f32_16x16x32_bf16 v[136:139], a[204:207], v[92:95], -4.0
v_cvt_pk_bf16_f32 v161, v130, v131
v_mov_b64 v[208:209], v[210:211]
v_mfma_f32_16x16x32_bf16 v[136:139], a[200:203], v[88:91], v[136:139]
v_exp_f32 v133, v133
v_mfma_f32_16x16x32_bf16 v[136:139], a[196:199], v[84:87], v[136:139]
s_waitcnt vmcnt(18)
v_exp_f32_e64 v134, v134
v_mfma_f32_16x16x32_bf16 v[136:139], a[192:195], v[80:83], v[136:139]
s_barrier
v_smfmac_f32_16x16x64_bf16 v[220:223], v[224:227], v[176:183], v248
buffer_load_dwordx4 v243, s[12:15], s38 offen nt lds
v_mfma_f32_16x16x32_bf16 a[16:19], a[224:227], v[192:195], a[16:19]
s_add_u32 m0, s33, 0x1040
v_cvt_pk_bf16_f32 v162, v132, v133
v_mov_b64 v[214:215], v[212:213]
v_mfma_f32_16x16x32_bf16 a[16:19], a[228:231], v[176:179], a[16:19]
v_exp_f32 v135, v135
v_mfma_f32_16x16x32_bf16 a[48:51], a[228:231], v[180:183], a[48:51]
v_exp_f32_e64 v140, v140
v_mfma_f32_16x16x32_bf16 a[48:51], a[224:227], v[196:199], a[48:51]
ds_read_b64_tr_b16 a[224:225], v241 offset:49536
ds_read_b64_tr_b16 a[226:227], v241 offset:53664
v_mfma_f32_16x16x32_bf16 a[52:55], a[232:235], v[196:199], a[52:55]
v_cvt_pk_bf16_f32 v163, v134, v135
v_cvt_pk_bf16_f32 v204, v204, v205
v_mfma_f32_16x16x32_bf16 a[52:55], a[236:239], v[180:183], a[52:55]
buffer_load_dwordx4 v243, s[8:11], s56 offen nt lds
v_mfma_f32_16x16x32_bf16 a[20:23], a[236:239], v[176:179], a[20:23]
v_exp_f32 v141, v141
v_mfma_f32_16x16x32_bf16 a[20:23], a[232:235], v[192:195], a[20:23]
ds_read_b64_tr_b16 a[228:229], v241 offset:57792
ds_read_b64_tr_b16 a[230:231], v241 offset:61920
v_mfma_f32_16x16x32_bf16 a[24:27], a[240:243], v[192:195], a[24:27]
s_add_u32 m0, s31, 0x0
v_exp_f32_e64 v142, v142
v_mfma_f32_16x16x32_bf16 a[24:27], a[244:247], v[176:179], a[24:27]
ds_read_b64_tr_b16 a[232:233], v241 offset:49544
ds_read_b64_tr_b16 a[234:235], v241 offset:53672
v_mfma_f32_16x16x32_bf16 a[56:59], a[244:247], v[180:183], a[56:59]
v_cvt_pk_bf16_f32 v166, v140, v141
v_cvt_pk_bf16_f32 v205, v206, v207
v_mfma_f32_16x16x32_bf16 a[56:59], a[240:243], v[196:199], a[56:59]
buffer_load_dwordx4 v243, s[12:15], s38 offen offset:1024 nt lds
v_mfma_f32_16x16x32_bf16 a[60:63], a[248:251], v[196:199], a[60:63]
L_pad4:
s_cbranch_vccnz L_pad8
s_xor_b32 s38, s29, 0x80c000
v_accvgpr_write_b32 a122, v204
v_accvgpr_write_b32 a123, v205
v_mfma_f32_16x16x32_bf16 a[60:63], a[252:255], v[180:183], a[60:63]
s_xor_b32 s39, s29, 0x808000
ds_read_b64_tr_b16 a[236:237], v241 offset:57800
ds_read_b64_tr_b16 a[238:239], v241 offset:61928
v_mfma_f32_16x16x32_bf16 a[28:31], a[252:255], v[176:179], a[28:31]
v_exp_f32 v143, v143
v_mfma_f32_16x16x32_bf16 a[28:31], a[248:251], v[192:195], a[28:31]
ds_read_b64_tr_b16 a[240:241], v241 offset:49792
ds_read_b64_tr_b16 a[242:243], v241 offset:53920
v_mfma_f32_16x16x32_bf16 v[208:211], v[236:239], v[208:211], 0
ds_read_b64_tr_b16 a[244:245], v241 offset:58048
ds_read_b64_tr_b16 a[246:247], v241 offset:62176
v_mfma_f32_16x16x32_bf16 v[212:215], v[236:239], v[212:215], 0
ds_read_b64_tr_b16 a[248:249], v241 offset:49800
ds_read_b64_tr_b16 a[250:251], v241 offset:53928
v_mfma_f32_16x16x32_bf16 v[144:147], a[192:195], v[96:99], -4.0
v_exp_f32 v136, v136
v_mfma_f32_16x16x32_bf16 v[144:147], a[196:199], v[100:103], v[144:147]
v_cvt_pk_bf16_f32 v167, v142, v143
v_cvt_pk_bf16_f32 v208, v208, v209
v_mfma_f32_16x16x32_bf16 v[144:147], a[200:203], v[104:107], v[144:147]
v_exp_f32 v137, v137
v_mfma_f32_16x16x32_bf16 v[144:147], a[204:207], v[108:111], v[144:147]
ds_read_b64_tr_b16 a[252:253], v241 offset:58056
v_cvt_pk_bf16_f32 v209, v210, v211
v_mfma_f32_16x16x32_bf16 v[148:151], a[220:223], v[108:111], -4.0
s_add_u32 m0, s31, 0x2080
v_exp_f32_e64 v138, v138
v_mfma_f32_16x16x32_bf16 v[148:151], a[216:219], v[104:107], v[148:151]
v_cvt_pk_bf16_f32 v164, v136, v137
v_accvgpr_write_b32 a124, v208
v_mfma_f32_16x16x32_bf16 v[148:151], a[212:215], v[100:103], v[148:151]
v_exp_f32_e64 v139, v139
v_mfma_f32_16x16x32_bf16 v[148:151], a[208:211], v[96:99], v[148:151]
buffer_load_dwordx4 v243, s[12:15], s38 offen nt lds
v_mfma_f32_16x16x32_bf16 v[156:159], a[208:211], v[112:115], -4.0
v_cvt_pk_bf16_f32 v165, v138, v139
v_accvgpr_write_b32 a125, v209
v_mfma_f32_16x16x32_bf16 v[156:159], a[212:215], v[116:119], v[156:159]
v_exp_f32 v144, v144
v_mfma_f32_16x16x32_bf16 v[156:159], a[216:219], v[120:123], v[156:159]
v_exp_f32 v145, v145
v_mfma_f32_16x16x32_bf16 v[156:159], a[220:223], v[124:127], v[156:159]
ds_read_b64_tr_b16 a[254:255], v241 offset:62184
ds_read_b128 a[208:211], v240 offset:20800
v_mfma_f32_16x16x32_bf16 v[152:155], a[204:207], v[124:127], -4.0
v_exp_f32_e64 v146, v146
v_mfma_f32_16x16x32_bf16 v[152:155], a[200:203], v[120:123], v[152:155]
v_cvt_pk_bf16_f32 v168, v144, v145
v_cvt_pk_bf16_f32 v212, v212, v213
v_mfma_f32_16x16x32_bf16 v[152:155], a[196:199], v[116:119], v[152:155]
v_exp_f32_e64 v147, v147
v_mfma_f32_16x16x32_bf16 v[152:155], a[192:195], v[112:115], v[152:155]
ds_read_b128 a[212:215], v240 offset:21056
ds_read_b128 a[216:219], v240 offset:21312
v_smfmac_f32_16x16x64_bf16 v[216:219], v[224:227], v[184:191], v248
s_waitcnt lgkmcnt(4)
ds_read_b128 a[220:223], v240 offset:21568
v_mfma_f32_16x16x32_bf16 v[0:3], a[224:227], v[184:187], v[0:3]
s_add_u32 m0, s31, 0x2080
v_exp_f32 v148, v148
v_mfma_f32_16x16x32_bf16 v[0:3], a[228:231], v[160:163], v[0:3]
buffer_load_dwordx4 v243, s[12:15], s38 offen offset:1024 nt lds
v_mfma_f32_16x16x32_bf16 v[32:35], a[228:231], v[164:167], v[32:35]
v_cvt_pk_bf16_f32 v169, v146, v147
v_cvt_pk_bf16_f32 v213, v214, v215
v_mfma_f32_16x16x32_bf16 v[32:35], a[224:227], v[188:191], v[32:35]
ds_read_b128 a[204:207], v240 offset:17408
v_accvgpr_write_b32 a126, v212
v_mfma_f32_16x16x32_bf16 v[36:39], a[232:235], v[188:191], v[36:39]
v_exp_f32_e64 v149, v149
v_mfma_f32_16x16x32_bf16 v[36:39], a[236:239], v[164:167], v[36:39]
ds_read_b128 a[200:203], v240 offset:17152
v_accvgpr_write_b32 a127, v213
v_mfma_f32_16x16x32_bf16 v[4:7], a[236:239], v[160:163], v[4:7]
v_exp_f32_e64 v150, v150
v_mfma_f32_16x16x32_bf16 v[4:7], a[232:235], v[184:187], v[4:7]
ds_read_b128 a[196:199], v240 offset:16896
v_cvt_pk_bf16_f32 v170, v148, v149
v_mfma_f32_16x16x32_bf16 v[8:11], a[240:243], v[184:187], v[8:11]
ds_read_b128 a[192:195], v240 offset:16640
v_mfma_f32_16x16x32_bf16 v[8:11], a[244:247], v[160:163], v[8:11]
v_exp_f32 v151, v151
v_mfma_f32_16x16x32_bf16 v[40:43], a[244:247], v[164:167], v[40:43]
s_add_u32 m0, s32, 0x8100
v_exp_f32 v156, v156
v_mfma_f32_16x16x32_bf16 v[40:43], a[240:243], v[188:191], v[40:43]
buffer_load_dwordx4 v243, s[16:19], s39 offen nt lds
v_mfma_f32_16x16x32_bf16 v[44:47], a[248:251], v[188:191], v[44:47]
s_waitcnt lgkmcnt(2)
v_exp_f32 v157, v157
v_mfma_f32_16x16x32_bf16 v[44:47], a[252:255], v[164:167], v[44:47]
v_exp_f32 v158, v158
v_mfma_f32_16x16x32_bf16 v[12:15], a[252:255], v[160:163], v[12:15]
v_cvt_pk_bf16_f32 v171, v150, v151
v_cvt_pk_bf16_f32 v174, v156, v157
v_mfma_f32_16x16x32_bf16 v[12:15], a[248:251], v[184:187], v[12:15]
s_waitcnt lgkmcnt(0)
v_exp_f32_e64 v159, v159
v_mfma_f32_16x16x32_bf16 v[128:131], a[192:195], a[64:67], -4.0
s_add_u32 m0, s33, 0x1040
v_exp_f32 v152, v152
v_mfma_f32_16x16x32_bf16 v[128:131], a[196:199], a[68:71], v[128:131]
v_exp_f32 v153, v153
v_mfma_f32_16x16x32_bf16 v[128:131], a[200:203], a[72:75], v[128:131]
v_exp_f32_e64 v154, v154
v_mfma_f32_16x16x32_bf16 v[128:131], a[204:207], a[76:79], v[128:131]
buffer_load_dwordx4 v243, s[8:11], s56 offen offset:1024 nt lds
v_mfma_f32_16x16x32_bf16 v[132:135], a[220:223], a[76:79], -4.0
s_add_u32 m0, s32, 0x8100
v_cvt_pk_bf16_f32 v175, v158, v159
v_cvt_pk_bf16_f32 v172, v152, v153
v_mfma_f32_16x16x32_bf16 v[132:135], a[216:219], a[72:75], v[132:135]
v_exp_f32 v155, v155
v_mfma_f32_16x16x32_bf16 v[132:135], a[212:215], a[68:71], v[132:135]
v_exp_f32 v128, v128
v_mfma_f32_16x16x32_bf16 v[132:135], a[208:211], a[64:67], v[132:135]
v_exp_f32 v129, v129
v_mfma_f32_16x16x32_bf16 v[140:143], a[208:211], a[80:83], -4.0
v_exp_f32 v130, v130
v_mfma_f32_16x16x32_bf16 v[140:143], a[212:215], a[84:87], v[140:143]
v_cvt_pk_bf16_f32 v173, v154, v155
v_cvt_pk_bf16_f32 v176, v128, v129
v_mfma_f32_16x16x32_bf16 v[140:143], a[216:219], a[88:91], v[140:143]
v_exp_f32_e64 v131, v131
v_mfma_f32_16x16x32_bf16 v[140:143], a[220:223], a[92:95], v[140:143]
buffer_load_dwordx4 v243, s[24:27], s39 offen offset:1032 nt lds
v_mfma_f32_16x16x32_bf16 v[136:139], a[204:207], a[92:95], -4.0
s_xor_b32 s39, s29, 0x80a000
v_exp_f32 v132, v132
v_mfma_f32_16x16x32_bf16 v[136:139], a[200:203], a[88:91], v[136:139]
s_xor_b32 s38, s29, 0x80e000
v_exp_f32 v133, v133
v_mfma_f32_16x16x32_bf16 v[136:139], a[196:199], a[84:87], v[136:139]
v_exp_f32_e64 v134, v134
v_mfma_f32_16x16x32_bf16 v[136:139], a[192:195], a[80:83], v[136:139]
v_cvt_pk_bf16_f32 v177, v130, v131
v_cvt_pk_bf16_f32 v178, v132, v133
v_smfmac_f32_16x16x64_bf16 v[220:223], v[224:227], v[228:235], v248
v_mfma_f32_16x16x32_bf16 a[0:3], a[224:227], v[228:231], a[0:3]
v_exp_f32 v135, v135
v_mfma_f32_16x16x32_bf16 a[0:3], a[228:231], v[168:171], a[0:3]
v_exp_f32 v140, v140
v_mfma_f32_16x16x32_bf16 a[32:35], a[228:231], v[172:175], a[32:35]
v_exp_f32 v141, v141
v_mfma_f32_16x16x32_bf16 a[32:35], a[224:227], v[232:235], a[32:35]
s_add_u32 m0, s32, 0xa140
ds_read_b64_tr_b16 a[224:225], v241 offset:50048
ds_read_b64_tr_b16 a[226:227], v241 offset:54176
v_mfma_f32_16x16x32_bf16 a[36:39], a[232:235], v[232:235], a[36:39]
v_exp_f32 v142, v142
v_mfma_f32_16x16x32_bf16 a[36:39], a[236:239], v[172:175], a[36:39]
buffer_load_dwordx4 v243, s[16:19], s39 offen nt lds
v_mfma_f32_16x16x32_bf16 a[4:7], a[236:239], v[168:171], a[4:7]
v_cvt_pk_bf16_f32 v179, v134, v135
v_cvt_pk_bf16_f32 v182, v140, v141
v_mfma_f32_16x16x32_bf16 a[4:7], a[232:235], v[228:231], a[4:7]
ds_read_b64_tr_b16 a[228:229], v241 offset:58304
ds_read_b64_tr_b16 a[230:231], v241 offset:62432
v_mfma_f32_16x16x32_bf16 a[8:11], a[240:243], v[228:231], a[8:11]
v_exp_f32_e64 v143, v143
v_mfma_f32_16x16x32_bf16 a[8:11], a[244:247], v[168:171], a[8:11]
ds_read_b64_tr_b16 a[232:233], v241 offset:50056
ds_read_b64_tr_b16 a[234:235], v241 offset:54184
v_mfma_f32_16x16x32_bf16 a[40:43], a[244:247], v[172:175], a[40:43]
v_exp_f32_e64 v136, v136
v_mfma_f32_16x16x32_bf16 a[40:43], a[240:243], v[232:235], a[40:43]
ds_read_b64_tr_b16 a[236:237], v241 offset:58312
ds_read_b64_tr_b16 a[238:239], v241 offset:62440
v_mfma_f32_16x16x32_bf16 a[44:47], a[248:251], v[232:235], a[44:47]
v_exp_f32 v137, v137
v_mfma_f32_16x16x32_bf16 a[44:47], a[252:255], v[172:175], a[44:47]
ds_read_b64_tr_b16 a[240:241], v241 offset:50304
ds_read_b64_tr_b16 a[242:243], v241 offset:54432
v_mfma_f32_16x16x32_bf16 a[12:15], a[252:255], v[168:171], a[12:15]
s_add_u32 m0, s32, 0xa140
v_exp_f32 v138, v138
v_mfma_f32_16x16x32_bf16 a[12:15], a[248:251], v[228:231], a[12:15]
buffer_load_dwordx4 v243, s[24:27], s39 offen offset:1032 nt lds
v_mfma_f32_16x16x32_bf16 v[144:147], a[192:195], a[96:99], -4.0
v_cvt_pk_bf16_f32 v183, v142, v143
v_cvt_pk_bf16_f32 v180, v136, v137
v_mfma_f32_16x16x32_bf16 v[144:147], a[196:199], a[100:103], v[144:147]
v_exp_f32_e64 v139, v139
v_mfma_f32_16x16x32_bf16 v[144:147], a[200:203], a[104:107], v[144:147]
v_cvt_pk_bf16_f32 v181, v138, v139
v_mfma_f32_16x16x32_bf16 v[144:147], a[204:207], a[108:111], v[144:147]
ds_read_b64_tr_b16 a[244:245], v241 offset:58560
ds_read_b64_tr_b16 a[246:247], v241 offset:62688
v_mfma_f32_16x16x32_bf16 v[148:151], a[220:223], a[108:111], -4.0
ds_read_b64_tr_b16 a[248:249], v241 offset:50312
ds_read_b64_tr_b16 a[250:251], v241 offset:54440
v_mfma_f32_16x16x32_bf16 v[148:151], a[216:219], a[104:107], v[148:151]
ds_read_b64_tr_b16 a[252:253], v241 offset:58568
ds_read_b64_tr_b16 a[254:255], v241 offset:62696
v_mfma_f32_16x16x32_bf16 v[148:151], a[212:215], a[100:103], v[148:151]
v_exp_f32 v144, v144
v_mfma_f32_16x16x32_bf16 v[148:151], a[208:211], a[96:99], v[148:151]
v_exp_f32 v145, v145
v_mfma_f32_16x16x32_bf16 v[156:159], a[208:211], a[112:115], -4.0
v_exp_f32 v146, v146
v_mfma_f32_16x16x32_bf16 v[156:159], a[212:215], a[116:119], v[156:159]
v_exp_f32 v147, v147
v_mfma_f32_16x16x32_bf16 v[156:159], a[216:219], a[120:123], v[156:159]
v_cvt_pk_bf16_f32 v192, v144, v145
v_mfma_f32_16x16x32_bf16 v[156:159], a[220:223], a[124:127], v[156:159]
ds_read_b128 a[208:211], v240 offset:29120
ds_read_b128 a[212:215], v240 offset:29376
v_mfma_f32_16x16x32_bf16 v[152:155], a[204:207], a[124:127], -4.0
v_exp_f32 v148, v148
v_mfma_f32_16x16x32_bf16 v[152:155], a[200:203], a[120:123], v[152:155]
s_add_u32 m0, s33, 0x1060
v_exp_f32 v149, v149
v_mfma_f32_16x16x32_bf16 v[152:155], a[196:199], a[116:119], v[152:155]
v_exp_f32 v150, v150
v_mfma_f32_16x16x32_bf16 v[152:155], a[192:195], a[112:115], v[152:155]
buffer_load_dwordx4 v243, s[8:11], s56 offen offset:2048 nt lds
v_smfmac_f32_16x16x64_bf16 v[216:219], v[224:227], v[160:167], v248
s_waitcnt lgkmcnt(2)
ds_read_b128 a[216:219], v240 offset:29632
v_mfma_f32_16x16x32_bf16 v[16:19], a[224:227], v[184:187], v[16:19]
v_cvt_pk_bf16_f32 v193, v146, v147
v_cvt_pk_bf16_f32 v194, v148, v149
v_mfma_f32_16x16x32_bf16 v[16:19], a[228:231], v[160:163], v[16:19]
ds_read_b128 a[220:223], v240 offset:29888
ds_read_b128 a[204:207], v240 offset:25728
v_mfma_f32_16x16x32_bf16 v[48:51], a[228:231], v[164:167], v[48:51]
v_add_f32 v250, v216, v217
v_add_f32 v251, v218, v219
v_mfma_f32_16x16x32_bf16 v[48:51], a[224:227], v[188:191], v[48:51]
ds_read_b128 a[200:203], v240 offset:25472
v_subrev_u32 v216, s36, v250
v_mfma_f32_16x16x32_bf16 v[52:55], a[232:235], v[188:191], v[52:55]
v_subrev_u32 v217, s36, v251
v_max_u32 v216, v216, v217
v_mfma_f32_16x16x32_bf16 v[52:55], a[236:239], v[164:167], v[52:55]
ds_read_b128 a[196:199], v240 offset:25216
ds_read_b128 a[192:195], v240 offset:24960
v_mfma_f32_16x16x32_bf16 v[20:23], a[236:239], v[160:163], v[20:23]
v_rcp_f32 v250, v250
v_mfma_f32_16x16x32_bf16 v[20:23], a[232:235], v[184:187], v[20:23]
v_rcp_f32 v251, v251
v_mfma_f32_16x16x32_bf16 v[24:27], a[240:243], v[184:187], v[24:27]
v_cmp_le_u32 s[40:41], s37, v216
v_mov_b64 v[216:217], 0
v_mfma_f32_16x16x32_bf16 v[24:27], a[244:247], v[160:163], v[24:27]
v_mov_b64 v[218:219], 0
v_mfma_f32_16x16x32_bf16 v[56:59], a[244:247], v[164:167], v[56:59]
v_exp_f32 v151, v151
v_mfma_f32_16x16x32_bf16 v[56:59], a[240:243], v[188:191], v[56:59]
v_exp_f32_e64 v156, v156
v_mfma_f32_16x16x32_bf16 v[60:63], a[248:251], v[188:191], v[60:63]
v_exp_f32 v157, v157
v_mfma_f32_16x16x32_bf16 v[60:63], a[252:255], v[164:167], v[60:63]
v_exp_f32 v158, v158
v_mfma_f32_16x16x32_bf16 v[28:31], a[252:255], v[160:163], v[28:31]
v_cvt_pk_bf16_f32 v195, v150, v151
v_cvt_pk_bf16_f32 v198, v156, v157
v_mfma_f32_16x16x32_bf16 v[28:31], a[248:251], v[184:187], v[28:31]
s_waitcnt lgkmcnt(0)
v_exp_f32 v159, v159
v_mfma_f32_16x16x32_bf16 v[128:131], a[192:195], a[64:67], -4.0
v_exp_f32 v152, v152
v_mfma_f32_16x16x32_bf16 v[128:131], a[196:199], a[68:71], v[128:131]
v_exp_f32 v153, v153
v_mfma_f32_16x16x32_bf16 v[128:131], a[200:203], a[72:75], v[128:131]
v_exp_f32_e64 v154, v154
v_mfma_f32_16x16x32_bf16 v[128:131], a[204:207], a[76:79], v[128:131]
v_cvt_pk_bf16_f32 v199, v158, v159
v_cvt_pk_bf16_f32 v196, v152, v153
v_mfma_f32_16x16x32_bf16 v[132:135], a[220:223], a[76:79], -4.0
v_exp_f32 v155, v155
v_mfma_f32_16x16x32_bf16 v[132:135], a[216:219], a[72:75], v[132:135]
v_cvt_pk_bf16_f32 v197, v154, v155
v_mfma_f32_16x16x32_bf16 v[132:135], a[212:215], a[68:71], v[132:135]
v_mfma_f32_16x16x32_bf16 v[132:135], a[208:211], a[64:67], v[132:135]
v_exp_f32 v128, v128
v_mfma_f32_16x16x32_bf16 v[140:143], a[208:211], a[80:83], -4.0
v_exp_f32_e64 v129, v129
v_mfma_f32_16x16x32_bf16 v[140:143], a[212:215], a[84:87], v[140:143]
v_exp_f32 v130, v130
v_mfma_f32_16x16x32_bf16 v[140:143], a[216:219], a[88:91], v[140:143]
v_exp_f32 v131, v131
v_mfma_f32_16x16x32_bf16 v[140:143], a[220:223], a[92:95], v[140:143]
s_add_u32 m0, s31, 0x4100
v_exp_f32_e64 v132, v132
v_mfma_f32_16x16x32_bf16 v[136:139], a[204:207], a[92:95], -4.0
v_cvt_pk_bf16_f32 v160, v128, v129
v_cvt_pk_bf16_f32 v161, v130, v131
v_mfma_f32_16x16x32_bf16 v[136:139], a[200:203], a[88:91], v[136:139]
v_exp_f32 v133, v133
v_mfma_f32_16x16x32_bf16 v[136:139], a[196:199], a[84:87], v[136:139]
s_waitcnt vmcnt(20)
v_exp_f32 v134, v134
v_mfma_f32_16x16x32_bf16 v[136:139], a[192:195], a[80:83], v[136:139]
s_barrier
v_smfmac_f32_16x16x64_bf16 v[220:223], v[224:227], v[168:175], v248
buffer_load_dwordx4 v243, s[12:15], s38 offen nt lds
v_mfma_f32_16x16x32_bf16 a[16:19], a[224:227], v[228:231], a[16:19]
v_exp_f32 v135, v135
v_mfma_f32_16x16x32_bf16 a[16:19], a[228:231], v[168:171], a[16:19]
v_exp_f32 v140, v140
v_mfma_f32_16x16x32_bf16 a[48:51], a[228:231], v[172:175], a[48:51]
v_cvt_pk_bf16_f32 v162, v132, v133
v_cvt_pk_bf16_f32 v163, v134, v135
v_mfma_f32_16x16x32_bf16 a[48:51], a[224:227], v[232:235], a[48:51]
ds_read_b64_tr_b16 a[224:225], v241
ds_read_b64_tr_b16 a[226:227], v241 offset:4128
v_mfma_f32_16x16x32_bf16 a[52:55], a[232:235], v[232:235], a[52:55]
v_add_f32 v252, v220, v221
v_add_f32 v253, v222, v223
v_mfma_f32_16x16x32_bf16 a[52:55], a[236:239], v[172:175], a[52:55]
ds_read_b64_tr_b16 a[228:229], v241 offset:8256
ds_read_b64_tr_b16 a[230:231], v241 offset:12384
v_mfma_f32_16x16x32_bf16 a[20:23], a[236:239], v[168:171], a[20:23]
v_subrev_u32 v220, s36, v252
v_subrev_u32 v221, s36, v253
v_mfma_f32_16x16x32_bf16 a[20:23], a[232:235], v[228:231], a[20:23]
ds_read_b64_tr_b16 a[232:233], v241 offset:8
ds_read_b64_tr_b16 a[234:235], v241 offset:4136
v_mfma_f32_16x16x32_bf16 a[24:27], a[240:243], v[228:231], a[24:27]
s_add_u32 m0, s31, 0x4100
v_max_u32 v220, v220, v221
v_rcp_f32 v252, v252
v_mfma_f32_16x16x32_bf16 a[24:27], a[244:247], v[168:171], a[24:27]
buffer_load_dwordx4 v243, s[12:15], s38 offen offset:1024 nt lds
v_mfma_f32_16x16x32_bf16 a[56:59], a[244:247], v[172:175], a[56:59]
s_add_u32 m0, s33, 0x1060
v_rcp_f32_e64 v253, v253
v_mfma_f32_16x16x32_bf16 a[56:59], a[240:243], v[232:235], a[56:59]
s_xor_b32 s38, s29, 0x810000
ds_read_b64_tr_b16 a[236:237], v241 offset:8264
ds_read_b64_tr_b16 a[238:239], v241 offset:12392
v_mfma_f32_16x16x32_bf16 a[60:63], a[248:251], v[232:235], a[60:63]
s_xor_b32 s39, s29, 0x80c000
v_cmp_le_u32 s[42:43], s37, v220
v_mov_b64 v[220:221], 0
v_mfma_f32_16x16x32_bf16 a[60:63], a[252:255], v[172:175], a[60:63]
ds_read_b64_tr_b16 a[240:241], v241 offset:256
v_exp_f32 v141, v141
v_exp_f32_e64 v142, v142
v_pk_mul_f32 v[6:7], v[6:7], v[250:251] op_sel:[0,0] op_sel_hi:[1,0]
v_pk_mul_f32 v[4:5], v[4:5], v[250:251] op_sel:[0,0] op_sel_hi:[1,0]
v_pk_mul_f32 v[2:3], v[2:3], v[250:251] op_sel:[0,0] op_sel_hi:[1,0]
v_pk_mul_f32 v[0:1], v[0:1], v[250:251] op_sel:[0,0] op_sel_hi:[1,0]
v_cvt_pk_bf16_f32 v0, v0, v1
v_mfma_f32_16x16x32_bf16 a[28:31], a[252:255], v[168:171], a[28:31]
v_mov_b64_e64 v[222:223], 0
v_cvt_pk_bf16_f32 v166, v140, v141
v_mfma_f32_16x16x32_bf16 a[28:31], a[248:251], v[228:231], a[28:31]
buffer_load_dwordx4 v243, s[8:11], s56 offen offset:3072 nt lds
v_mfma_f32_16x16x32_bf16 v[144:147], a[192:195], a[96:99], -4.0
s_xor_b32 s56, s28, 0x2002000
v_exp_f32 v143, v143
v_mfma_f32_16x16x32_bf16 v[144:147], a[196:199], a[100:103], v[144:147]
v_exp_f32 v136, v136
v_mfma_f32_16x16x32_bf16 v[144:147], a[200:203], a[104:107], v[144:147]
s_add_u32 m0, s31, 0x6180
v_cvt_pk_bf16_f32 v167, v142, v143
v_cvt_pk_bf16_f32 v1, v2, v3
v_mfma_f32_16x16x32_bf16 v[144:147], a[204:207], a[108:111], v[144:147]
ds_read_b64_tr_b16 a[242:243], v241 offset:4384
ds_read_b64_tr_b16 a[244:245], v241 offset:8512
v_mfma_f32_16x16x32_bf16 v[148:151], a[220:223], a[108:111], -4.0
v_exp_f32 v137, v137
v_mfma_f32_16x16x32_bf16 v[148:151], a[216:219], a[104:107], v[148:151]
s_waitcnt vmcnt(15) lgkmcnt(2)
v_exp_f32_e64 v138, v138
v_mfma_f32_16x16x32_bf16 v[148:151], a[212:215], a[100:103], v[148:151]
v_cvt_pk_bf16_f32 v164, v136, v137
v_cvt_pk_bf16_f32 v2, v4, v5
v_mfma_f32_16x16x32_bf16 v[148:151], a[208:211], a[96:99], v[148:151]
buffer_load_dwordx4 v243, s[12:15], s38 offen nt lds
v_mfma_f32_16x16x32_bf16 v[156:159], a[208:211], a[112:115], -4.0
v_exp_f32_e64 v139, v139
v_mfma_f32_16x16x32_bf16 v[156:159], a[212:215], a[116:119], v[156:159]
v_cvt_pk_bf16_f32 v165, v138, v139
v_cvt_pk_bf16_f32 v3, v6, v7
v_mfma_f32_16x16x32_bf16 v[156:159], a[216:219], a[120:123], v[156:159]
v_exp_f32 v144, v144
v_mfma_f32_16x16x32_bf16 v[156:159], a[220:223], a[124:127], v[156:159]
ds_read_b64_tr_b16 a[246:247], v241 offset:12640
ds_read_b64_tr_b16 a[248:249], v241 offset:264
v_mfma_f32_16x16x32_bf16 v[152:155], a[204:207], a[124:127], -4.0
v_exp_f32 v145, v145
v_mfma_f32_16x16x32_bf16 v[152:155], a[200:203], a[120:123], v[152:155]
v_exp_f32 v146, v146
v_mfma_f32_16x16x32_bf16 v[152:155], a[196:199], a[116:119], v[152:155]
v_exp_f32 v147, v147
v_mfma_f32_16x16x32_bf16 v[152:155], a[192:195], a[112:115], v[152:155]
ds_read_b64_tr_b16 a[250:251], v241 offset:4392
ds_read_b64_tr_b16 a[252:253], v241 offset:8520
v_smfmac_f32_16x16x64_bf16 v[216:219], v[224:227], v[176:183], v248
s_add_u32 m0, s31, 0x6180
ds_read_b64_tr_b16 a[254:255], v241 offset:12648
v_mfma_f32_16x16x32_bf16 v[64:67], a[224:227], v[176:179], 0
v_exp_f32_e64 v148, v148
v_mfma_f32_16x16x32_bf16 v[64:67], a[228:231], v[160:163], v[64:67]
ds_read_b128 a[208:211], v240 offset:37440
ds_read_b128 a[212:215], v240 offset:37696
v_mfma_f32_16x16x32_bf16 v[96:99], a[228:231], v[164:167], 0
v_cvt_pk_bf16_f32 v184, v144, v145
v_cvt_pk_bf16_f32 v185, v146, v147
v_mfma_f32_16x16x32_bf16 v[96:99], a[224:227], v[180:183], v[96:99]
ds_read_b128 a[216:219], v240 offset:37952
ds_read_b128 v[202:205], v242
v_exp_f32 v149, v149
v_exp_f32 v150, v150
v_pk_mul_f32 v[14:15], v[14:15], v[250:251] op_sel:[0,0] op_sel_hi:[1,0]
v_pk_mul_f32 v[12:13], v[12:13], v[250:251] op_sel:[0,0] op_sel_hi:[1,0]
v_pk_mul_f32 v[10:11], v[10:11], v[250:251] op_sel:[0,0] op_sel_hi:[1,0]
v_pk_mul_f32 v[8:9], v[8:9], v[250:251] op_sel:[0,0] op_sel_hi:[1,0]
v_cvt_pk_bf16_f32 v8, v8, v9
v_mfma_f32_16x16x32_bf16 v[100:103], a[232:235], v[180:183], 0
ds_read_b128 a[220:223], v240 offset:38208
v_cvt_pk_bf16_f32 v186, v148, v149
v_mfma_f32_16x16x32_bf16 v[100:103], a[236:239], v[164:167], v[100:103]
ds_read_b128 a[204:207], v240 offset:34048
ds_read_b128 a[200:203], v240 offset:33792
v_mfma_f32_16x16x32_bf16 v[68:71], a[236:239], v[160:163], 0
v_exp_f32 v151, v151
v_mfma_f32_16x16x32_bf16 v[68:71], a[232:235], v[176:179], v[68:71]
s_waitcnt lgkmcnt(7)
ds_read_b128 a[196:199], v240 offset:33536
v_cvt_pk_bf16_f32 v9, v10, v11
v_mfma_f32_16x16x32_bf16 v[72:75], a[240:243], v[176:179], 0
ds_read_b128 a[192:195], v240 offset:33280
v_cvt_pk_bf16_f32 v10, v12, v13
v_mfma_f32_16x16x32_bf16 v[72:75], a[244:247], v[160:163], v[72:75]
buffer_load_dwordx4 v243, s[12:15], s38 offen offset:1024 nt lds
v_mfma_f32_16x16x32_bf16 v[104:107], a[244:247], v[164:167], 0
s_waitcnt lgkmcnt(5)
v_exp_f32 v156, v156
v_mfma_f32_16x16x32_bf16 v[104:107], a[240:243], v[180:183], v[104:107]
ds_read_b128 v[210:213], v242 offset:256
v_cvt_pk_bf16_f32 v187, v150, v151
v_mfma_f32_16x16x32_bf16 v[108:111], a[248:251], v[180:183], 0
v_exp_f32_e64 v157, v157
v_mfma_f32_16x16x32_bf16 v[108:111], a[252:255], v[164:167], v[108:111]
v_exp_f32 v158, v158
v_mfma_f32_16x16x32_bf16 v[76:79], a[252:255], v[160:163], 0
v_cvt_pk_bf16_f32 v190, v156, v157
v_mov_b64 v[200:201], v[202:203]
v_mfma_f32_16x16x32_bf16 v[76:79], a[248:251], v[176:179], v[76:79]
s_waitcnt lgkmcnt(1)
v_exp_f32 v159, v159
v_mfma_f32_16x16x32_bf16 v[128:131], a[192:195], a[64:67], -4.0
v_exp_f32_e64 v152, v152
v_mfma_f32_16x16x32_bf16 v[128:131], a[196:199], a[68:71], v[128:131]
v_cvt_pk_bf16_f32 v191, v158, v159
v_mov_b64 v[206:207], v[204:205]
v_mfma_f32_16x16x32_bf16 v[128:131], a[200:203], a[72:75], v[128:131]
s_add_u32 m0, s32, 0xc180
v_exp_f32_e64 v153, v153
v_mfma_f32_16x16x32_bf16 v[128:131], a[204:207], a[76:79], v[128:131]
s_waitcnt lgkmcnt(0)
buffer_load_dwordx4 v243, s[16:19], s39 offen nt lds
v_mfma_f32_16x16x32_bf16 v[132:135], a[220:223], a[76:79], -4.0
v_exp_f32 v154, v154
v_mfma_f32_16x16x32_bf16 v[132:135], a[216:219], a[72:75], v[132:135]
v_cvt_pk_bf16_f32 v188, v152, v153
v_mov_b64 v[208:209], v[210:211]
v_mfma_f32_16x16x32_bf16 v[132:135], a[212:215], a[68:71], v[132:135]
v_exp_f32 v155, v155
v_mfma_f32_16x16x32_bf16 v[132:135], a[208:211], a[64:67], v[132:135]
v_cvt_pk_bf16_f32 v189, v154, v155
v_mov_b64 v[214:215], v[212:213]
v_mfma_f32_16x16x32_bf16 v[140:143], a[208:211], a[80:83], -4.0
v_exp_f32 v128, v128
v_mfma_f32_16x16x32_bf16 v[140:143], a[212:215], a[84:87], v[140:143]
v_exp_f32 v129, v129
v_mfma_f32_16x16x32_bf16 v[140:143], a[216:219], a[88:91], v[140:143]
v_exp_f32_e64 v130, v130
v_mfma_f32_16x16x32_bf16 v[140:143], a[220:223], a[92:95], v[140:143]
v_cvt_pk_bf16_f32 v168, v128, v129
v_cvt_pk_bf16_f32 v11, v14, v15
v_mfma_f32_16x16x32_bf16 v[136:139], a[204:207], a[92:95], -4.0
s_add_u32 m0, s32, 0xc180
v_exp_f32 v131, v131
v_mfma_f32_16x16x32_bf16 v[136:139], a[200:203], a[88:91], v[136:139]
v_exp_f32 v132, v132
v_mfma_f32_16x16x32_bf16 v[136:139], a[196:199], a[84:87], v[136:139]
v_cvt_pk_bf16_f32 v169, v130, v131
v_mov_b64_e64 v[12:13], v[0:1]
v_mfma_f32_16x16x32_bf16 v[136:139], a[192:195], a[80:83], v[136:139]
buffer_load_dwordx4 v243, s[24:27], s39 offen offset:1032 nt lds
v_mfma_f32_16x16x32_bf16 v[200:203], v[236:239], v[200:203], 0
s_xor_b32 s39, s29, 0x80e000
v_exp_f32 v133, v133
v_mfma_f32_16x16x32_bf16 v[204:207], v[236:239], v[204:207], 0
s_xor_b32 s38, s29, 0x812000
v_exp_f32 v134, v134
v_smfmac_f32_16x16x64_bf16 v[220:223], v[224:227], v[192:199], v248
v_cvt_pk_bf16_f32 v170, v132, v133
v_mfma_f32_16x16x32_bf16 v[208:211], v[236:239], v[208:211], 0
v_exp_f32 v135, v135
v_mfma_f32_16x16x32_bf16 v[212:215], v[236:239], v[212:215], 0
v_exp_f32 v140, v140
v_mfma_f32_16x16x32_bf16 a[128:131], a[224:227], v[192:195], 0
v_cvt_pk_bf16_f32 v171, v134, v135
v_mov_b64 v[14:15], v[2:3]
v_mfma_f32_16x16x32_bf16 a[128:131], a[228:231], v[184:187], a[128:131]
v_exp_f32 v141, v141
v_mfma_f32_16x16x32_bf16 a[160:163], a[228:231], v[188:191], 0
v_exp_f32_e64 v142, v142
v_mfma_f32_16x16x32_bf16 a[160:163], a[224:227], v[196:199], a[160:163]
ds_read_b64_tr_b16 a[224:225], v241 offset:512
ds_read_b64_tr_b16 a[226:227], v241 offset:4640
v_mfma_f32_16x16x32_bf16 a[164:167], a[232:235], v[196:199], 0
v_cvt_pk_bf16_f32 v174, v140, v141
v_mov_b32_dpp v0, v8 row_ror:8 row_mask:0xf bank_mask:0xc
v_mfma_f32_16x16x32_bf16 a[164:167], a[236:239], v[188:191], a[164:167]
ds_read_b64_tr_b16 a[228:229], v241 offset:8768
ds_read_b64_tr_b16 a[230:231], v241 offset:12896
v_mfma_f32_16x16x32_bf16 a[132:135], a[236:239], v[184:187], 0
v_exp_f32_e64 v143, v143
v_mfma_f32_16x16x32_bf16 a[132:135], a[232:235], v[192:195], a[132:135]
s_add_u32 m0, s32, 0xe1c0
ds_read_b64_tr_b16 a[232:233], v241 offset:520
ds_read_b64_tr_b16 a[234:235], v241 offset:4648
v_mfma_f32_16x16x32_bf16 a[136:139], a[240:243], v[192:195], 0
v_exp_f32_e64 v136, v136
v_mfma_f32_16x16x32_bf16 a[136:139], a[244:247], v[184:187], a[136:139]
buffer_load_dwordx4 v243, s[16:19], s39 offen nt lds
v_mfma_f32_16x16x32_bf16 a[168:171], a[244:247], v[188:191], 0
v_cvt_pk_bf16_f32 v175, v142, v143
v_mov_b32_dpp v1, v9 row_ror:8 row_mask:0xf bank_mask:0xc
v_mfma_f32_16x16x32_bf16 a[168:171], a[240:243], v[196:199], a[168:171]
ds_read_b64_tr_b16 a[236:237], v241 offset:8776
ds_read_b64_tr_b16 a[238:239], v241 offset:12904
v_mfma_f32_16x16x32_bf16 a[172:175], a[248:251], v[196:199], 0
v_exp_f32 v137, v137
v_mfma_f32_16x16x32_bf16 a[172:175], a[252:255], v[188:191], a[172:175]
ds_read_b64_tr_b16 a[240:241], v241 offset:768
ds_read_b64_tr_b16 a[242:243], v241 offset:4896
v_mfma_f32_16x16x32_bf16 a[140:143], a[252:255], v[184:187], 0
v_exp_f32 v138, v138
v_mfma_f32_16x16x32_bf16 a[140:143], a[248:251], v[192:195], a[140:143]
ds_read_b64_tr_b16 a[244:245], v241 offset:9024
v_cvt_pk_bf16_f32 v172, v136, v137
v_mfma_f32_16x16x32_bf16 v[144:147], a[192:195], a[96:99], -4.0
v_exp_f32_e64 v139, v139
v_mfma_f32_16x16x32_bf16 v[144:147], a[196:199], a[100:103], v[144:147]
v_cvt_pk_bf16_f32 v173, v138, v139
v_mov_b32_dpp v2, v10 row_ror:8 row_mask:0xf bank_mask:0xc
v_mfma_f32_16x16x32_bf16 v[144:147], a[200:203], a[104:107], v[144:147]
s_add_u32 m0, s32, 0xe1c0
v_mov_b32_dpp v3, v11 row_ror:8 row_mask:0xf bank_mask:0xc
v_mov_b32_dpp v8, v12 row_ror:8 row_mask:0xf bank_mask:0x3
v_mfma_f32_16x16x32_bf16 v[144:147], a[204:207], a[108:111], v[144:147]
buffer_load_dwordx4 v243, s[24:27], s39 offen offset:1032 nt lds
v_mfma_f32_16x16x32_bf16 v[148:151], a[220:223], a[108:111], -4.0
v_mov_b32_dpp v9, v13 row_ror:8 row_mask:0xf bank_mask:0x3
v_mov_b32_dpp v10, v14 row_ror:8 row_mask:0xf bank_mask:0x3
v_mfma_f32_16x16x32_bf16 v[148:151], a[216:219], a[104:107], v[148:151]
v_mov_b32_dpp v11, v15 row_ror:8 row_mask:0xf bank_mask:0x3
v_mfma_f32_16x16x32_bf16 v[148:151], a[212:215], a[100:103], v[148:151]
ds_read_b64_tr_b16 a[246:247], v241 offset:13152
ds_read_b64_tr_b16 a[248:249], v241 offset:776
v_mfma_f32_16x16x32_bf16 v[148:151], a[208:211], a[96:99], v[148:151]
ds_read_b64_tr_b16 a[250:251], v241 offset:4904
v_exp_f32 v144, v144
v_exp_f32 v145, v145
v_pk_mul_f32 v[22:23], v[22:23], v[250:251] op_sel:[0,0] op_sel_hi:[1,0]
v_pk_mul_f32 v[20:21], v[20:21], v[250:251] op_sel:[0,0] op_sel_hi:[1,0]
v_pk_mul_f32 v[18:19], v[18:19], v[250:251] op_sel:[0,0] op_sel_hi:[1,0]
v_pk_mul_f32 v[16:17], v[16:17], v[250:251] op_sel:[0,0] op_sel_hi:[1,0]
v_cvt_pk_bf16_f32 v16, v16, v17
L_pad5:
s_cbranch_vccnz L_pad9
v_mfma_f32_16x16x32_bf16 v[156:159], a[208:211], a[112:115], -4.0
v_exp_f32 v146, v146
v_mfma_f32_16x16x32_bf16 v[156:159], a[212:215], a[116:119], v[156:159]
v_cvt_pk_bf16_f32 v228, v144, v145
v_cvt_pk_bf16_f32 v17, v18, v19
v_mfma_f32_16x16x32_bf16 v[156:159], a[216:219], a[120:123], v[156:159]
v_exp_f32 v147, v147
v_mfma_f32_16x16x32_bf16 v[156:159], a[220:223], a[124:127], v[156:159]
buffer_store_dwordx4 v[0:3], v249, s[20:23], s57 offen sc1
v_mfma_f32_16x16x32_bf16 v[152:155], a[204:207], a[124:127], -4.0
v_exp_f32 v148, v148
v_mfma_f32_16x16x32_bf16 v[152:155], a[200:203], a[120:123], v[152:155]
v_cvt_pk_bf16_f32 v229, v146, v147
v_cvt_pk_bf16_f32 v18, v20, v21
v_mfma_f32_16x16x32_bf16 v[152:155], a[196:199], a[116:119], v[152:155]
v_exp_f32_e64 v149, v149
v_mfma_f32_16x16x32_bf16 v[152:155], a[192:195], a[112:115], v[152:155]
ds_read_b64_tr_b16 a[252:253], v241 offset:9032
ds_read_b64_tr_b16 a[254:255], v241 offset:13160
v_smfmac_f32_16x16x64_bf16 v[216:219], v[224:227], v[160:167], v248
s_waitcnt lgkmcnt(2)
ds_read_b128 a[208:211], v240 offset:45760
v_mfma_f32_16x16x32_bf16 v[80:83], a[224:227], v[176:179], 0
v_exp_f32 v150, v150
v_mfma_f32_16x16x32_bf16 v[80:83], a[228:231], v[160:163], v[80:83]
ds_read_b128 a[212:215], v240 offset:46016
ds_read_b128 a[216:219], v240 offset:46272
v_mfma_f32_16x16x32_bf16 v[112:115], a[228:231], v[164:167], 0
v_cvt_pk_bf16_f32 v230, v148, v149
v_cvt_pk_bf16_f32 v19, v22, v23
v_mfma_f32_16x16x32_bf16 v[112:115], a[224:227], v[180:183], v[112:115]
ds_read_b128 a[220:223], v240 offset:46528
v_exp_f32 v151, v151
v_exp_f32 v156, v156
v_pk_mul_f32 v[30:31], v[30:31], v[250:251] op_sel:[0,0] op_sel_hi:[1,0]
v_pk_mul_f32 v[28:29], v[28:29], v[250:251] op_sel:[0,0] op_sel_hi:[1,0]
v_pk_mul_f32 v[26:27], v[26:27], v[250:251] op_sel:[0,0] op_sel_hi:[1,0]
v_pk_mul_f32 v[24:25], v[24:25], v[250:251] op_sel:[0,0] op_sel_hi:[1,0]
v_cvt_pk_bf16_f32 v24, v24, v25
v_mfma_f32_16x16x32_bf16 v[116:119], a[232:235], v[180:183], 0
v_cvt_pk_bf16_f32 v231, v150, v151
v_cvt_pk_bf16_f32 v25, v26, v27
v_mfma_f32_16x16x32_bf16 v[116:119], a[236:239], v[164:167], v[116:119]
ds_read_b128 a[204:207], v240 offset:42368
ds_read_b128 a[200:203], v240 offset:42112
v_mfma_f32_16x16x32_bf16 v[84:87], a[236:239], v[160:163], 0
v_exp_f32_e64 v157, v157
v_mfma_f32_16x16x32_bf16 v[84:87], a[232:235], v[176:179], v[84:87]
ds_read_b128 a[196:199], v240 offset:41856
v_cvt_pk_bf16_f32 v26, v28, v29
v_mfma_f32_16x16x32_bf16 v[88:91], a[240:243], v[176:179], 0
ds_read_b128 a[192:195], v240 offset:41600
v_cvt_pk_bf16_f32 v27, v30, v31
v_mfma_f32_16x16x32_bf16 v[88:91], a[244:247], v[160:163], v[88:91]
buffer_store_dwordx4 v[8:11], v249, s[20:23], s57 offen offset:2048 sc1
v_mfma_f32_16x16x32_bf16 v[120:123], a[244:247], v[164:167], 0
v_exp_f32 v158, v158
v_mfma_f32_16x16x32_bf16 v[120:123], a[240:243], v[180:183], v[120:123]
v_cvt_pk_bf16_f32 v234, v156, v157
v_mov_b64 v[28:29], v[16:17]
v_mfma_f32_16x16x32_bf16 v[124:127], a[248:251], v[180:183], 0
s_waitcnt lgkmcnt(2)
v_exp_f32 v159, v159
v_mfma_f32_16x16x32_bf16 v[124:127], a[252:255], v[164:167], v[124:127]
v_exp_f32 v152, v152
v_mfma_f32_16x16x32_bf16 v[92:95], a[252:255], v[160:163], 0
v_cvt_pk_bf16_f32 v235, v158, v159
v_mov_b64 v[30:31], v[18:19]
v_mfma_f32_16x16x32_bf16 v[92:95], a[248:251], v[176:179], v[92:95]
s_waitcnt lgkmcnt(0)
v_exp_f32 v153, v153
v_mfma_f32_16x16x32_bf16 v[128:131], a[192:195], a[64:67], -4.0
v_exp_f32_e64 v154, v154
v_mfma_f32_16x16x32_bf16 v[128:131], a[196:199], a[68:71], v[128:131]
v_cvt_pk_bf16_f32 v232, v152, v153
v_mov_b32_dpp v16, v24 row_ror:8 row_mask:0xf bank_mask:0xc
v_mfma_f32_16x16x32_bf16 v[128:131], a[200:203], a[72:75], v[128:131]
v_exp_f32_e64 v155, v155
v_mfma_f32_16x16x32_bf16 v[128:131], a[204:207], a[76:79], v[128:131]
v_cvt_pk_bf16_f32 v233, v154, v155
v_mov_b32_dpp v17, v25 row_ror:8 row_mask:0xf bank_mask:0xc
v_mfma_f32_16x16x32_bf16 v[132:135], a[220:223], a[76:79], -4.0
v_mov_b32_dpp v18, v26 row_ror:8 row_mask:0xf bank_mask:0xc
v_mov_b32_dpp v19, v27 row_ror:8 row_mask:0xf bank_mask:0xc
v_mfma_f32_16x16x32_bf16 v[132:135], a[216:219], a[72:75], v[132:135]
v_mov_b32_dpp v24, v28 row_ror:8 row_mask:0xf bank_mask:0x3
v_mov_b32_dpp v25, v29 row_ror:8 row_mask:0xf bank_mask:0x3
v_mfma_f32_16x16x32_bf16 v[132:135], a[212:215], a[68:71], v[132:135]
v_exp_f32_e64 v128, v128
v_mfma_f32_16x16x32_bf16 v[132:135], a[208:211], a[64:67], v[132:135]
buffer_store_dwordx4 v[16:19], v249, s[20:23], s57 offen offset:128 sc1
v_mfma_f32_16x16x32_bf16 v[140:143], a[208:211], a[80:83], -4.0
v_exp_f32 v129, v129
v_mfma_f32_16x16x32_bf16 v[140:143], a[212:215], a[84:87], v[140:143]
v_exp_f32 v130, v130
v_mfma_f32_16x16x32_bf16 v[140:143], a[216:219], a[88:91], v[140:143]
v_cvt_pk_bf16_f32 v160, v128, v129
v_mov_b32_dpp v26, v30 row_ror:8 row_mask:0xf bank_mask:0x3
v_mfma_f32_16x16x32_bf16 v[140:143], a[220:223], a[92:95], v[140:143]
s_add_u32 m0, s31, 0x8200
v_exp_f32 v131, v131
v_mfma_f32_16x16x32_bf16 v[136:139], a[204:207], a[92:95], -4.0
v_exp_f32 v132, v132
v_mfma_f32_16x16x32_bf16 v[136:139], a[200:203], a[88:91], v[136:139]
v_cvt_pk_bf16_f32 v161, v130, v131
v_mov_b32_dpp v27, v31 row_ror:8 row_mask:0xf bank_mask:0x3
v_mfma_f32_16x16x32_bf16 v[136:139], a[196:199], a[84:87], v[136:139]
s_waitcnt vmcnt(20)
v_exp_f32 v133, v133
v_mfma_f32_16x16x32_bf16 v[136:139], a[192:195], a[80:83], v[136:139]
s_barrier
v_smfmac_f32_16x16x64_bf16 v[220:223], v[224:227], v[184:191], v248
v_cvt_pk_bf16_f32 v0, v200, v201
v_mfma_f32_16x16x32_bf16 a[144:147], a[224:227], v[192:195], 0
v_exp_f32 v134, v134
v_mfma_f32_16x16x32_bf16 a[144:147], a[228:231], v[184:187], a[144:147]
buffer_load_dwordx4 v243, s[12:15], s38 offen nt lds
v_mfma_f32_16x16x32_bf16 a[176:179], a[228:231], v[188:191], 0
v_cvt_pk_bf16_f32 v162, v132, v133
v_cvt_pk_bf16_f32 v1, v202, v203
v_mfma_f32_16x16x32_bf16 a[176:179], a[224:227], v[196:199], a[176:179]
ds_read_b64_tr_b16 a[224:225], v241 offset:16512
ds_read_b64_tr_b16 a[226:227], v241 offset:20640
v_mfma_f32_16x16x32_bf16 a[180:183], a[232:235], v[196:199], 0
v_exp_f32_e64 v135, v135
v_mfma_f32_16x16x32_bf16 a[180:183], a[236:239], v[188:191], a[180:183]
ds_read_b64_tr_b16 a[228:229], v241 offset:24768
ds_read_b64_tr_b16 a[230:231], v241 offset:28896
v_mfma_f32_16x16x32_bf16 a[148:151], a[236:239], v[184:187], 0
v_exp_f32_e64 v140, v140
v_mfma_f32_16x16x32_bf16 a[148:151], a[232:235], v[192:195], a[148:151]
buffer_store_dwordx4 v[24:27], v249, s[20:23], s57 offen offset:2176 sc1
v_mfma_f32_16x16x32_bf16 a[152:155], a[240:243], v[192:195], 0
v_cvt_pk_bf16_f32 v163, v134, v135
v_cvt_pk_bf16_f32 v2, v204, v205
v_mfma_f32_16x16x32_bf16 a[152:155], a[244:247], v[184:187], a[152:155]
ds_read_b64_tr_b16 a[232:233], v241 offset:16520
ds_read_b64_tr_b16 a[234:235], v241 offset:20648
v_mfma_f32_16x16x32_bf16 a[184:187], a[244:247], v[188:191], 0
s_add_u32 m0, s31, 0x8200
v_exp_f32_e64 v141, v141
v_mfma_f32_16x16x32_bf16 a[184:187], a[240:243], v[196:199], a[184:187]
ds_read_b64_tr_b16 a[236:237], v241 offset:24776
ds_read_b64_tr_b16 a[238:239], v241 offset:28904
v_mfma_f32_16x16x32_bf16 a[188:191], a[248:251], v[196:199], 0
v_exp_f32_e64 v142, v142
v_mfma_f32_16x16x32_bf16 a[188:191], a[252:255], v[188:191], a[188:191]
ds_read_b64_tr_b16 a[240:241], v241 offset:16768
ds_read_b64_tr_b16 a[242:243], v241 offset:20896
v_mfma_f32_16x16x32_bf16 a[156:159], a[252:255], v[184:187], 0
v_cvt_pk_bf16_f32 v166, v140, v141
v_cvt_pk_bf16_f32 v3, v206, v207
v_mfma_f32_16x16x32_bf16 a[156:159], a[248:251], v[192:195], a[156:159]
ds_read_b64_tr_b16 a[244:245], v241 offset:25024
v_cvt_pk_bf16_f32 v4, v208, v209
v_mfma_f32_16x16x32_bf16 v[144:147], a[192:195], a[96:99], -4.0
v_exp_f32_e64 v143, v143
v_mfma_f32_16x16x32_bf16 v[144:147], a[196:199], a[100:103], v[144:147]
v_exp_f32_e64 v136, v136
v_mfma_f32_16x16x32_bf16 v[144:147], a[200:203], a[104:107], v[144:147]
v_cvt_pk_bf16_f32 v167, v142, v143
v_cvt_pk_bf16_f32 v5, v210, v211
v_mfma_f32_16x16x32_bf16 v[144:147], a[204:207], a[108:111], v[144:147]
buffer_load_dwordx4 v243, s[12:15], s38 offen offset:1024 nt lds
v_mfma_f32_16x16x32_bf16 v[148:151], a[220:223], a[108:111], -4.0
s_xor_b32 s38, s29, 0x814000
v_exp_f32 v137, v137
v_mfma_f32_16x16x32_bf16 v[148:151], a[216:219], a[104:107], v[148:151]
s_xor_b32 s39, s29, 0x810000
v_exp_f32 v138, v138
v_mfma_f32_16x16x32_bf16 v[148:151], a[212:215], a[100:103], v[148:151]
v_cvt_pk_bf16_f32 v164, v136, v137
v_cvt_pk_bf16_f32 v6, v212, v213
v_mfma_f32_16x16x32_bf16 v[148:151], a[208:211], a[96:99], v[148:151]
ds_read_b64_tr_b16 a[246:247], v241 offset:29152
ds_read_b64_tr_b16 a[248:249], v241 offset:16776
v_mfma_f32_16x16x32_bf16 v[156:159], a[208:211], a[112:115], -4.0
v_exp_f32 v139, v139
v_mfma_f32_16x16x32_bf16 v[156:159], a[212:215], a[116:119], v[156:159]
v_cvt_pk_bf16_f32 v165, v138, v139
v_cvt_pk_bf16_f32 v7, v214, v215
v_mfma_f32_16x16x32_bf16 v[156:159], a[216:219], a[120:123], v[156:159]
v_exp_f32 v144, v144
v_mfma_f32_16x16x32_bf16 v[156:159], a[220:223], a[124:127], v[156:159]
ds_read_b64_tr_b16 a[250:251], v241 offset:20904
ds_read_b64_tr_b16 a[252:253], v241 offset:25032
v_mfma_f32_16x16x32_bf16 v[152:155], a[204:207], a[124:127], -4.0
s_add_u32 m0, s31, 0xa280
v_exp_f32 v145, v145
v_mfma_f32_16x16x32_bf16 v[152:155], a[200:203], a[120:123], v[152:155]
v_exp_f32 v146, v146
v_mfma_f32_16x16x32_bf16 v[152:155], a[196:199], a[116:119], v[152:155]
v_exp_f32 v147, v147
v_mfma_f32_16x16x32_bf16 v[152:155], a[192:195], a[112:115], v[152:155]
buffer_load_dwordx4 v243, s[12:15], s38 offen nt lds
v_smfmac_f32_16x16x64_bf16 v[216:219], v[224:227], v[168:175], v248
s_waitcnt lgkmcnt(2)
ds_read_b64_tr_b16 a[254:255], v241 offset:29160
v_mfma_f32_16x16x32_bf16 v[64:67], a[224:227], v[168:171], v[64:67]
v_exp_f32_e64 v148, v148
v_mfma_f32_16x16x32_bf16 v[64:67], a[228:231], v[160:163], v[64:67]
ds_read_b128 a[208:211], v240 offset:54080
ds_read_b128 a[212:215], v240 offset:54336
v_mfma_f32_16x16x32_bf16 v[96:99], a[228:231], v[164:167], v[96:99]
v_cvt_pk_bf16_f32 v176, v144, v145
v_cvt_pk_bf16_f32 v177, v146, v147
v_mfma_f32_16x16x32_bf16 v[96:99], a[224:227], v[172:175], v[96:99]
ds_read_b128 a[216:219], v240 offset:54592
ds_read_b128 a[220:223], v240 offset:54848
v_mfma_f32_16x16x32_bf16 v[100:103], a[232:235], v[172:175], v[100:103]
v_exp_f32 v149, v149
v_mfma_f32_16x16x32_bf16 v[100:103], a[236:239], v[164:167], v[100:103]
ds_read_b128 a[204:207], v240 offset:50688
ds_read_b128 a[200:203], v240 offset:50432
v_mfma_f32_16x16x32_bf16 v[68:71], a[236:239], v[160:163], v[68:71]
v_exp_f32 v150, v150
v_mfma_f32_16x16x32_bf16 v[68:71], a[232:235], v[168:171], v[68:71]
s_add_u32 m0, s31, 0xa280
ds_read_b128 a[196:199], v240 offset:50176
v_cvt_pk_bf16_f32 v178, v148, v149
v_mfma_f32_16x16x32_bf16 v[72:75], a[240:243], v[168:171], v[72:75]
ds_read_b128 a[192:195], v240 offset:49920
ds_read_b128 v[202:205], v242 offset:512
v_mfma_f32_16x16x32_bf16 v[72:75], a[244:247], v[160:163], v[72:75]
buffer_load_dwordx4 v243, s[12:15], s38 offen offset:1024 nt lds
v_mfma_f32_16x16x32_bf16 v[104:107], a[244:247], v[164:167], v[104:107]
v_exp_f32 v151, v151
v_mfma_f32_16x16x32_bf16 v[104:107], a[240:243], v[172:175], v[104:107]
s_waitcnt lgkmcnt(5)
ds_read_b128 v[210:213], v242 offset:768
v_mfma_f32_16x16x32_bf16 v[108:111], a[248:251], v[172:175], v[108:111]
v_exp_f32 v156, v156
v_mfma_f32_16x16x32_bf16 v[108:111], a[252:255], v[164:167], v[108:111]
v_exp_f32 v157, v157
v_mfma_f32_16x16x32_bf16 v[76:79], a[252:255], v[160:163], v[76:79]
v_exp_f32_e64 v158, v158
v_mfma_f32_16x16x32_bf16 v[76:79], a[248:251], v[168:171], v[76:79]
s_waitcnt lgkmcnt(1)
v_cvt_pk_bf16_f32 v179, v150, v151
v_cvt_pk_bf16_f32 v182, v156, v157
v_mfma_f32_16x16x32_bf16 v[128:131], a[192:195], a[64:67], -4.0
v_exp_f32 v159, v159
v_mfma_f32_16x16x32_bf16 v[128:131], a[196:199], a[68:71], v[128:131]
v_exp_f32 v152, v152
v_mfma_f32_16x16x32_bf16 v[128:131], a[200:203], a[72:75], v[128:131]
s_add_u32 m0, s32, 0x0
v_cvt_pk_bf16_f32 v183, v158, v159
v_mov_b64 v[200:201], v[202:203]
v_mfma_f32_16x16x32_bf16 v[128:131], a[204:207], a[76:79], v[128:131]
s_waitcnt lgkmcnt(0)
buffer_load_dwordx4 v243, s[16:19], s39 offen nt lds
v_mfma_f32_16x16x32_bf16 v[132:135], a[220:223], a[76:79], -4.0
s_add_u32 m0, s33, 0x0
v_exp_f32 v153, v153
v_mfma_f32_16x16x32_bf16 v[132:135], a[216:219], a[72:75], v[132:135]
v_exp_f32_e64 v154, v154
v_mfma_f32_16x16x32_bf16 v[132:135], a[212:215], a[68:71], v[132:135]
v_cvt_pk_bf16_f32 v180, v152, v153
v_mov_b64 v[206:207], v[204:205]
v_mfma_f32_16x16x32_bf16 v[132:135], a[208:211], a[64:67], v[132:135]
v_exp_f32 v155, v155
v_mfma_f32_16x16x32_bf16 v[140:143], a[208:211], a[80:83], -4.0
v_cvt_pk_bf16_f32 v181, v154, v155
v_mov_b64 v[208:209], v[210:211]
v_mfma_f32_16x16x32_bf16 v[140:143], a[212:215], a[84:87], v[140:143]
v_exp_f32 v128, v128
v_mfma_f32_16x16x32_bf16 v[140:143], a[216:219], a[88:91], v[140:143]
v_exp_f32 v129, v129
v_mfma_f32_16x16x32_bf16 v[140:143], a[220:223], a[92:95], v[140:143]
buffer_load_dwordx4 v243, s[8:11], s56 offen nt lds
v_mfma_f32_16x16x32_bf16 v[136:139], a[204:207], a[92:95], -4.0
s_add_u32 m0, s32, 0x0
v_exp_f32 v130, v130
v_mfma_f32_16x16x32_bf16 v[136:139], a[200:203], a[88:91], v[136:139]
v_cvt_pk_bf16_f32 v184, v128, v129
v_mov_b64 v[214:215], v[212:213]
v_mfma_f32_16x16x32_bf16 v[136:139], a[196:199], a[84:87], v[136:139]
v_exp_f32 v131, v131
v_mfma_f32_16x16x32_bf16 v[136:139], a[192:195], a[80:83], v[136:139]
v_exp_f32 v132, v132
v_mfma_f32_16x16x32_bf16 v[200:203], v[236:239], v[200:203], 0
v_exp_f32 v133, v133
v_mfma_f32_16x16x32_bf16 v[204:207], v[236:239], v[204:207], 0
v_exp_f32 v134, v134
v_smfmac_f32_16x16x64_bf16 v[220:223], v[224:227], v[228:235], v248
buffer_load_dwordx4 v243, s[24:27], s39 offen offset:1032 nt lds
v_mfma_f32_16x16x32_bf16 v[208:211], v[236:239], v[208:211], 0
s_xor_b32 s39, s29, 0x812000
v_cvt_pk_bf16_f32 v185, v130, v131
v_cvt_pk_bf16_f32 v186, v132, v133
v_mfma_f32_16x16x32_bf16 v[212:215], v[236:239], v[212:215], 0
s_xor_b32 s38, s29, 0x816000
v_exp_f32 v135, v135
v_mfma_f32_16x16x32_bf16 a[128:131], a[224:227], v[228:231], a[128:131]
v_exp_f32 v140, v140
v_mfma_f32_16x16x32_bf16 a[128:131], a[228:231], v[176:179], a[128:131]
v_cvt_pk_bf16_f32 v187, v134, v135
v_cvt_pk_bf16_f32 v8, v200, v201
v_mfma_f32_16x16x32_bf16 a[160:163], a[228:231], v[180:183], a[160:163]
v_exp_f32_e64 v141, v141
v_mfma_f32_16x16x32_bf16 a[160:163], a[224:227], v[232:235], a[160:163]
ds_read_b64_tr_b16 a[224:225], v241 offset:17024
ds_read_b64_tr_b16 a[226:227], v241 offset:21152
v_mfma_f32_16x16x32_bf16 a[164:167], a[232:235], v[232:235], a[164:167]
v_exp_f32_e64 v142, v142
v_mfma_f32_16x16x32_bf16 a[164:167], a[236:239], v[180:183], a[164:167]
ds_read_b64_tr_b16 a[228:229], v241 offset:25280
ds_read_b64_tr_b16 a[230:231], v241 offset:29408
v_mfma_f32_16x16x32_bf16 a[132:135], a[236:239], v[176:179], a[132:135]
v_cvt_pk_bf16_f32 v190, v140, v141
v_cvt_pk_bf16_f32 v9, v202, v203
v_mfma_f32_16x16x32_bf16 a[132:135], a[232:235], v[228:231], a[132:135]
ds_read_b64_tr_b16 a[232:233], v241 offset:17032
ds_read_b64_tr_b16 a[234:235], v241 offset:21160
v_mfma_f32_16x16x32_bf16 a[136:139], a[240:243], v[228:231], a[136:139]
s_add_u32 m0, s32, 0x2040
v_exp_f32_e64 v143, v143
v_mfma_f32_16x16x32_bf16 a[136:139], a[244:247], v[176:179], a[136:139]
buffer_load_dwordx4 v243, s[16:19], s39 offen nt lds
v_mfma_f32_16x16x32_bf16 a[168:171], a[244:247], v[180:183], a[168:171]
v_exp_f32_e64 v136, v136
v_mfma_f32_16x16x32_bf16 a[168:171], a[240:243], v[232:235], a[168:171]
ds_read_b64_tr_b16 a[236:237], v241 offset:25288
ds_read_b64_tr_b16 a[238:239], v241 offset:29416
v_mfma_f32_16x16x32_bf16 a[172:175], a[248:251], v[232:235], a[172:175]
v_cvt_pk_bf16_f32 v191, v142, v143
v_cvt_pk_bf16_f32 v10, v204, v205
v_mfma_f32_16x16x32_bf16 a[172:175], a[252:255], v[180:183], a[172:175]
ds_read_b64_tr_b16 a[240:241], v241 offset:17280
ds_read_b64_tr_b16 a[242:243], v241 offset:21408
v_mfma_f32_16x16x32_bf16 a[140:143], a[252:255], v[176:179], a[140:143]
v_exp_f32_e64 v137, v137
v_mfma_f32_16x16x32_bf16 a[140:143], a[248:251], v[228:231], a[140:143]
ds_read_b64_tr_b16 a[244:245], v241 offset:25536
v_cvt_pk_bf16_f32 v11, v206, v207
v_mfma_f32_16x16x32_bf16 v[144:147], a[192:195], a[96:99], -4.0
v_exp_f32 v138, v138
v_mfma_f32_16x16x32_bf16 v[144:147], a[196:199], a[100:103], v[144:147]
s_waitcnt vmcnt(18) lgkmcnt(5)
v_cvt_pk_bf16_f32 v188, v136, v137
v_cvt_pk_bf16_f32 v12, v208, v209
v_mfma_f32_16x16x32_bf16 v[144:147], a[200:203], a[104:107], v[144:147]
s_add_u32 m0, s32, 0x2040
v_exp_f32_e64 v139, v139
v_mfma_f32_16x16x32_bf16 v[144:147], a[204:207], a[108:111], v[144:147]
buffer_load_dwordx4 v243, s[24:27], s39 offen offset:1032 nt lds
v_mfma_f32_16x16x32_bf16 v[148:151], a[220:223], a[108:111], -4.0
v_cvt_pk_bf16_f32 v189, v138, v139
v_cvt_pk_bf16_f32 v13, v210, v211
v_mfma_f32_16x16x32_bf16 v[148:151], a[216:219], a[104:107], v[148:151]
v_cvt_pk_bf16_f32 v14, v212, v213
v_cvt_pk_bf16_f32 v15, v214, v215
v_mfma_f32_16x16x32_bf16 v[148:151], a[212:215], a[100:103], v[148:151]
v_exp_f32 v144, v144
v_mfma_f32_16x16x32_bf16 v[148:151], a[208:211], a[96:99], v[148:151]
ds_read_b64_tr_b16 a[246:247], v241 offset:29664
ds_read_b128 v[202:205], v242 offset:4160
v_exp_f32 v145, v145
v_exp_f32_e64 v146, v146
v_pk_mul_f32 v[38:39], v[38:39], v[250:251] op_sel:[0,1] op_sel_hi:[1,1]
v_pk_mul_f32 v[36:37], v[36:37], v[250:251] op_sel:[0,1] op_sel_hi:[1,1]
v_pk_mul_f32 v[34:35], v[34:35], v[250:251] op_sel:[0,1] op_sel_hi:[1,1]
v_pk_mul_f32 v[32:33], v[32:33], v[250:251] op_sel:[0,1] op_sel_hi:[1,1]
v_cvt_pk_bf16_f32 v32, v32, v33
v_mfma_f32_16x16x32_bf16 v[156:159], a[208:211], a[112:115], -4.0
v_cvt_pk_bf16_f32 v192, v144, v145
v_cvt_pk_bf16_f32 v33, v34, v35
v_mfma_f32_16x16x32_bf16 v[156:159], a[212:215], a[116:119], v[156:159]
v_exp_f32_e64 v147, v147
v_mfma_f32_16x16x32_bf16 v[156:159], a[216:219], a[120:123], v[156:159]
v_exp_f32_e64 v148, v148
v_mfma_f32_16x16x32_bf16 v[156:159], a[220:223], a[124:127], v[156:159]
ds_read_b64_tr_b16 a[248:249], v241 offset:17288
ds_read_b64_tr_b16 a[250:251], v241 offset:21416
v_mfma_f32_16x16x32_bf16 v[152:155], a[204:207], a[124:127], -4.0
v_cvt_pk_bf16_f32 v193, v146, v147
v_cvt_pk_bf16_f32 v34, v36, v37
v_mfma_f32_16x16x32_bf16 v[152:155], a[200:203], a[120:123], v[152:155]
v_exp_f32 v149, v149
v_mfma_f32_16x16x32_bf16 v[152:155], a[196:199], a[116:119], v[152:155]
s_waitcnt lgkmcnt(2)
v_exp_f32_e64 v150, v150
v_mfma_f32_16x16x32_bf16 v[152:155], a[192:195], a[112:115], v[152:155]
ds_read_b64_tr_b16 a[252:253], v241 offset:25544
ds_read_b64_tr_b16 a[254:255], v241 offset:29672
v_smfmac_f32_16x16x64_bf16 v[216:219], v[224:227], v[160:167], v248
ds_read_b128 a[208:211], v240 offset:4160
v_mfma_f32_16x16x32_bf16 v[80:83], a[224:227], v[168:171], v[80:83]
v_cvt_pk_bf16_f32 v194, v148, v149
v_mov_b64 v[200:201], v[202:203]
v_mfma_f32_16x16x32_bf16 v[80:83], a[228:231], v[160:163], v[80:83]
ds_read_b128 a[212:215], v240 offset:4416
ds_read_b128 a[216:219], v240 offset:4672
v_mfma_f32_16x16x32_bf16 v[112:115], a[228:231], v[164:167], v[112:115]
v_exp_f32 v151, v151
v_mfma_f32_16x16x32_bf16 v[112:115], a[224:227], v[172:175], v[112:115]
ds_read_b128 a[220:223], v240 offset:4928
ds_read_b128 a[204:207], v240 offset:768
v_mfma_f32_16x16x32_bf16 v[116:119], a[232:235], v[172:175], v[116:119]
s_add_u32 m0, s33, 0x0
v_exp_f32 v156, v156
v_mfma_f32_16x16x32_bf16 v[116:119], a[236:239], v[164:167], v[116:119]
buffer_load_dwordx4 v243, s[8:11], s56 offen offset:1024 nt lds
v_mfma_f32_16x16x32_bf16 v[84:87], a[236:239], v[160:163], v[84:87]
ds_read_b128 a[200:203], v240 offset:512
v_cvt_pk_bf16_f32 v195, v150, v151
v_mfma_f32_16x16x32_bf16 v[84:87], a[232:235], v[168:171], v[84:87]
ds_read_b128 a[196:199], v240 offset:256
v_mov_b64_e64 v[206:207], v[204:205]
v_mfma_f32_16x16x32_bf16 v[88:91], a[240:243], v[168:171], v[88:91]
ds_read_b128 a[192:195], v240
v_cvt_pk_bf16_f32 v35, v38, v39
v_mfma_f32_16x16x32_bf16 v[88:91], a[244:247], v[160:163], v[88:91]
ds_read_b128 v[210:213], v242 offset:4416
v_mfma_f32_16x16x32_bf16 v[120:123], a[244:247], v[164:167], v[120:123]
v_exp_f32 v157, v157
v_mfma_f32_16x16x32_bf16 v[120:123], a[240:243], v[172:175], v[120:123]
s_waitcnt lgkmcnt(4)
v_exp_f32 v158, v158
v_mfma_f32_16x16x32_bf16 v[124:127], a[248:251], v[172:175], v[124:127]
v_exp_f32 v159, v159
v_mfma_f32_16x16x32_bf16 v[124:127], a[252:255], v[164:167], v[124:127]
v_exp_f32 v152, v152
v_mfma_f32_16x16x32_bf16 v[92:95], a[252:255], v[160:163], v[92:95]
v_cvt_pk_bf16_f32 v198, v156, v157
v_cvt_pk_bf16_f32 v199, v158, v159
v_mfma_f32_16x16x32_bf16 v[92:95], a[248:251], v[168:171], v[92:95]
v_exp_f32 v153, v153
v_exp_f32_e64 v154, v154
v_cvt_pk_bf16_f32 v196, v152, v153
v_pk_mul_f32 v[46:47], v[46:47], v[250:251] op_sel:[0,1] op_sel_hi:[1,1]
v_pk_mul_f32 v[44:45], v[44:45], v[250:251] op_sel:[0,1] op_sel_hi:[1,1]
v_pk_mul_f32 v[42:43], v[42:43], v[250:251] op_sel:[0,1] op_sel_hi:[1,1]
v_pk_mul_f32 v[40:41], v[40:41], v[250:251] op_sel:[0,1] op_sel_hi:[1,1]
v_cvt_pk_bf16_f32 v40, v40, v41
v_mfma_f32_16x16x32_bf16 v[200:203], v[236:239], v[200:203], 0
v_exp_f32 v155, v155
v_mfma_f32_16x16x32_bf16 v[204:207], v[236:239], v[204:207], 0
s_waitcnt lgkmcnt(1)
v_cvt_pk_bf16_f32 v197, v154, v155
v_cvt_pk_bf16_f32 v41, v42, v43
v_mfma_f32_16x16x32_bf16 v[128:131], a[192:195], a[64:67], -4.0
s_waitcnt lgkmcnt(0)
v_mov_b64 v[208:209], v[210:211]
v_mov_b64 v[214:215], v[212:213]
v_mfma_f32_16x16x32_bf16 v[128:131], a[196:199], a[68:71], v[128:131]
v_cvt_pk_bf16_f32 v42, v44, v45
v_cvt_pk_bf16_f32 v43, v46, v47
v_mfma_f32_16x16x32_bf16 v[128:131], a[200:203], a[72:75], v[128:131]
v_mov_b64 v[44:45], v[32:33]
v_mov_b64_e64 v[46:47], v[34:35]
v_mfma_f32_16x16x32_bf16 v[128:131], a[204:207], a[76:79], v[128:131]
v_mov_b32_dpp v32, v40 row_ror:8 row_mask:0xf bank_mask:0xc
v_mov_b32_dpp v33, v41 row_ror:8 row_mask:0xf bank_mask:0xc
v_mfma_f32_16x16x32_bf16 v[132:135], a[220:223], a[76:79], -4.0
v_mov_b32_dpp v34, v42 row_ror:8 row_mask:0xf bank_mask:0xc
v_mov_b32_dpp v35, v43 row_ror:8 row_mask:0xf bank_mask:0xc
v_mfma_f32_16x16x32_bf16 v[132:135], a[216:219], a[72:75], v[132:135]
v_mov_b32_dpp v40, v44 row_ror:8 row_mask:0xf bank_mask:0x3
v_mov_b32_dpp v41, v45 row_ror:8 row_mask:0xf bank_mask:0x3
v_mfma_f32_16x16x32_bf16 v[132:135], a[212:215], a[68:71], v[132:135]
v_exp_f32 v128, v128
v_mfma_f32_16x16x32_bf16 v[132:135], a[208:211], a[64:67], v[132:135]
buffer_store_dwordx4 v[32:35], v249, s[20:23], s58 offen sc1
v_mfma_f32_16x16x32_bf16 v[140:143], a[208:211], a[80:83], -4.0
v_exp_f32 v129, v129
v_mfma_f32_16x16x32_bf16 v[140:143], a[212:215], a[84:87], v[140:143]
v_exp_f32 v130, v130
v_mfma_f32_16x16x32_bf16 v[140:143], a[216:219], a[88:91], v[140:143]
v_cvt_pk_bf16_f32 v160, v128, v129
v_mov_b32_dpp v42, v46 row_ror:8 row_mask:0xf bank_mask:0x3
v_mfma_f32_16x16x32_bf16 v[140:143], a[220:223], a[92:95], v[140:143]
s_add_u32 m0, s31, 0xc300
v_exp_f32 v131, v131
v_mfma_f32_16x16x32_bf16 v[136:139], a[204:207], a[92:95], -4.0
v_exp_f32_e64 v132, v132
v_mfma_f32_16x16x32_bf16 v[136:139], a[200:203], a[88:91], v[136:139]
v_cvt_pk_bf16_f32 v161, v130, v131
v_mov_b32_dpp v43, v47 row_ror:8 row_mask:0xf bank_mask:0x3
v_mfma_f32_16x16x32_bf16 v[136:139], a[196:199], a[84:87], v[136:139]
v_exp_f32 v133, v133
v_mfma_f32_16x16x32_bf16 v[136:139], a[192:195], a[80:83], v[136:139]
s_barrier
v_smfmac_f32_16x16x64_bf16 v[220:223], v[224:227], v[176:183], v248
v_mfma_f32_16x16x32_bf16 v[208:211], v[236:239], v[208:211], 0
v_exp_f32 v134, v134
v_mfma_f32_16x16x32_bf16 v[212:215], v[236:239], v[212:215], 0
v_exp_f32 v135, v135
v_mfma_f32_16x16x32_bf16 a[144:147], a[224:227], v[228:231], a[144:147]
v_exp_f32_e64 v140, v140
v_mfma_f32_16x16x32_bf16 a[144:147], a[228:231], v[176:179], a[144:147]
buffer_load_dwordx4 v243, s[12:15], s38 offen nt lds
v_mfma_f32_16x16x32_bf16 a[176:179], a[228:231], v[180:183], a[176:179]
v_cvt_pk_bf16_f32 v162, v132, v133
v_cvt_pk_bf16_f32 v163, v134, v135
v_mfma_f32_16x16x32_bf16 a[176:179], a[224:227], v[232:235], a[176:179]
ds_read_b64_tr_b16 a[224:225], v241 offset:33024
ds_read_b64_tr_b16 a[226:227], v241 offset:37152
v_mfma_f32_16x16x32_bf16 a[180:183], a[232:235], v[232:235], a[180:183]
v_exp_f32_e64 v141, v141
v_mfma_f32_16x16x32_bf16 a[180:183], a[236:239], v[180:183], a[180:183]
ds_read_b64_tr_b16 a[228:229], v241 offset:41280
ds_read_b64_tr_b16 a[230:231], v241 offset:45408
v_mfma_f32_16x16x32_bf16 a[148:151], a[236:239], v[176:179], a[148:151]
v_exp_f32 v142, v142
v_mfma_f32_16x16x32_bf16 a[148:151], a[232:235], v[228:231], a[148:151]
buffer_store_dwordx4 v[40:43], v249, s[20:23], s58 offen offset:2048 sc1
v_mfma_f32_16x16x32_bf16 a[152:155], a[240:243], v[228:231], a[152:155]
v_exp_f32 v143, v143
v_mfma_f32_16x16x32_bf16 a[152:155], a[244:247], v[176:179], a[152:155]
ds_read_b64_tr_b16 a[232:233], v241 offset:33032
ds_read_b64_tr_b16 a[234:235], v241 offset:37160
v_mfma_f32_16x16x32_bf16 a[184:187], a[244:247], v[180:183], a[184:187]
s_add_u32 m0, s31, 0xc300
v_exp_f32_e64 v136, v136
v_mfma_f32_16x16x32_bf16 a[184:187], a[240:243], v[232:235], a[184:187]
ds_read_b64_tr_b16 a[236:237], v241 offset:41288
ds_read_b64_tr_b16 a[238:239], v241 offset:45416
v_mfma_f32_16x16x32_bf16 a[188:191], a[248:251], v[232:235], a[188:191]
v_cvt_pk_bf16_f32 v166, v140, v141
v_cvt_pk_bf16_f32 v167, v142, v143
v_mfma_f32_16x16x32_bf16 a[188:191], a[252:255], v[180:183], a[188:191]
ds_read_b64_tr_b16 a[240:241], v241 offset:33280
ds_read_b64_tr_b16 a[242:243], v241 offset:37408
v_mfma_f32_16x16x32_bf16 a[156:159], a[252:255], v[176:179], a[156:159]
v_exp_f32_e64 v137, v137
v_mfma_f32_16x16x32_bf16 a[156:159], a[248:251], v[228:231], a[156:159]
ds_read_b64_tr_b16 a[244:245], v241 offset:41536
ds_read_b64_tr_b16 a[246:247], v241 offset:45664
v_mfma_f32_16x16x32_bf16 v[144:147], a[192:195], a[96:99], -4.0
v_exp_f32 v138, v138
v_mfma_f32_16x16x32_bf16 v[144:147], a[196:199], a[100:103], v[144:147]
v_exp_f32 v139, v139
v_mfma_f32_16x16x32_bf16 v[144:147], a[200:203], a[104:107], v[144:147]
v_cvt_pk_bf16_f32 v164, v136, v137
v_cvt_pk_bf16_f32 v165, v138, v139
v_mfma_f32_16x16x32_bf16 v[144:147], a[204:207], a[108:111], v[144:147]
buffer_load_dwordx4 v243, s[12:15], s38 offen offset:1024 nt lds
v_mfma_f32_16x16x32_bf16 v[148:151], a[220:223], a[108:111], -4.0
s_add_u32 m0, s33, 0x20
ds_read_b64_tr_b16 a[248:249], v241 offset:33288
ds_read_b64_tr_b16 a[250:251], v241 offset:37416
v_mfma_f32_16x16x32_bf16 v[148:151], a[216:219], a[104:107], v[148:151]
s_xor_b32 s38, s29, 0x818000
ds_read_b64_tr_b16 a[252:253], v241 offset:41544
ds_read_b64_tr_b16 a[254:255], v241 offset:45672
v_mfma_f32_16x16x32_bf16 v[148:151], a[212:215], a[100:103], v[148:151]
s_xor_b32 s39, s29, 0x814000
v_exp_f32 v144, v144
v_mfma_f32_16x16x32_bf16 v[148:151], a[208:211], a[96:99], v[148:151]
v_exp_f32 v145, v145
v_exp_f32 v146, v146
v_cvt_pk_bf16_f32 v168, v144, v145
v_pk_mul_f32 v[54:55], v[54:55], v[250:251] op_sel:[0,1] op_sel_hi:[1,1]
v_pk_mul_f32 v[52:53], v[52:53], v[250:251] op_sel:[0,1] op_sel_hi:[1,1]
v_pk_mul_f32 v[50:51], v[50:51], v[250:251] op_sel:[0,1] op_sel_hi:[1,1]
v_pk_mul_f32 v[48:49], v[48:49], v[250:251] op_sel:[0,1] op_sel_hi:[1,1]
v_cvt_pk_bf16_f32 v48, v48, v49
v_mfma_f32_16x16x32_bf16 v[156:159], a[208:211], a[112:115], -4.0
L_pad6:
s_cbranch_vccnz L_pad10
v_exp_f32_e64 v147, v147
v_mfma_f32_16x16x32_bf16 v[156:159], a[212:215], a[116:119], v[156:159]
v_exp_f32 v148, v148
v_mfma_f32_16x16x32_bf16 v[156:159], a[216:219], a[120:123], v[156:159]
v_cvt_pk_bf16_f32 v169, v146, v147
v_cvt_pk_bf16_f32 v49, v50, v51
v_mfma_f32_16x16x32_bf16 v[156:159], a[220:223], a[124:127], v[156:159]
buffer_load_dwordx4 v243, s[8:11], s56 offen offset:2048 nt lds
v_mfma_f32_16x16x32_bf16 v[152:155], a[204:207], a[124:127], -4.0
s_add_u32 m0, s31, 0x0
v_exp_f32 v149, v149
v_mfma_f32_16x16x32_bf16 v[152:155], a[200:203], a[120:123], v[152:155]
v_exp_f32 v150, v150
v_mfma_f32_16x16x32_bf16 v[152:155], a[196:199], a[116:119], v[152:155]
v_cvt_pk_bf16_f32 v170, v148, v149
v_cvt_pk_bf16_f32 v50, v52, v53
v_mfma_f32_16x16x32_bf16 v[152:155], a[192:195], a[112:115], v[152:155]
ds_read_b128 a[208:211], v240 offset:12480
ds_read_b128 a[212:215], v240 offset:12736
v_smfmac_f32_16x16x64_bf16 v[216:219], v[224:227], v[184:191], v248
s_waitcnt lgkmcnt(2)
buffer_load_dwordx4 v243, s[12:15], s38 offen nt lds
v_mfma_f32_16x16x32_bf16 v[64:67], a[224:227], v[184:187], v[64:67]
v_exp_f32 v151, v151
v_mfma_f32_16x16x32_bf16 v[64:67], a[228:231], v[160:163], v[64:67]
ds_read_b128 a[216:219], v240 offset:12992
ds_read_b128 a[220:223], v240 offset:13248
v_mfma_f32_16x16x32_bf16 v[96:99], a[228:231], v[164:167], v[96:99]
v_exp_f32 v156, v156
v_mfma_f32_16x16x32_bf16 v[96:99], a[224:227], v[188:191], v[96:99]
ds_read_b128 a[204:207], v240 offset:9088
v_cvt_pk_bf16_f32 v171, v150, v151
v_mfma_f32_16x16x32_bf16 v[100:103], a[232:235], v[188:191], v[100:103]
v_exp_f32_e64 v157, v157
v_mfma_f32_16x16x32_bf16 v[100:103], a[236:239], v[164:167], v[100:103]
ds_read_b128 a[200:203], v240 offset:8832
v_cvt_pk_bf16_f32 v51, v54, v55
v_mfma_f32_16x16x32_bf16 v[68:71], a[236:239], v[160:163], v[68:71]
v_exp_f32 v158, v158
v_mfma_f32_16x16x32_bf16 v[68:71], a[232:235], v[184:187], v[68:71]
ds_read_b128 a[196:199], v240 offset:8576
v_cvt_pk_bf16_f32 v174, v156, v157
v_mfma_f32_16x16x32_bf16 v[72:75], a[240:243], v[184:187], v[72:75]
s_add_u32 m0, s31, 0x0
ds_read_b128 a[192:195], v240 offset:8320
v_mfma_f32_16x16x32_bf16 v[72:75], a[244:247], v[160:163], v[72:75]
buffer_load_dwordx4 v243, s[12:15], s38 offen offset:1024 nt lds
v_mfma_f32_16x16x32_bf16 v[104:107], a[244:247], v[164:167], v[104:107]
v_exp_f32 v159, v159
v_mfma_f32_16x16x32_bf16 v[104:107], a[240:243], v[188:191], v[104:107]
v_exp_f32 v152, v152
v_cvt_pk_bf16_f32 v175, v158, v159
v_exp_f32_e64 v153, v153
v_pk_mul_f32 v[62:63], v[62:63], v[250:251] op_sel:[0,1] op_sel_hi:[1,1]
v_pk_mul_f32 v[60:61], v[60:61], v[250:251] op_sel:[0,1] op_sel_hi:[1,1]
v_pk_mul_f32 v[58:59], v[58:59], v[250:251] op_sel:[0,1] op_sel_hi:[1,1]
v_pk_mul_f32 v[56:57], v[56:57], v[250:251] op_sel:[0,1] op_sel_hi:[1,1]
v_cvt_pk_bf16_f32 v56, v56, v57
v_mfma_f32_16x16x32_bf16 v[108:111], a[248:251], v[188:191], v[108:111]
v_exp_f32 v154, v154
v_mfma_f32_16x16x32_bf16 v[108:111], a[252:255], v[164:167], v[108:111]
v_cvt_pk_bf16_f32 v172, v152, v153
v_cvt_pk_bf16_f32 v57, v58, v59
v_mfma_f32_16x16x32_bf16 v[76:79], a[252:255], v[160:163], v[76:79]
v_exp_f32 v155, v155
v_mfma_f32_16x16x32_bf16 v[76:79], a[248:251], v[184:187], v[76:79]
s_waitcnt lgkmcnt(0)
v_cvt_pk_bf16_f32 v173, v154, v155
v_cvt_pk_bf16_f32 v58, v60, v61
v_mfma_f32_16x16x32_bf16 v[128:131], a[192:195], a[64:67], -4.0
v_cvt_pk_bf16_f32 v59, v62, v63
v_mov_b64 v[60:61], v[48:49]
v_mfma_f32_16x16x32_bf16 v[128:131], a[196:199], a[68:71], v[128:131]
v_mov_b64_e64 v[62:63], v[50:51]
v_mov_b32_dpp v48, v56 row_ror:8 row_mask:0xf bank_mask:0xc
v_mfma_f32_16x16x32_bf16 v[128:131], a[200:203], a[72:75], v[128:131]
s_add_u32 m0, s32, 0x4080
v_mov_b32_dpp v49, v57 row_ror:8 row_mask:0xf bank_mask:0xc
v_mov_b32_dpp v50, v58 row_ror:8 row_mask:0xf bank_mask:0xc
v_mfma_f32_16x16x32_bf16 v[128:131], a[204:207], a[76:79], v[128:131]
buffer_load_dwordx4 v243, s[16:19], s39 offen nt lds
v_mfma_f32_16x16x32_bf16 v[132:135], a[220:223], a[76:79], -4.0
v_mov_b32_dpp v51, v59 row_ror:8 row_mask:0xf bank_mask:0xc
v_mov_b32_dpp v56, v60 row_ror:8 row_mask:0xf bank_mask:0x3
v_mfma_f32_16x16x32_bf16 v[132:135], a[216:219], a[72:75], v[132:135]
v_mov_b32_dpp v57, v61 row_ror:8 row_mask:0xf bank_mask:0x3
v_mov_b32_dpp v58, v62 row_ror:8 row_mask:0xf bank_mask:0x3
v_mfma_f32_16x16x32_bf16 v[132:135], a[212:215], a[68:71], v[132:135]
v_exp_f32 v128, v128
v_mfma_f32_16x16x32_bf16 v[132:135], a[208:211], a[64:67], v[132:135]
v_exp_f32 v129, v129
v_mfma_f32_16x16x32_bf16 v[140:143], a[208:211], a[80:83], -4.0
v_exp_f32 v130, v130
v_mfma_f32_16x16x32_bf16 v[140:143], a[212:215], a[84:87], v[140:143]
v_cvt_pk_bf16_f32 v176, v128, v129
v_mov_b32_dpp v59, v63 row_ror:8 row_mask:0xf bank_mask:0x3
v_mfma_f32_16x16x32_bf16 v[140:143], a[216:219], a[88:91], v[140:143]
v_exp_f32 v131, v131
v_mfma_f32_16x16x32_bf16 v[140:143], a[220:223], a[92:95], v[140:143]
buffer_store_dwordx4 v[48:51], v249, s[20:23], s58 offen offset:128 sc1
v_mfma_f32_16x16x32_bf16 v[136:139], a[204:207], a[92:95], -4.0
s_add_u32 m0, s32, 0x4080
v_exp_f32 v132, v132
v_mfma_f32_16x16x32_bf16 v[136:139], a[200:203], a[88:91], v[136:139]
v_cvt_pk_bf16_f32 v177, v130, v131
v_cvt_pk_bf16_f32 v16, v200, v201
v_mfma_f32_16x16x32_bf16 v[136:139], a[196:199], a[84:87], v[136:139]
v_exp_f32 v133, v133
v_mfma_f32_16x16x32_bf16 v[136:139], a[192:195], a[80:83], v[136:139]
v_exp_f32 v134, v134
v_smfmac_f32_16x16x64_bf16 v[220:223], v[224:227], v[192:199], v248
v_cvt_pk_bf16_f32 v178, v132, v133
v_mfma_f32_16x16x32_bf16 a[128:131], a[224:227], v[192:195], a[128:131]
v_exp_f32 v135, v135
v_mfma_f32_16x16x32_bf16 a[128:131], a[228:231], v[168:171], a[128:131]
v_exp_f32_e64 v140, v140
v_mfma_f32_16x16x32_bf16 a[160:163], a[228:231], v[172:175], a[160:163]
v_cvt_pk_bf16_f32 v179, v134, v135
v_cvt_pk_bf16_f32 v17, v202, v203
v_mfma_f32_16x16x32_bf16 a[160:163], a[224:227], v[196:199], a[160:163]
ds_read_b64_tr_b16 a[224:225], v241 offset:33536
ds_read_b64_tr_b16 a[226:227], v241 offset:37664
v_mfma_f32_16x16x32_bf16 a[164:167], a[232:235], v[196:199], a[164:167]
v_exp_f32_e64 v141, v141
v_mfma_f32_16x16x32_bf16 a[164:167], a[236:239], v[172:175], a[164:167]
buffer_load_dwordx4 v243, s[24:27], s39 offen offset:1032 nt lds
v_mfma_f32_16x16x32_bf16 a[132:135], a[236:239], v[168:171], a[132:135]
s_add_u32 m0, s33, 0x20
v_exp_f32 v142, v142
v_mfma_f32_16x16x32_bf16 a[132:135], a[232:235], v[192:195], a[132:135]
s_xor_b32 s39, s29, 0x816000
ds_read_b64_tr_b16 a[228:229], v241 offset:41792
ds_read_b64_tr_b16 a[230:231], v241 offset:45920
v_mfma_f32_16x16x32_bf16 a[136:139], a[240:243], v[192:195], a[136:139]
s_xor_b32 s38, s29, 0x81a000
v_cvt_pk_bf16_f32 v182, v140, v141
v_cvt_pk_bf16_f32 v18, v204, v205
v_mfma_f32_16x16x32_bf16 a[136:139], a[244:247], v[168:171], a[136:139]
ds_read_b64_tr_b16 a[232:233], v241 offset:33544
ds_read_b64_tr_b16 a[234:235], v241 offset:37672
v_mfma_f32_16x16x32_bf16 a[168:171], a[244:247], v[172:175], a[168:171]
v_exp_f32_e64 v143, v143
v_mfma_f32_16x16x32_bf16 a[168:171], a[240:243], v[196:199], a[168:171]
buffer_load_dwordx4 v243, s[8:11], s56 offen offset:3072 nt lds
v_mfma_f32_16x16x32_bf16 a[172:175], a[248:251], v[196:199], a[172:175]
s_xor_b32 s56, s28, 0x2003000
v_exp_f32_e64 v136, v136
v_mfma_f32_16x16x32_bf16 a[172:175], a[252:255], v[172:175], a[172:175]
ds_read_b64_tr_b16 a[236:237], v241 offset:41800
ds_read_b64_tr_b16 a[238:239], v241 offset:45928
v_mfma_f32_16x16x32_bf16 a[140:143], a[252:255], v[168:171], a[140:143]
s_add_u32 m0, s32, 0x60c0
v_cvt_pk_bf16_f32 v183, v142, v143
v_cvt_pk_bf16_f32 v19, v206, v207
v_mfma_f32_16x16x32_bf16 a[140:143], a[248:251], v[192:195], a[140:143]
ds_read_b64_tr_b16 a[240:241], v241 offset:33792
ds_read_b64_tr_b16 a[242:243], v241 offset:37920
v_mfma_f32_16x16x32_bf16 v[144:147], a[192:195], a[96:99], -4.0
v_exp_f32_e64 v137, v137
v_mfma_f32_16x16x32_bf16 v[144:147], a[196:199], a[100:103], v[144:147]
v_exp_f32 v138, v138
v_mfma_f32_16x16x32_bf16 v[144:147], a[200:203], a[104:107], v[144:147]
v_cvt_pk_bf16_f32 v180, v136, v137
v_cvt_pk_bf16_f32 v20, v208, v209
v_mfma_f32_16x16x32_bf16 v[144:147], a[204:207], a[108:111], v[144:147]
buffer_load_dwordx4 v243, s[16:19], s39 offen nt lds
v_mfma_f32_16x16x32_bf16 v[148:151], a[220:223], a[108:111], -4.0
v_exp_f32 v139, v139
v_mfma_f32_16x16x32_bf16 v[148:151], a[216:219], a[104:107], v[148:151]
v_cvt_pk_bf16_f32 v181, v138, v139
v_cvt_pk_bf16_f32 v21, v210, v211
v_mfma_f32_16x16x32_bf16 v[148:151], a[212:215], a[100:103], v[148:151]
v_cvt_pk_bf16_f32 v22, v212, v213
v_cvt_pk_bf16_f32 v23, v214, v215
v_mfma_f32_16x16x32_bf16 v[148:151], a[208:211], a[96:99], v[148:151]
ds_read_b64_tr_b16 a[244:245], v241 offset:42048
ds_read_b64_tr_b16 a[246:247], v241 offset:46176
v_mfma_f32_16x16x32_bf16 v[156:159], a[208:211], a[112:115], -4.0
v_exp_f32 v144, v144
v_mfma_f32_16x16x32_bf16 v[156:159], a[212:215], a[116:119], v[156:159]
v_exp_f32 v145, v145
v_mfma_f32_16x16x32_bf16 v[156:159], a[216:219], a[120:123], v[156:159]
v_exp_f32_e64 v146, v146
v_mfma_f32_16x16x32_bf16 v[156:159], a[220:223], a[124:127], v[156:159]
buffer_store_dwordx4 v[56:59], v249, s[20:23], s58 offen offset:2176 sc1
v_mfma_f32_16x16x32_bf16 v[152:155], a[204:207], a[124:127], -4.0
s_add_u32 m0, s32, 0x60c0
v_exp_f32 v147, v147
v_mfma_f32_16x16x32_bf16 v[152:155], a[200:203], a[120:123], v[152:155]
s_xor_b32 s59, s28, 0x2000
v_exp_f32 v148, v148
v_mfma_f32_16x16x32_bf16 v[152:155], a[196:199], a[116:119], v[152:155]
s_xor_b32 s35, s28, 0x3000
ds_read_b64_tr_b16 a[248:249], v241 offset:33800
v_cvt_pk_bf16_f32 v228, v144, v145
v_mfma_f32_16x16x32_bf16 v[152:155], a[192:195], a[112:115], v[152:155]
ds_read_b64_tr_b16 a[250:251], v241 offset:37928
ds_read_b64_tr_b16 a[252:253], v241 offset:42056
v_smfmac_f32_16x16x64_bf16 v[216:219], v[224:227], v[160:167], v248
s_waitcnt lgkmcnt(3)
ds_read_b64_tr_b16 a[254:255], v241 offset:46184
v_mfma_f32_16x16x32_bf16 v[80:83], a[224:227], v[184:187], v[80:83]
v_exp_f32 v149, v149
v_mfma_f32_16x16x32_bf16 v[80:83], a[228:231], v[160:163], v[80:83]
ds_read_b128 a[208:211], v240 offset:20800
ds_read_b128 a[212:215], v240 offset:21056
v_mfma_f32_16x16x32_bf16 v[112:115], a[228:231], v[164:167], v[112:115]
v_exp_f32_e64 v150, v150
v_mfma_f32_16x16x32_bf16 v[112:115], a[224:227], v[188:191], v[112:115]
ds_read_b128 a[216:219], v240 offset:21312
ds_read_b128 a[220:223], v240 offset:21568
v_mfma_f32_16x16x32_bf16 v[116:119], a[232:235], v[188:191], v[116:119]
v_cvt_pk_bf16_f32 v229, v146, v147
v_cvt_pk_bf16_f32 v230, v148, v149
v_mfma_f32_16x16x32_bf16 v[116:119], a[236:239], v[164:167], v[116:119]
ds_read_b128 a[204:207], v240 offset:17408
ds_read_b128 a[200:203], v240 offset:17152
v_mfma_f32_16x16x32_bf16 v[84:87], a[236:239], v[160:163], v[84:87]
v_exp_f32_e64 v151, v151
v_mfma_f32_16x16x32_bf16 v[84:87], a[232:235], v[184:187], v[84:87]
ds_read_b128 a[196:199], v240 offset:16896
ds_read_b128 v[202:205], v242 offset:4672
v_mfma_f32_16x16x32_bf16 v[88:91], a[240:243], v[184:187], v[88:91]
ds_read_b128 a[192:195], v240 offset:16640
ds_read_b128 v[210:213], v242 offset:4928
v_mfma_f32_16x16x32_bf16 v[88:91], a[244:247], v[160:163], v[88:91]
buffer_load_dwordx4 v243, s[24:27], s39 offen offset:1032 nt lds
v_mfma_f32_16x16x32_bf16 v[120:123], a[244:247], v[164:167], v[120:123]
v_exp_f32 v156, v156
v_mfma_f32_16x16x32_bf16 v[120:123], a[240:243], v[188:191], v[120:123]
s_waitcnt lgkmcnt(6)
v_exp_f32 v157, v157
v_mfma_f32_16x16x32_bf16 v[124:127], a[248:251], v[188:191], v[124:127]
v_exp_f32 v158, v158
v_mfma_f32_16x16x32_bf16 v[124:127], a[252:255], v[164:167], v[124:127]
v_cvt_pk_bf16_f32 v231, v150, v151
v_cvt_pk_bf16_f32 v234, v156, v157
v_mfma_f32_16x16x32_bf16 v[92:95], a[252:255], v[160:163], v[92:95]
s_waitcnt lgkmcnt(2)
v_exp_f32 v159, v159
v_mfma_f32_16x16x32_bf16 v[92:95], a[248:251], v[184:187], v[92:95]
s_waitcnt lgkmcnt(0)
v_exp_f32 v152, v152
v_mfma_f32_16x16x32_bf16 v[128:131], a[192:195], a[64:67], -4.0
v_cvt_pk_bf16_f32 v235, v158, v159
v_mov_b64 v[200:201], v[202:203]
v_mfma_f32_16x16x32_bf16 v[128:131], a[196:199], a[68:71], v[128:131]
v_exp_f32 v153, v153
v_mfma_f32_16x16x32_bf16 v[128:131], a[200:203], a[72:75], v[128:131]
v_exp_f32 v154, v154
v_mfma_f32_16x16x32_bf16 v[128:131], a[204:207], a[76:79], v[128:131]
v_cvt_pk_bf16_f32 v232, v152, v153
v_mov_b64 v[206:207], v[204:205]
v_mfma_f32_16x16x32_bf16 v[132:135], a[220:223], a[76:79], -4.0
v_exp_f32_e64 v155, v155
v_mfma_f32_16x16x32_bf16 v[132:135], a[216:219], a[72:75], v[132:135]
s_add_u32 m0, s33, 0x1040
v_cvt_pk_bf16_f32 v233, v154, v155
v_mov_b64 v[208:209], v[210:211]
v_mfma_f32_16x16x32_bf16 v[132:135], a[212:215], a[68:71], v[132:135]
v_exp_f32 v128, v128
v_mfma_f32_16x16x32_bf16 v[132:135], a[208:211], a[64:67], v[132:135]
buffer_load_dwordx4 v243, s[8:11], s56 offen nt lds
v_mfma_f32_16x16x32_bf16 v[140:143], a[208:211], a[80:83], -4.0
v_exp_f32 v129, v129
v_mfma_f32_16x16x32_bf16 v[140:143], a[212:215], a[84:87], v[140:143]
v_exp_f32 v130, v130
v_mfma_f32_16x16x32_bf16 v[140:143], a[216:219], a[88:91], v[140:143]
v_cvt_pk_bf16_f32 v160, v128, v129
v_mov_b64 v[214:215], v[212:213]
v_mfma_f32_16x16x32_bf16 v[140:143], a[220:223], a[92:95], v[140:143]
s_add_u32 m0, s31, 0x2080
v_exp_f32 v131, v131
v_mfma_f32_16x16x32_bf16 v[136:139], a[204:207], a[92:95], -4.0
v_exp_f32 v132, v132
v_mfma_f32_16x16x32_bf16 v[136:139], a[200:203], a[88:91], v[136:139]
v_exp_f32 v133, v133
v_mfma_f32_16x16x32_bf16 v[136:139], a[196:199], a[84:87], v[136:139]
s_waitcnt vmcnt(23)
v_exp_f32_e64 v134, v134
v_mfma_f32_16x16x32_bf16 v[136:139], a[192:195], a[80:83], v[136:139]
s_barrier
v_smfmac_f32_16x16x64_bf16 v[220:223], v[224:227], v[168:175], v248
buffer_load_dwordx4 v243, s[12:15], s38 offen nt lds
v_mfma_f32_16x16x32_bf16 v[200:203], v[236:239], v[200:203], 0
v_cvt_pk_bf16_f32 v161, v130, v131
v_cvt_pk_bf16_f32 v162, v132, v133
v_mfma_f32_16x16x32_bf16 v[204:207], v[236:239], v[204:207], 0
v_exp_f32 v135, v135
v_mfma_f32_16x16x32_bf16 a[144:147], a[224:227], v[192:195], a[144:147]
v_exp_f32 v140, v140
v_mfma_f32_16x16x32_bf16 a[144:147], a[228:231], v[168:171], a[144:147]
v_exp_f32_e64 v141, v141
v_mfma_f32_16x16x32_bf16 a[176:179], a[228:231], v[172:175], a[176:179]
v_cvt_pk_bf16_f32 v163, v134, v135
v_cvt_pk_bf16_f32 v24, v200, v201
v_mfma_f32_16x16x32_bf16 a[176:179], a[224:227], v[196:199], a[176:179]
ds_read_b64_tr_b16 a[224:225], v241 offset:49536
ds_read_b64_tr_b16 a[226:227], v241 offset:53664
v_mfma_f32_16x16x32_bf16 a[180:183], a[232:235], v[196:199], a[180:183]
v_exp_f32_e64 v142, v142
v_mfma_f32_16x16x32_bf16 a[180:183], a[236:239], v[172:175], a[180:183]
ds_read_b64_tr_b16 a[228:229], v241 offset:57792
ds_read_b64_tr_b16 a[230:231], v241 offset:61920
v_mfma_f32_16x16x32_bf16 a[148:151], a[236:239], v[168:171], a[148:151]
v_cvt_pk_bf16_f32 v166, v140, v141
v_cvt_pk_bf16_f32 v25, v202, v203
v_mfma_f32_16x16x32_bf16 a[148:151], a[232:235], v[192:195], a[148:151]
ds_read_b64_tr_b16 a[232:233], v241 offset:49544
ds_read_b64_tr_b16 a[234:235], v241 offset:53672
v_mfma_f32_16x16x32_bf16 a[152:155], a[240:243], v[192:195], a[152:155]
s_add_u32 m0, s31, 0x2080
v_exp_f32 v143, v143
v_mfma_f32_16x16x32_bf16 a[152:155], a[244:247], v[168:171], a[152:155]
buffer_load_dwordx4 v243, s[12:15], s38 offen offset:1024 nt lds
v_mfma_f32_16x16x32_bf16 a[184:187], a[244:247], v[172:175], a[184:187]
s_xor_b32 s38, s29, 0x81c000
v_exp_f32 v136, v136
v_mfma_f32_16x16x32_bf16 a[184:187], a[240:243], v[196:199], a[184:187]
s_xor_b32 s39, s29, 0x818000
ds_read_b64_tr_b16 a[236:237], v241 offset:57800
ds_read_b64_tr_b16 a[238:239], v241 offset:61928
v_mfma_f32_16x16x32_bf16 a[188:191], a[248:251], v[196:199], a[188:191]
v_cvt_pk_bf16_f32 v167, v142, v143
v_cvt_pk_bf16_f32 v26, v204, v205
v_mfma_f32_16x16x32_bf16 a[188:191], a[252:255], v[172:175], a[188:191]
ds_read_b64_tr_b16 a[240:241], v241 offset:49792
ds_read_b64_tr_b16 a[242:243], v241 offset:53920
v_mfma_f32_16x16x32_bf16 a[156:159], a[252:255], v[168:171], a[156:159]
v_exp_f32_e64 v137, v137
v_mfma_f32_16x16x32_bf16 a[156:159], a[248:251], v[192:195], a[156:159]
ds_read_b64_tr_b16 a[244:245], v241 offset:58048
v_cvt_pk_bf16_f32 v27, v206, v207
v_mfma_f32_16x16x32_bf16 v[208:211], v[236:239], v[208:211], 0
ds_read_b64_tr_b16 a[246:247], v241 offset:62176
ds_read_b64_tr_b16 a[248:249], v241 offset:49800
v_mfma_f32_16x16x32_bf16 v[212:215], v[236:239], v[212:215], 0
ds_read_b64_tr_b16 a[250:251], v241 offset:53928
ds_read_b64_tr_b16 a[252:253], v241 offset:58056
v_mfma_f32_16x16x32_bf16 v[144:147], a[192:195], a[96:99], -4.0
v_exp_f32_e64 v138, v138
v_mfma_f32_16x16x32_bf16 v[144:147], a[196:199], a[100:103], v[144:147]
v_cvt_pk_bf16_f32 v164, v136, v137
v_cvt_pk_bf16_f32 v28, v208, v209
v_mfma_f32_16x16x32_bf16 v[144:147], a[200:203], a[104:107], v[144:147]
s_add_u32 m0, s31, 0x4100
v_exp_f32_e64 v139, v139
v_mfma_f32_16x16x32_bf16 v[144:147], a[204:207], a[108:111], v[144:147]
buffer_load_dwordx4 v243, s[12:15], s38 offen nt lds
v_mfma_f32_16x16x32_bf16 v[148:151], a[220:223], a[108:111], -4.0
v_cvt_pk_bf16_f32 v165, v138, v139
v_cvt_pk_bf16_f32 v29, v210, v211
v_mfma_f32_16x16x32_bf16 v[148:151], a[216:219], a[104:107], v[148:151]
v_cvt_pk_bf16_f32 v30, v212, v213
v_cvt_pk_bf16_f32 v31, v214, v215
v_mfma_f32_16x16x32_bf16 v[148:151], a[212:215], a[100:103], v[148:151]
v_exp_f32_e64 v144, v144
v_mfma_f32_16x16x32_bf16 v[148:151], a[208:211], a[96:99], v[148:151]
ds_read_b64_tr_b16 a[254:255], v241 offset:62184
v_accvgpr_read_b32 v200, a0
v_mfma_f32_16x16x32_bf16 v[156:159], a[208:211], a[112:115], -4.0
v_exp_f32 v145, v145
v_mfma_f32_16x16x32_bf16 v[156:159], a[212:215], a[116:119], v[156:159]
v_exp_f32 v146, v146
v_mfma_f32_16x16x32_bf16 v[156:159], a[216:219], a[120:123], v[156:159]
v_cvt_pk_bf16_f32 v184, v144, v145
v_accvgpr_read_b32 v201, a1
v_mfma_f32_16x16x32_bf16 v[156:159], a[220:223], a[124:127], v[156:159]
ds_read_b128 a[208:211], v240 offset:29120
v_accvgpr_read_b32 v202, a2
v_mfma_f32_16x16x32_bf16 v[152:155], a[204:207], a[124:127], -4.0
s_add_u32 m0, s31, 0x4100
v_exp_f32 v147, v147
v_mfma_f32_16x16x32_bf16 v[152:155], a[200:203], a[120:123], v[152:155]
v_exp_f32 v148, v148
v_mfma_f32_16x16x32_bf16 v[152:155], a[196:199], a[116:119], v[152:155]
v_cvt_pk_bf16_f32 v185, v146, v147
v_accvgpr_read_b32 v203, a3
v_mfma_f32_16x16x32_bf16 v[152:155], a[192:195], a[112:115], v[152:155]
buffer_load_dwordx4 v243, s[12:15], s38 offen offset:1024 nt lds
v_smfmac_f32_16x16x64_bf16 v[216:219], v[224:227], v[176:183], v248
s_waitcnt lgkmcnt(1)
ds_read_b128 a[212:215], v240 offset:29376
v_mfma_f32_16x16x32_bf16 v[64:67], a[224:227], v[176:179], v[64:67]
s_add_u32 m0, s33, 0x1040
v_exp_f32 v149, v149
v_mfma_f32_16x16x32_bf16 v[64:67], a[228:231], v[160:163], v[64:67]
ds_read_b128 a[216:219], v240 offset:29632
ds_read_b128 a[220:223], v240 offset:29888
v_mfma_f32_16x16x32_bf16 v[96:99], a[228:231], v[164:167], v[96:99]
v_exp_f32_e64 v150, v150
v_mfma_f32_16x16x32_bf16 v[96:99], a[224:227], v[180:183], v[96:99]
buffer_load_dwordx4 v243, s[8:11], s56 offen offset:1024 nt lds
v_mfma_f32_16x16x32_bf16 v[100:103], a[232:235], v[180:183], v[100:103]
v_cvt_pk_bf16_f32 v186, v148, v149
v_accvgpr_read_b32 v204, a4
v_mfma_f32_16x16x32_bf16 v[100:103], a[236:239], v[164:167], v[100:103]
ds_read_b128 a[204:207], v240 offset:25728
ds_read_b128 a[200:203], v240 offset:25472
v_mfma_f32_16x16x32_bf16 v[68:71], a[236:239], v[160:163], v[68:71]
v_exp_f32_e64 v151, v151
v_mfma_f32_16x16x32_bf16 v[68:71], a[232:235], v[176:179], v[68:71]
s_add_u32 m0, s32, 0x8100
ds_read_b128 a[196:199], v240 offset:25216
v_accvgpr_read_b32 v205, a5
v_mfma_f32_16x16x32_bf16 v[72:75], a[240:243], v[176:179], v[72:75]
ds_read_b128 a[192:195], v240 offset:24960
v_accvgpr_read_b32 v206, a6
v_mfma_f32_16x16x32_bf16 v[72:75], a[244:247], v[160:163], v[72:75]
buffer_load_dwordx4 v243, s[16:19], s39 offen nt lds
v_mfma_f32_16x16x32_bf16 v[104:107], a[244:247], v[164:167], v[104:107]
v_exp_f32 v156, v156
v_mfma_f32_16x16x32_bf16 v[104:107], a[240:243], v[180:183], v[104:107]
v_cvt_pk_bf16_f32 v187, v150, v151
v_accvgpr_read_b32 v207, a7
v_mfma_f32_16x16x32_bf16 v[108:111], a[248:251], v[180:183], v[108:111]
v_exp_f32 v157, v157
v_mfma_f32_16x16x32_bf16 v[108:111], a[252:255], v[164:167], v[108:111]
v_exp_f32 v158, v158
v_cvt_pk_bf16_f32 v190, v156, v157
v_exp_f32 v159, v159
v_pk_mul_f32 v[206:207], v[206:207], v[252:253] op_sel:[0,0] op_sel_hi:[1,0]
v_pk_mul_f32 v[204:205], v[204:205], v[252:253] op_sel:[0,0] op_sel_hi:[1,0]
v_pk_mul_f32 v[202:203], v[202:203], v[252:253] op_sel:[0,0] op_sel_hi:[1,0]
v_pk_mul_f32 v[200:201], v[200:201], v[252:253] op_sel:[0,0] op_sel_hi:[1,0]
v_cvt_pk_bf16_f32 v200, v200, v201
v_mfma_f32_16x16x32_bf16 v[76:79], a[252:255], v[160:163], v[76:79]
v_exp_f32 v152, v152
v_mfma_f32_16x16x32_bf16 v[76:79], a[248:251], v[176:179], v[76:79]
s_waitcnt lgkmcnt(0)
v_cvt_pk_bf16_f32 v191, v158, v159
v_cvt_pk_bf16_f32 v201, v202, v203
v_mfma_f32_16x16x32_bf16 v[128:131], a[192:195], a[64:67], -4.0
v_exp_f32 v153, v153
v_mfma_f32_16x16x32_bf16 v[128:131], a[196:199], a[68:71], v[128:131]
v_exp_f32 v154, v154
v_mfma_f32_16x16x32_bf16 v[128:131], a[200:203], a[72:75], v[128:131]
s_add_u32 m0, s32, 0x8100
v_cvt_pk_bf16_f32 v188, v152, v153
v_cvt_pk_bf16_f32 v202, v204, v205
v_mfma_f32_16x16x32_bf16 v[128:131], a[204:207], a[76:79], v[128:131]
buffer_load_dwordx4 v243, s[24:27], s39 offen offset:1032 nt lds
v_mfma_f32_16x16x32_bf16 v[132:135], a[220:223], a[76:79], -4.0
s_xor_b32 s39, s29, 0x81a000
v_exp_f32_e64 v155, v155
v_mfma_f32_16x16x32_bf16 v[132:135], a[216:219], a[72:75], v[132:135]
s_xor_b32 s38, s29, 0x81e000
v_cvt_pk_bf16_f32 v189, v154, v155
v_cvt_pk_bf16_f32 v203, v206, v207
v_mfma_f32_16x16x32_bf16 v[132:135], a[212:215], a[68:71], v[132:135]
v_exp_f32 v128, v128
v_mfma_f32_16x16x32_bf16 v[132:135], a[208:211], a[64:67], v[132:135]
v_exp_f32 v129, v129
v_mfma_f32_16x16x32_bf16 v[140:143], a[208:211], a[80:83], -4.0
v_exp_f32_e64 v130, v130
v_mfma_f32_16x16x32_bf16 v[140:143], a[212:215], a[84:87], v[140:143]
v_cvt_pk_bf16_f32 v168, v128, v129
v_accvgpr_read_b32 v208, a8
v_mfma_f32_16x16x32_bf16 v[140:143], a[216:219], a[88:91], v[140:143]
v_exp_f32 v131, v131
v_mfma_f32_16x16x32_bf16 v[140:143], a[220:223], a[92:95], v[140:143]
v_exp_f32 v132, v132
v_mfma_f32_16x16x32_bf16 v[136:139], a[204:207], a[92:95], -4.0
s_add_u32 m0, s32, 0xa140
v_cvt_pk_bf16_f32 v169, v130, v131
v_accvgpr_read_b32 v209, a9
v_mfma_f32_16x16x32_bf16 v[136:139], a[200:203], a[88:91], v[136:139]
v_exp_f32 v133, v133
v_mfma_f32_16x16x32_bf16 v[136:139], a[196:199], a[84:87], v[136:139]
v_exp_f32 v134, v134
v_mfma_f32_16x16x32_bf16 v[136:139], a[192:195], a[80:83], v[136:139]
buffer_load_dwordx4 v243, s[16:19], s39 offen nt lds
v_smfmac_f32_16x16x64_bf16 v[220:223], v[224:227], v[228:235], v248
v_cvt_pk_bf16_f32 v170, v132, v133
v_mfma_f32_16x16x32_bf16 a[128:131], a[224:227], v[228:231], a[128:131]
v_exp_f32 v135, v135
v_mfma_f32_16x16x32_bf16 a[128:131], a[228:231], v[184:187], a[128:131]
v_exp_f32 v140, v140
v_mfma_f32_16x16x32_bf16 a[160:163], a[228:231], v[188:191], a[160:163]
v_cvt_pk_bf16_f32 v171, v134, v135
v_accvgpr_read_b32 v210, a10
v_mfma_f32_16x16x32_bf16 a[160:163], a[224:227], v[232:235], a[160:163]
ds_read_b64_tr_b16 a[224:225], v241 offset:50048
ds_read_b64_tr_b16 a[226:227], v241 offset:54176
v_mfma_f32_16x16x32_bf16 a[164:167], a[232:235], v[232:235], a[164:167]
v_exp_f32 v141, v141
v_mfma_f32_16x16x32_bf16 a[164:167], a[236:239], v[188:191], a[164:167]
ds_read_b64_tr_b16 a[228:229], v241 offset:58304
ds_read_b64_tr_b16 a[230:231], v241 offset:62432
v_mfma_f32_16x16x32_bf16 a[132:135], a[236:239], v[184:187], a[132:135]
v_exp_f32 v142, v142
v_mfma_f32_16x16x32_bf16 a[132:135], a[232:235], v[228:231], a[132:135]
s_add_u32 m0, s32, 0xa140
ds_read_b64_tr_b16 a[232:233], v241 offset:50056
ds_read_b64_tr_b16 a[234:235], v241 offset:54184
v_mfma_f32_16x16x32_bf16 a[136:139], a[240:243], v[228:231], a[136:139]
v_cvt_pk_bf16_f32 v174, v140, v141
v_accvgpr_read_b32 v211, a11
v_mfma_f32_16x16x32_bf16 a[136:139], a[244:247], v[184:187], a[136:139]
buffer_load_dwordx4 v243, s[24:27], s39 offen offset:1032 nt lds
v_mfma_f32_16x16x32_bf16 a[168:171], a[244:247], v[188:191], a[168:171]
v_exp_f32 v143, v143
v_mfma_f32_16x16x32_bf16 a[168:171], a[240:243], v[232:235], a[168:171]
ds_read_b64_tr_b16 a[236:237], v241 offset:58312
ds_read_b64_tr_b16 a[238:239], v241 offset:62440
v_mfma_f32_16x16x32_bf16 a[172:175], a[248:251], v[232:235], a[172:175]
v_exp_f32 v136, v136
v_mfma_f32_16x16x32_bf16 a[172:175], a[252:255], v[188:191], a[172:175]
s_add_u32 m0, s33, 0x1060
ds_read_b64_tr_b16 a[240:241], v241 offset:50304
ds_read_b64_tr_b16 a[242:243], v241 offset:54432
v_mfma_f32_16x16x32_bf16 a[140:143], a[252:255], v[184:187], a[140:143]
v_cvt_pk_bf16_f32 v175, v142, v143
v_accvgpr_read_b32 v212, a12
v_mfma_f32_16x16x32_bf16 a[140:143], a[248:251], v[228:231], a[140:143]
buffer_load_dwordx4 v243, s[8:11], s56 offen offset:2048 nt lds
v_mfma_f32_16x16x32_bf16 v[144:147], a[192:195], a[96:99], -4.0
v_exp_f32 v137, v137
v_mfma_f32_16x16x32_bf16 v[144:147], a[196:199], a[100:103], v[144:147]
v_exp_f32 v138, v138
v_mfma_f32_16x16x32_bf16 v[144:147], a[200:203], a[104:107], v[144:147]
v_cvt_pk_bf16_f32 v172, v136, v137
v_accvgpr_read_b32 v213, a13
v_mfma_f32_16x16x32_bf16 v[144:147], a[204:207], a[108:111], v[144:147]
ds_read_b64_tr_b16 a[244:245], v241 offset:58560
ds_read_b64_tr_b16 a[246:247], v241 offset:62688
v_mfma_f32_16x16x32_bf16 v[148:151], a[220:223], a[108:111], -4.0
v_exp_f32 v139, v139
v_mfma_f32_16x16x32_bf16 v[148:151], a[216:219], a[104:107], v[148:151]
v_cvt_pk_bf16_f32 v173, v138, v139
v_accvgpr_read_b32 v214, a14
v_mfma_f32_16x16x32_bf16 v[148:151], a[212:215], a[100:103], v[148:151]
v_exp_f32 v144, v144
v_mfma_f32_16x16x32_bf16 v[148:151], a[208:211], a[96:99], v[148:151]
ds_read_b64_tr_b16 a[248:249], v241 offset:50312
ds_read_b64_tr_b16 a[250:251], v241 offset:54440
v_mfma_f32_16x16x32_bf16 v[156:159], a[208:211], a[112:115], -4.0
v_exp_f32 v145, v145
v_mfma_f32_16x16x32_bf16 v[156:159], a[212:215], a[116:119], v[156:159]
v_exp_f32 v146, v146
v_mfma_f32_16x16x32_bf16 v[156:159], a[216:219], a[120:123], v[156:159]
v_cvt_pk_bf16_f32 v192, v144, v145
v_accvgpr_read_b32 v215, a15
v_mfma_f32_16x16x32_bf16 v[156:159], a[220:223], a[124:127], v[156:159]
ds_read_b64_tr_b16 a[252:253], v241 offset:58568
v_exp_f32 v147, v147
v_exp_f32 v148, v148
v_pk_mul_f32 v[214:215], v[214:215], v[252:253] op_sel:[0,0] op_sel_hi:[1,0]
v_pk_mul_f32 v[212:213], v[212:213], v[252:253] op_sel:[0,0] op_sel_hi:[1,0]
v_pk_mul_f32 v[210:211], v[210:211], v[252:253] op_sel:[0,0] op_sel_hi:[1,0]
v_pk_mul_f32 v[208:209], v[208:209], v[252:253] op_sel:[0,0] op_sel_hi:[1,0]
v_cvt_pk_bf16_f32 v208, v208, v209
v_mfma_f32_16x16x32_bf16 v[152:155], a[204:207], a[124:127], -4.0
L_pad7:
s_cbranch_vccnz L_pad11
v_cvt_pk_bf16_f32 v193, v146, v147
v_cvt_pk_bf16_f32 v209, v210, v211
v_mfma_f32_16x16x32_bf16 v[152:155], a[200:203], a[120:123], v[152:155]
v_exp_f32 v149, v149
v_mfma_f32_16x16x32_bf16 v[152:155], a[196:199], a[116:119], v[152:155]
v_exp_f32 v150, v150
v_mfma_f32_16x16x32_bf16 v[152:155], a[192:195], a[112:115], v[152:155]
ds_read_b64_tr_b16 a[254:255], v241 offset:62696
ds_read_b128 a[208:211], v240 offset:37440
v_smfmac_f32_16x16x64_bf16 v[216:219], v[224:227], v[160:167], v248
s_waitcnt lgkmcnt(3)
ds_read_b128 a[212:215], v240 offset:37696
v_mfma_f32_16x16x32_bf16 v[80:83], a[224:227], v[176:179], v[80:83]
v_cvt_pk_bf16_f32 v194, v148, v149
v_cvt_pk_bf16_f32 v210, v212, v213
v_mfma_f32_16x16x32_bf16 v[80:83], a[228:231], v[160:163], v[80:83]
ds_read_b128 a[216:219], v240 offset:37952
ds_read_b128 a[220:223], v240 offset:38208
v_mfma_f32_16x16x32_bf16 v[112:115], a[228:231], v[164:167], v[112:115]
v_exp_f32 v151, v151
v_mfma_f32_16x16x32_bf16 v[112:115], a[224:227], v[180:183], v[112:115]
ds_read_b128 a[204:207], v240 offset:34048
v_cvt_pk_bf16_f32 v211, v214, v215
v_mfma_f32_16x16x32_bf16 v[116:119], a[232:235], v[180:183], v[116:119]
v_exp_f32 v156, v156
v_mfma_f32_16x16x32_bf16 v[116:119], a[236:239], v[164:167], v[116:119]
ds_read_b128 a[200:203], v240 offset:33792
v_cvt_pk_bf16_f32 v195, v150, v151
v_mfma_f32_16x16x32_bf16 v[84:87], a[236:239], v[160:163], v[84:87]
v_exp_f32 v157, v157
v_mfma_f32_16x16x32_bf16 v[84:87], a[232:235], v[176:179], v[84:87]
ds_read_b128 a[196:199], v240 offset:33536
v_mov_b64 v[212:213], v[200:201]
v_mfma_f32_16x16x32_bf16 v[88:91], a[240:243], v[176:179], v[88:91]
ds_read_b128 a[192:195], v240 offset:33280
v_mov_b64 v[214:215], v[202:203]
v_mfma_f32_16x16x32_bf16 v[88:91], a[244:247], v[160:163], v[88:91]
v_exp_f32 v158, v158
v_mfma_f32_16x16x32_bf16 v[120:123], a[244:247], v[164:167], v[120:123]
v_cvt_pk_bf16_f32 v198, v156, v157
v_mov_b32_dpp v200, v208 row_ror:8 row_mask:0xf bank_mask:0xc
v_mfma_f32_16x16x32_bf16 v[120:123], a[240:243], v[180:183], v[120:123]
v_exp_f32 v159, v159
v_mfma_f32_16x16x32_bf16 v[124:127], a[248:251], v[180:183], v[124:127]
s_waitcnt lgkmcnt(2)
v_exp_f32 v152, v152
v_mfma_f32_16x16x32_bf16 v[124:127], a[252:255], v[164:167], v[124:127]
v_cvt_pk_bf16_f32 v199, v158, v159
v_mov_b32_dpp v201, v209 row_ror:8 row_mask:0xf bank_mask:0xc
v_mfma_f32_16x16x32_bf16 v[92:95], a[252:255], v[160:163], v[92:95]
v_exp_f32 v153, v153
v_mfma_f32_16x16x32_bf16 v[92:95], a[248:251], v[176:179], v[92:95]
s_waitcnt lgkmcnt(0)
v_exp_f32 v154, v154
v_mfma_f32_16x16x32_bf16 v[128:131], a[192:195], a[64:67], -4.0
v_cvt_pk_bf16_f32 v196, v152, v153
v_mov_b32_dpp v202, v210 row_ror:8 row_mask:0xf bank_mask:0xc
v_mfma_f32_16x16x32_bf16 v[128:131], a[196:199], a[68:71], v[128:131]
v_exp_f32_e64 v155, v155
v_mfma_f32_16x16x32_bf16 v[128:131], a[200:203], a[72:75], v[128:131]
v_cvt_pk_bf16_f32 v197, v154, v155
v_mov_b32_dpp v203, v211 row_ror:8 row_mask:0xf bank_mask:0xc
v_mfma_f32_16x16x32_bf16 v[128:131], a[204:207], a[76:79], v[128:131]
buffer_store_dwordx4 v[200:203], v249, s[20:23], s59 offen sc1
v_mfma_f32_16x16x32_bf16 v[132:135], a[220:223], a[76:79], -4.0
v_mov_b32_dpp v208, v212 row_ror:8 row_mask:0xf bank_mask:0x3
v_mov_b32_dpp v209, v213 row_ror:8 row_mask:0xf bank_mask:0x3
v_mfma_f32_16x16x32_bf16 v[132:135], a[216:219], a[72:75], v[132:135]
v_mov_b32_dpp v210, v214 row_ror:8 row_mask:0xf bank_mask:0x3
v_mov_b32_dpp v211, v215 row_ror:8 row_mask:0xf bank_mask:0x3
v_mfma_f32_16x16x32_bf16 v[132:135], a[212:215], a[68:71], v[132:135]
v_exp_f32 v128, v128
v_mfma_f32_16x16x32_bf16 v[132:135], a[208:211], a[64:67], v[132:135]
v_exp_f32 v129, v129
v_mfma_f32_16x16x32_bf16 v[140:143], a[208:211], a[80:83], -4.0
v_exp_f32 v130, v130
v_mfma_f32_16x16x32_bf16 v[140:143], a[212:215], a[84:87], v[140:143]
v_cvt_pk_bf16_f32 v160, v128, v129
v_accvgpr_read_b32 v200, a16
v_mfma_f32_16x16x32_bf16 v[140:143], a[216:219], a[88:91], v[140:143]
v_exp_f32 v131, v131
v_mfma_f32_16x16x32_bf16 v[140:143], a[220:223], a[92:95], v[140:143]
s_add_u32 m0, s31, 0x6180
v_exp_f32 v132, v132
v_mfma_f32_16x16x32_bf16 v[136:139], a[204:207], a[92:95], -4.0
v_cvt_pk_bf16_f32 v161, v130, v131
v_accvgpr_read_b32 v201, a17
v_mfma_f32_16x16x32_bf16 v[136:139], a[200:203], a[88:91], v[136:139]
v_exp_f32 v133, v133
v_mfma_f32_16x16x32_bf16 v[136:139], a[196:199], a[84:87], v[136:139]
s_waitcnt vmcnt(22)
v_exp_f32_e64 v134, v134
v_mfma_f32_16x16x32_bf16 v[136:139], a[192:195], a[80:83], v[136:139]
s_barrier
v_smfmac_f32_16x16x64_bf16 v[220:223], v[224:227], v[184:191], v248
buffer_load_dwordx4 v243, s[12:15], s38 offen nt lds
v_mfma_f32_16x16x32_bf16 a[144:147], a[224:227], v[228:231], a[144:147]
s_add_u32 m0, s33, 0x1060
v_cvt_pk_bf16_f32 v162, v132, v133
v_accvgpr_read_b32 v202, a18
v_mfma_f32_16x16x32_bf16 a[144:147], a[228:231], v[184:187], a[144:147]
v_exp_f32 v135, v135
v_mfma_f32_16x16x32_bf16 a[176:179], a[228:231], v[188:191], a[176:179]
v_exp_f32 v140, v140
v_mfma_f32_16x16x32_bf16 a[176:179], a[224:227], v[232:235], a[176:179]
ds_read_b64_tr_b16 a[224:225], v241
ds_read_b64_tr_b16 a[226:227], v241 offset:4128
v_mfma_f32_16x16x32_bf16 a[180:183], a[232:235], v[232:235], a[180:183]
v_cvt_pk_bf16_f32 v163, v134, v135
v_accvgpr_read_b32 v203, a19
v_mfma_f32_16x16x32_bf16 a[180:183], a[236:239], v[188:191], a[180:183]
buffer_load_dwordx4 v243, s[8:11], s56 offen offset:3072 nt lds
v_mfma_f32_16x16x32_bf16 a[148:151], a[236:239], v[184:187], a[148:151]
s_xor_b32 s56, s28, 0x3000000
v_exp_f32_e64 v141, v141
v_mfma_f32_16x16x32_bf16 a[148:151], a[232:235], v[228:231], a[148:151]
ds_read_b64_tr_b16 a[228:229], v241 offset:8256
ds_read_b64_tr_b16 a[230:231], v241 offset:12384
v_mfma_f32_16x16x32_bf16 a[152:155], a[240:243], v[228:231], a[152:155]
s_add_u32 m0, s31, 0x6180
v_exp_f32_e64 v142, v142
v_mfma_f32_16x16x32_bf16 a[152:155], a[244:247], v[184:187], a[152:155]
ds_read_b64_tr_b16 a[232:233], v241 offset:8
ds_read_b64_tr_b16 a[234:235], v241 offset:4136
v_mfma_f32_16x16x32_bf16 a[184:187], a[244:247], v[188:191], a[184:187]
v_cvt_pk_bf16_f32 v166, v140, v141
v_accvgpr_read_b32 v204, a20
v_mfma_f32_16x16x32_bf16 a[184:187], a[240:243], v[232:235], a[184:187]
buffer_load_dwordx4 v243, s[12:15], s38 offen offset:1024 nt lds
v_mfma_f32_16x16x32_bf16 a[188:191], a[248:251], v[232:235], a[188:191]
s_xor_b32 s38, s29, 0x1000000
v_exp_f32_e64 v143, v143
v_mfma_f32_16x16x32_bf16 a[188:191], a[252:255], v[188:191], a[188:191]
s_waitcnt vmcnt(18) lgkmcnt(4)
ds_read_b64_tr_b16 a[236:237], v241 offset:8264
ds_read_b64_tr_b16 a[238:239], v241 offset:12392
v_mfma_f32_16x16x32_bf16 a[156:159], a[252:255], v[184:187], a[156:159]
s_xor_b32 s39, s29, 0x81c000
v_exp_f32 v136, v136
v_mfma_f32_16x16x32_bf16 a[156:159], a[248:251], v[228:231], a[156:159]
ds_read_b64_tr_b16 a[240:241], v241 offset:256
ds_read_b64_tr_b16 a[242:243], v241 offset:4384
v_mfma_f32_16x16x32_bf16 v[144:147], a[192:195], a[96:99], -4.0
v_cvt_pk_bf16_f32 v167, v142, v143
v_accvgpr_read_b32 v205, a21
v_mfma_f32_16x16x32_bf16 v[144:147], a[196:199], a[100:103], v[144:147]
v_exp_f32 v137, v137
v_mfma_f32_16x16x32_bf16 v[144:147], a[200:203], a[104:107], v[144:147]
v_exp_f32 v138, v138
v_mfma_f32_16x16x32_bf16 v[144:147], a[204:207], a[108:111], v[144:147]
buffer_store_dwordx4 v[208:211], v249, s[20:23], s59 offen offset:2048 sc1
v_mfma_f32_16x16x32_bf16 v[148:151], a[220:223], a[108:111], -4.0
s_add_u32 m0, s31, 0x8200
v_cvt_pk_bf16_f32 v164, v136, v137
v_accvgpr_read_b32 v206, a22
v_mfma_f32_16x16x32_bf16 v[148:151], a[216:219], a[104:107], v[148:151]
v_exp_f32_e64 v139, v139
v_mfma_f32_16x16x32_bf16 v[148:151], a[212:215], a[100:103], v[148:151]
v_cvt_pk_bf16_f32 v165, v138, v139
v_accvgpr_read_b32 v207, a23
v_mfma_f32_16x16x32_bf16 v[148:151], a[208:211], a[96:99], v[148:151]
ds_read_b64_tr_b16 a[244:245], v241 offset:8512
v_exp_f32 v144, v144
v_exp_f32 v145, v145
v_pk_mul_f32 v[206:207], v[206:207], v[252:253] op_sel:[0,0] op_sel_hi:[1,0]
v_pk_mul_f32 v[204:205], v[204:205], v[252:253] op_sel:[0,0] op_sel_hi:[1,0]
v_pk_mul_f32 v[202:203], v[202:203], v[252:253] op_sel:[0,0] op_sel_hi:[1,0]
v_pk_mul_f32 v[200:201], v[200:201], v[252:253] op_sel:[0,0] op_sel_hi:[1,0]
v_cvt_pk_bf16_f32 v200, v200, v201
v_mfma_f32_16x16x32_bf16 v[156:159], a[208:211], a[112:115], -4.0
v_exp_f32 v146, v146
v_mfma_f32_16x16x32_bf16 v[156:159], a[212:215], a[116:119], v[156:159]
v_cvt_pk_bf16_f32 v176, v144, v145
v_cvt_pk_bf16_f32 v201, v202, v203
v_mfma_f32_16x16x32_bf16 v[156:159], a[216:219], a[120:123], v[156:159]
v_exp_f32 v147, v147
v_mfma_f32_16x16x32_bf16 v[156:159], a[220:223], a[124:127], v[156:159]
ds_read_b64_tr_b16 a[246:247], v241 offset:12640
ds_read_b64_tr_b16 a[248:249], v241 offset:264
v_mfma_f32_16x16x32_bf16 v[152:155], a[204:207], a[124:127], -4.0
v_exp_f32_e64 v148, v148
v_mfma_f32_16x16x32_bf16 v[152:155], a[200:203], a[120:123], v[152:155]
v_cvt_pk_bf16_f32 v177, v146, v147
v_cvt_pk_bf16_f32 v202, v204, v205
v_mfma_f32_16x16x32_bf16 v[152:155], a[196:199], a[116:119], v[152:155]
v_exp_f32 v149, v149
v_mfma_f32_16x16x32_bf16 v[152:155], a[192:195], a[112:115], v[152:155]
ds_read_b64_tr_b16 a[250:251], v241 offset:4392
ds_read_b64_tr_b16 a[252:253], v241 offset:8520
v_smfmac_f32_16x16x64_bf16 v[216:219], v[224:227], v[168:175], v248
buffer_load_dwordx4 v243, s[12:15], s38 offen nt lds
v_mfma_f32_16x16x32_bf16 v[64:67], a[224:227], v[168:171], v[64:67]
s_waitcnt lgkmcnt(4)
ds_read_b64_tr_b16 a[254:255], v241 offset:12648
v_cvt_pk_bf16_f32 v203, v206, v207
v_mfma_f32_16x16x32_bf16 v[64:67], a[228:231], v[160:163], v[64:67]
ds_read_b128 a[208:211], v240 offset:45760
ds_read_b128 a[212:215], v240 offset:46016
v_mfma_f32_16x16x32_bf16 v[96:99], a[228:231], v[164:167], v[96:99]
v_exp_f32_e64 v150, v150
v_mfma_f32_16x16x32_bf16 v[96:99], a[224:227], v[172:175], v[96:99]
ds_read_b128 a[216:219], v240 offset:46272
ds_read_b128 a[220:223], v240 offset:46528
v_mfma_f32_16x16x32_bf16 v[100:103], a[232:235], v[172:175], v[100:103]
v_cvt_pk_bf16_f32 v178, v148, v149
v_accvgpr_read_b32 v208, a24
v_mfma_f32_16x16x32_bf16 v[100:103], a[236:239], v[164:167], v[100:103]
ds_read_b128 a[204:207], v240 offset:42368
ds_read_b128 a[200:203], v240 offset:42112
v_mfma_f32_16x16x32_bf16 v[68:71], a[236:239], v[160:163], v[68:71]
v_exp_f32 v151, v151
v_mfma_f32_16x16x32_bf16 v[68:71], a[232:235], v[168:171], v[68:71]
ds_read_b128 a[196:199], v240 offset:41856
v_accvgpr_read_b32 v209, a25
v_mfma_f32_16x16x32_bf16 v[72:75], a[240:243], v[168:171], v[72:75]
s_waitcnt lgkmcnt(5)
ds_read_b128 a[192:195], v240 offset:41600
v_accvgpr_read_b32 v210, a26
v_mfma_f32_16x16x32_bf16 v[72:75], a[244:247], v[160:163], v[72:75]
s_add_u32 m0, s31, 0x8200
v_exp_f32_e64 v156, v156
v_mfma_f32_16x16x32_bf16 v[104:107], a[244:247], v[164:167], v[104:107]
v_cvt_pk_bf16_f32 v179, v150, v151
v_accvgpr_read_b32 v211, a27
v_mfma_f32_16x16x32_bf16 v[104:107], a[240:243], v[172:175], v[104:107]
buffer_load_dwordx4 v243, s[12:15], s38 offen offset:1024 nt lds
v_mfma_f32_16x16x32_bf16 v[108:111], a[248:251], v[172:175], v[108:111]
v_exp_f32 v157, v157
v_mfma_f32_16x16x32_bf16 v[108:111], a[252:255], v[164:167], v[108:111]
v_exp_f32 v158, v158
v_mfma_f32_16x16x32_bf16 v[76:79], a[252:255], v[160:163], v[76:79]
v_cvt_pk_bf16_f32 v182, v156, v157
v_accvgpr_read_b32 v212, a28
v_mfma_f32_16x16x32_bf16 v[76:79], a[248:251], v[168:171], v[76:79]
s_waitcnt lgkmcnt(0)
v_exp_f32 v159, v159
v_mfma_f32_16x16x32_bf16 v[128:131], a[192:195], a[64:67], -4.0
v_exp_f32 v152, v152
v_mfma_f32_16x16x32_bf16 v[128:131], a[196:199], a[68:71], v[128:131]
v_cvt_pk_bf16_f32 v183, v158, v159
v_accvgpr_read_b32 v213, a29
v_mfma_f32_16x16x32_bf16 v[128:131], a[200:203], a[72:75], v[128:131]
v_exp_f32 v153, v153
v_mfma_f32_16x16x32_bf16 v[128:131], a[204:207], a[76:79], v[128:131]
v_exp_f32_e64 v154, v154
v_mfma_f32_16x16x32_bf16 v[132:135], a[220:223], a[76:79], -4.0
s_add_u32 m0, s32, 0xc180
v_cvt_pk_bf16_f32 v180, v152, v153
v_accvgpr_read_b32 v214, a30
v_mfma_f32_16x16x32_bf16 v[132:135], a[216:219], a[72:75], v[132:135]
v_exp_f32_e64 v155, v155
v_mfma_f32_16x16x32_bf16 v[132:135], a[212:215], a[68:71], v[132:135]
v_cvt_pk_bf16_f32 v181, v154, v155
v_accvgpr_read_b32 v215, a31
v_mfma_f32_16x16x32_bf16 v[132:135], a[208:211], a[64:67], v[132:135]
buffer_load_dwordx4 v243, s[16:19], s39 offen nt lds
v_mfma_f32_16x16x32_bf16 v[140:143], a[208:211], a[80:83], -4.0
v_exp_f32 v128, v128
v_mfma_f32_16x16x32_bf16 v[140:143], a[212:215], a[84:87], v[140:143]
v_exp_f32 v129, v129
v_mfma_f32_16x16x32_bf16 v[140:143], a[216:219], a[88:91], v[140:143]
v_exp_f32_e64 v130, v130
v_mfma_f32_16x16x32_bf16 v[140:143], a[220:223], a[92:95], v[140:143]
v_cvt_pk_bf16_f32 v184, v128, v129
v_exp_f32 v131, v131
v_exp_f32 v132, v132
v_pk_mul_f32 v[214:215], v[214:215], v[252:253] op_sel:[0,0] op_sel_hi:[1,0]
v_pk_mul_f32 v[212:213], v[212:213], v[252:253] op_sel:[0,0] op_sel_hi:[1,0]
v_pk_mul_f32 v[210:211], v[210:211], v[252:253] op_sel:[0,0] op_sel_hi:[1,0]
v_pk_mul_f32 v[208:209], v[208:209], v[252:253] op_sel:[0,0] op_sel_hi:[1,0]
v_cvt_pk_bf16_f32 v208, v208, v209
v_mfma_f32_16x16x32_bf16 v[136:139], a[204:207], a[92:95], -4.0
v_cvt_pk_bf16_f32 v185, v130, v131
v_cvt_pk_bf16_f32 v209, v210, v211
v_mfma_f32_16x16x32_bf16 v[136:139], a[200:203], a[88:91], v[136:139]
v_exp_f32 v133, v133
v_mfma_f32_16x16x32_bf16 v[136:139], a[196:199], a[84:87], v[136:139]
v_exp_f32 v134, v134
v_mfma_f32_16x16x32_bf16 v[136:139], a[192:195], a[80:83], v[136:139]
v_cvt_pk_bf16_f32 v186, v132, v133
v_cvt_pk_bf16_f32 v210, v212, v213
v_smfmac_f32_16x16x64_bf16 v[220:223], v[224:227], v[192:199], v248
s_mov_b64 vcc, -1
s_cmp_lg_u32 s3, 0
s_cbranch_scc0 L_pad12
s_cmp_lg_u32 s3, 1
s_cbranch_scc0 L_pad13
s_cmp_lg_u32 s3, 2
s_cbranch_scc0 L_pad14
s_cmp_lg_u32 s3, 3
s_cbranch_scc0 L_pad15
L_back:
s_mov_b64 vcc, 0
s_add_u32 m0, s32, 0xc180
v_cvt_pk_bf16_f32 v211, v214, v215
v_mfma_f32_16x16x32_bf16 a[128:131], a[224:227], v[192:195], a[128:131]
v_exp_f32 v135, v135
v_mfma_f32_16x16x32_bf16 a[128:131], a[228:231], v[176:179], a[128:131]
buffer_load_dwordx4 v243, s[24:27], s39 offen offset:1032 nt lds
v_mfma_f32_16x16x32_bf16 a[160:163], a[228:231], v[180:183], a[160:163]
s_xor_b32 s39, s29, 0x81e000
v_exp_f32 v140, v140
v_mfma_f32_16x16x32_bf16 a[160:163], a[224:227], v[196:199], a[160:163]
s_xor_b32 s38, s29, 0x1002000
ds_read_b64_tr_b16 a[224:225], v241 offset:512
ds_read_b64_tr_b16 a[226:227], v241 offset:4640
v_mfma_f32_16x16x32_bf16 a[164:167], a[232:235], v[196:199], a[164:167]
v_cvt_pk_bf16_f32 v187, v134, v135
v_mov_b64_e64 v[212:213], v[200:201]
v_mfma_f32_16x16x32_bf16 a[164:167], a[236:239], v[180:183], a[164:167]
ds_read_b64_tr_b16 a[228:229], v241 offset:8768
ds_read_b64_tr_b16 a[230:231], v241 offset:12896
v_mfma_f32_16x16x32_bf16 a[132:135], a[236:239], v[176:179], a[132:135]
v_exp_f32 v141, v141
v_mfma_f32_16x16x32_bf16 a[132:135], a[232:235], v[192:195], a[132:135]
ds_read_b64_tr_b16 a[232:233], v241 offset:520
ds_read_b64_tr_b16 a[234:235], v241 offset:4648
v_mfma_f32_16x16x32_bf16 a[136:139], a[240:243], v[192:195], a[136:139]
v_exp_f32 v142, v142
v_mfma_f32_16x16x32_bf16 a[136:139], a[244:247], v[176:179], a[136:139]
ds_read_b64_tr_b16 a[236:237], v241 offset:8776
ds_read_b64_tr_b16 a[238:239], v241 offset:12904
v_mfma_f32_16x16x32_bf16 a[168:171], a[244:247], v[180:183], a[168:171]
s_add_u32 m0, s32, 0xe1c0
v_cvt_pk_bf16_f32 v190, v140, v141
v_mov_b64_e64 v[214:215], v[202:203]
v_mfma_f32_16x16x32_bf16 a[168:171], a[240:243], v[196:199], a[168:171]
buffer_load_dwordx4 v243, s[16:19], s39 offen nt lds
v_mfma_f32_16x16x32_bf16 a[172:175], a[248:251], v[196:199], a[172:175]
v_exp_f32 v143, v143
v_mfma_f32_16x16x32_bf16 a[172:175], a[252:255], v[180:183], a[172:175]
ds_read_b64_tr_b16 a[240:241], v241 offset:768
ds_read_b64_tr_b16 a[242:243], v241 offset:4896
v_mfma_f32_16x16x32_bf16 a[140:143], a[252:255], v[176:179], a[140:143]
v_exp_f32 v136, v136
v_mfma_f32_16x16x32_bf16 a[140:143], a[248:251], v[192:195], a[140:143]
ds_read_b64_tr_b16 a[244:245], v241 offset:9024
v_cvt_pk_bf16_f32 v191, v142, v143
v_mfma_f32_16x16x32_bf16 v[144:147], a[192:195], a[96:99], -4.0
v_exp_f32 v137, v137
v_mfma_f32_16x16x32_bf16 v[144:147], a[196:199], a[100:103], v[144:147]
v_exp_f32 v138, v138
v_mfma_f32_16x16x32_bf16 v[144:147], a[200:203], a[104:107], v[144:147]
v_cvt_pk_bf16_f32 v188, v136, v137
v_mov_b32_dpp v200, v208 row_ror:8 row_mask:0xf bank_mask:0xc
v_mfma_f32_16x16x32_bf16 v[144:147], a[204:207], a[108:111], v[144:147]
ds_read_b64_tr_b16 a[246:247], v241 offset:13152
ds_read_b64_tr_b16 a[248:249], v241 offset:776
v_mfma_f32_16x16x32_bf16 v[148:151], a[220:223], a[108:111], -4.0
s_add_u32 m0, s32, 0xe1c0
v_exp_f32_e64 v139, v139
v_mfma_f32_16x16x32_bf16 v[148:151], a[216:219], a[104:107], v[148:151]
v_cvt_pk_bf16_f32 v189, v138, v139
v_mov_b32_dpp v201, v209 row_ror:8 row_mask:0xf bank_mask:0xc
v_mfma_f32_16x16x32_bf16 v[148:151], a[212:215], a[100:103], v[148:151]
v_exp_f32 v144, v144
v_mfma_f32_16x16x32_bf16 v[148:151], a[208:211], a[96:99], v[148:151]
buffer_load_dwordx4 v243, s[24:27], s39 offen offset:1032 nt lds
v_mfma_f32_16x16x32_bf16 v[156:159], a[208:211], a[112:115], -4.0
v_mov_b32_dpp v202, v210 row_ror:8 row_mask:0xf bank_mask:0xc
v_mov_b32_dpp v203, v211 row_ror:8 row_mask:0xf bank_mask:0xc
v_mfma_f32_16x16x32_bf16 v[156:159], a[212:215], a[116:119], v[156:159]
v_exp_f32 v145, v145
v_mfma_f32_16x16x32_bf16 v[156:159], a[216:219], a[120:123], v[156:159]
v_exp_f32_e64 v146, v146
v_mfma_f32_16x16x32_bf16 v[156:159], a[220:223], a[124:127], v[156:159]
ds_read_b64_tr_b16 a[250:251], v241 offset:4904
ds_read_b64_tr_b16 a[252:253], v241 offset:9032
v_mov_b32_dpp v208, v212 row_ror:8 row_mask:0xf bank_mask:0x3
v_mfma_f32_16x16x32_bf16 v[152:155], a[204:207], a[124:127], -4.0
v_cvt_pk_bf16_f32 v228, v144, v145
v_mov_b32_dpp v209, v213 row_ror:8 row_mask:0xf bank_mask:0x3
v_mfma_f32_16x16x32_bf16 v[152:155], a[200:203], a[120:123], v[152:155]
v_mov_b32_dpp v210, v214 row_ror:8 row_mask:0xf bank_mask:0x3
v_mov_b32_dpp v211, v215 row_ror:8 row_mask:0xf bank_mask:0x3
v_mfma_f32_16x16x32_bf16 v[152:155], a[196:199], a[116:119], v[152:155]
v_exp_f32_e64 v147, v147
v_mfma_f32_16x16x32_bf16 v[152:155], a[192:195], a[112:115], v[152:155]
buffer_store_dwordx4 v[200:203], v249, s[20:23], s59 offen offset:128 sc1
v_smfmac_f32_16x16x64_bf16 v[216:219], v[224:227], v[160:167], v248
s_waitcnt lgkmcnt(2)
ds_read_b64_tr_b16 a[254:255], v241 offset:13160
v_mfma_f32_16x16x32_bf16 v[80:83], a[224:227], v[168:171], v[80:83]
v_exp_f32 v148, v148
v_mfma_f32_16x16x32_bf16 v[80:83], a[228:231], v[160:163], v[80:83]
ds_read_b128 a[208:211], v240 offset:54080
ds_read_b128 a[212:215], v240 offset:54336
v_mfma_f32_16x16x32_bf16 v[112:115], a[228:231], v[164:167], v[112:115]
v_exp_f32 v149, v149
v_mfma_f32_16x16x32_bf16 v[112:115], a[224:227], v[172:175], v[112:115]
ds_read_b128 a[216:219], v240 offset:54592
ds_read_b128 a[220:223], v240 offset:54848
v_mfma_f32_16x16x32_bf16 v[116:119], a[232:235], v[172:175], v[116:119]
v_exp_f32 v150, v150
v_mfma_f32_16x16x32_bf16 v[116:119], a[236:239], v[164:167], v[116:119]
ds_read_b128 a[204:207], v240 offset:50688
ds_read_b128 a[200:203], v240 offset:50432
v_mfma_f32_16x16x32_bf16 v[84:87], a[236:239], v[160:163], v[84:87]
v_cvt_pk_bf16_f32 v229, v146, v147
v_cvt_pk_bf16_f32 v230, v148, v149
v_mfma_f32_16x16x32_bf16 v[84:87], a[232:235], v[168:171], v[84:87]
ds_read_b128 a[196:199], v240 offset:50176
ds_read_b128 v[202:205], v242
v_mfma_f32_16x16x32_bf16 v[88:91], a[240:243], v[168:171], v[88:91]
ds_read_b128 a[192:195], v240 offset:49920
v_mfma_f32_16x16x32_bf16 v[88:91], a[244:247], v[160:163], v[88:91]
buffer_store_dwordx4 v[208:211], v249, s[20:23], s59 offen offset:2176 sc1
v_mfma_f32_16x16x32_bf16 v[120:123], a[244:247], v[164:167], v[120:123]
v_exp_f32 v151, v151
v_mfma_f32_16x16x32_bf16 v[120:123], a[240:243], v[172:175], v[120:123]
s_waitcnt lgkmcnt(5)
ds_read_b128 v[210:213], v242 offset:256
v_exp_f32 v156, v156
v_mfma_f32_16x16x32_bf16 v[124:127], a[248:251], v[172:175], v[124:127]
v_exp_f32 v157, v157
v_mfma_f32_16x16x32_bf16 v[124:127], a[252:255], v[164:167], v[124:127]
v_exp_f32 v158, v158
v_mfma_f32_16x16x32_bf16 v[92:95], a[252:255], v[160:163], v[92:95]
s_waitcnt lgkmcnt(2)
v_cvt_pk_bf16_f32 v231, v150, v151
v_cvt_pk_bf16_f32 v234, v156, v157
v_mfma_f32_16x16x32_bf16 v[92:95], a[248:251], v[168:171], v[92:95]
s_waitcnt lgkmcnt(1)
v_mov_b64 v[200:201], v[202:203]
v_mov_b64_e64 v[206:207], v[204:205]
v_mfma_f32_16x16x32_bf16 v[128:131], a[192:195], a[64:67], -4.0
v_exp_f32 v159, v159
v_mfma_f32_16x16x32_bf16 v[128:131], a[196:199], a[68:71], v[128:131]
v_exp_f32 v152, v152
v_mfma_f32_16x16x32_bf16 v[128:131], a[200:203], a[72:75], v[128:131]
s_waitcnt lgkmcnt(0)
v_cvt_pk_bf16_f32 v235, v158, v159
v_mov_b64 v[208:209], v[210:211]
v_mfma_f32_16x16x32_bf16 v[128:131], a[204:207], a[76:79], v[128:131]
v_mov_b64 v[214:215], v[212:213]
v_exp_f32 v153, v153
v_mfma_f32_16x16x32_bf16 v[132:135], a[220:223], a[76:79], -4.0
v_exp_f32 v154, v154
v_mfma_f32_16x16x32_bf16 v[132:135], a[216:219], a[72:75], v[132:135]
v_exp_f32 v155, v155
v_mfma_f32_16x16x32_bf16 v[132:135], a[212:215], a[68:71], v[132:135]
v_cvt_pk_bf16_f32 v232, v152, v153
v_cvt_pk_bf16_f32 v233, v154, v155
v_mfma_f32_16x16x32_bf16 v[132:135], a[208:211], a[64:67], v[132:135]
v_exp_f32_e64 v128, v128
v_mfma_f32_16x16x32_bf16 v[140:143], a[208:211], a[80:83], -4.0
v_exp_f32 v129, v129
v_mfma_f32_16x16x32_bf16 v[140:143], a[212:215], a[84:87], v[140:143]
v_exp_f32 v130, v130
v_mfma_f32_16x16x32_bf16 v[140:143], a[216:219], a[88:91], v[140:143]
v_exp_f32 v131, v131
v_mfma_f32_16x16x32_bf16 v[140:143], a[220:223], a[92:95], v[140:143]
s_add_u32 m0, s31, 0xa280
v_exp_f32 v132, v132
v_mfma_f32_16x16x32_bf16 v[136:139], a[204:207], a[92:95], -4.0
v_cvt_pk_bf16_f32 v160, v128, v129
v_cvt_pk_bf16_f32 v161, v130, v131
v_mfma_f32_16x16x32_bf16 v[136:139], a[200:203], a[88:91], v[136:139]
v_exp_f32 v133, v133
v_mfma_f32_16x16x32_bf16 v[136:139], a[196:199], a[84:87], v[136:139]
s_waitcnt vmcnt(21)
v_exp_f32 v134, v134
v_mfma_f32_16x16x32_bf16 v[136:139], a[192:195], a[80:83], v[136:139]
s_barrier
v_smfmac_f32_16x16x64_bf16 v[220:223], v[224:227], v[176:183], v248
buffer_load_dwordx4 v243, s[12:15], s38 offen nt lds
v_mfma_f32_16x16x32_bf16 v[200:203], v[236:239], v[200:203], 0
v_exp_f32 v135, v135
v_mfma_f32_16x16x32_bf16 v[204:207], v[236:239], v[204:207], 0
v_exp_f32 v140, v140
v_mfma_f32_16x16x32_bf16 a[144:147], a[224:227], v[192:195], a[144:147]
v_cvt_pk_bf16_f32 v162, v132, v133
v_cvt_pk_bf16_f32 v163, v134, v135
v_mfma_f32_16x16x32_bf16 a[144:147], a[228:231], v[176:179], a[144:147]
v_exp_f32_e64 v141, v141
v_cvt_pk_bf16_f32 v32, v200, v201
v_mfma_f32_16x16x32_bf16 a[176:179], a[228:231], v[180:183], a[176:179]
v_cvt_pk_bf16_f32 v33, v202, v203
v_cvt_pk_bf16_f32 v34, v204, v205
v_mfma_f32_16x16x32_bf16 a[176:179], a[224:227], v[196:199], a[176:179]
ds_read_b64_tr_b16 a[224:225], v241 offset:16512
ds_read_b64_tr_b16 a[226:227], v241 offset:20640
v_cvt_pk_bf16_f32 v35, v206, v207
v_mfma_f32_16x16x32_bf16 a[180:183], a[232:235], v[196:199], a[180:183]
v_exp_f32 v142, v142
v_mfma_f32_16x16x32_bf16 a[180:183], a[236:239], v[180:183], a[180:183]
ds_read_b64_tr_b16 a[228:229], v241 offset:24768
ds_read_b64_tr_b16 a[230:231], v241 offset:28896
v_mfma_f32_16x16x32_bf16 a[148:151], a[236:239], v[176:179], a[148:151]
v_exp_f32 v143, v143
v_mfma_f32_16x16x32_bf16 a[148:151], a[232:235], v[192:195], a[148:151]
ds_read_b64_tr_b16 a[232:233], v241 offset:16520
ds_read_b64_tr_b16 a[234:235], v241 offset:20648
v_mfma_f32_16x16x32_bf16 a[152:155], a[240:243], v[192:195], a[152:155]
s_add_u32 m0, s31, 0xa280
v_exp_f32_e64 v136, v136
v_mfma_f32_16x16x32_bf16 a[152:155], a[244:247], v[176:179], a[152:155]
buffer_load_dwordx4 v243, s[12:15], s38 offen offset:1024 nt lds
v_mfma_f32_16x16x32_bf16 a[184:187], a[244:247], v[180:183], a[184:187]
s_xor_b32 s38, s29, 0x1004000
v_cvt_pk_bf16_f32 v166, v140, v141
v_cvt_pk_bf16_f32 v167, v142, v143
v_mfma_f32_16x16x32_bf16 a[184:187], a[240:243], v[196:199], a[184:187]
s_xor_b32 s39, s29, 0x1000000
ds_read_b64_tr_b16 a[236:237], v241 offset:24776
ds_read_b64_tr_b16 a[238:239], v241 offset:28904
v_mfma_f32_16x16x32_bf16 a[188:191], a[248:251], v[196:199], a[188:191]
v_exp_f32 v137, v137
v_mfma_f32_16x16x32_bf16 a[188:191], a[252:255], v[180:183], a[188:191]
ds_read_b64_tr_b16 a[240:241], v241 offset:16768
ds_read_b64_tr_b16 a[242:243], v241 offset:20896
v_mfma_f32_16x16x32_bf16 a[156:159], a[252:255], v[176:179], a[156:159]
v_exp_f32 v138, v138
v_mfma_f32_16x16x32_bf16 a[156:159], a[248:251], v[192:195], a[156:159]
ds_read_b64_tr_b16 a[244:245], v241 offset:25024
ds_read_b128 v[202:205], v242 offset:512
v_mfma_f32_16x16x32_bf16 v[208:211], v[236:239], v[208:211], 0
ds_read_b64_tr_b16 a[246:247], v241 offset:29152
v_cvt_pk_bf16_f32 v164, v136, v137
v_mfma_f32_16x16x32_bf16 v[212:215], v[236:239], v[212:215], 0
ds_read_b64_tr_b16 a[248:249], v241 offset:16776
ds_read_b64_tr_b16 a[250:251], v241 offset:20904
v_mfma_f32_16x16x32_bf16 v[144:147], a[192:195], a[96:99], -4.0
v_exp_f32_e64 v139, v139
v_mfma_f32_16x16x32_bf16 v[144:147], a[196:199], a[100:103], v[144:147]
v_cvt_pk_bf16_f32 v165, v138, v139
v_cvt_pk_bf16_f32 v36, v208, v209
v_mfma_f32_16x16x32_bf16 v[144:147], a[200:203], a[104:107], v[144:147]
s_add_u32 m0, s31, 0xc300
v_cvt_pk_bf16_f32 v37, v210, v211
v_cvt_pk_bf16_f32 v38, v212, v213
v_mfma_f32_16x16x32_bf16 v[144:147], a[204:207], a[108:111], v[144:147]
buffer_load_dwordx4 v243, s[12:15], s38 offen nt lds
v_mfma_f32_16x16x32_bf16 v[148:151], a[220:223], a[108:111], -4.0
v_cvt_pk_bf16_f32 v39, v214, v215
v_mfma_f32_16x16x32_bf16 v[148:151], a[216:219], a[104:107], v[148:151]
ds_read_b64_tr_b16 a[252:253], v241 offset:25032
ds_read_b128 v[210:213], v242 offset:768
v_mfma_f32_16x16x32_bf16 v[148:151], a[212:215], a[100:103], v[148:151]
s_waitcnt lgkmcnt(2)
v_mov_b64 v[200:201], v[202:203]
v_mov_b64 v[206:207], v[204:205]
v_mfma_f32_16x16x32_bf16 v[148:151], a[208:211], a[96:99], v[148:151]
ds_read_b64_tr_b16 a[254:255], v241 offset:29160
v_exp_f32 v144, v144
v_mfma_f32_16x16x32_bf16 v[156:159], a[208:211], a[112:115], -4.0
v_exp_f32 v145, v145
v_mfma_f32_16x16x32_bf16 v[156:159], a[212:215], a[116:119], v[156:159]
v_exp_f32 v146, v146
v_mfma_f32_16x16x32_bf16 v[156:159], a[216:219], a[120:123], v[156:159]
v_exp_f32_e64 v147, v147
v_mfma_f32_16x16x32_bf16 v[156:159], a[220:223], a[124:127], v[156:159]
ds_read_b128 a[208:211], v240 offset:4160
v_cvt_pk_bf16_f32 v168, v144, v145
v_mfma_f32_16x16x32_bf16 v[152:155], a[204:207], a[124:127], -4.0
s_add_u32 m0, s31, 0xc300
v_exp_f32 v148, v148
v_mfma_f32_16x16x32_bf16 v[152:155], a[200:203], a[120:123], v[152:155]
s_waitcnt lgkmcnt(2)
v_cvt_pk_bf16_f32 v169, v146, v147
v_mov_b64 v[208:209], v[210:211]
v_mfma_f32_16x16x32_bf16 v[152:155], a[196:199], a[116:119], v[152:155]
v_mov_b64_e64 v[214:215], v[212:213]
v_mfma_f32_16x16x32_bf16 v[152:155], a[192:195], a[112:115], v[152:155]
buffer_load_dwordx4 v243, s[12:15], s38 offen offset:1024 nt lds
v_mfma_f32_16x16x32_bf16 v[200:203], v[236:239], v[200:203], 0
s_add_u32 m0, s33, 0x0
ds_read_b128 a[212:215], v240 offset:4416
ds_read_b128 a[216:219], v240 offset:4672
v_mfma_f32_16x16x32_bf16 v[204:207], v[236:239], v[204:207], 0
L_pad8:
s_cbranch_vccnz L_main
ds_read_b128 a[220:223], v240 offset:4928
ds_read_b128 a[204:207], v240 offset:768
v_smfmac_f32_16x16x64_bf16 v[216:219], v[224:227], v[184:191], v248
ds_read_b128 a[200:203], v240 offset:512
v_cvt_pk_bf16_f32 v40, v200, v201
v_mfma_f32_16x16x32_bf16 v[208:211], v[236:239], v[208:211], 0
ds_read_b128 a[196:199], v240 offset:256
v_cvt_pk_bf16_f32 v41, v202, v203
v_cvt_pk_bf16_f32 v42, v204, v205
v_mfma_f32_16x16x32_bf16 v[212:215], v[236:239], v[212:215], 0
ds_read_b128 a[192:195], v240
v_cvt_pk_bf16_f32 v43, v206, v207
v_mfma_f32_16x16x32_bf16 v[64:67], a[224:227], v[184:187], v[64:67]
v_exp_f32 v149, v149
v_mfma_f32_16x16x32_bf16 v[64:67], a[228:231], v[160:163], v[64:67]
v_exp_f32 v150, v150
v_mfma_f32_16x16x32_bf16 v[96:99], a[228:231], v[164:167], v[96:99]
v_cvt_pk_bf16_f32 v170, v148, v149
v_cvt_pk_bf16_f32 v44, v208, v209
v_mfma_f32_16x16x32_bf16 v[96:99], a[224:227], v[188:191], v[96:99]
buffer_load_dwordx4 v243, s[8:11], s56 offen nt lds
v_mfma_f32_16x16x32_bf16 v[100:103], a[232:235], v[188:191], v[100:103]
v_exp_f32 v151, v151
v_mfma_f32_16x16x32_bf16 v[100:103], a[236:239], v[164:167], v[100:103]
v_exp_f32 v156, v156
v_mfma_f32_16x16x32_bf16 v[68:71], a[236:239], v[160:163], v[68:71]
v_cvt_pk_bf16_f32 v171, v150, v151
v_cvt_pk_bf16_f32 v45, v210, v211
v_mfma_f32_16x16x32_bf16 v[68:71], a[232:235], v[184:187], v[68:71]
s_add_u32 m0, s32, 0x0
v_exp_f32 v157, v157
v_mfma_f32_16x16x32_bf16 v[72:75], a[240:243], v[184:187], v[72:75]
v_exp_f32 v158, v158
v_mfma_f32_16x16x32_bf16 v[72:75], a[244:247], v[160:163], v[72:75]
buffer_load_dwordx4 v243, s[16:19], s39 offen nt lds
v_mfma_f32_16x16x32_bf16 v[104:107], a[244:247], v[164:167], v[104:107]
v_cvt_pk_bf16_f32 v174, v156, v157
v_cvt_pk_bf16_f32 v46, v212, v213
v_mfma_f32_16x16x32_bf16 v[104:107], a[240:243], v[188:191], v[104:107]
v_exp_f32 v159, v159
v_mfma_f32_16x16x32_bf16 v[108:111], a[248:251], v[188:191], v[108:111]
s_waitcnt lgkmcnt(0)
v_exp_f32_e64 v152, v152
v_mfma_f32_16x16x32_bf16 v[108:111], a[252:255], v[164:167], v[108:111]
v_cvt_pk_bf16_f32 v175, v158, v159
v_cvt_pk_bf16_f32 v47, v214, v215
v_mfma_f32_16x16x32_bf16 v[76:79], a[252:255], v[160:163], v[76:79]
v_exp_f32 v153, v153
v_mfma_f32_16x16x32_bf16 v[76:79], a[248:251], v[184:187], v[76:79]
v_exp_f32 v154, v154
v_mfma_f32_16x16x32_bf16 v[128:131], a[192:195], a[64:67], -4.0
v_cvt_pk_bf16_f32 v172, v152, v153
v_accvgpr_read_b32 v200, a32
v_mfma_f32_16x16x32_bf16 v[128:131], a[196:199], a[68:71], v[128:131]
v_exp_f32 v155, v155
v_mfma_f32_16x16x32_bf16 v[128:131], a[200:203], a[72:75], v[128:131]
s_add_u32 m0, s32, 0x0
v_cvt_pk_bf16_f32 v173, v154, v155
v_accvgpr_read_b32 v201, a33
v_mfma_f32_16x16x32_bf16 v[128:131], a[204:207], a[76:79], v[128:131]
buffer_load_dwordx4 v243, s[24:27], s39 offen offset:1032 nt lds
v_mfma_f32_16x16x32_bf16 v[132:135], a[220:223], a[76:79], -4.0
s_xor_b32 s39, s29, 0x1002000
v_accvgpr_read_b32 v202, a34
v_accvgpr_read_b32 v203, a35
v_mfma_f32_16x16x32_bf16 v[132:135], a[216:219], a[72:75], v[132:135]
s_xor_b32 s38, s29, 0x1006000
v_accvgpr_read_b32 v204, a36
v_accvgpr_read_b32 v205, a37
v_mfma_f32_16x16x32_bf16 v[132:135], a[212:215], a[68:71], v[132:135]
v_exp_f32 v128, v128
v_mfma_f32_16x16x32_bf16 v[132:135], a[208:211], a[64:67], v[132:135]
v_exp_f32 v129, v129
v_mfma_f32_16x16x32_bf16 v[140:143], a[208:211], a[80:83], -4.0
v_exp_f32_e64 v130, v130
v_mfma_f32_16x16x32_bf16 v[140:143], a[212:215], a[84:87], v[140:143]
v_cvt_pk_bf16_f32 v176, v128, v129
v_accvgpr_read_b32 v206, a38
v_mfma_f32_16x16x32_bf16 v[140:143], a[216:219], a[88:91], v[140:143]
v_exp_f32 v131, v131
v_mfma_f32_16x16x32_bf16 v[140:143], a[220:223], a[92:95], v[140:143]
v_exp_f32 v132, v132
v_mfma_f32_16x16x32_bf16 v[136:139], a[204:207], a[92:95], -4.0
s_add_u32 m0, s32, 0x2040
v_cvt_pk_bf16_f32 v177, v130, v131
v_accvgpr_read_b32 v207, a39
v_mfma_f32_16x16x32_bf16 v[136:139], a[200:203], a[88:91], v[136:139]
v_exp_f32 v133, v133
v_mfma_f32_16x16x32_bf16 v[136:139], a[196:199], a[84:87], v[136:139]
v_exp_f32 v134, v134
v_mfma_f32_16x16x32_bf16 v[136:139], a[192:195], a[80:83], v[136:139]
buffer_load_dwordx4 v243, s[16:19], s39 offen nt lds
v_smfmac_f32_16x16x64_bf16 v[220:223], v[224:227], v[228:235], v248
v_cvt_pk_bf16_f32 v178, v132, v133
v_exp_f32 v135, v135
v_exp_f32 v140, v140
v_pk_mul_f32 v[206:207], v[206:207], v[252:253] op_sel:[0,1] op_sel_hi:[1,1]
v_pk_mul_f32 v[204:205], v[204:205], v[252:253] op_sel:[0,1] op_sel_hi:[1,1]
v_pk_mul_f32 v[202:203], v[202:203], v[252:253] op_sel:[0,1] op_sel_hi:[1,1]
v_pk_mul_f32 v[200:201], v[200:201], v[252:253] op_sel:[0,1] op_sel_hi:[1,1]
v_cvt_pk_bf16_f32 v200, v200, v201
v_mfma_f32_16x16x32_bf16 a[128:131], a[224:227], v[228:231], a[128:131]
v_cvt_pk_bf16_f32 v179, v134, v135
v_cvt_pk_bf16_f32 v201, v202, v203
v_mfma_f32_16x16x32_bf16 a[128:131], a[228:231], v[168:171], a[128:131]
v_exp_f32 v141, v141
v_mfma_f32_16x16x32_bf16 a[160:163], a[228:231], v[172:175], a[160:163]
v_exp_f32 v142, v142
v_mfma_f32_16x16x32_bf16 a[160:163], a[224:227], v[232:235], a[160:163]
ds_read_b64_tr_b16 a[224:225], v241 offset:17024
ds_read_b64_tr_b16 a[226:227], v241 offset:21152
v_mfma_f32_16x16x32_bf16 a[164:167], a[232:235], v[232:235], a[164:167]
v_cvt_pk_bf16_f32 v182, v140, v141
v_cvt_pk_bf16_f32 v202, v204, v205
v_mfma_f32_16x16x32_bf16 a[164:167], a[236:239], v[172:175], a[164:167]
ds_read_b64_tr_b16 a[228:229], v241 offset:25280
ds_read_b64_tr_b16 a[230:231], v241 offset:29408
v_mfma_f32_16x16x32_bf16 a[132:135], a[236:239], v[168:171], a[132:135]
v_exp_f32_e64 v143, v143
v_mfma_f32_16x16x32_bf16 a[132:135], a[232:235], v[228:231], a[132:135]
s_add_u32 m0, s32, 0x2040
ds_read_b64_tr_b16 a[232:233], v241 offset:17032
ds_read_b64_tr_b16 a[234:235], v241 offset:21160
v_mfma_f32_16x16x32_bf16 a[136:139], a[240:243], v[228:231], a[136:139]
s_waitcnt vmcnt(18)
v_exp_f32 v136, v136
v_mfma_f32_16x16x32_bf16 a[136:139], a[244:247], v[168:171], a[136:139]
buffer_load_dwordx4 v243, s[24:27], s39 offen offset:1032 nt lds
v_mfma_f32_16x16x32_bf16 a[168:171], a[244:247], v[172:175], a[168:171]
v_cvt_pk_bf16_f32 v183, v142, v143
v_cvt_pk_bf16_f32 v203, v206, v207
v_mfma_f32_16x16x32_bf16 a[168:171], a[240:243], v[232:235], a[168:171]
ds_read_b64_tr_b16 a[236:237], v241 offset:25288
ds_read_b64_tr_b16 a[238:239], v241 offset:29416
v_mfma_f32_16x16x32_bf16 a[172:175], a[248:251], v[232:235], a[172:175]
v_exp_f32 v137, v137
v_mfma_f32_16x16x32_bf16 a[172:175], a[252:255], v[172:175], a[172:175]
s_add_u32 m0, s33, 0x0
ds_read_b64_tr_b16 a[240:241], v241 offset:17280
ds_read_b64_tr_b16 a[242:243], v241 offset:21408
v_mfma_f32_16x16x32_bf16 a[140:143], a[252:255], v[168:171], a[140:143]
v_exp_f32 v138, v138
v_mfma_f32_16x16x32_bf16 a[140:143], a[248:251], v[228:231], a[140:143]
buffer_load_dwordx4 v243, s[8:11], s56 offen offset:1024 nt lds
v_mfma_f32_16x16x32_bf16 v[144:147], a[192:195], a[96:99], -4.0
v_cvt_pk_bf16_f32 v180, v136, v137
v_accvgpr_read_b32 v208, a40
v_mfma_f32_16x16x32_bf16 v[144:147], a[196:199], a[100:103], v[144:147]
v_exp_f32 v139, v139
v_mfma_f32_16x16x32_bf16 v[144:147], a[200:203], a[104:107], v[144:147]
v_cvt_pk_bf16_f32 v181, v138, v139
v_accvgpr_read_b32 v209, a41
v_mfma_f32_16x16x32_bf16 v[144:147], a[204:207], a[108:111], v[144:147]
ds_read_b64_tr_b16 a[244:245], v241 offset:25536
ds_read_b64_tr_b16 a[246:247], v241 offset:29664
v_mfma_f32_16x16x32_bf16 v[148:151], a[220:223], a[108:111], -4.0
v_accvgpr_read_b32 v210, a42
v_accvgpr_read_b32 v211, a43
v_mfma_f32_16x16x32_bf16 v[148:151], a[216:219], a[104:107], v[148:151]
v_accvgpr_read_b32 v212, a44
v_accvgpr_read_b32 v213, a45
v_mfma_f32_16x16x32_bf16 v[148:151], a[212:215], a[100:103], v[148:151]
v_exp_f32_e64 v144, v144
v_mfma_f32_16x16x32_bf16 v[148:151], a[208:211], a[96:99], v[148:151]
ds_read_b64_tr_b16 a[248:249], v241 offset:17288
ds_read_b64_tr_b16 a[250:251], v241 offset:21416
v_mfma_f32_16x16x32_bf16 v[156:159], a[208:211], a[112:115], -4.0
v_exp_f32 v145, v145
v_mfma_f32_16x16x32_bf16 v[156:159], a[212:215], a[116:119], v[156:159]
v_exp_f32 v146, v146
v_mfma_f32_16x16x32_bf16 v[156:159], a[216:219], a[120:123], v[156:159]
v_cvt_pk_bf16_f32 v192, v144, v145
v_accvgpr_read_b32 v214, a46
v_mfma_f32_16x16x32_bf16 v[156:159], a[220:223], a[124:127], v[156:159]
ds_read_b64_tr_b16 a[252:253], v241 offset:25544
ds_read_b64_tr_b16 a[254:255], v241 offset:29672
v_mfma_f32_16x16x32_bf16 v[152:155], a[204:207], a[124:127], -4.0
v_exp_f32 v147, v147
v_mfma_f32_16x16x32_bf16 v[152:155], a[200:203], a[120:123], v[152:155]
v_exp_f32 v148, v148
v_mfma_f32_16x16x32_bf16 v[152:155], a[196:199], a[116:119], v[152:155]
v_cvt_pk_bf16_f32 v193, v146, v147
v_accvgpr_read_b32 v215, a47
v_mfma_f32_16x16x32_bf16 v[152:155], a[192:195], a[112:115], v[152:155]
ds_read_b128 a[208:211], v240 offset:12480
v_exp_f32 v149, v149
v_exp_f32 v150, v150
v_pk_mul_f32 v[214:215], v[214:215], v[252:253] op_sel:[0,1] op_sel_hi:[1,1]
v_pk_mul_f32 v[212:213], v[212:213], v[252:253] op_sel:[0,1] op_sel_hi:[1,1]
v_pk_mul_f32 v[210:211], v[210:211], v[252:253] op_sel:[0,1] op_sel_hi:[1,1]
v_pk_mul_f32 v[208:209], v[208:209], v[252:253] op_sel:[0,1] op_sel_hi:[1,1]
v_cvt_pk_bf16_f32 v208, v208, v209
v_smfmac_f32_16x16x64_bf16 v[216:219], v[224:227], v[160:167], v248
s_waitcnt lgkmcnt(3)
ds_read_b128 a[212:215], v240 offset:12736
v_mfma_f32_16x16x32_bf16 v[80:83], a[224:227], v[184:187], v[80:83]
v_cvt_pk_bf16_f32 v194, v148, v149
v_cvt_pk_bf16_f32 v209, v210, v211
v_mfma_f32_16x16x32_bf16 v[80:83], a[228:231], v[160:163], v[80:83]
ds_read_b128 a[216:219], v240 offset:12992
ds_read_b128 a[220:223], v240 offset:13248
v_mfma_f32_16x16x32_bf16 v[112:115], a[228:231], v[164:167], v[112:115]
v_exp_f32 v151, v151
v_mfma_f32_16x16x32_bf16 v[112:115], a[224:227], v[188:191], v[112:115]
ds_read_b128 a[204:207], v240 offset:9088
v_cvt_pk_bf16_f32 v210, v212, v213
v_mfma_f32_16x16x32_bf16 v[116:119], a[232:235], v[188:191], v[116:119]
v_exp_f32_e64 v156, v156
v_mfma_f32_16x16x32_bf16 v[116:119], a[236:239], v[164:167], v[116:119]
ds_read_b128 a[200:203], v240 offset:8832
v_cvt_pk_bf16_f32 v195, v150, v151
v_mfma_f32_16x16x32_bf16 v[84:87], a[236:239], v[160:163], v[84:87]
v_exp_f32_e64 v157, v157
v_mfma_f32_16x16x32_bf16 v[84:87], a[232:235], v[184:187], v[84:87]
ds_read_b128 a[196:199], v240 offset:8576
v_cvt_pk_bf16_f32 v211, v214, v215
v_mfma_f32_16x16x32_bf16 v[88:91], a[240:243], v[184:187], v[88:91]
ds_read_b128 a[192:195], v240 offset:8320
v_mov_b64 v[212:213], v[200:201]
v_mfma_f32_16x16x32_bf16 v[88:91], a[244:247], v[160:163], v[88:91]
v_exp_f32 v158, v158
v_mfma_f32_16x16x32_bf16 v[120:123], a[244:247], v[164:167], v[120:123]
v_cvt_pk_bf16_f32 v198, v156, v157
v_mov_b64 v[214:215], v[202:203]
v_mfma_f32_16x16x32_bf16 v[120:123], a[240:243], v[188:191], v[120:123]
v_exp_f32 v159, v159
v_mfma_f32_16x16x32_bf16 v[124:127], a[248:251], v[188:191], v[124:127]
s_waitcnt lgkmcnt(2)
v_exp_f32 v152, v152
v_mfma_f32_16x16x32_bf16 v[124:127], a[252:255], v[164:167], v[124:127]
v_cvt_pk_bf16_f32 v199, v158, v159
v_mov_b32_dpp v200, v208 row_ror:8 row_mask:0xf bank_mask:0xc
v_mfma_f32_16x16x32_bf16 v[92:95], a[252:255], v[160:163], v[92:95]
v_exp_f32 v153, v153
v_mfma_f32_16x16x32_bf16 v[92:95], a[248:251], v[184:187], v[92:95]
s_waitcnt lgkmcnt(0)
v_exp_f32_e64 v154, v154
v_mfma_f32_16x16x32_bf16 v[128:131], a[192:195], a[64:67], -4.0
v_cvt_pk_bf16_f32 v196, v152, v153
v_mov_b32_dpp v201, v209 row_ror:8 row_mask:0xf bank_mask:0xc
v_mfma_f32_16x16x32_bf16 v[128:131], a[196:199], a[68:71], v[128:131]
v_exp_f32_e64 v155, v155
v_mfma_f32_16x16x32_bf16 v[128:131], a[200:203], a[72:75], v[128:131]
v_cvt_pk_bf16_f32 v197, v154, v155
v_mov_b32_dpp v202, v210 row_ror:8 row_mask:0xf bank_mask:0xc
v_mfma_f32_16x16x32_bf16 v[128:131], a[204:207], a[76:79], v[128:131]
v_mov_b32_dpp v203, v211 row_ror:8 row_mask:0xf bank_mask:0xc
v_mov_b32_dpp v208, v212 row_ror:8 row_mask:0xf bank_mask:0x3
v_mfma_f32_16x16x32_bf16 v[132:135], a[220:223], a[76:79], -4.0
v_mov_b32_dpp v209, v213 row_ror:8 row_mask:0xf bank_mask:0x3
v_mov_b32_dpp v210, v214 row_ror:8 row_mask:0xf bank_mask:0x3
v_mfma_f32_16x16x32_bf16 v[132:135], a[216:219], a[72:75], v[132:135]
v_mov_b32_dpp v211, v215 row_ror:8 row_mask:0xf bank_mask:0x3
v_mfma_f32_16x16x32_bf16 v[132:135], a[212:215], a[68:71], v[132:135]
v_exp_f32 v128, v128
v_mfma_f32_16x16x32_bf16 v[132:135], a[208:211], a[64:67], v[132:135]
buffer_store_dwordx4 v[200:203], v249, s[20:23], s35 offen sc1
v_mfma_f32_16x16x32_bf16 v[140:143], a[208:211], a[80:83], -4.0
v_exp_f32 v129, v129
v_mfma_f32_16x16x32_bf16 v[140:143], a[212:215], a[84:87], v[140:143]
v_exp_f32_e64 v130, v130
v_mfma_f32_16x16x32_bf16 v[140:143], a[216:219], a[88:91], v[140:143]
v_cvt_pk_bf16_f32 v160, v128, v129
v_accvgpr_read_b32 v200, a48
v_mfma_f32_16x16x32_bf16 v[140:143], a[220:223], a[92:95], v[140:143]
s_add_u32 m0, s31, 0x0
v_exp_f32 v131, v131
v_mfma_f32_16x16x32_bf16 v[136:139], a[204:207], a[92:95], -4.0
v_exp_f32_e64 v132, v132
v_mfma_f32_16x16x32_bf16 v[136:139], a[200:203], a[88:91], v[136:139]
v_cvt_pk_bf16_f32 v161, v130, v131
v_accvgpr_read_b32 v201, a49
v_mfma_f32_16x16x32_bf16 v[136:139], a[196:199], a[84:87], v[136:139]
s_waitcnt vmcnt(20)
v_exp_f32_e64 v133, v133
v_mfma_f32_16x16x32_bf16 v[136:139], a[192:195], a[80:83], v[136:139]
s_barrier
v_smfmac_f32_16x16x64_bf16 v[220:223], v[224:227], v[168:175], v248
v_accvgpr_read_b32 v202, a50
v_mfma_f32_16x16x32_bf16 a[144:147], a[224:227], v[228:231], a[144:147]
v_exp_f32 v134, v134
v_mfma_f32_16x16x32_bf16 a[144:147], a[228:231], v[168:171], a[144:147]
buffer_load_dwordx4 v243, s[12:15], s38 offen nt lds
v_mfma_f32_16x16x32_bf16 a[176:179], a[228:231], v[172:175], a[176:179]
s_add_u32 m0, s33, 0x20
v_cvt_pk_bf16_f32 v162, v132, v133
v_accvgpr_read_b32 v203, a51
v_mfma_f32_16x16x32_bf16 a[176:179], a[224:227], v[232:235], a[176:179]
ds_read_b64_tr_b16 a[224:225], v241 offset:33024
ds_read_b64_tr_b16 a[226:227], v241 offset:37152
v_mfma_f32_16x16x32_bf16 a[180:183], a[232:235], v[232:235], a[180:183]
v_exp_f32 v135, v135
v_mfma_f32_16x16x32_bf16 a[180:183], a[236:239], v[172:175], a[180:183]
ds_read_b64_tr_b16 a[228:229], v241 offset:41280
ds_read_b64_tr_b16 a[230:231], v241 offset:45408
v_mfma_f32_16x16x32_bf16 a[148:151], a[236:239], v[168:171], a[148:151]
v_exp_f32 v140, v140
v_mfma_f32_16x16x32_bf16 a[148:151], a[232:235], v[228:231], a[148:151]
buffer_load_dwordx4 v243, s[8:11], s56 offen offset:2048 nt lds
v_mfma_f32_16x16x32_bf16 a[152:155], a[240:243], v[228:231], a[152:155]
v_cvt_pk_bf16_f32 v163, v134, v135
v_accvgpr_read_b32 v204, a52
v_mfma_f32_16x16x32_bf16 a[152:155], a[244:247], v[168:171], a[152:155]
ds_read_b64_tr_b16 a[232:233], v241 offset:33032
ds_read_b64_tr_b16 a[234:235], v241 offset:37160
v_mfma_f32_16x16x32_bf16 a[184:187], a[244:247], v[172:175], a[184:187]
s_add_u32 m0, s31, 0x0
v_exp_f32 v141, v141
v_mfma_f32_16x16x32_bf16 a[184:187], a[240:243], v[232:235], a[184:187]
ds_read_b64_tr_b16 a[236:237], v241 offset:41288
ds_read_b64_tr_b16 a[238:239], v241 offset:45416
v_mfma_f32_16x16x32_bf16 a[188:191], a[248:251], v[232:235], a[188:191]
v_exp_f32_e64 v142, v142
v_mfma_f32_16x16x32_bf16 a[188:191], a[252:255], v[172:175], a[188:191]
buffer_load_dwordx4 v243, s[12:15], s38 offen offset:1024 nt lds
v_mfma_f32_16x16x32_bf16 a[156:159], a[252:255], v[168:171], a[156:159]
s_xor_b32 s38, s29, 0x1008000
v_cvt_pk_bf16_f32 v166, v140, v141
v_accvgpr_read_b32 v205, a53
v_mfma_f32_16x16x32_bf16 a[156:159], a[248:251], v[228:231], a[156:159]
s_xor_b32 s39, s29, 0x1004000
ds_read_b64_tr_b16 a[240:241], v241 offset:33280
ds_read_b64_tr_b16 a[242:243], v241 offset:37408
v_accvgpr_read_b32 v206, a54
v_mfma_f32_16x16x32_bf16 v[144:147], a[192:195], a[96:99], -4.0
v_exp_f32 v143, v143
v_mfma_f32_16x16x32_bf16 v[144:147], a[196:199], a[100:103], v[144:147]
v_exp_f32 v136, v136
v_mfma_f32_16x16x32_bf16 v[144:147], a[200:203], a[104:107], v[144:147]
v_cvt_pk_bf16_f32 v167, v142, v143
v_accvgpr_read_b32 v207, a55
v_mfma_f32_16x16x32_bf16 v[144:147], a[204:207], a[108:111], v[144:147]
buffer_store_dwordx4 v[208:211], v249, s[20:23], s35 offen offset:2048 sc1
v_mfma_f32_16x16x32_bf16 v[148:151], a[220:223], a[108:111], -4.0
v_exp_f32 v137, v137
v_mfma_f32_16x16x32_bf16 v[148:151], a[216:219], a[104:107], v[148:151]
v_exp_f32 v138, v138
v_mfma_f32_16x16x32_bf16 v[148:151], a[212:215], a[100:103], v[148:151]
s_add_u32 m0, s31, 0x2080
v_exp_f32_e64 v139, v139
v_mfma_f32_16x16x32_bf16 v[148:151], a[208:211], a[96:99], v[148:151]
ds_read_b64_tr_b16 a[244:245], v241 offset:41536
v_cvt_pk_bf16_f32 v164, v136, v137
v_cvt_pk_bf16_f32 v165, v138, v139
v_exp_f32_e64 v144, v144
v_pk_mul_f32 v[206:207], v[206:207], v[252:253] op_sel:[0,1] op_sel_hi:[1,1]
v_pk_mul_f32 v[204:205], v[204:205], v[252:253] op_sel:[0,1] op_sel_hi:[1,1]
v_pk_mul_f32 v[202:203], v[202:203], v[252:253] op_sel:[0,1] op_sel_hi:[1,1]
v_pk_mul_f32 v[200:201], v[200:201], v[252:253] op_sel:[0,1] op_sel_hi:[1,1]
v_cvt_pk_bf16_f32 v200, v200, v201
v_mfma_f32_16x16x32_bf16 v[156:159], a[208:211], a[112:115], -4.0
v_exp_f32 v145, v145
v_mfma_f32_16x16x32_bf16 v[156:159], a[212:215], a[116:119], v[156:159]
v_exp_f32 v146, v146
v_mfma_f32_16x16x32_bf16 v[156:159], a[216:219], a[120:123], v[156:159]
v_cvt_pk_bf16_f32 v184, v144, v145
v_cvt_pk_bf16_f32 v201, v202, v203
v_mfma_f32_16x16x32_bf16 v[156:159], a[220:223], a[124:127], v[156:159]
ds_read_b64_tr_b16 a[246:247], v241 offset:45664
ds_read_b64_tr_b16 a[248:249], v241 offset:33288
v_mfma_f32_16x16x32_bf16 v[152:155], a[204:207], a[124:127], -4.0
v_exp_f32 v147, v147
v_mfma_f32_16x16x32_bf16 v[152:155], a[200:203], a[120:123], v[152:155]
v_exp_f32 v148, v148
v_mfma_f32_16x16x32_bf16 v[152:155], a[196:199], a[116:119], v[152:155]
v_cvt_pk_bf16_f32 v185, v146, v147
v_cvt_pk_bf16_f32 v202, v204, v205
v_mfma_f32_16x16x32_bf16 v[152:155], a[192:195], a[112:115], v[152:155]
ds_read_b64_tr_b16 a[250:251], v241 offset:37416
ds_read_b64_tr_b16 a[252:253], v241 offset:41544
v_smfmac_f32_16x16x64_bf16 v[216:219], v[224:227], v[176:183], v248
s_waitcnt lgkmcnt(4)
buffer_load_dwordx4 v243, s[12:15], s38 offen nt lds
v_mfma_f32_16x16x32_bf16 v[64:67], a[224:227], v[176:179], v[64:67]
ds_read_b64_tr_b16 a[254:255], v241 offset:45672
v_cvt_pk_bf16_f32 v203, v206, v207
v_mfma_f32_16x16x32_bf16 v[64:67], a[228:231], v[160:163], v[64:67]
ds_read_b128 a[208:211], v240 offset:20800
ds_read_b128 a[212:215], v240 offset:21056
v_mfma_f32_16x16x32_bf16 v[96:99], a[228:231], v[164:167], v[96:99]
v_exp_f32 v149, v149
v_mfma_f32_16x16x32_bf16 v[96:99], a[224:227], v[180:183], v[96:99]
ds_read_b128 a[216:219], v240 offset:21312
ds_read_b128 a[220:223], v240 offset:21568
v_mfma_f32_16x16x32_bf16 v[100:103], a[232:235], v[180:183], v[100:103]
v_exp_f32 v150, v150
v_mfma_f32_16x16x32_bf16 v[100:103], a[236:239], v[164:167], v[100:103]
ds_read_b128 a[204:207], v240 offset:17408
ds_read_b128 a[200:203], v240 offset:17152
v_mfma_f32_16x16x32_bf16 v[68:71], a[236:239], v[160:163], v[68:71]
v_cvt_pk_bf16_f32 v186, v148, v149
v_accvgpr_read_b32 v208, a56
v_mfma_f32_16x16x32_bf16 v[68:71], a[232:235], v[176:179], v[68:71]
ds_read_b128 a[196:199], v240 offset:16896
v_accvgpr_read_b32 v209, a57
v_mfma_f32_16x16x32_bf16 v[72:75], a[240:243], v[176:179], v[72:75]
s_waitcnt lgkmcnt(5)
ds_read_b128 a[192:195], v240 offset:16640
v_accvgpr_read_b32 v210, a58
v_mfma_f32_16x16x32_bf16 v[72:75], a[244:247], v[160:163], v[72:75]
s_add_u32 m0, s31, 0x2080
v_exp_f32 v151, v151
v_mfma_f32_16x16x32_bf16 v[104:107], a[244:247], v[164:167], v[104:107]
v_exp_f32 v156, v156
v_mfma_f32_16x16x32_bf16 v[104:107], a[240:243], v[180:183], v[104:107]
buffer_load_dwordx4 v243, s[12:15], s38 offen offset:1024 nt lds
v_mfma_f32_16x16x32_bf16 v[108:111], a[248:251], v[180:183], v[108:111]
v_cvt_pk_bf16_f32 v187, v150, v151
v_accvgpr_read_b32 v211, a59
v_mfma_f32_16x16x32_bf16 v[108:111], a[252:255], v[164:167], v[108:111]
v_accvgpr_read_b32 v212, a60
v_accvgpr_read_b32 v213, a61
v_mfma_f32_16x16x32_bf16 v[76:79], a[252:255], v[160:163], v[76:79]
v_exp_f32 v157, v157
v_mfma_f32_16x16x32_bf16 v[76:79], a[248:251], v[176:179], v[76:79]
s_waitcnt lgkmcnt(0)
v_accvgpr_read_b32 v214, a62
v_accvgpr_read_b32 v215, a63
v_mfma_f32_16x16x32_bf16 v[128:131], a[192:195], a[64:67], -4.0
v_exp_f32 v158, v158
v_mfma_f32_16x16x32_bf16 v[128:131], a[196:199], a[68:71], v[128:131]
s_add_u32 m0, s33, 0x20
v_exp_f32 v159, v159
v_mfma_f32_16x16x32_bf16 v[128:131], a[200:203], a[72:75], v[128:131]
v_exp_f32 v152, v152
v_mfma_f32_16x16x32_bf16 v[128:131], a[204:207], a[76:79], v[128:131]
buffer_load_dwordx4 v243, s[8:11], s56 offen offset:3072 nt lds
v_mfma_f32_16x16x32_bf16 v[132:135], a[220:223], a[76:79], -4.0
s_add_u32 m0, s32, 0x4080
v_cvt_pk_bf16_f32 v190, v156, v157
v_cvt_pk_bf16_f32 v191, v158, v159
v_mfma_f32_16x16x32_bf16 v[132:135], a[216:219], a[72:75], v[132:135]
s_xor_b32 s56, s28, 0x3001000
v_exp_f32 v153, v153
v_mfma_f32_16x16x32_bf16 v[132:135], a[212:215], a[68:71], v[132:135]
v_exp_f32 v154, v154
v_mfma_f32_16x16x32_bf16 v[132:135], a[208:211], a[64:67], v[132:135]
v_cvt_pk_bf16_f32 v188, v152, v153
v_exp_f32 v155, v155
v_mfma_f32_16x16x32_bf16 v[140:143], a[208:211], a[80:83], -4.0
v_exp_f32 v128, v128
v_mfma_f32_16x16x32_bf16 v[140:143], a[212:215], a[84:87], v[140:143]
v_exp_f32 v129, v129
v_mfma_f32_16x16x32_bf16 v[140:143], a[216:219], a[88:91], v[140:143]
v_exp_f32 v130, v130
v_mfma_f32_16x16x32_bf16 v[140:143], a[220:223], a[92:95], v[140:143]
buffer_load_dwordx4 v243, s[16:19], s39 offen nt lds
v_mfma_f32_16x16x32_bf16 v[136:139], a[204:207], a[92:95], -4.0
v_cvt_pk_bf16_f32 v189, v154, v155
v_cvt_pk_bf16_f32 v168, v128, v129
v_mfma_f32_16x16x32_bf16 v[136:139], a[200:203], a[88:91], v[136:139]
v_exp_f32 v131, v131
v_mfma_f32_16x16x32_bf16 v[136:139], a[196:199], a[84:87], v[136:139]
v_exp_f32 v132, v132
v_mfma_f32_16x16x32_bf16 v[136:139], a[192:195], a[80:83], v[136:139]
v_cvt_pk_bf16_f32 v169, v130, v131
v_exp_f32 v133, v133
v_exp_f32 v134, v134
v_pk_mul_f32 v[214:215], v[214:215], v[252:253] op_sel:[0,1] op_sel_hi:[1,1]
v_pk_mul_f32 v[212:213], v[212:213], v[252:253] op_sel:[0,1] op_sel_hi:[1,1]
v_pk_mul_f32 v[210:211], v[210:211], v[252:253] op_sel:[0,1] op_sel_hi:[1,1]
v_pk_mul_f32 v[208:209], v[208:209], v[252:253] op_sel:[0,1] op_sel_hi:[1,1]
v_cvt_pk_bf16_f32 v208, v208, v209
v_smfmac_f32_16x16x64_bf16 v[220:223], v[224:227], v[192:199], v248
v_cvt_pk_bf16_f32 v170, v132, v133
v_cvt_pk_bf16_f32 v209, v210, v211
v_mfma_f32_16x16x32_bf16 a[128:131], a[224:227], v[192:195], a[128:131]
v_cvt_pk_bf16_f32 v210, v212, v213
v_cvt_pk_bf16_f32 v211, v214, v215
v_mfma_f32_16x16x32_bf16 a[128:131], a[228:231], v[184:187], a[128:131]
v_exp_f32 v135, v135
v_mfma_f32_16x16x32_bf16 a[160:163], a[228:231], v[188:191], a[160:163]
v_exp_f32 v140, v140
v_mfma_f32_16x16x32_bf16 a[160:163], a[224:227], v[196:199], a[160:163]
s_add_u32 m0, s32, 0x4080
ds_read_b64_tr_b16 a[224:225], v241 offset:33536
ds_read_b64_tr_b16 a[226:227], v241 offset:37664
v_mfma_f32_16x16x32_bf16 a[164:167], a[232:235], v[196:199], a[164:167]
v_cvt_pk_bf16_f32 v171, v134, v135
v_mov_b64_e64 v[212:213], v[200:201]
v_mfma_f32_16x16x32_bf16 a[164:167], a[236:239], v[188:191], a[164:167]
buffer_load_dwordx4 v243, s[24:27], s39 offen offset:1032 nt lds
v_mfma_f32_16x16x32_bf16 a[132:135], a[236:239], v[184:187], a[132:135]
s_xor_b32 s39, s29, 0x1006000
v_exp_f32 v141, v141
v_mfma_f32_16x16x32_bf16 a[132:135], a[232:235], v[192:195], a[132:135]
s_xor_b32 s38, s29, 0x100a000
ds_read_b64_tr_b16 a[228:229], v241 offset:41792
ds_read_b64_tr_b16 a[230:231], v241 offset:45920
v_mfma_f32_16x16x32_bf16 a[136:139], a[240:243], v[192:195], a[136:139]
v_exp_f32 v142, v142
v_mfma_f32_16x16x32_bf16 a[136:139], a[244:247], v[184:187], a[136:139]
ds_read_b64_tr_b16 a[232:233], v241 offset:33544
ds_read_b64_tr_b16 a[234:235], v241 offset:37672
v_mov_b64_e64 v[214:215], v[202:203]
v_mfma_f32_16x16x32_bf16 a[168:171], a[244:247], v[188:191], a[168:171]
v_cvt_pk_bf16_f32 v174, v140, v141
v_mov_b32_dpp v200, v208 row_ror:8 row_mask:0xf bank_mask:0xc
v_mfma_f32_16x16x32_bf16 a[168:171], a[240:243], v[196:199], a[168:171]
ds_read_b64_tr_b16 a[236:237], v241 offset:41800
ds_read_b64_tr_b16 a[238:239], v241 offset:45928
v_mfma_f32_16x16x32_bf16 a[172:175], a[248:251], v[196:199], a[172:175]
v_mov_b32_dpp v201, v209 row_ror:8 row_mask:0xf bank_mask:0xc
v_mov_b32_dpp v202, v210 row_ror:8 row_mask:0xf bank_mask:0xc
v_mfma_f32_16x16x32_bf16 a[172:175], a[252:255], v[188:191], a[172:175]
ds_read_b64_tr_b16 a[240:241], v241 offset:33792
ds_read_b64_tr_b16 a[242:243], v241 offset:37920
v_mfma_f32_16x16x32_bf16 a[140:143], a[252:255], v[184:187], a[140:143]
s_add_u32 m0, s32, 0x60c0
v_exp_f32 v143, v143
v_mfma_f32_16x16x32_bf16 a[140:143], a[248:251], v[192:195], a[140:143]
buffer_load_dwordx4 v243, s[16:19], s39 offen nt lds
v_mfma_f32_16x16x32_bf16 v[144:147], a[192:195], a[96:99], -4.0
v_exp_f32 v136, v136
v_mfma_f32_16x16x32_bf16 v[144:147], a[196:199], a[100:103], v[144:147]
v_cvt_pk_bf16_f32 v175, v142, v143
v_mov_b32_dpp v203, v211 row_ror:8 row_mask:0xf bank_mask:0xc
v_mfma_f32_16x16x32_bf16 v[144:147], a[200:203], a[104:107], v[144:147]
v_exp_f32 v137, v137
v_mfma_f32_16x16x32_bf16 v[144:147], a[204:207], a[108:111], v[144:147]
ds_read_b64_tr_b16 a[244:245], v241 offset:42048
ds_read_b64_tr_b16 a[246:247], v241 offset:46176
v_mov_b32_dpp v208, v212 row_ror:8 row_mask:0xf bank_mask:0x3
v_mfma_f32_16x16x32_bf16 v[148:151], a[220:223], a[108:111], -4.0
v_exp_f32 v138, v138
v_mfma_f32_16x16x32_bf16 v[148:151], a[216:219], a[104:107], v[148:151]
v_cvt_pk_bf16_f32 v172, v136, v137
v_mov_b32_dpp v209, v213 row_ror:8 row_mask:0xf bank_mask:0x3
v_mfma_f32_16x16x32_bf16 v[148:151], a[212:215], a[100:103], v[148:151]
v_exp_f32_e64 v139, v139
v_mfma_f32_16x16x32_bf16 v[148:151], a[208:211], a[96:99], v[148:151]
buffer_store_dwordx4 v[200:203], v249, s[20:23], s35 offen offset:128 sc1
v_mfma_f32_16x16x32_bf16 v[156:159], a[208:211], a[112:115], -4.0
s_add_u32 m0, s32, 0x60c0
v_cvt_pk_bf16_f32 v173, v138, v139
v_mov_b32_dpp v210, v214 row_ror:8 row_mask:0xf bank_mask:0x3
v_mfma_f32_16x16x32_bf16 v[156:159], a[212:215], a[116:119], v[156:159]
v_mov_b32_dpp v211, v215 row_ror:8 row_mask:0xf bank_mask:0x3
v_mfma_f32_16x16x32_bf16 v[156:159], a[216:219], a[120:123], v[156:159]
v_exp_f32_e64 v144, v144
v_mfma_f32_16x16x32_bf16 v[156:159], a[220:223], a[124:127], v[156:159]
ds_read_b64_tr_b16 a[248:249], v241 offset:33800
ds_read_b64_tr_b16 a[250:251], v241 offset:37928
v_mfma_f32_16x16x32_bf16 v[152:155], a[204:207], a[124:127], -4.0
v_exp_f32 v145, v145
v_mfma_f32_16x16x32_bf16 v[152:155], a[200:203], a[120:123], v[152:155]
v_exp_f32 v146, v146
v_mfma_f32_16x16x32_bf16 v[152:155], a[196:199], a[116:119], v[152:155]
v_exp_f32_e64 v147, v147
v_mfma_f32_16x16x32_bf16 v[152:155], a[192:195], a[112:115], v[152:155]
ds_read_b64_tr_b16 a[252:253], v241 offset:42056
ds_read_b64_tr_b16 a[254:255], v241 offset:46184
v_smfmac_f32_16x16x64_bf16 v[216:219], v[224:227], v[160:167], v248
s_waitcnt lgkmcnt(4)
ds_read_b128 a[208:211], v240 offset:29120
v_mfma_f32_16x16x32_bf16 v[80:83], a[224:227], v[176:179], v[80:83]
v_exp_f32 v148, v148
v_mfma_f32_16x16x32_bf16 v[80:83], a[228:231], v[160:163], v[80:83]
buffer_load_dwordx4 v243, s[24:27], s39 offen offset:1032 nt lds
v_mfma_f32_16x16x32_bf16 v[112:115], a[228:231], v[164:167], v[112:115]
L_pad9:
s_cbranch_vccnz L_main
ds_read_b128 a[212:215], v240 offset:29376
ds_read_b128 v[202:205], v242 offset:4160
v_mfma_f32_16x16x32_bf16 v[112:115], a[224:227], v[180:183], v[112:115]
ds_read_b128 a[216:219], v240 offset:29632
ds_read_b128 a[220:223], v240 offset:29888
v_mfma_f32_16x16x32_bf16 v[116:119], a[232:235], v[180:183], v[116:119]
v_cvt_pk_bf16_f32 v228, v144, v145
v_cvt_pk_bf16_f32 v229, v146, v147
v_mfma_f32_16x16x32_bf16 v[116:119], a[236:239], v[164:167], v[116:119]
ds_read_b128 a[204:207], v240 offset:25728
ds_read_b128 a[200:203], v240 offset:25472
v_mfma_f32_16x16x32_bf16 v[84:87], a[236:239], v[160:163], v[84:87]
v_exp_f32 v149, v149
v_mfma_f32_16x16x32_bf16 v[84:87], a[232:235], v[176:179], v[84:87]
ds_read_b128 a[196:199], v240 offset:25216
ds_read_b128 a[192:195], v240 offset:24960
v_mfma_f32_16x16x32_bf16 v[88:91], a[240:243], v[176:179], v[88:91]
v_exp_f32 v150, v150
v_mfma_f32_16x16x32_bf16 v[88:91], a[244:247], v[160:163], v[88:91]
s_waitcnt lgkmcnt(6)
buffer_store_dwordx4 v[208:211], v249, s[20:23], s35 offen offset:2176 sc1
v_mfma_f32_16x16x32_bf16 v[120:123], a[244:247], v[164:167], v[120:123]
s_xor_b32 s59, s28, 0x1002000
v_cvt_pk_bf16_f32 v230, v148, v149
v_mov_b64_e64 v[200:201], v[202:203]
v_mfma_f32_16x16x32_bf16 v[120:123], a[240:243], v[180:183], v[120:123]
s_xor_b32 s35, s28, 0x1003000
ds_read_b128 v[210:213], v242 offset:4416
v_mov_b64 v[206:207], v[204:205]
v_mfma_f32_16x16x32_bf16 v[124:127], a[248:251], v[180:183], v[124:127]
v_exp_f32 v151, v151
v_mfma_f32_16x16x32_bf16 v[124:127], a[252:255], v[164:167], v[124:127]
v_exp_f32 v156, v156
v_mfma_f32_16x16x32_bf16 v[92:95], a[252:255], v[160:163], v[92:95]
v_exp_f32 v157, v157
v_mfma_f32_16x16x32_bf16 v[92:95], a[248:251], v[176:179], v[92:95]
v_exp_f32 v158, v158
v_mfma_f32_16x16x32_bf16 v[200:203], v[236:239], v[200:203], 0
v_cvt_pk_bf16_f32 v231, v150, v151
v_cvt_pk_bf16_f32 v234, v156, v157
v_mfma_f32_16x16x32_bf16 v[204:207], v[236:239], v[204:207], 0
s_waitcnt lgkmcnt(1)
v_exp_f32 v159, v159
v_mfma_f32_16x16x32_bf16 v[128:131], a[192:195], a[64:67], -4.0
v_exp_f32 v152, v152
v_mfma_f32_16x16x32_bf16 v[128:131], a[196:199], a[68:71], v[128:131]
v_cvt_pk_bf16_f32 v235, v158, v159
v_cvt_pk_bf16_f32 v48, v200, v201
v_mfma_f32_16x16x32_bf16 v[128:131], a[200:203], a[72:75], v[128:131]
s_waitcnt lgkmcnt(0)
v_mov_b64 v[208:209], v[210:211]
v_mov_b64_e64 v[214:215], v[212:213]
v_mfma_f32_16x16x32_bf16 v[128:131], a[204:207], a[76:79], v[128:131]
v_cvt_pk_bf16_f32 v49, v202, v203
v_cvt_pk_bf16_f32 v50, v204, v205
v_cvt_pk_bf16_f32 v51, v206, v207
v_mfma_f32_16x16x32_bf16 v[132:135], a[220:223], a[76:79], -4.0
v_exp_f32 v153, v153
v_mfma_f32_16x16x32_bf16 v[132:135], a[216:219], a[72:75], v[132:135]
v_exp_f32 v154, v154
v_mfma_f32_16x16x32_bf16 v[132:135], a[212:215], a[68:71], v[132:135]
v_exp_f32_e64 v155, v155
v_mfma_f32_16x16x32_bf16 v[132:135], a[208:211], a[64:67], v[132:135]
ds_read_b128 v[202:205], v242 offset:4672
v_cvt_pk_bf16_f32 v232, v152, v153
v_mfma_f32_16x16x32_bf16 v[140:143], a[208:211], a[80:83], -4.0
v_exp_f32 v128, v128
v_mfma_f32_16x16x32_bf16 v[140:143], a[212:215], a[84:87], v[140:143]
v_exp_f32 v129, v129
v_mfma_f32_16x16x32_bf16 v[140:143], a[216:219], a[88:91], v[140:143]
v_exp_f32_e64 v130, v130
v_mfma_f32_16x16x32_bf16 v[140:143], a[220:223], a[92:95], v[140:143]
s_add_u32 m0, s31, 0x4100
v_cvt_pk_bf16_f32 v233, v154, v155
v_cvt_pk_bf16_f32 v160, v128, v129
v_mfma_f32_16x16x32_bf16 v[136:139], a[204:207], a[92:95], -4.0
v_exp_f32 v131, v131
v_mfma_f32_16x16x32_bf16 v[136:139], a[200:203], a[88:91], v[136:139]
v_exp_f32_e64 v132, v132
v_mfma_f32_16x16x32_bf16 v[136:139], a[196:199], a[84:87], v[136:139]
s_waitcnt vmcnt(22) lgkmcnt(0)
v_cvt_pk_bf16_f32 v161, v130, v131
v_mov_b64 v[200:201], v[202:203]
v_mfma_f32_16x16x32_bf16 v[136:139], a[192:195], a[80:83], v[136:139]
s_barrier
v_smfmac_f32_16x16x64_bf16 v[220:223], v[224:227], v[184:191], v248
buffer_load_dwordx4 v243, s[12:15], s38 offen nt lds
v_mfma_f32_16x16x32_bf16 v[208:211], v[236:239], v[208:211], 0
v_mov_b64 v[206:207], v[204:205]
v_exp_f32 v133, v133
v_mfma_f32_16x16x32_bf16 v[212:215], v[236:239], v[212:215], 0
v_exp_f32 v134, v134
v_mfma_f32_16x16x32_bf16 a[144:147], a[224:227], v[192:195], a[144:147]
v_exp_f32 v135, v135
v_mfma_f32_16x16x32_bf16 a[144:147], a[228:231], v[184:187], a[144:147]
v_exp_f32_e64 v140, v140
v_cvt_pk_bf16_f32 v52, v208, v209
v_mfma_f32_16x16x32_bf16 a[176:179], a[228:231], v[188:191], a[176:179]
v_cvt_pk_bf16_f32 v162, v132, v133
v_cvt_pk_bf16_f32 v163, v134, v135
v_mfma_f32_16x16x32_bf16 a[176:179], a[224:227], v[196:199], a[176:179]
ds_read_b64_tr_b16 a[224:225], v241 offset:49536
ds_read_b64_tr_b16 a[226:227], v241 offset:53664
v_cvt_pk_bf16_f32 v53, v210, v211
v_mfma_f32_16x16x32_bf16 a[180:183], a[232:235], v[196:199], a[180:183]
v_cvt_pk_bf16_f32 v54, v212, v213
v_cvt_pk_bf16_f32 v55, v214, v215
v_mfma_f32_16x16x32_bf16 a[180:183], a[236:239], v[188:191], a[180:183]
ds_read_b64_tr_b16 a[228:229], v241 offset:57792
ds_read_b64_tr_b16 a[230:231], v241 offset:61920
v_mfma_f32_16x16x32_bf16 a[148:151], a[236:239], v[184:187], a[148:151]
v_exp_f32_e64 v141, v141
v_mfma_f32_16x16x32_bf16 a[148:151], a[232:235], v[192:195], a[148:151]
ds_read_b64_tr_b16 a[232:233], v241 offset:49544
ds_read_b64_tr_b16 a[234:235], v241 offset:53672
v_mfma_f32_16x16x32_bf16 a[152:155], a[240:243], v[192:195], a[152:155]
s_add_u32 m0, s31, 0x4100
v_exp_f32 v142, v142
v_mfma_f32_16x16x32_bf16 a[152:155], a[244:247], v[184:187], a[152:155]
buffer_load_dwordx4 v243, s[12:15], s38 offen offset:1024 nt lds
v_mfma_f32_16x16x32_bf16 a[184:187], a[244:247], v[188:191], a[184:187]
s_xor_b32 s38, s29, 0x100c000
v_exp_f32 v143, v143
v_mfma_f32_16x16x32_bf16 a[184:187], a[240:243], v[196:199], a[184:187]
s_xor_b32 s39, s29, 0x1008000
ds_read_b64_tr_b16 a[236:237], v241 offset:57800
ds_read_b64_tr_b16 a[238:239], v241 offset:61928
v_mfma_f32_16x16x32_bf16 a[188:191], a[248:251], v[196:199], a[188:191]
v_exp_f32_e64 v136, v136
v_mfma_f32_16x16x32_bf16 a[188:191], a[252:255], v[188:191], a[188:191]
ds_read_b64_tr_b16 a[240:241], v241 offset:49792
ds_read_b64_tr_b16 a[242:243], v241 offset:53920
v_mfma_f32_16x16x32_bf16 a[156:159], a[252:255], v[184:187], a[156:159]
v_cvt_pk_bf16_f32 v166, v140, v141
v_cvt_pk_bf16_f32 v167, v142, v143
v_mfma_f32_16x16x32_bf16 a[156:159], a[248:251], v[192:195], a[156:159]
ds_read_b64_tr_b16 a[244:245], v241 offset:58048
ds_read_b128 v[210:213], v242 offset:4928
v_mfma_f32_16x16x32_bf16 v[200:203], v[236:239], v[200:203], 0
ds_read_b64_tr_b16 a[246:247], v241 offset:62176
ds_read_b64_tr_b16 a[248:249], v241 offset:49800
v_mfma_f32_16x16x32_bf16 v[204:207], v[236:239], v[204:207], 0
ds_read_b64_tr_b16 a[250:251], v241 offset:53928
ds_read_b64_tr_b16 a[252:253], v241 offset:58056
v_mfma_f32_16x16x32_bf16 v[144:147], a[192:195], a[96:99], -4.0
v_exp_f32_e64 v137, v137
v_mfma_f32_16x16x32_bf16 v[144:147], a[196:199], a[100:103], v[144:147]
v_cvt_pk_bf16_f32 v56, v200, v201
v_cvt_pk_bf16_f32 v57, v202, v203
v_mfma_f32_16x16x32_bf16 v[144:147], a[200:203], a[104:107], v[144:147]
s_add_u32 m0, s31, 0x6180
v_exp_f32_e64 v138, v138
v_mfma_f32_16x16x32_bf16 v[144:147], a[204:207], a[108:111], v[144:147]
buffer_load_dwordx4 v243, s[12:15], s38 offen nt lds
v_mfma_f32_16x16x32_bf16 v[148:151], a[220:223], a[108:111], -4.0
v_cvt_pk_bf16_f32 v164, v136, v137
v_cvt_pk_bf16_f32 v58, v204, v205
v_mfma_f32_16x16x32_bf16 v[148:151], a[216:219], a[104:107], v[148:151]
v_cvt_pk_bf16_f32 v59, v206, v207
v_mfma_f32_16x16x32_bf16 v[148:151], a[212:215], a[100:103], v[148:151]
s_waitcnt lgkmcnt(0)
v_exp_f32 v139, v139
v_mfma_f32_16x16x32_bf16 v[148:151], a[208:211], a[96:99], v[148:151]
s_add_u32 m0, s33, 0x1040
ds_read_b64_tr_b16 a[254:255], v241 offset:62184
v_cvt_pk_bf16_f32 v165, v138, v139
v_mfma_f32_16x16x32_bf16 v[156:159], a[208:211], a[112:115], -4.0
v_exp_f32 v144, v144
v_mfma_f32_16x16x32_bf16 v[156:159], a[212:215], a[116:119], v[156:159]
v_exp_f32 v145, v145
v_mfma_f32_16x16x32_bf16 v[156:159], a[216:219], a[120:123], v[156:159]
v_exp_f32_e64 v146, v146
v_mfma_f32_16x16x32_bf16 v[156:159], a[220:223], a[124:127], v[156:159]
buffer_load_dwordx4 v243, s[8:11], s56 offen nt lds
v_mfma_f32_16x16x32_bf16 v[152:155], a[204:207], a[124:127], -4.0
s_add_u32 m0, s31, 0x6180
v_cvt_pk_bf16_f32 v176, v144, v145
v_mov_b64 v[208:209], v[210:211]
v_mfma_f32_16x16x32_bf16 v[152:155], a[200:203], a[120:123], v[152:155]
v_exp_f32 v147, v147
v_mfma_f32_16x16x32_bf16 v[152:155], a[196:199], a[116:119], v[152:155]
v_mov_b64_e64 v[214:215], v[212:213]
v_mfma_f32_16x16x32_bf16 v[152:155], a[192:195], a[112:115], v[152:155]
ds_read_b128 a[208:211], v240 offset:37440
ds_read_b128 a[212:215], v240 offset:37696
v_mfma_f32_16x16x32_bf16 v[208:211], v[236:239], v[208:211], 0
ds_read_b128 a[216:219], v240 offset:37952
ds_read_b128 a[220:223], v240 offset:38208
v_mfma_f32_16x16x32_bf16 v[212:215], v[236:239], v[212:215], 0
ds_read_b128 a[204:207], v240 offset:34048
ds_read_b128 a[200:203], v240 offset:33792
v_smfmac_f32_16x16x64_bf16 v[216:219], v[224:227], v[168:175], v248
buffer_load_dwordx4 v243, s[12:15], s38 offen offset:1024 nt lds
v_mfma_f32_16x16x32_bf16 v[64:67], a[224:227], v[168:171], v[64:67]
v_cvt_pk_bf16_f32 v60, v208, v209
v_cvt_pk_bf16_f32 v61, v210, v211
v_mfma_f32_16x16x32_bf16 v[64:67], a[228:231], v[160:163], v[64:67]
ds_read_b128 a[196:199], v240 offset:33536
v_cvt_pk_bf16_f32 v62, v212, v213
v_mfma_f32_16x16x32_bf16 v[96:99], a[228:231], v[164:167], v[96:99]
v_exp_f32 v148, v148
v_mfma_f32_16x16x32_bf16 v[96:99], a[224:227], v[172:175], v[96:99]
ds_read_b128 a[192:195], v240 offset:33280
v_cvt_pk_bf16_f32 v177, v146, v147
v_mfma_f32_16x16x32_bf16 v[100:103], a[232:235], v[172:175], v[100:103]
v_exp_f32 v149, v149
v_mfma_f32_16x16x32_bf16 v[100:103], a[236:239], v[164:167], v[100:103]
v_exp_f32_e64 v150, v150
v_mfma_f32_16x16x32_bf16 v[68:71], a[236:239], v[160:163], v[68:71]
v_cvt_pk_bf16_f32 v178, v148, v149
v_cvt_pk_bf16_f32 v63, v214, v215
v_mfma_f32_16x16x32_bf16 v[68:71], a[232:235], v[168:171], v[68:71]
v_exp_f32 v151, v151
v_mfma_f32_16x16x32_bf16 v[72:75], a[240:243], v[168:171], v[72:75]
s_add_u32 m0, s32, 0x8100
v_exp_f32 v156, v156
v_mfma_f32_16x16x32_bf16 v[72:75], a[244:247], v[160:163], v[72:75]
buffer_load_dwordx4 v243, s[16:19], s39 offen nt lds
v_mfma_f32_16x16x32_bf16 v[104:107], a[244:247], v[164:167], v[104:107]
v_exp_f32 v157, v157
v_mfma_f32_16x16x32_bf16 v[104:107], a[240:243], v[172:175], v[104:107]
v_exp_f32 v158, v158
v_mfma_f32_16x16x32_bf16 v[108:111], a[248:251], v[172:175], v[108:111]
s_waitcnt lgkmcnt(0)
v_cvt_pk_bf16_f32 v179, v150, v151
v_cvt_pk_bf16_f32 v182, v156, v157
v_mfma_f32_16x16x32_bf16 v[108:111], a[252:255], v[164:167], v[108:111]
v_exp_f32 v159, v159
v_mfma_f32_16x16x32_bf16 v[76:79], a[252:255], v[160:163], v[76:79]
v_exp_f32 v152, v152
v_mfma_f32_16x16x32_bf16 v[76:79], a[248:251], v[168:171], v[76:79]
v_exp_f32 v153, v153
v_mfma_f32_16x16x32_bf16 v[128:131], a[192:195], v[0:3], -4.0
v_exp_f32_e64 v154, v154
v_mfma_f32_16x16x32_bf16 v[128:131], a[196:199], v[4:7], v[128:131]
v_cvt_pk_bf16_f32 v183, v158, v159
v_cvt_pk_bf16_f32 v180, v152, v153
v_mfma_f32_16x16x32_bf16 v[128:131], a[200:203], v[8:11], v[128:131]
s_add_u32 m0, s32, 0x8100
v_exp_f32_e64 v155, v155
v_mfma_f32_16x16x32_bf16 v[128:131], a[204:207], v[12:15], v[128:131]
buffer_load_dwordx4 v243, s[24:27], s39 offen offset:1032 nt lds
v_mfma_f32_16x16x32_bf16 v[132:135], a[220:223], v[12:15], -4.0
s_xor_b32 s39, s29, 0x100a000
v_cvt_pk_bf16_f32 v181, v154, v155
v_mfma_f32_16x16x32_bf16 v[132:135], a[216:219], v[8:11], v[132:135]
s_xor_b32 s38, s29, 0x100e000
v_mfma_f32_16x16x32_bf16 v[132:135], a[212:215], v[4:7], v[132:135]
v_mfma_f32_16x16x32_bf16 v[132:135], a[208:211], v[0:3], v[132:135]
v_exp_f32 v128, v128
v_mfma_f32_16x16x32_bf16 v[140:143], a[208:211], v[16:19], -4.0
v_exp_f32 v129, v129
v_mfma_f32_16x16x32_bf16 v[140:143], a[212:215], v[20:23], v[140:143]
v_exp_f32_e64 v130, v130
v_mfma_f32_16x16x32_bf16 v[140:143], a[216:219], v[24:27], v[140:143]
v_exp_f32 v131, v131
v_mfma_f32_16x16x32_bf16 v[140:143], a[220:223], v[28:31], v[140:143]
v_exp_f32 v132, v132
v_mfma_f32_16x16x32_bf16 v[136:139], a[204:207], v[28:31], -4.0
s_add_u32 m0, s32, 0xa140
v_cvt_pk_bf16_f32 v184, v128, v129
v_cvt_pk_bf16_f32 v185, v130, v131
v_mfma_f32_16x16x32_bf16 v[136:139], a[200:203], v[24:27], v[136:139]
v_exp_f32 v133, v133
v_mfma_f32_16x16x32_bf16 v[136:139], a[196:199], v[20:23], v[136:139]
v_exp_f32 v134, v134
v_mfma_f32_16x16x32_bf16 v[136:139], a[192:195], v[16:19], v[136:139]
buffer_load_dwordx4 v243, s[16:19], s39 offen nt lds
v_smfmac_f32_16x16x64_bf16 v[220:223], v[224:227], v[228:235], v248
v_cvt_pk_bf16_f32 v186, v132, v133
v_mfma_f32_16x16x32_bf16 a[128:131], a[224:227], v[228:231], a[128:131]
v_exp_f32_e64 v135, v135
v_mfma_f32_16x16x32_bf16 a[128:131], a[228:231], v[176:179], a[128:131]
v_exp_f32 v140, v140
v_mfma_f32_16x16x32_bf16 a[160:163], a[228:231], v[180:183], a[160:163]
v_exp_f32 v141, v141
v_mfma_f32_16x16x32_bf16 a[160:163], a[224:227], v[232:235], a[160:163]
ds_read_b64_tr_b16 a[224:225], v241 offset:50048
ds_read_b64_tr_b16 a[226:227], v241 offset:54176
v_mfma_f32_16x16x32_bf16 a[164:167], a[232:235], v[232:235], a[164:167]
s_add_u32 m0, s33, 0x1040
v_exp_f32_e64 v142, v142
v_mfma_f32_16x16x32_bf16 a[164:167], a[236:239], v[180:183], a[164:167]
buffer_load_dwordx4 v243, s[8:11], s56 offen offset:1024 nt lds
v_mfma_f32_16x16x32_bf16 a[132:135], a[236:239], v[176:179], a[132:135]
v_cvt_pk_bf16_f32 v187, v134, v135
v_cvt_pk_bf16_f32 v190, v140, v141
v_mfma_f32_16x16x32_bf16 a[132:135], a[232:235], v[228:231], a[132:135]
s_add_u32 m0, s32, 0xa140
ds_read_b64_tr_b16 a[228:229], v241 offset:58304
ds_read_b64_tr_b16 a[230:231], v241 offset:62432
v_mfma_f32_16x16x32_bf16 a[136:139], a[240:243], v[228:231], a[136:139]
v_exp_f32 v143, v143
v_mfma_f32_16x16x32_bf16 a[136:139], a[244:247], v[176:179], a[136:139]
ds_read_b64_tr_b16 a[232:233], v241 offset:50056
ds_read_b64_tr_b16 a[234:235], v241 offset:54184
v_mfma_f32_16x16x32_bf16 a[168:171], a[244:247], v[180:183], a[168:171]
v_exp_f32 v136, v136
v_mfma_f32_16x16x32_bf16 a[168:171], a[240:243], v[232:235], a[168:171]
buffer_load_dwordx4 v243, s[24:27], s39 offen offset:1032 nt lds
v_mfma_f32_16x16x32_bf16 a[172:175], a[248:251], v[232:235], a[172:175]
v_exp_f32 v137, v137
v_mfma_f32_16x16x32_bf16 a[172:175], a[252:255], v[180:183], a[172:175]
ds_read_b64_tr_b16 a[236:237], v241 offset:58312
ds_read_b64_tr_b16 a[238:239], v241 offset:62440
v_mfma_f32_16x16x32_bf16 a[140:143], a[252:255], v[176:179], a[140:143]
v_exp_f32 v138, v138
v_mfma_f32_16x16x32_bf16 a[140:143], a[248:251], v[228:231], a[140:143]
ds_read_b64_tr_b16 a[240:241], v241 offset:50304
ds_read_b64_tr_b16 a[242:243], v241 offset:54432
v_mfma_f32_16x16x32_bf16 v[144:147], a[192:195], v[32:35], -4.0
v_cvt_pk_bf16_f32 v191, v142, v143
v_cvt_pk_bf16_f32 v188, v136, v137
v_mfma_f32_16x16x32_bf16 v[144:147], a[196:199], v[36:39], v[144:147]
v_exp_f32_e64 v139, v139
v_mfma_f32_16x16x32_bf16 v[144:147], a[200:203], v[40:43], v[144:147]
v_cvt_pk_bf16_f32 v189, v138, v139
v_mfma_f32_16x16x32_bf16 v[144:147], a[204:207], v[44:47], v[144:147]
ds_read_b64_tr_b16 a[244:245], v241 offset:58560
ds_read_b64_tr_b16 a[246:247], v241 offset:62688
v_mfma_f32_16x16x32_bf16 v[148:151], a[220:223], v[44:47], -4.0
ds_read_b64_tr_b16 a[248:249], v241 offset:50312
ds_read_b64_tr_b16 a[250:251], v241 offset:54440
v_mfma_f32_16x16x32_bf16 v[148:151], a[216:219], v[40:43], v[148:151]
ds_read_b64_tr_b16 a[252:253], v241 offset:58568
ds_read_b64_tr_b16 a[254:255], v241 offset:62696
v_mfma_f32_16x16x32_bf16 v[148:151], a[212:215], v[36:39], v[148:151]
v_exp_f32 v144, v144
v_mfma_f32_16x16x32_bf16 v[148:151], a[208:211], v[32:35], v[148:151]
v_exp_f32 v145, v145
v_mfma_f32_16x16x32_bf16 v[156:159], a[208:211], v[48:51], -4.0
v_exp_f32_e64 v146, v146
v_mfma_f32_16x16x32_bf16 v[156:159], a[212:215], v[52:55], v[156:159]
v_exp_f32 v147, v147
v_mfma_f32_16x16x32_bf16 v[156:159], a[216:219], v[56:59], v[156:159]
v_cvt_pk_bf16_f32 v192, v144, v145
v_mfma_f32_16x16x32_bf16 v[156:159], a[220:223], v[60:63], v[156:159]
ds_read_b128 a[208:211], v240 offset:45760
ds_read_b128 a[212:215], v240 offset:46016
v_mfma_f32_16x16x32_bf16 v[152:155], a[204:207], v[60:63], -4.0
v_exp_f32 v148, v148
v_mfma_f32_16x16x32_bf16 v[152:155], a[200:203], v[56:59], v[152:155]
v_exp_f32 v149, v149
v_mfma_f32_16x16x32_bf16 v[152:155], a[196:199], v[52:55], v[152:155]
v_exp_f32_e64 v150, v150
v_mfma_f32_16x16x32_bf16 v[152:155], a[192:195], v[48:51], v[152:155]
ds_read_b128 a[216:219], v240 offset:46272
v_cvt_pk_bf16_f32 v193, v146, v147
v_smfmac_f32_16x16x64_bf16 v[216:219], v[224:227], v[160:167], v248
s_waitcnt lgkmcnt(3)
ds_read_b128 a[220:223], v240 offset:46528
v_mfma_f32_16x16x32_bf16 v[80:83], a[224:227], v[168:171], v[80:83]
v_exp_f32_e64 v151, v151
v_mfma_f32_16x16x32_bf16 v[80:83], a[228:231], v[160:163], v[80:83]
ds_read_b128 a[204:207], v240 offset:42368
v_cvt_pk_bf16_f32 v194, v148, v149
v_mfma_f32_16x16x32_bf16 v[112:115], a[228:231], v[164:167], v[112:115]
v_add_f32_e64 v250, v216, v217
v_add_f32 v251, v218, v219
v_mfma_f32_16x16x32_bf16 v[112:115], a[224:227], v[172:175], v[112:115]
ds_read_b128 a[200:203], v240 offset:42112
v_subrev_u32 v216, s36, v250
v_mfma_f32_16x16x32_bf16 v[116:119], a[232:235], v[172:175], v[116:119]
v_subrev_u32 v217, s36, v251
v_max_u32 v216, v216, v217
v_mfma_f32_16x16x32_bf16 v[116:119], a[236:239], v[164:167], v[116:119]
ds_read_b128 a[196:199], v240 offset:41856
ds_read_b128 a[192:195], v240 offset:41600
v_mfma_f32_16x16x32_bf16 v[84:87], a[236:239], v[160:163], v[84:87]
v_rcp_f32 v250, v250
v_mfma_f32_16x16x32_bf16 v[84:87], a[232:235], v[168:171], v[84:87]
v_rcp_f32 v251, v251
v_mfma_f32_16x16x32_bf16 v[88:91], a[240:243], v[168:171], v[88:91]
v_cmp_le_u32 s[44:45], s37, v216
v_mov_b64 v[216:217], 0
v_mfma_f32_16x16x32_bf16 v[88:91], a[244:247], v[160:163], v[88:91]
v_mov_b64 v[218:219], 0
v_mfma_f32_16x16x32_bf16 v[120:123], a[244:247], v[164:167], v[120:123]
v_exp_f32 v156, v156
v_mfma_f32_16x16x32_bf16 v[120:123], a[240:243], v[172:175], v[120:123]
v_exp_f32 v157, v157
v_mfma_f32_16x16x32_bf16 v[124:127], a[248:251], v[172:175], v[124:127]
v_exp_f32 v158, v158
v_mfma_f32_16x16x32_bf16 v[124:127], a[252:255], v[164:167], v[124:127]
v_cvt_pk_bf16_f32 v195, v150, v151
v_cvt_pk_bf16_f32 v198, v156, v157
v_mfma_f32_16x16x32_bf16 v[92:95], a[252:255], v[160:163], v[92:95]
v_exp_f32 v159, v159
v_mfma_f32_16x16x32_bf16 v[92:95], a[248:251], v[168:171], v[92:95]
s_waitcnt lgkmcnt(0)
v_exp_f32 v152, v152
v_mfma_f32_16x16x32_bf16 v[128:131], a[192:195], v[0:3], -4.0
s_add_u32 m0, s33, 0x1060
v_exp_f32 v153, v153
v_mfma_f32_16x16x32_bf16 v[128:131], a[196:199], v[4:7], v[128:131]
v_exp_f32 v154, v154
v_mfma_f32_16x16x32_bf16 v[128:131], a[200:203], v[8:11], v[128:131]
v_cvt_pk_bf16_f32 v199, v158, v159
v_cvt_pk_bf16_f32 v196, v152, v153
v_mfma_f32_16x16x32_bf16 v[128:131], a[204:207], v[12:15], v[128:131]
buffer_load_dwordx4 v243, s[8:11], s56 offen offset:2048 nt lds
v_mfma_f32_16x16x32_bf16 v[132:135], a[220:223], v[12:15], -4.0
v_exp_f32 v155, v155
v_mfma_f32_16x16x32_bf16 v[132:135], a[216:219], v[8:11], v[132:135]
s_waitcnt vmcnt(17)
v_cvt_pk_bf16_f32 v197, v154, v155
v_mfma_f32_16x16x32_bf16 v[132:135], a[212:215], v[4:7], v[132:135]
v_mfma_f32_16x16x32_bf16 v[132:135], a[208:211], v[0:3], v[132:135]
v_exp_f32 v128, v128
v_mfma_f32_16x16x32_bf16 v[140:143], a[208:211], v[16:19], -4.0
v_exp_f32 v129, v129
v_mfma_f32_16x16x32_bf16 v[140:143], a[212:215], v[20:23], v[140:143]
v_exp_f32 v130, v130
v_mfma_f32_16x16x32_bf16 v[140:143], a[216:219], v[24:27], v[140:143]
v_exp_f32 v131, v131
v_mfma_f32_16x16x32_bf16 v[140:143], a[220:223], v[28:31], v[140:143]
s_add_u32 m0, s31, 0x8200
v_exp_f32 v132, v132
v_mfma_f32_16x16x32_bf16 v[136:139], a[204:207], v[28:31], -4.0
v_cvt_pk_bf16_f32 v160, v128, v129
v_cvt_pk_bf16_f32 v161, v130, v131
v_mfma_f32_16x16x32_bf16 v[136:139], a[200:203], v[24:27], v[136:139]
v_exp_f32 v133, v133
v_mfma_f32_16x16x32_bf16 v[136:139], a[196:199], v[20:23], v[136:139]
v_exp_f32 v134, v134
v_mfma_f32_16x16x32_bf16 v[136:139], a[192:195], v[16:19], v[136:139]
s_barrier
v_smfmac_f32_16x16x64_bf16 v[220:223], v[224:227], v[176:183], v248
buffer_load_dwordx4 v243, s[12:15], s38 offen nt lds
v_mfma_f32_16x16x32_bf16 a[144:147], a[224:227], v[228:231], a[144:147]
v_exp_f32 v135, v135
v_mfma_f32_16x16x32_bf16 a[144:147], a[228:231], v[176:179], a[144:147]
v_exp_f32 v140, v140
v_mfma_f32_16x16x32_bf16 a[176:179], a[228:231], v[180:183], a[176:179]
v_cvt_pk_bf16_f32 v162, v132, v133
v_cvt_pk_bf16_f32 v163, v134, v135
v_mfma_f32_16x16x32_bf16 a[176:179], a[224:227], v[232:235], a[176:179]
ds_read_b64_tr_b16 a[224:225], v241
ds_read_b64_tr_b16 a[226:227], v241 offset:4128
v_mfma_f32_16x16x32_bf16 a[180:183], a[232:235], v[232:235], a[180:183]
v_add_f32 v252, v220, v221
v_add_f32 v253, v222, v223
v_mfma_f32_16x16x32_bf16 a[180:183], a[236:239], v[180:183], a[180:183]
ds_read_b64_tr_b16 a[228:229], v241 offset:8256
ds_read_b64_tr_b16 a[230:231], v241 offset:12384
v_mfma_f32_16x16x32_bf16 a[148:151], a[236:239], v[176:179], a[148:151]
v_subrev_u32 v220, s36, v252
v_subrev_u32 v221, s36, v253
v_mfma_f32_16x16x32_bf16 a[148:151], a[232:235], v[228:231], a[148:151]
ds_read_b64_tr_b16 a[232:233], v241 offset:8
ds_read_b64_tr_b16 a[234:235], v241 offset:4136
v_mfma_f32_16x16x32_bf16 a[152:155], a[240:243], v[228:231], a[152:155]
s_add_u32 m0, s31, 0x8200
v_max_u32 v220, v220, v221
v_rcp_f32 v252, v252
v_mfma_f32_16x16x32_bf16 a[152:155], a[244:247], v[176:179], a[152:155]
buffer_load_dwordx4 v243, s[12:15], s38 offen offset:1024 nt lds
v_mfma_f32_16x16x32_bf16 a[184:187], a[244:247], v[180:183], a[184:187]
s_xor_b32 s38, s29, 0x1010000
v_rcp_f32_e64 v253, v253
v_mfma_f32_16x16x32_bf16 a[184:187], a[240:243], v[232:235], a[184:187]
s_xor_b32 s39, s29, 0x100c000
ds_read_b64_tr_b16 a[236:237], v241 offset:8264
ds_read_b64_tr_b16 a[238:239], v241 offset:12392
v_mfma_f32_16x16x32_bf16 a[188:191], a[248:251], v[232:235], a[188:191]
v_cmp_le_u32 s[46:47], s37, v220
v_mov_b64 v[220:221], 0
v_mfma_f32_16x16x32_bf16 a[188:191], a[252:255], v[180:183], a[188:191]
ds_read_b64_tr_b16 a[240:241], v241 offset:256
ds_read_b64_tr_b16 a[242:243], v241 offset:4384
v_mfma_f32_16x16x32_bf16 a[156:159], a[252:255], v[176:179], a[156:159]
v_mov_b64 v[222:223], 0
v_accvgpr_read_b32 v200, a128
v_mfma_f32_16x16x32_bf16 a[156:159], a[248:251], v[228:231], a[156:159]
ds_read_b64_tr_b16 a[244:245], v241 offset:8512
v_accvgpr_read_b32 v201, a129
v_mfma_f32_16x16x32_bf16 v[144:147], a[192:195], v[32:35], -4.0
v_exp_f32 v141, v141
v_mfma_f32_16x16x32_bf16 v[144:147], a[196:199], v[36:39], v[144:147]
v_exp_f32 v142, v142
v_mfma_f32_16x16x32_bf16 v[144:147], a[200:203], v[40:43], v[144:147]
s_add_u32 m0, s31, 0xa280
v_cvt_pk_bf16_f32 v166, v140, v141
v_accvgpr_read_b32 v202, a130
v_mfma_f32_16x16x32_bf16 v[144:147], a[204:207], v[44:47], v[144:147]
buffer_load_dwordx4 v243, s[12:15], s38 offen nt lds
v_mfma_f32_16x16x32_bf16 v[148:151], a[220:223], v[44:47], -4.0
v_exp_f32 v143, v143
v_mfma_f32_16x16x32_bf16 v[148:151], a[216:219], v[40:43], v[148:151]
v_exp_f32 v136, v136
v_mfma_f32_16x16x32_bf16 v[148:151], a[212:215], v[36:39], v[148:151]
v_cvt_pk_bf16_f32 v167, v142, v143
v_accvgpr_read_b32 v203, a131
v_mfma_f32_16x16x32_bf16 v[148:151], a[208:211], v[32:35], v[148:151]
ds_read_b64_tr_b16 a[246:247], v241 offset:12640
ds_read_b64_tr_b16 a[248:249], v241 offset:264
v_mfma_f32_16x16x32_bf16 v[156:159], a[208:211], v[48:51], -4.0
v_exp_f32_e64 v137, v137
v_mfma_f32_16x16x32_bf16 v[156:159], a[212:215], v[52:55], v[156:159]
v_exp_f32_e64 v138, v138
v_mfma_f32_16x16x32_bf16 v[156:159], a[216:219], v[56:59], v[156:159]
v_cvt_pk_bf16_f32 v164, v136, v137
v_accvgpr_read_b32 v204, a132
v_mfma_f32_16x16x32_bf16 v[156:159], a[220:223], v[60:63], v[156:159]
ds_read_b64_tr_b16 a[250:251], v241 offset:4392
ds_read_b64_tr_b16 a[252:253], v241 offset:8520
v_mfma_f32_16x16x32_bf16 v[152:155], a[204:207], v[60:63], -4.0
s_add_u32 m0, s31, 0xa280
v_exp_f32 v139, v139
v_mfma_f32_16x16x32_bf16 v[152:155], a[200:203], v[56:59], v[152:155]
v_cvt_pk_bf16_f32 v165, v138, v139
v_accvgpr_read_b32 v205, a133
v_mfma_f32_16x16x32_bf16 v[152:155], a[196:199], v[52:55], v[152:155]
v_exp_f32 v144, v144
v_mfma_f32_16x16x32_bf16 v[152:155], a[192:195], v[48:51], v[152:155]
buffer_load_dwordx4 v243, s[12:15], s38 offen offset:1024 nt lds
v_smfmac_f32_16x16x64_bf16 v[216:219], v[224:227], v[184:191], v248
s_waitcnt lgkmcnt(2)
ds_read_b64_tr_b16 a[254:255], v241 offset:12648
v_mfma_f32_16x16x32_bf16 a[0:3], a[224:227], v[184:187], 0
s_add_u32 m0, s33, 0x1060
v_exp_f32 v145, v145
v_mfma_f32_16x16x32_bf16 a[0:3], a[228:231], v[160:163], a[0:3]
ds_read_b128 a[208:211], v240 offset:54080
ds_read_b128 a[212:215], v240 offset:54336
v_mfma_f32_16x16x32_bf16 a[32:35], a[228:231], v[164:167], 0
v_exp_f32_e64 v146, v146
v_mfma_f32_16x16x32_bf16 a[32:35], a[224:227], v[188:191], a[32:35]
ds_read_b128 a[216:219], v240 offset:54592
ds_read_b128 a[220:223], v240 offset:54848
v_mfma_f32_16x16x32_bf16 a[36:39], a[232:235], v[188:191], 0
v_cvt_pk_bf16_f32 v168, v144, v145
v_accvgpr_read_b32 v206, a134
v_mfma_f32_16x16x32_bf16 a[36:39], a[236:239], v[164:167], a[36:39]
ds_read_b128 a[204:207], v240 offset:50688
ds_read_b128 a[200:203], v240 offset:50432
v_mfma_f32_16x16x32_bf16 a[4:7], a[236:239], v[160:163], 0
v_exp_f32_e64 v147, v147
v_mfma_f32_16x16x32_bf16 a[4:7], a[232:235], v[184:187], a[4:7]
ds_read_b128 a[196:199], v240 offset:50176
v_accvgpr_read_b32 v207, a135
v_mfma_f32_16x16x32_bf16 a[8:11], a[240:243], v[184:187], 0
ds_read_b128 a[192:195], v240 offset:49920
v_mfma_f32_16x16x32_bf16 a[8:11], a[244:247], v[160:163], a[8:11]
buffer_load_dwordx4 v243, s[8:11], s56 offen offset:3072 nt lds
v_mfma_f32_16x16x32_bf16 a[40:43], a[244:247], v[164:167], 0
s_add_u32 m0, s32, 0xc180
v_exp_f32_e64 v148, v148
v_mfma_f32_16x16x32_bf16 a[40:43], a[240:243], v[188:191], a[40:43]
s_waitcnt lgkmcnt(4)
v_cvt_pk_bf16_f32 v169, v146, v147
v_exp_f32 v149, v149
v_exp_f32_e64 v150, v150
v_pk_mul_f32 v[206:207], v[206:207], v[252:253] op_sel:[0,0] op_sel_hi:[1,0]
v_pk_mul_f32 v[204:205], v[204:205], v[252:253] op_sel:[0,0] op_sel_hi:[1,0]
v_pk_mul_f32 v[202:203], v[202:203], v[252:253] op_sel:[0,0] op_sel_hi:[1,0]
v_pk_mul_f32 v[200:201], v[200:201], v[252:253] op_sel:[0,0] op_sel_hi:[1,0]
v_cvt_pk_bf16_f32 v200, v200, v201
v_mfma_f32_16x16x32_bf16 a[44:47], a[248:251], v[188:191], 0
s_xor_b32 s56, s28, 0x3002000
v_cvt_pk_bf16_f32 v170, v148, v149
v_cvt_pk_bf16_f32 v201, v202, v203
v_mfma_f32_16x16x32_bf16 a[44:47], a[252:255], v[164:167], a[44:47]
v_exp_f32 v151, v151
v_mfma_f32_16x16x32_bf16 a[12:15], a[252:255], v[160:163], 0
v_exp_f32 v156, v156
v_mfma_f32_16x16x32_bf16 a[12:15], a[248:251], v[184:187], a[12:15]
L_pad10:
s_cbranch_vccnz L_main
s_waitcnt lgkmcnt(0)
buffer_load_dwordx4 v243, s[16:19], s39 offen nt lds
v_mfma_f32_16x16x32_bf16 v[128:131], a[192:195], v[0:3], -4.0
v_cvt_pk_bf16_f32 v171, v150, v151
v_cvt_pk_bf16_f32 v202, v204, v205
v_mfma_f32_16x16x32_bf16 v[128:131], a[196:199], v[4:7], v[128:131]
v_exp_f32_e64 v157, v157
v_mfma_f32_16x16x32_bf16 v[128:131], a[200:203], v[8:11], v[128:131]
v_exp_f32 v158, v158
v_mfma_f32_16x16x32_bf16 v[128:131], a[204:207], v[12:15], v[128:131]
v_cvt_pk_bf16_f32 v174, v156, v157
v_cvt_pk_bf16_f32 v203, v206, v207
v_mfma_f32_16x16x32_bf16 v[132:135], a[220:223], v[12:15], -4.0
v_exp_f32 v159, v159
v_mfma_f32_16x16x32_bf16 v[132:135], a[216:219], v[8:11], v[132:135]
v_exp_f32_e64 v152, v152
v_mfma_f32_16x16x32_bf16 v[132:135], a[212:215], v[4:7], v[132:135]
v_cvt_pk_bf16_f32 v175, v158, v159
v_accvgpr_read_b32 v208, a136
v_mfma_f32_16x16x32_bf16 v[132:135], a[208:211], v[0:3], v[132:135]
v_exp_f32 v153, v153
v_mfma_f32_16x16x32_bf16 v[140:143], a[208:211], v[16:19], -4.0
s_add_u32 m0, s32, 0xc180
v_exp_f32 v154, v154
v_mfma_f32_16x16x32_bf16 v[140:143], a[212:215], v[20:23], v[140:143]
v_cvt_pk_bf16_f32 v172, v152, v153
v_accvgpr_read_b32 v209, a137
v_mfma_f32_16x16x32_bf16 v[140:143], a[216:219], v[24:27], v[140:143]
v_exp_f32_e64 v155, v155
v_mfma_f32_16x16x32_bf16 v[140:143], a[220:223], v[28:31], v[140:143]
buffer_load_dwordx4 v243, s[24:27], s39 offen offset:1032 nt lds
v_mfma_f32_16x16x32_bf16 v[136:139], a[204:207], v[28:31], -4.0
s_xor_b32 s39, s29, 0x100e000
v_cvt_pk_bf16_f32 v173, v154, v155
v_accvgpr_read_b32 v210, a138
v_mfma_f32_16x16x32_bf16 v[136:139], a[200:203], v[24:27], v[136:139]
s_xor_b32 s38, s29, 0x1012000
v_exp_f32 v128, v128
v_mfma_f32_16x16x32_bf16 v[136:139], a[196:199], v[20:23], v[136:139]
v_exp_f32 v129, v129
v_mfma_f32_16x16x32_bf16 v[136:139], a[192:195], v[16:19], v[136:139]
v_exp_f32_e64 v130, v130
v_smfmac_f32_16x16x64_bf16 v[220:223], v[224:227], v[192:199], v248
v_cvt_pk_bf16_f32 v176, v128, v129
v_mfma_f32_16x16x32_bf16 a[64:67], a[224:227], v[192:195], 0
v_exp_f32 v131, v131
v_mfma_f32_16x16x32_bf16 a[64:67], a[228:231], v[168:171], a[64:67]
v_exp_f32 v132, v132
v_mfma_f32_16x16x32_bf16 a[96:99], a[228:231], v[172:175], 0
v_cvt_pk_bf16_f32 v177, v130, v131
v_accvgpr_read_b32 v211, a139
v_mfma_f32_16x16x32_bf16 a[96:99], a[224:227], v[196:199], a[96:99]
s_add_u32 m0, s32, 0xe1c0
ds_read_b64_tr_b16 a[224:225], v241 offset:512
ds_read_b64_tr_b16 a[226:227], v241 offset:4640
v_mfma_f32_16x16x32_bf16 a[100:103], a[232:235], v[196:199], 0
v_exp_f32_e64 v133, v133
v_mfma_f32_16x16x32_bf16 a[100:103], a[236:239], v[172:175], a[100:103]
buffer_load_dwordx4 v243, s[16:19], s39 offen nt lds
v_mfma_f32_16x16x32_bf16 a[68:71], a[236:239], v[168:171], 0
v_exp_f32_e64 v134, v134
v_mfma_f32_16x16x32_bf16 a[68:71], a[232:235], v[192:195], a[68:71]
ds_read_b64_tr_b16 a[228:229], v241 offset:8768
ds_read_b64_tr_b16 a[230:231], v241 offset:12896
v_mfma_f32_16x16x32_bf16 a[72:75], a[240:243], v[192:195], 0
v_cvt_pk_bf16_f32 v178, v132, v133
v_accvgpr_read_b32 v212, a140
v_mfma_f32_16x16x32_bf16 a[72:75], a[244:247], v[168:171], a[72:75]
ds_read_b64_tr_b16 a[232:233], v241 offset:520
ds_read_b64_tr_b16 a[234:235], v241 offset:4648
v_mfma_f32_16x16x32_bf16 a[104:107], a[244:247], v[172:175], 0
v_exp_f32_e64 v135, v135
v_mfma_f32_16x16x32_bf16 a[104:107], a[240:243], v[196:199], a[104:107]
ds_read_b64_tr_b16 a[236:237], v241 offset:8776
ds_read_b64_tr_b16 a[238:239], v241 offset:12904
v_mfma_f32_16x16x32_bf16 a[108:111], a[248:251], v[196:199], 0
v_exp_f32_e64 v140, v140
v_mfma_f32_16x16x32_bf16 a[108:111], a[252:255], v[172:175], a[108:111]
ds_read_b64_tr_b16 a[240:241], v241 offset:768
ds_read_b64_tr_b16 a[242:243], v241 offset:4896
v_mfma_f32_16x16x32_bf16 a[76:79], a[252:255], v[168:171], 0
s_add_u32 m0, s32, 0xe1c0
v_cvt_pk_bf16_f32 v179, v134, v135
v_accvgpr_read_b32 v213, a141
v_mfma_f32_16x16x32_bf16 a[76:79], a[248:251], v[192:195], a[76:79]
buffer_load_dwordx4 v243, s[24:27], s39 offen offset:1032 nt lds
v_mfma_f32_16x16x32_bf16 v[144:147], a[192:195], v[32:35], -4.0
v_exp_f32 v141, v141
v_mfma_f32_16x16x32_bf16 v[144:147], a[196:199], v[36:39], v[144:147]
v_exp_f32 v142, v142
v_mfma_f32_16x16x32_bf16 v[144:147], a[200:203], v[40:43], v[144:147]
v_cvt_pk_bf16_f32 v182, v140, v141
v_accvgpr_read_b32 v214, a142
v_mfma_f32_16x16x32_bf16 v[144:147], a[204:207], v[44:47], v[144:147]
ds_read_b64_tr_b16 a[244:245], v241 offset:9024
ds_read_b64_tr_b16 a[246:247], v241 offset:13152
v_accvgpr_read_b32 v215, a143
v_mfma_f32_16x16x32_bf16 v[148:151], a[220:223], v[44:47], -4.0
v_exp_f32 v143, v143
v_mfma_f32_16x16x32_bf16 v[148:151], a[216:219], v[40:43], v[148:151]
v_exp_f32 v136, v136
v_mfma_f32_16x16x32_bf16 v[148:151], a[212:215], v[36:39], v[148:151]
v_exp_f32 v137, v137
v_mfma_f32_16x16x32_bf16 v[148:151], a[208:211], v[32:35], v[148:151]
ds_read_b64_tr_b16 a[248:249], v241 offset:776
v_cvt_pk_bf16_f32 v183, v142, v143
v_exp_f32 v138, v138
v_cvt_pk_bf16_f32 v180, v136, v137
v_pk_mul_f32 v[214:215], v[214:215], v[252:253] op_sel:[0,0] op_sel_hi:[1,0]
v_pk_mul_f32 v[212:213], v[212:213], v[252:253] op_sel:[0,0] op_sel_hi:[1,0]
v_pk_mul_f32 v[210:211], v[210:211], v[252:253] op_sel:[0,0] op_sel_hi:[1,0]
v_pk_mul_f32 v[208:209], v[208:209], v[252:253] op_sel:[0,0] op_sel_hi:[1,0]
v_cvt_pk_bf16_f32 v208, v208, v209
v_mfma_f32_16x16x32_bf16 v[156:159], a[208:211], v[48:51], -4.0
v_exp_f32_e64 v139, v139
v_mfma_f32_16x16x32_bf16 v[156:159], a[212:215], v[52:55], v[156:159]
v_cvt_pk_bf16_f32 v181, v138, v139
v_cvt_pk_bf16_f32 v209, v210, v211
v_mfma_f32_16x16x32_bf16 v[156:159], a[216:219], v[56:59], v[156:159]
v_exp_f32_e64 v144, v144
v_mfma_f32_16x16x32_bf16 v[156:159], a[220:223], v[60:63], v[156:159]
ds_read_b64_tr_b16 a[250:251], v241 offset:4904
ds_read_b64_tr_b16 a[252:253], v241 offset:9032
v_mfma_f32_16x16x32_bf16 v[152:155], a[204:207], v[60:63], -4.0
v_exp_f32_e64 v145, v145
v_mfma_f32_16x16x32_bf16 v[152:155], a[200:203], v[56:59], v[152:155]
v_exp_f32 v146, v146
v_mfma_f32_16x16x32_bf16 v[152:155], a[196:199], v[52:55], v[152:155]
v_cvt_pk_bf16_f32 v228, v144, v145
v_cvt_pk_bf16_f32 v210, v212, v213
v_mfma_f32_16x16x32_bf16 v[152:155], a[192:195], v[48:51], v[152:155]
ds_read_b64_tr_b16 a[254:255], v241 offset:13160
ds_read_b128 a[208:211], v240 offset:4160
v_smfmac_f32_16x16x64_bf16 v[216:219], v[224:227], v[160:167], v248
s_waitcnt lgkmcnt(4)
ds_read_b128 a[212:215], v240 offset:4416
v_mfma_f32_16x16x32_bf16 a[16:19], a[224:227], v[184:187], 0
v_exp_f32 v147, v147
v_mfma_f32_16x16x32_bf16 a[16:19], a[228:231], v[160:163], a[16:19]
ds_read_b128 a[216:219], v240 offset:4672
ds_read_b128 a[220:223], v240 offset:4928
v_mfma_f32_16x16x32_bf16 a[48:51], a[228:231], v[164:167], 0
v_exp_f32 v148, v148
v_mfma_f32_16x16x32_bf16 a[48:51], a[224:227], v[188:191], a[48:51]
ds_read_b128 a[204:207], v240 offset:768
v_cvt_pk_bf16_f32 v229, v146, v147
v_mfma_f32_16x16x32_bf16 a[52:55], a[232:235], v[188:191], 0
v_cvt_pk_bf16_f32 v211, v214, v215
v_mov_b64 v[212:213], v[200:201]
v_mfma_f32_16x16x32_bf16 a[52:55], a[236:239], v[164:167], a[52:55]
ds_read_b128 a[200:203], v240 offset:512
v_mov_b64 v[214:215], v[202:203]
v_mfma_f32_16x16x32_bf16 a[20:23], a[236:239], v[160:163], 0
v_exp_f32 v149, v149
v_mfma_f32_16x16x32_bf16 a[20:23], a[232:235], v[184:187], a[20:23]
ds_read_b128 a[196:199], v240 offset:256
v_mov_b32_dpp v200, v208 row_ror:8 row_mask:0xf bank_mask:0xc
v_mfma_f32_16x16x32_bf16 a[24:27], a[240:243], v[184:187], 0
ds_read_b128 a[192:195], v240
v_mov_b32_dpp v201, v209 row_ror:8 row_mask:0xf bank_mask:0xc
v_mfma_f32_16x16x32_bf16 a[24:27], a[244:247], v[160:163], a[24:27]
v_exp_f32 v150, v150
v_mfma_f32_16x16x32_bf16 a[56:59], a[244:247], v[164:167], 0
v_cvt_pk_bf16_f32 v230, v148, v149
v_mov_b32_dpp v202, v210 row_ror:8 row_mask:0xf bank_mask:0xc
v_mfma_f32_16x16x32_bf16 a[56:59], a[240:243], v[188:191], a[56:59]
s_waitcnt lgkmcnt(3)
v_exp_f32 v151, v151
v_mfma_f32_16x16x32_bf16 a[60:63], a[248:251], v[188:191], 0
v_exp_f32_e64 v156, v156
v_mfma_f32_16x16x32_bf16 a[60:63], a[252:255], v[164:167], a[60:63]
v_cvt_pk_bf16_f32 v231, v150, v151
v_mov_b32_dpp v203, v211 row_ror:8 row_mask:0xf bank_mask:0xc
v_mov_b32_dpp v208, v212 row_ror:8 row_mask:0xf bank_mask:0x3
v_mfma_f32_16x16x32_bf16 a[28:31], a[252:255], v[160:163], 0
v_exp_f32 v157, v157
v_mfma_f32_16x16x32_bf16 a[28:31], a[248:251], v[184:187], a[28:31]
s_waitcnt lgkmcnt(0)
buffer_store_dwordx4 v[200:203], v249, s[20:23], s59 offen sc1
v_mfma_f32_16x16x32_bf16 v[128:131], a[192:195], v[0:3], -4.0
v_exp_f32 v158, v158
v_mfma_f32_16x16x32_bf16 v[128:131], a[196:199], v[4:7], v[128:131]
v_cvt_pk_bf16_f32 v234, v156, v157
v_mov_b32_dpp v209, v213 row_ror:8 row_mask:0xf bank_mask:0x3
v_mfma_f32_16x16x32_bf16 v[128:131], a[200:203], v[8:11], v[128:131]
v_exp_f32 v159, v159
v_mfma_f32_16x16x32_bf16 v[128:131], a[204:207], v[12:15], v[128:131]
v_mov_b32_dpp v210, v214 row_ror:8 row_mask:0xf bank_mask:0x3
v_mov_b32_dpp v211, v215 row_ror:8 row_mask:0xf bank_mask:0x3
v_accvgpr_read_b32 v200, a144
v_mfma_f32_16x16x32_bf16 v[132:135], a[220:223], v[12:15], -4.0
v_exp_f32 v152, v152
v_mfma_f32_16x16x32_bf16 v[132:135], a[216:219], v[8:11], v[132:135]
v_cvt_pk_bf16_f32 v235, v158, v159
v_accvgpr_read_b32 v201, a145
v_mfma_f32_16x16x32_bf16 v[132:135], a[212:215], v[4:7], v[132:135]
v_exp_f32 v153, v153
v_mfma_f32_16x16x32_bf16 v[132:135], a[208:211], v[0:3], v[132:135]
v_accvgpr_read_b32 v202, a146
v_accvgpr_read_b32 v203, a147
v_accvgpr_read_b32 v204, a148
v_mfma_f32_16x16x32_bf16 v[140:143], a[208:211], v[16:19], -4.0
v_exp_f32_e64 v154, v154
v_mfma_f32_16x16x32_bf16 v[140:143], a[212:215], v[20:23], v[140:143]
v_cvt_pk_bf16_f32 v232, v152, v153
v_accvgpr_read_b32 v205, a149
v_mfma_f32_16x16x32_bf16 v[140:143], a[216:219], v[24:27], v[140:143]
v_exp_f32 v155, v155
v_mfma_f32_16x16x32_bf16 v[140:143], a[220:223], v[28:31], v[140:143]
s_add_u32 m0, s31, 0xc300
v_cvt_pk_bf16_f32 v233, v154, v155
v_accvgpr_read_b32 v206, a150
v_accvgpr_read_b32 v207, a151
v_mfma_f32_16x16x32_bf16 v[136:139], a[204:207], v[28:31], -4.0
v_exp_f32 v128, v128
v_mfma_f32_16x16x32_bf16 v[136:139], a[200:203], v[24:27], v[136:139]
v_exp_f32 v129, v129
v_mfma_f32_16x16x32_bf16 v[136:139], a[196:199], v[20:23], v[136:139]
s_waitcnt vmcnt(19)
v_exp_f32 v130, v130
v_mfma_f32_16x16x32_bf16 v[136:139], a[192:195], v[16:19], v[136:139]
s_barrier
v_smfmac_f32_16x16x64_bf16 v[220:223], v[224:227], v[168:175], v248
buffer_load_dwordx4 v243, s[12:15], s38 offen nt lds
v_mfma_f32_16x16x32_bf16 a[80:83], a[224:227], v[192:195], 0
v_exp_f32 v131, v131
v_mfma_f32_16x16x32_bf16 a[80:83], a[228:231], v[168:171], a[80:83]
v_cvt_pk_bf16_f32 v160, v128, v129
v_exp_f32 v132, v132
v_cvt_pk_bf16_f32 v161, v130, v131
v_exp_f32_e64 v133, v133
v_pk_mul_f32 v[206:207], v[206:207], v[252:253] op_sel:[0,0] op_sel_hi:[1,0]
v_pk_mul_f32 v[204:205], v[204:205], v[252:253] op_sel:[0,0] op_sel_hi:[1,0]
v_pk_mul_f32 v[202:203], v[202:203], v[252:253] op_sel:[0,0] op_sel_hi:[1,0]
v_pk_mul_f32 v[200:201], v[200:201], v[252:253] op_sel:[0,0] op_sel_hi:[1,0]
v_cvt_pk_bf16_f32 v200, v200, v201
v_mfma_f32_16x16x32_bf16 a[112:115], a[228:231], v[172:175], 0
v_exp_f32_e64 v134, v134
v_mfma_f32_16x16x32_bf16 a[112:115], a[224:227], v[196:199], a[112:115]
ds_read_b64_tr_b16 a[224:225], v241 offset:16512
ds_read_b64_tr_b16 a[226:227], v241 offset:20640
v_mfma_f32_16x16x32_bf16 a[116:119], a[232:235], v[196:199], 0
v_cvt_pk_bf16_f32 v162, v132, v133
v_cvt_pk_bf16_f32 v201, v202, v203
v_mfma_f32_16x16x32_bf16 a[116:119], a[236:239], v[172:175], a[116:119]
buffer_store_dwordx4 v[208:211], v249, s[20:23], s59 offen offset:2048 sc1
v_mfma_f32_16x16x32_bf16 a[84:87], a[236:239], v[168:171], 0
v_exp_f32_e64 v135, v135
v_mfma_f32_16x16x32_bf16 a[84:87], a[232:235], v[192:195], a[84:87]
ds_read_b64_tr_b16 a[228:229], v241 offset:24768
ds_read_b64_tr_b16 a[230:231], v241 offset:28896
v_mfma_f32_16x16x32_bf16 a[88:91], a[240:243], v[192:195], 0
s_add_u32 m0, s31, 0xc300
v_exp_f32_e64 v140, v140
v_mfma_f32_16x16x32_bf16 a[88:91], a[244:247], v[168:171], a[88:91]
ds_read_b64_tr_b16 a[232:233], v241 offset:16520
ds_read_b64_tr_b16 a[234:235], v241 offset:20648
v_cvt_pk_bf16_f32 v202, v204, v205
v_mfma_f32_16x16x32_bf16 a[120:123], a[244:247], v[172:175], 0
v_cvt_pk_bf16_f32 v163, v134, v135
v_cvt_pk_bf16_f32 v203, v206, v207
v_mfma_f32_16x16x32_bf16 a[120:123], a[240:243], v[196:199], a[120:123]
ds_read_b64_tr_b16 a[236:237], v241 offset:24776
ds_read_b64_tr_b16 a[238:239], v241 offset:28904
v_mfma_f32_16x16x32_bf16 a[124:127], a[248:251], v[196:199], 0
v_exp_f32_e64 v141, v141
v_mfma_f32_16x16x32_bf16 a[124:127], a[252:255], v[172:175], a[124:127]
ds_read_b64_tr_b16 a[240:241], v241 offset:16768
ds_read_b64_tr_b16 a[242:243], v241 offset:20896
v_mfma_f32_16x16x32_bf16 a[92:95], a[252:255], v[168:171], 0
v_exp_f32_e64 v142, v142
v_mfma_f32_16x16x32_bf16 a[92:95], a[248:251], v[192:195], a[92:95]
buffer_load_dwordx4 v243, s[12:15], s38 offen offset:1024 nt lds
v_mfma_f32_16x16x32_bf16 v[144:147], a[192:195], v[32:35], -4.0
s_xor_b32 s38, s29, 0x1014000
v_cvt_pk_bf16_f32 v166, v140, v141
v_accvgpr_read_b32 v208, a152
v_mfma_f32_16x16x32_bf16 v[144:147], a[196:199], v[36:39], v[144:147]
s_xor_b32 s39, s29, 0x1010000
v_exp_f32 v143, v143
v_mfma_f32_16x16x32_bf16 v[144:147], a[200:203], v[40:43], v[144:147]
v_exp_f32 v136, v136
v_mfma_f32_16x16x32_bf16 v[144:147], a[204:207], v[44:47], v[144:147]
ds_read_b64_tr_b16 a[244:245], v241 offset:25024
ds_read_b64_tr_b16 a[246:247], v241 offset:29152
v_accvgpr_read_b32 v209, a153
v_mfma_f32_16x16x32_bf16 v[148:151], a[220:223], v[44:47], -4.0
v_cvt_pk_bf16_f32 v167, v142, v143
v_accvgpr_read_b32 v210, a154
v_mfma_f32_16x16x32_bf16 v[148:151], a[216:219], v[40:43], v[148:151]
v_exp_f32_e64 v137, v137
v_mfma_f32_16x16x32_bf16 v[148:151], a[212:215], v[36:39], v[148:151]
v_exp_f32 v138, v138
v_mfma_f32_16x16x32_bf16 v[148:151], a[208:211], v[32:35], v[148:151]
ds_read_b64_tr_b16 a[248:249], v241 offset:16776
ds_read_b64_tr_b16 a[250:251], v241 offset:20904
v_accvgpr_read_b32 v211, a155
v_mfma_f32_16x16x32_bf16 v[156:159], a[208:211], v[48:51], -4.0
s_add_u32 m0, s31, 0x0
v_cvt_pk_bf16_f32 v164, v136, v137
v_accvgpr_read_b32 v212, a156
v_mfma_f32_16x16x32_bf16 v[156:159], a[212:215], v[52:55], v[156:159]
v_exp_f32_e64 v139, v139
v_mfma_f32_16x16x32_bf16 v[156:159], a[216:219], v[56:59], v[156:159]
v_cvt_pk_bf16_f32 v165, v138, v139
v_accvgpr_read_b32 v213, a157
v_mfma_f32_16x16x32_bf16 v[156:159], a[220:223], v[60:63], v[156:159]
buffer_load_dwordx4 v243, s[12:15], s38 offen nt lds
v_mfma_f32_16x16x32_bf16 v[152:155], a[204:207], v[60:63], -4.0
v_accvgpr_read_b32 v214, a158
v_accvgpr_read_b32 v215, a159
v_mfma_f32_16x16x32_bf16 v[152:155], a[200:203], v[56:59], v[152:155]
v_exp_f32 v144, v144
v_mfma_f32_16x16x32_bf16 v[152:155], a[196:199], v[52:55], v[152:155]
v_exp_f32 v145, v145
v_mfma_f32_16x16x32_bf16 v[152:155], a[192:195], v[48:51], v[152:155]
ds_read_b64_tr_b16 a[252:253], v241 offset:25032
v_exp_f32 v146, v146
v_cvt_pk_bf16_f32 v184, v144, v145
v_exp_f32 v147, v147
v_pk_mul_f32 v[214:215], v[214:215], v[252:253] op_sel:[0,0] op_sel_hi:[1,0]
v_pk_mul_f32 v[212:213], v[212:213], v[252:253] op_sel:[0,0] op_sel_hi:[1,0]
v_pk_mul_f32 v[210:211], v[210:211], v[252:253] op_sel:[0,0] op_sel_hi:[1,0]
v_pk_mul_f32 v[208:209], v[208:209], v[252:253] op_sel:[0,0] op_sel_hi:[1,0]
v_cvt_pk_bf16_f32 v208, v208, v209
v_smfmac_f32_16x16x64_bf16 v[216:219], v[224:227], v[176:183], v248
s_waitcnt lgkmcnt(1)
ds_read_b64_tr_b16 a[254:255], v241 offset:29160
v_mfma_f32_16x16x32_bf16 a[0:3], a[224:227], v[176:179], a[0:3]
v_exp_f32 v148, v148
v_mfma_f32_16x16x32_bf16 a[0:3], a[228:231], v[160:163], a[0:3]
ds_read_b128 a[208:211], v240 offset:12480
ds_read_b128 a[212:215], v240 offset:12736
v_mfma_f32_16x16x32_bf16 a[32:35], a[228:231], v[164:167], a[32:35]
v_cvt_pk_bf16_f32 v185, v146, v147
v_cvt_pk_bf16_f32 v209, v210, v211
v_mfma_f32_16x16x32_bf16 a[32:35], a[224:227], v[180:183], a[32:35]
s_add_u32 m0, s31, 0x0
ds_read_b128 a[216:219], v240 offset:12992
ds_read_b128 a[220:223], v240 offset:13248
v_mfma_f32_16x16x32_bf16 a[36:39], a[232:235], v[180:183], a[36:39]
v_exp_f32 v149, v149
v_mfma_f32_16x16x32_bf16 a[36:39], a[236:239], v[164:167], a[36:39]
ds_read_b128 a[204:207], v240 offset:9088
ds_read_b128 a[200:203], v240 offset:8832
v_mfma_f32_16x16x32_bf16 a[4:7], a[236:239], v[160:163], a[4:7]
v_cvt_pk_bf16_f32 v210, v212, v213
v_cvt_pk_bf16_f32 v211, v214, v215
v_mfma_f32_16x16x32_bf16 a[4:7], a[232:235], v[176:179], a[4:7]
ds_read_b128 a[196:199], v240 offset:8576
v_mov_b64_e64 v[212:213], v[200:201]
v_mfma_f32_16x16x32_bf16 a[8:11], a[240:243], v[176:179], a[8:11]
ds_read_b128 a[192:195], v240 offset:8320
v_mov_b64 v[214:215], v[202:203]
v_mfma_f32_16x16x32_bf16 a[8:11], a[244:247], v[160:163], a[8:11]
buffer_load_dwordx4 v243, s[12:15], s38 offen offset:1024 nt lds
v_mfma_f32_16x16x32_bf16 a[40:43], a[244:247], v[164:167], a[40:43]
v_exp_f32 v150, v150
v_mfma_f32_16x16x32_bf16 a[40:43], a[240:243], v[180:183], a[40:43]
v_cvt_pk_bf16_f32 v186, v148, v149
v_mov_b32_dpp v200, v208 row_ror:8 row_mask:0xf bank_mask:0xc
v_mfma_f32_16x16x32_bf16 a[44:47], a[248:251], v[180:183], a[44:47]
s_waitcnt lgkmcnt(2)
v_exp_f32 v151, v151
v_mfma_f32_16x16x32_bf16 a[44:47], a[252:255], v[164:167], a[44:47]
v_exp_f32 v156, v156
v_mfma_f32_16x16x32_bf16 a[12:15], a[252:255], v[160:163], a[12:15]
v_cvt_pk_bf16_f32 v187, v150, v151
v_mov_b32_dpp v201, v209 row_ror:8 row_mask:0xf bank_mask:0xc
v_mfma_f32_16x16x32_bf16 a[12:15], a[248:251], v[176:179], a[12:15]
s_waitcnt lgkmcnt(0)
v_exp_f32 v157, v157
v_mfma_f32_16x16x32_bf16 v[128:131], a[192:195], v[0:3], -4.0
v_exp_f32 v158, v158
v_mfma_f32_16x16x32_bf16 v[128:131], a[196:199], v[4:7], v[128:131]
v_cvt_pk_bf16_f32 v190, v156, v157
v_mov_b32_dpp v202, v210 row_ror:8 row_mask:0xf bank_mask:0xc
v_mfma_f32_16x16x32_bf16 v[128:131], a[200:203], v[8:11], v[128:131]
s_add_u32 m0, s32, 0x0
v_exp_f32 v159, v159
v_mfma_f32_16x16x32_bf16 v[128:131], a[204:207], v[12:15], v[128:131]
buffer_load_dwordx4 v243, s[16:19], s39 offen nt lds
v_mfma_f32_16x16x32_bf16 v[132:135], a[220:223], v[12:15], -4.0
v_exp_f32 v152, v152
v_mfma_f32_16x16x32_bf16 v[132:135], a[216:219], v[8:11], v[132:135]
v_cvt_pk_bf16_f32 v191, v158, v159
v_mov_b32_dpp v203, v211 row_ror:8 row_mask:0xf bank_mask:0xc
v_mfma_f32_16x16x32_bf16 v[132:135], a[212:215], v[4:7], v[132:135]
v_exp_f32 v153, v153
v_mfma_f32_16x16x32_bf16 v[132:135], a[208:211], v[0:3], v[132:135]
v_mov_b32_dpp v208, v212 row_ror:8 row_mask:0xf bank_mask:0x3
v_mov_b32_dpp v209, v213 row_ror:8 row_mask:0xf bank_mask:0x3
v_mfma_f32_16x16x32_bf16 v[140:143], a[208:211], v[16:19], -4.0
v_exp_f32 v154, v154
v_mfma_f32_16x16x32_bf16 v[140:143], a[212:215], v[20:23], v[140:143]
v_cvt_pk_bf16_f32 v188, v152, v153
v_mov_b32_dpp v210, v214 row_ror:8 row_mask:0xf bank_mask:0x3
v_mfma_f32_16x16x32_bf16 v[140:143], a[216:219], v[24:27], v[140:143]
v_exp_f32 v155, v155
v_mfma_f32_16x16x32_bf16 v[140:143], a[220:223], v[28:31], v[140:143]
buffer_store_dwordx4 v[200:203], v249, s[20:23], s59 offen offset:128 sc1
v_mfma_f32_16x16x32_bf16 v[136:139], a[204:207], v[28:31], -4.0
s_add_u32 m0, s32, 0x0
v_cvt_pk_bf16_f32 v189, v154, v155
v_mov_b32_dpp v211, v215 row_ror:8 row_mask:0xf bank_mask:0x3
v_mfma_f32_16x16x32_bf16 v[136:139], a[200:203], v[24:27], v[136:139]
v_exp_f32 v128, v128
v_mfma_f32_16x16x32_bf16 v[136:139], a[196:199], v[20:23], v[136:139]
v_exp_f32 v129, v129
v_mfma_f32_16x16x32_bf16 v[136:139], a[192:195], v[16:19], v[136:139]
ds_read_b128 v[202:205], v242
v_smfmac_f32_16x16x64_bf16 v[220:223], v[224:227], v[228:235], v248
v_mfma_f32_16x16x32_bf16 a[64:67], a[224:227], v[228:231], a[64:67]
v_exp_f32 v130, v130
v_mfma_f32_16x16x32_bf16 a[64:67], a[228:231], v[184:187], a[64:67]
v_exp_f32_e64 v131, v131
v_mfma_f32_16x16x32_bf16 a[96:99], a[228:231], v[188:191], a[96:99]
v_exp_f32 v132, v132
v_mfma_f32_16x16x32_bf16 a[96:99], a[224:227], v[232:235], a[96:99]
ds_read_b64_tr_b16 a[224:225], v241 offset:17024
ds_read_b64_tr_b16 a[226:227], v241 offset:21152
v_mfma_f32_16x16x32_bf16 a[100:103], a[232:235], v[232:235], a[100:103]
v_cvt_pk_bf16_f32 v168, v128, v129
v_cvt_pk_bf16_f32 v169, v130, v131
v_mfma_f32_16x16x32_bf16 a[100:103], a[236:239], v[188:191], a[100:103]
s_waitcnt lgkmcnt(2)
buffer_load_dwordx4 v243, s[24:27], s39 offen offset:1032 nt lds
v_mfma_f32_16x16x32_bf16 a[68:71], a[236:239], v[184:187], a[68:71]
s_xor_b32 s39, s29, 0x1012000
v_exp_f32 v133, v133
v_mfma_f32_16x16x32_bf16 a[68:71], a[232:235], v[228:231], a[68:71]
s_xor_b32 s38, s29, 0x1016000
ds_read_b64_tr_b16 a[228:229], v241 offset:25280
ds_read_b64_tr_b16 a[230:231], v241 offset:29408
v_mov_b64 v[200:201], v[202:203]
v_mfma_f32_16x16x32_bf16 a[72:75], a[240:243], v[228:231], a[72:75]
v_exp_f32 v134, v134
v_mfma_f32_16x16x32_bf16 a[72:75], a[244:247], v[184:187], a[72:75]
ds_read_b64_tr_b16 a[232:233], v241 offset:17032
ds_read_b64_tr_b16 a[234:235], v241 offset:21160
v_mov_b64 v[206:207], v[204:205]
v_mfma_f32_16x16x32_bf16 a[104:107], a[244:247], v[188:191], a[104:107]
v_exp_f32_e64 v135, v135
v_mfma_f32_16x16x32_bf16 a[104:107], a[240:243], v[232:235], a[104:107]
buffer_store_dwordx4 v[208:211], v249, s[20:23], s59 offen offset:2176 sc1
v_mfma_f32_16x16x32_bf16 a[108:111], a[248:251], v[232:235], a[108:111]
v_exp_f32_e64 v140, v140
v_mfma_f32_16x16x32_bf16 a[108:111], a[252:255], v[188:191], a[108:111]
ds_read_b64_tr_b16 a[236:237], v241 offset:25288
ds_read_b64_tr_b16 a[238:239], v241 offset:29416
v_mfma_f32_16x16x32_bf16 a[76:79], a[252:255], v[184:187], a[76:79]
s_add_u32 m0, s32, 0x2040
v_cvt_pk_bf16_f32 v170, v132, v133
v_cvt_pk_bf16_f32 v171, v134, v135
v_mfma_f32_16x16x32_bf16 a[76:79], a[248:251], v[228:231], a[76:79]
ds_read_b64_tr_b16 a[240:241], v241 offset:17280
ds_read_b64_tr_b16 a[242:243], v241 offset:21408
v_mfma_f32_16x16x32_bf16 v[200:203], v[236:239], v[200:203], 0
ds_read_b64_tr_b16 a[244:245], v241 offset:25536
ds_read_b128 v[210:213], v242 offset:256
v_mfma_f32_16x16x32_bf16 v[204:207], v[236:239], v[204:207], 0
ds_read_b64_tr_b16 a[246:247], v241 offset:29664
ds_read_b64_tr_b16 a[248:249], v241 offset:17288
v_mfma_f32_16x16x32_bf16 v[144:147], a[192:195], v[32:35], -4.0
v_exp_f32 v141, v141
v_mfma_f32_16x16x32_bf16 v[144:147], a[196:199], v[36:39], v[144:147]
v_exp_f32 v142, v142
v_mfma_f32_16x16x32_bf16 v[144:147], a[200:203], v[40:43], v[144:147]
v_cvt_pk_bf16_f32 v174, v140, v141
v_cvt_pk_bf16_f32 v200, v200, v201
v_mfma_f32_16x16x32_bf16 v[144:147], a[204:207], v[44:47], v[144:147]
ds_read_b64_tr_b16 a[250:251], v241 offset:21416
v_cvt_pk_bf16_f32 v201, v202, v203
v_accvgpr_write_b32 a128, v200
v_mfma_f32_16x16x32_bf16 v[148:151], a[220:223], v[44:47], -4.0
v_exp_f32 v143, v143
v_mfma_f32_16x16x32_bf16 v[148:151], a[216:219], v[40:43], v[148:151]
v_exp_f32 v136, v136
v_mfma_f32_16x16x32_bf16 v[148:151], a[212:215], v[36:39], v[148:151]
s_waitcnt lgkmcnt(1)
v_cvt_pk_bf16_f32 v175, v142, v143
v_mov_b64 v[208:209], v[210:211]
v_mfma_f32_16x16x32_bf16 v[148:151], a[208:211], v[32:35], v[148:151]
buffer_load_dwordx4 v243, s[16:19], s39 offen nt lds
v_mfma_f32_16x16x32_bf16 v[156:159], a[208:211], v[48:51], -4.0
v_exp_f32 v137, v137
v_mfma_f32_16x16x32_bf16 v[156:159], a[212:215], v[52:55], v[156:159]
v_exp_f32 v138, v138
v_mfma_f32_16x16x32_bf16 v[156:159], a[216:219], v[56:59], v[156:159]
v_cvt_pk_bf16_f32 v172, v136, v137
v_mov_b64 v[214:215], v[212:213]
v_mfma_f32_16x16x32_bf16 v[156:159], a[220:223], v[60:63], v[156:159]
ds_read_b64_tr_b16 a[252:253], v241 offset:25544
ds_read_b64_tr_b16 a[254:255], v241 offset:29672
v_accvgpr_write_b32 a129, v201
v_mfma_f32_16x16x32_bf16 v[152:155], a[204:207], v[60:63], -4.0
v_exp_f32 v139, v139
v_mfma_f32_16x16x32_bf16 v[152:155], a[200:203], v[56:59], v[152:155]
v_cvt_pk_bf16_f32 v173, v138, v139
v_cvt_pk_bf16_f32 v204, v204, v205
v_mfma_f32_16x16x32_bf16 v[152:155], a[196:199], v[52:55], v[152:155]
v_exp_f32_e64 v144, v144
v_mfma_f32_16x16x32_bf16 v[152:155], a[192:195], v[48:51], v[152:155]
ds_read_b128 a[208:211], v240 offset:20800
ds_read_b128 a[212:215], v240 offset:21056
v_cvt_pk_bf16_f32 v205, v206, v207
v_mfma_f32_16x16x32_bf16 v[208:211], v[236:239], v[208:211], 0
ds_read_b128 a[216:219], v240 offset:21312
v_accvgpr_write_b32 a130, v204
v_accvgpr_write_b32 a131, v205
v_mfma_f32_16x16x32_bf16 v[212:215], v[236:239], v[212:215], 0
ds_read_b128 a[220:223], v240 offset:21568
ds_read_b128 v[202:205], v242 offset:512
v_smfmac_f32_16x16x64_bf16 v[216:219], v[224:227], v[160:167], v248
s_add_u32 m0, s32, 0x2040
ds_read_b128 a[204:207], v240 offset:17408
v_cvt_pk_bf16_f32 v208, v208, v209
v_mfma_f32_16x16x32_bf16 a[16:19], a[224:227], v[176:179], a[16:19]
v_exp_f32_e64 v145, v145
v_mfma_f32_16x16x32_bf16 a[16:19], a[228:231], v[160:163], a[16:19]
buffer_load_dwordx4 v243, s[24:27], s39 offen offset:1032 nt lds
v_mfma_f32_16x16x32_bf16 a[48:51], a[228:231], v[164:167], a[48:51]
v_exp_f32 v146, v146
v_mfma_f32_16x16x32_bf16 a[48:51], a[224:227], v[180:183], a[48:51]
ds_read_b128 a[200:203], v240 offset:17152
v_cvt_pk_bf16_f32 v192, v144, v145
v_cvt_pk_bf16_f32 v209, v210, v211
v_mfma_f32_16x16x32_bf16 a[52:55], a[232:235], v[180:183], a[52:55]
v_exp_f32 v147, v147
v_mfma_f32_16x16x32_bf16 a[52:55], a[236:239], v[164:167], a[52:55]
s_waitcnt lgkmcnt(2)
ds_read_b128 a[196:199], v240 offset:16896
v_mov_b64 v[200:201], v[202:203]
v_mov_b64 v[206:207], v[204:205]
v_mfma_f32_16x16x32_bf16 a[20:23], a[236:239], v[160:163], a[20:23]
v_exp_f32 v148, v148
v_mfma_f32_16x16x32_bf16 a[20:23], a[232:235], v[176:179], a[20:23]
ds_read_b128 a[192:195], v240 offset:16640
v_cvt_pk_bf16_f32 v193, v146, v147
v_accvgpr_write_b32 a132, v208
v_mfma_f32_16x16x32_bf16 a[24:27], a[240:243], v[176:179], a[24:27]
v_exp_f32 v149, v149
v_mfma_f32_16x16x32_bf16 a[24:27], a[244:247], v[160:163], a[24:27]
v_exp_f32 v150, v150
v_accvgpr_write_b32 a133, v209
v_mfma_f32_16x16x32_bf16 a[56:59], a[244:247], v[164:167], a[56:59]
v_cvt_pk_bf16_f32 v194, v148, v149
v_cvt_pk_bf16_f32 v212, v212, v213
v_mfma_f32_16x16x32_bf16 a[56:59], a[240:243], v[180:183], a[56:59]
v_exp_f32 v151, v151
v_cvt_pk_bf16_f32 v213, v214, v215
v_mfma_f32_16x16x32_bf16 a[60:63], a[248:251], v[180:183], a[60:63]
v_exp_f32 v156, v156
v_mfma_f32_16x16x32_bf16 a[60:63], a[252:255], v[164:167], a[60:63]
v_cvt_pk_bf16_f32 v195, v150, v151
v_accvgpr_write_b32 a134, v212
v_accvgpr_write_b32 a135, v213
v_mfma_f32_16x16x32_bf16 a[28:31], a[252:255], v[160:163], a[28:31]
L_pad11:
s_cbranch_vccnz L_main
v_exp_f32 v157, v157
v_mfma_f32_16x16x32_bf16 a[28:31], a[248:251], v[176:179], a[28:31]
ds_read_b128 v[210:213], v242 offset:768
v_mfma_f32_16x16x32_bf16 v[200:203], v[236:239], v[200:203], 0
s_waitcnt vmcnt(16) lgkmcnt(1)
v_exp_f32 v158, v158
v_mfma_f32_16x16x32_bf16 v[204:207], v[236:239], v[204:207], 0
v_exp_f32 v159, v159
v_mfma_f32_16x16x32_bf16 v[128:131], a[192:195], v[0:3], -4.0
v_exp_f32 v152, v152
v_mfma_f32_16x16x32_bf16 v[128:131], a[196:199], v[4:7], v[128:131]
v_cvt_pk_bf16_f32 v198, v156, v157
v_cvt_pk_bf16_f32 v199, v158, v159
v_mfma_f32_16x16x32_bf16 v[128:131], a[200:203], v[8:11], v[128:131]
v_exp_f32 v153, v153
v_mfma_f32_16x16x32_bf16 v[128:131], a[204:207], v[12:15], v[128:131]
v_exp_f32 v154, v154
v_mfma_f32_16x16x32_bf16 v[132:135], a[220:223], v[12:15], -4.0
v_cvt_pk_bf16_f32 v196, v152, v153
v_cvt_pk_bf16_f32 v200, v200, v201
v_mfma_f32_16x16x32_bf16 v[132:135], a[216:219], v[8:11], v[132:135]
v_cvt_pk_bf16_f32 v201, v202, v203
v_accvgpr_write_b32 a136, v200
v_mfma_f32_16x16x32_bf16 v[132:135], a[212:215], v[4:7], v[132:135]
s_waitcnt lgkmcnt(0)
v_exp_f32_e64 v155, v155
v_mfma_f32_16x16x32_bf16 v[132:135], a[208:211], v[0:3], v[132:135]
s_add_u32 m0, s33, 0x0
v_cvt_pk_bf16_f32 v197, v154, v155
v_mov_b64 v[208:209], v[210:211]
v_mov_b64 v[214:215], v[212:213]
v_mfma_f32_16x16x32_bf16 v[140:143], a[208:211], v[16:19], -4.0
v_exp_f32 v128, v128
v_mfma_f32_16x16x32_bf16 v[140:143], a[212:215], v[20:23], v[140:143]
v_accvgpr_write_b32 a137, v201
v_cvt_pk_bf16_f32 v204, v204, v205
v_mfma_f32_16x16x32_bf16 v[140:143], a[216:219], v[24:27], v[140:143]
v_exp_f32 v129, v129
v_mfma_f32_16x16x32_bf16 v[140:143], a[220:223], v[28:31], v[140:143]
buffer_load_dwordx4 v243, s[8:11], s56 offen nt lds
v_mfma_f32_16x16x32_bf16 v[136:139], a[204:207], v[28:31], -4.0
s_add_u32 m0, s31, 0x2080
v_exp_f32_e64 v130, v130
v_mfma_f32_16x16x32_bf16 v[136:139], a[200:203], v[24:27], v[136:139]
v_cvt_pk_bf16_f32 v160, v128, v129
v_cvt_pk_bf16_f32 v205, v206, v207
v_mfma_f32_16x16x32_bf16 v[136:139], a[196:199], v[20:23], v[136:139]
v_exp_f32 v131, v131
v_mfma_f32_16x16x32_bf16 v[136:139], a[192:195], v[16:19], v[136:139]
s_barrier
v_smfmac_f32_16x16x64_bf16 v[220:223], v[224:227], v[184:191], v248
buffer_load_dwordx4 v243, s[12:15], s38 offen nt lds
v_mfma_f32_16x16x32_bf16 v[208:211], v[236:239], v[208:211], 0
v_exp_f32_e64 v132, v132
v_mfma_f32_16x16x32_bf16 v[212:215], v[236:239], v[212:215], 0
v_cvt_pk_bf16_f32 v161, v130, v131
v_accvgpr_write_b32 a138, v204
v_mfma_f32_16x16x32_bf16 a[80:83], a[224:227], v[228:231], a[80:83]
v_exp_f32 v133, v133
v_mfma_f32_16x16x32_bf16 a[80:83], a[228:231], v[184:187], a[80:83]
v_exp_f32 v134, v134
v_mfma_f32_16x16x32_bf16 a[112:115], a[228:231], v[188:191], a[112:115]
v_cvt_pk_bf16_f32 v162, v132, v133
v_accvgpr_write_b32 a139, v205
v_mfma_f32_16x16x32_bf16 a[112:115], a[224:227], v[232:235], a[112:115]
ds_read_b64_tr_b16 a[224:225], v241 offset:33024
ds_read_b64_tr_b16 a[226:227], v241 offset:37152
v_mfma_f32_16x16x32_bf16 a[116:119], a[232:235], v[232:235], a[116:119]
v_exp_f32_e64 v135, v135
v_mfma_f32_16x16x32_bf16 a[116:119], a[236:239], v[188:191], a[116:119]
ds_read_b64_tr_b16 a[228:229], v241 offset:41280
ds_read_b64_tr_b16 a[230:231], v241 offset:45408
v_mfma_f32_16x16x32_bf16 a[84:87], a[236:239], v[184:187], a[84:87]
v_exp_f32_e64 v140, v140
v_mfma_f32_16x16x32_bf16 a[84:87], a[232:235], v[228:231], a[84:87]
ds_read_b64_tr_b16 a[232:233], v241 offset:33032
ds_read_b64_tr_b16 a[234:235], v241 offset:37160
v_mfma_f32_16x16x32_bf16 a[88:91], a[240:243], v[228:231], a[88:91]
s_add_u32 m0, s31, 0x2080
v_cvt_pk_bf16_f32 v163, v134, v135
v_cvt_pk_bf16_f32 v208, v208, v209
v_mfma_f32_16x16x32_bf16 a[88:91], a[244:247], v[184:187], a[88:91]
buffer_load_dwordx4 v243, s[12:15], s38 offen offset:1024 nt lds
v_mfma_f32_16x16x32_bf16 a[120:123], a[244:247], v[188:191], a[120:123]
s_xor_b32 s38, s29, 0x1018000
v_exp_f32_e64 v141, v141
v_mfma_f32_16x16x32_bf16 a[120:123], a[240:243], v[232:235], a[120:123]
s_xor_b32 s39, s29, 0x1014000
ds_read_b64_tr_b16 a[236:237], v241 offset:41288
ds_read_b64_tr_b16 a[238:239], v241 offset:45416
v_mfma_f32_16x16x32_bf16 a[124:127], a[248:251], v[232:235], a[124:127]
v_exp_f32_e64 v142, v142
v_mfma_f32_16x16x32_bf16 a[124:127], a[252:255], v[188:191], a[124:127]
ds_read_b64_tr_b16 a[240:241], v241 offset:33280
ds_read_b64_tr_b16 a[242:243], v241 offset:37408
v_cvt_pk_bf16_f32 v209, v210, v211
v_mfma_f32_16x16x32_bf16 a[92:95], a[252:255], v[184:187], a[92:95]
v_cvt_pk_bf16_f32 v166, v140, v141
v_accvgpr_write_b32 a140, v208
v_mfma_f32_16x16x32_bf16 a[92:95], a[248:251], v[228:231], a[92:95]
ds_read_b64_tr_b16 a[244:245], v241 offset:41536
v_accvgpr_write_b32 a141, v209
v_mfma_f32_16x16x32_bf16 v[144:147], a[192:195], v[32:35], -4.0
v_exp_f32_e64 v143, v143
v_mfma_f32_16x16x32_bf16 v[144:147], a[196:199], v[36:39], v[144:147]
v_exp_f32_e64 v136, v136
v_mfma_f32_16x16x32_bf16 v[144:147], a[200:203], v[40:43], v[144:147]
s_add_u32 m0, s31, 0x4100
v_cvt_pk_bf16_f32 v167, v142, v143
v_cvt_pk_bf16_f32 v212, v212, v213
v_mfma_f32_16x16x32_bf16 v[144:147], a[204:207], v[44:47], v[144:147]
buffer_load_dwordx4 v243, s[12:15], s38 offen nt lds
v_mfma_f32_16x16x32_bf16 v[148:151], a[220:223], v[44:47], -4.0
v_exp_f32 v137, v137
v_mfma_f32_16x16x32_bf16 v[148:151], a[216:219], v[40:43], v[148:151]
v_exp_f32 v138, v138
v_mfma_f32_16x16x32_bf16 v[148:151], a[212:215], v[36:39], v[148:151]
v_cvt_pk_bf16_f32 v164, v136, v137
v_cvt_pk_bf16_f32 v213, v214, v215
v_mfma_f32_16x16x32_bf16 v[148:151], a[208:211], v[32:35], v[148:151]
ds_read_b64_tr_b16 a[246:247], v241 offset:45664
ds_read_b64_tr_b16 a[248:249], v241 offset:33288
v_mfma_f32_16x16x32_bf16 v[156:159], a[208:211], v[48:51], -4.0
v_exp_f32 v139, v139
v_mfma_f32_16x16x32_bf16 v[156:159], a[212:215], v[52:55], v[156:159]
v_cvt_pk_bf16_f32 v165, v138, v139
v_accvgpr_write_b32 a142, v212
v_mfma_f32_16x16x32_bf16 v[156:159], a[216:219], v[56:59], v[156:159]
v_exp_f32 v144, v144
v_mfma_f32_16x16x32_bf16 v[156:159], a[220:223], v[60:63], v[156:159]
ds_read_b64_tr_b16 a[250:251], v241 offset:37416
ds_read_b64_tr_b16 a[252:253], v241 offset:41544
v_mfma_f32_16x16x32_bf16 v[152:155], a[204:207], v[60:63], -4.0
s_add_u32 m0, s31, 0x4100
v_accvgpr_write_b32 a143, v213
v_accvgpr_read_b32 v200, a160
v_mfma_f32_16x16x32_bf16 v[152:155], a[200:203], v[56:59], v[152:155]
v_exp_f32_e64 v145, v145
v_mfma_f32_16x16x32_bf16 v[152:155], a[196:199], v[52:55], v[152:155]
v_exp_f32 v146, v146
v_mfma_f32_16x16x32_bf16 v[152:155], a[192:195], v[48:51], v[152:155]
buffer_load_dwordx4 v243, s[12:15], s38 offen offset:1024 nt lds
v_smfmac_f32_16x16x64_bf16 v[216:219], v[224:227], v[168:175], v248
s_waitcnt lgkmcnt(2)
ds_read_b64_tr_b16 a[254:255], v241 offset:45672
v_accvgpr_read_b32 v201, a161
v_mfma_f32_16x16x32_bf16 a[0:3], a[224:227], v[168:171], a[0:3]
v_cvt_pk_bf16_f32 v176, v144, v145
v_accvgpr_read_b32 v202, a162
v_mfma_f32_16x16x32_bf16 a[0:3], a[228:231], v[160:163], a[0:3]
ds_read_b128 a[208:211], v240 offset:29120
ds_read_b128 a[212:215], v240 offset:29376
v_accvgpr_read_b32 v203, a163
v_mfma_f32_16x16x32_bf16 a[32:35], a[228:231], v[164:167], a[32:35]
v_exp_f32_e64 v147, v147
v_mfma_f32_16x16x32_bf16 a[32:35], a[224:227], v[172:175], a[32:35]
ds_read_b128 a[216:219], v240 offset:29632
ds_read_b128 a[220:223], v240 offset:29888
v_accvgpr_read_b32 v204, a164
v_mfma_f32_16x16x32_bf16 a[36:39], a[232:235], v[172:175], a[36:39]
s_add_u32 m0, s33, 0x0
v_exp_f32 v148, v148
v_mfma_f32_16x16x32_bf16 a[36:39], a[236:239], v[164:167], a[36:39]
ds_read_b128 a[204:207], v240 offset:25728
ds_read_b128 a[200:203], v240 offset:25472
v_accvgpr_read_b32 v205, a165
v_mfma_f32_16x16x32_bf16 a[4:7], a[236:239], v[160:163], a[4:7]
v_cvt_pk_bf16_f32 v177, v146, v147
v_accvgpr_read_b32 v206, a166
v_mfma_f32_16x16x32_bf16 a[4:7], a[232:235], v[168:171], a[4:7]
ds_read_b128 a[196:199], v240 offset:25216
v_accvgpr_read_b32 v207, a167
v_mfma_f32_16x16x32_bf16 a[8:11], a[240:243], v[168:171], a[8:11]
ds_read_b128 a[192:195], v240 offset:24960
v_mfma_f32_16x16x32_bf16 a[8:11], a[244:247], v[160:163], a[8:11]
buffer_load_dwordx4 v243, s[8:11], s56 offen offset:1024 nt lds
v_mfma_f32_16x16x32_bf16 a[40:43], a[244:247], v[164:167], a[40:43]
s_add_u32 m0, s32, 0x4080
v_exp_f32 v149, v149
v_mfma_f32_16x16x32_bf16 a[40:43], a[240:243], v[172:175], a[40:43]
s_waitcnt lgkmcnt(4)
v_exp_f32 v150, v150
v_cvt_pk_bf16_f32 v178, v148, v149
v_exp_f32 v151, v151
v_pk_mul_f32 v[206:207], v[206:207], v[252:253] op_sel:[0,1] op_sel_hi:[1,1]
v_pk_mul_f32 v[204:205], v[204:205], v[252:253] op_sel:[0,1] op_sel_hi:[1,1]
v_pk_mul_f32 v[202:203], v[202:203], v[252:253] op_sel:[0,1] op_sel_hi:[1,1]
v_pk_mul_f32 v[200:201], v[200:201], v[252:253] op_sel:[0,1] op_sel_hi:[1,1]
v_cvt_pk_bf16_f32 v200, v200, v201
v_mfma_f32_16x16x32_bf16 a[44:47], a[248:251], v[172:175], a[44:47]
v_exp_f32 v156, v156
v_mfma_f32_16x16x32_bf16 a[44:47], a[252:255], v[164:167], a[44:47]
v_cvt_pk_bf16_f32 v179, v150, v151
v_cvt_pk_bf16_f32 v201, v202, v203
v_mfma_f32_16x16x32_bf16 a[12:15], a[252:255], v[160:163], a[12:15]
v_exp_f32_e64 v157, v157
v_mfma_f32_16x16x32_bf16 a[12:15], a[248:251], v[168:171], a[12:15]
s_waitcnt lgkmcnt(0)
buffer_load_dwordx4 v243, s[16:19], s39 offen nt lds
v_mfma_f32_16x16x32_bf16 v[128:131], a[192:195], v[0:3], -4.0
v_exp_f32 v158, v158
v_mfma_f32_16x16x32_bf16 v[128:131], a[196:199], v[4:7], v[128:131]
v_cvt_pk_bf16_f32 v182, v156, v157
v_cvt_pk_bf16_f32 v202, v204, v205
v_mfma_f32_16x16x32_bf16 v[128:131], a[200:203], v[8:11], v[128:131]
v_exp_f32 v159, v159
v_mfma_f32_16x16x32_bf16 v[128:131], a[204:207], v[12:15], v[128:131]
v_exp_f32_e64 v152, v152
v_mfma_f32_16x16x32_bf16 v[132:135], a[220:223], v[12:15], -4.0
v_cvt_pk_bf16_f32 v183, v158, v159
v_cvt_pk_bf16_f32 v203, v206, v207
v_mfma_f32_16x16x32_bf16 v[132:135], a[216:219], v[8:11], v[132:135]
v_exp_f32 v153, v153
v_mfma_f32_16x16x32_bf16 v[132:135], a[212:215], v[4:7], v[132:135]
v_exp_f32 v154, v154
v_mfma_f32_16x16x32_bf16 v[132:135], a[208:211], v[0:3], v[132:135]
v_cvt_pk_bf16_f32 v180, v152, v153
v_accvgpr_read_b32 v208, a168
v_mfma_f32_16x16x32_bf16 v[140:143], a[208:211], v[16:19], -4.0
s_add_u32 m0, s32, 0x4080
v_exp_f32 v155, v155
v_mfma_f32_16x16x32_bf16 v[140:143], a[212:215], v[20:23], v[140:143]
v_cvt_pk_bf16_f32 v181, v154, v155
v_accvgpr_read_b32 v209, a169
v_mfma_f32_16x16x32_bf16 v[140:143], a[216:219], v[24:27], v[140:143]
v_exp_f32 v128, v128
v_mfma_f32_16x16x32_bf16 v[140:143], a[220:223], v[28:31], v[140:143]
buffer_load_dwordx4 v243, s[24:27], s39 offen offset:1032 nt lds
v_mfma_f32_16x16x32_bf16 v[136:139], a[204:207], v[28:31], -4.0
s_xor_b32 s39, s29, 0x1016000
v_exp_f32 v129, v129
v_mfma_f32_16x16x32_bf16 v[136:139], a[200:203], v[24:27], v[136:139]
s_xor_b32 s38, s29, 0x101a000
v_exp_f32 v130, v130
v_mfma_f32_16x16x32_bf16 v[136:139], a[196:199], v[20:23], v[136:139]
v_cvt_pk_bf16_f32 v184, v128, v129
v_accvgpr_read_b32 v210, a170
v_mfma_f32_16x16x32_bf16 v[136:139], a[192:195], v[16:19], v[136:139]
v_exp_f32 v131, v131
v_smfmac_f32_16x16x64_bf16 v[220:223], v[224:227], v[192:199], v248
v_accvgpr_read_b32 v211, a171
v_mfma_f32_16x16x32_bf16 a[64:67], a[224:227], v[192:195], a[64:67]
v_exp_f32 v132, v132
v_mfma_f32_16x16x32_bf16 a[64:67], a[228:231], v[176:179], a[64:67]
v_cvt_pk_bf16_f32 v185, v130, v131
v_accvgpr_read_b32 v212, a172
v_accvgpr_read_b32 v213, a173
v_mfma_f32_16x16x32_bf16 a[96:99], a[228:231], v[180:183], a[96:99]
v_exp_f32_e64 v133, v133
v_mfma_f32_16x16x32_bf16 a[96:99], a[224:227], v[196:199], a[96:99]
s_add_u32 m0, s32, 0x60c0
ds_read_b64_tr_b16 a[224:225], v241 offset:33536
ds_read_b64_tr_b16 a[226:227], v241 offset:37664
v_accvgpr_read_b32 v214, a174
v_mfma_f32_16x16x32_bf16 a[100:103], a[232:235], v[196:199], a[100:103]
v_exp_f32_e64 v134, v134
v_mfma_f32_16x16x32_bf16 a[100:103], a[236:239], v[180:183], a[100:103]
buffer_load_dwordx4 v243, s[16:19], s39 offen nt lds
v_mfma_f32_16x16x32_bf16 a[68:71], a[236:239], v[176:179], a[68:71]
v_cvt_pk_bf16_f32 v186, v132, v133
v_accvgpr_read_b32 v215, a175
v_mfma_f32_16x16x32_bf16 a[68:71], a[232:235], v[192:195], a[68:71]
ds_read_b64_tr_b16 a[228:229], v241 offset:41792
v_exp_f32 v135, v135
v_exp_f32 v140, v140
v_pk_mul_f32 v[214:215], v[214:215], v[252:253] op_sel:[0,1] op_sel_hi:[1,1]
v_pk_mul_f32 v[212:213], v[212:213], v[252:253] op_sel:[0,1] op_sel_hi:[1,1]
v_pk_mul_f32 v[210:211], v[210:211], v[252:253] op_sel:[0,1] op_sel_hi:[1,1]
v_pk_mul_f32 v[208:209], v[208:209], v[252:253] op_sel:[0,1] op_sel_hi:[1,1]
v_cvt_pk_bf16_f32 v208, v208, v209
v_mfma_f32_16x16x32_bf16 a[72:75], a[240:243], v[192:195], a[72:75]
v_cvt_pk_bf16_f32 v187, v134, v135
v_cvt_pk_bf16_f32 v209, v210, v211
v_mfma_f32_16x16x32_bf16 a[72:75], a[244:247], v[176:179], a[72:75]
ds_read_b64_tr_b16 a[230:231], v241 offset:45920
ds_read_b64_tr_b16 a[232:233], v241 offset:33544
v_mfma_f32_16x16x32_bf16 a[104:107], a[244:247], v[180:183], a[104:107]
v_exp_f32 v141, v141
v_mfma_f32_16x16x32_bf16 a[104:107], a[240:243], v[196:199], a[104:107]
ds_read_b64_tr_b16 a[234:235], v241 offset:37672
ds_read_b64_tr_b16 a[236:237], v241 offset:41800
v_mfma_f32_16x16x32_bf16 a[108:111], a[248:251], v[196:199], a[108:111]
v_exp_f32 v142, v142
v_mfma_f32_16x16x32_bf16 a[108:111], a[252:255], v[180:183], a[108:111]
ds_read_b64_tr_b16 a[238:239], v241 offset:45928
ds_read_b64_tr_b16 a[240:241], v241 offset:33792
v_mfma_f32_16x16x32_bf16 a[76:79], a[252:255], v[176:179], a[76:79]
s_add_u32 m0, s32, 0x60c0
v_cvt_pk_bf16_f32 v190, v140, v141
v_cvt_pk_bf16_f32 v210, v212, v213
v_mfma_f32_16x16x32_bf16 a[76:79], a[248:251], v[192:195], a[76:79]
buffer_load_dwordx4 v243, s[24:27], s39 offen offset:1032 nt lds
v_mfma_f32_16x16x32_bf16 v[144:147], a[192:195], v[32:35], -4.0
v_exp_f32_e64 v143, v143
v_mfma_f32_16x16x32_bf16 v[144:147], a[196:199], v[36:39], v[144:147]
v_exp_f32 v136, v136
v_mfma_f32_16x16x32_bf16 v[144:147], a[200:203], v[40:43], v[144:147]
v_cvt_pk_bf16_f32 v191, v142, v143
v_cvt_pk_bf16_f32 v211, v214, v215
v_mfma_f32_16x16x32_bf16 v[144:147], a[204:207], v[44:47], v[144:147]
s_add_u32 m0, s33, 0x20
ds_read_b64_tr_b16 a[242:243], v241 offset:37920
ds_read_b64_tr_b16 a[244:245], v241 offset:42048
v_mfma_f32_16x16x32_bf16 v[148:151], a[220:223], v[44:47], -4.0
v_exp_f32 v137, v137
v_mfma_f32_16x16x32_bf16 v[148:151], a[216:219], v[40:43], v[148:151]
v_exp_f32 v138, v138
v_mfma_f32_16x16x32_bf16 v[148:151], a[212:215], v[36:39], v[148:151]
v_cvt_pk_bf16_f32 v188, v136, v137
v_mov_b64_e64 v[212:213], v[200:201]
v_mfma_f32_16x16x32_bf16 v[148:151], a[208:211], v[32:35], v[148:151]
buffer_load_dwordx4 v243, s[8:11], s56 offen offset:2048 nt lds
v_mfma_f32_16x16x32_bf16 v[156:159], a[208:211], v[48:51], -4.0
v_exp_f32_e64 v139, v139
v_mfma_f32_16x16x32_bf16 v[156:159], a[212:215], v[52:55], v[156:159]
v_cvt_pk_bf16_f32 v189, v138, v139
v_mov_b64_e64 v[214:215], v[202:203]
v_mfma_f32_16x16x32_bf16 v[156:159], a[216:219], v[56:59], v[156:159]
v_exp_f32_e64 v144, v144
v_mfma_f32_16x16x32_bf16 v[156:159], a[220:223], v[60:63], v[156:159]
ds_read_b64_tr_b16 a[246:247], v241 offset:46176
ds_read_b64_tr_b16 a[248:249], v241 offset:33800
v_mfma_f32_16x16x32_bf16 v[152:155], a[204:207], v[60:63], -4.0
v_exp_f32_e64 v145, v145
v_mfma_f32_16x16x32_bf16 v[152:155], a[200:203], v[56:59], v[152:155]
v_mov_b32_dpp v200, v208 row_ror:8 row_mask:0xf bank_mask:0xc
v_mov_b32_dpp v201, v209 row_ror:8 row_mask:0xf bank_mask:0xc
v_mfma_f32_16x16x32_bf16 v[152:155], a[196:199], v[52:55], v[152:155]
v_exp_f32 v146, v146
v_mfma_f32_16x16x32_bf16 v[152:155], a[192:195], v[48:51], v[152:155]
ds_read_b64_tr_b16 a[250:251], v241 offset:37928
ds_read_b64_tr_b16 a[252:253], v241 offset:42056
v_mov_b32_dpp v202, v210 row_ror:8 row_mask:0xf bank_mask:0xc
v_smfmac_f32_16x16x64_bf16 v[216:219], v[224:227], v[160:167], v248
s_waitcnt lgkmcnt(4)
ds_read_b64_tr_b16 a[254:255], v241 offset:46184
v_mfma_f32_16x16x32_bf16 a[16:19], a[224:227], v[168:171], a[16:19]
v_cvt_pk_bf16_f32 v228, v144, v145
v_mov_b32_dpp v203, v211 row_ror:8 row_mask:0xf bank_mask:0xc
v_mfma_f32_16x16x32_bf16 a[16:19], a[228:231], v[160:163], a[16:19]
ds_read_b128 a[208:211], v240 offset:37440
ds_read_b128 a[212:215], v240 offset:37696
v_mov_b32_dpp v208, v212 row_ror:8 row_mask:0xf bank_mask:0x3
v_mfma_f32_16x16x32_bf16 a[48:51], a[228:231], v[164:167], a[48:51]
v_exp_f32_e64 v147, v147
v_mfma_f32_16x16x32_bf16 a[48:51], a[224:227], v[172:175], a[48:51]
ds_read_b128 a[216:219], v240 offset:37952
ds_read_b128 a[220:223], v240 offset:38208
v_mov_b32_dpp v209, v213 row_ror:8 row_mask:0xf bank_mask:0x3
v_mfma_f32_16x16x32_bf16 a[52:55], a[232:235], v[172:175], a[52:55]
v_exp_f32_e64 v148, v148
v_mfma_f32_16x16x32_bf16 a[52:55], a[236:239], v[164:167], a[52:55]
ds_read_b128 a[204:207], v240 offset:34048
ds_read_b128 a[200:203], v240 offset:33792
v_mov_b32_dpp v210, v214 row_ror:8 row_mask:0xf bank_mask:0x3
v_mfma_f32_16x16x32_bf16 a[20:23], a[236:239], v[160:163], a[20:23]
v_cvt_pk_bf16_f32 v229, v146, v147
v_mov_b32_dpp v211, v215 row_ror:8 row_mask:0xf bank_mask:0x3
v_mfma_f32_16x16x32_bf16 a[20:23], a[232:235], v[168:171], a[20:23]
ds_read_b128 a[196:199], v240 offset:33536
ds_read_b128 a[192:195], v240 offset:33280
v_mfma_f32_16x16x32_bf16 a[24:27], a[240:243], v[168:171], a[24:27]
s_waitcnt lgkmcnt(6)
v_exp_f32 v149, v149
v_mfma_f32_16x16x32_bf16 a[24:27], a[244:247], v[160:163], a[24:27]
buffer_store_dwordx4 v[200:203], v249, s[20:23], s35 offen sc1
v_mfma_f32_16x16x32_bf16 a[56:59], a[244:247], v[164:167], a[56:59]
v_exp_f32_e64 v150, v150
v_mfma_f32_16x16x32_bf16 a[56:59], a[240:243], v[172:175], a[56:59]
v_cvt_pk_bf16_f32 v230, v148, v149
v_accvgpr_read_b32 v200, a176
v_accvgpr_read_b32 v201, a177
v_mfma_f32_16x16x32_bf16 a[60:63], a[248:251], v[172:175], a[60:63]
v_exp_f32 v151, v151
v_mfma_f32_16x16x32_bf16 a[60:63], a[252:255], v[164:167], a[60:63]
v_exp_f32 v156, v156
v_accvgpr_read_b32 v202, a178
v_mfma_f32_16x16x32_bf16 a[28:31], a[252:255], v[160:163], a[28:31]
v_cvt_pk_bf16_f32 v231, v150, v151
v_accvgpr_read_b32 v203, a179
v_mfma_f32_16x16x32_bf16 a[28:31], a[248:251], v[168:171], a[28:31]
s_waitcnt lgkmcnt(0)
v_exp_f32 v157, v157
v_accvgpr_read_b32 v204, a180
v_mfma_f32_16x16x32_bf16 v[128:131], a[192:195], v[0:3], -4.0
v_exp_f32_e64 v158, v158
v_mfma_f32_16x16x32_bf16 v[128:131], a[196:199], v[4:7], v[128:131]
v_cvt_pk_bf16_f32 v234, v156, v157
v_accvgpr_read_b32 v205, a181
v_mfma_f32_16x16x32_bf16 v[128:131], a[200:203], v[8:11], v[128:131]
v_exp_f32 v159, v159
v_mfma_f32_16x16x32_bf16 v[128:131], a[204:207], v[12:15], v[128:131]
buffer_store_dwordx4 v[208:211], v249, s[20:23], s35 offen offset:2048 sc1
v_mfma_f32_16x16x32_bf16 v[132:135], a[220:223], v[12:15], -4.0
v_exp_f32 v152, v152
v_mfma_f32_16x16x32_bf16 v[132:135], a[216:219], v[8:11], v[132:135]
v_cvt_pk_bf16_f32 v235, v158, v159
v_accvgpr_read_b32 v206, a182
v_mfma_f32_16x16x32_bf16 v[132:135], a[212:215], v[4:7], v[132:135]
v_exp_f32 v153, v153
v_mfma_f32_16x16x32_bf16 v[132:135], a[208:211], v[0:3], v[132:135]
v_accvgpr_read_b32 v207, a183
v_exp_f32 v154, v154
v_mfma_f32_16x16x32_bf16 v[140:143], a[208:211], v[16:19], -4.0
v_exp_f32_e64 v155, v155
v_mfma_f32_16x16x32_bf16 v[140:143], a[212:215], v[20:23], v[140:143]
v_cvt_pk_bf16_f32 v232, v152, v153
v_cvt_pk_bf16_f32 v233, v154, v155
v_mfma_f32_16x16x32_bf16 v[140:143], a[216:219], v[24:27], v[140:143]
v_exp_f32 v128, v128
v_mfma_f32_16x16x32_bf16 v[140:143], a[220:223], v[28:31], v[140:143]
s_add_u32 m0, s31, 0x6180
v_exp_f32 v129, v129
v_exp_f32_e64 v130, v130
v_cvt_pk_bf16_f32 v160, v128, v129
v_pk_mul_f32 v[206:207], v[206:207], v[252:253] op_sel:[0,1] op_sel_hi:[1,1]
v_pk_mul_f32 v[204:205], v[204:205], v[252:253] op_sel:[0,1] op_sel_hi:[1,1]
v_pk_mul_f32 v[202:203], v[202:203], v[252:253] op_sel:[0,1] op_sel_hi:[1,1]
v_pk_mul_f32 v[200:201], v[200:201], v[252:253] op_sel:[0,1] op_sel_hi:[1,1]
v_cvt_pk_bf16_f32 v200, v200, v201
v_mfma_f32_16x16x32_bf16 v[136:139], a[204:207], v[28:31], -4.0
v_cvt_pk_bf16_f32 v201, v202, v203
v_cvt_pk_bf16_f32 v202, v204, v205
v_mfma_f32_16x16x32_bf16 v[136:139], a[200:203], v[24:27], v[136:139]
v_exp_f32 v131, v131
v_mfma_f32_16x16x32_bf16 v[136:139], a[196:199], v[20:23], v[136:139]
s_waitcnt vmcnt(21)
v_exp_f32 v132, v132
v_mfma_f32_16x16x32_bf16 v[136:139], a[192:195], v[16:19], v[136:139]
s_barrier
v_smfmac_f32_16x16x64_bf16 v[220:223], v[224:227], v[176:183], v248
buffer_load_dwordx4 v243, s[12:15], s38 offen nt lds
v_mfma_f32_16x16x32_bf16 a[80:83], a[224:227], v[192:195], a[80:83]
s_add_u32 m0, s33, 0x20
v_cvt_pk_bf16_f32 v161, v130, v131
v_cvt_pk_bf16_f32 v203, v206, v207
v_mfma_f32_16x16x32_bf16 a[80:83], a[228:231], v[176:179], a[80:83]
v_exp_f32 v133, v133
v_mfma_f32_16x16x32_bf16 a[112:115], a[228:231], v[180:183], a[112:115]
v_exp_f32_e64 v134, v134
v_mfma_f32_16x16x32_bf16 a[112:115], a[224:227], v[196:199], a[112:115]
ds_read_b64_tr_b16 a[224:225], v241 offset:49536
ds_read_b64_tr_b16 a[226:227], v241 offset:53664
v_mfma_f32_16x16x32_bf16 a[116:119], a[232:235], v[196:199], a[116:119]
v_cvt_pk_bf16_f32 v162, v132, v133
v_accvgpr_read_b32 v208, a184
v_mfma_f32_16x16x32_bf16 a[116:119], a[236:239], v[180:183], a[116:119]
buffer_load_dwordx4 v243, s[8:11], s56 offen offset:3072 nt lds
v_mfma_f32_16x16x32_bf16 a[84:87], a[236:239], v[176:179], a[84:87]
s_xor_b32 s56, s28, 0x3003000
v_exp_f32 v135, v135
v_mfma_f32_16x16x32_bf16 a[84:87], a[232:235], v[192:195], a[84:87]
ds_read_b64_tr_b16 a[228:229], v241 offset:57792
ds_read_b64_tr_b16 a[230:231], v241 offset:61920
v_accvgpr_read_b32 v209, a185
v_mfma_f32_16x16x32_bf16 a[88:91], a[240:243], v[192:195], a[88:91]
s_add_u32 m0, s31, 0x6180
v_exp_f32 v140, v140
v_mfma_f32_16x16x32_bf16 a[88:91], a[244:247], v[176:179], a[88:91]
ds_read_b64_tr_b16 a[232:233], v241 offset:49544
ds_read_b64_tr_b16 a[234:235], v241 offset:53672
v_accvgpr_read_b32 v210, a186
v_mfma_f32_16x16x32_bf16 a[120:123], a[244:247], v[180:183], a[120:123]
v_cvt_pk_bf16_f32 v163, v134, v135
v_accvgpr_read_b32 v211, a187
v_mfma_f32_16x16x32_bf16 a[120:123], a[240:243], v[196:199], a[120:123]
buffer_load_dwordx4 v243, s[12:15], s38 offen offset:1024 nt lds
v_mfma_f32_16x16x32_bf16 a[124:127], a[248:251], v[196:199], a[124:127]
s_xor_b32 s38, s29, 0x101c000
v_exp_f32_e64 v141, v141
v_mfma_f32_16x16x32_bf16 a[124:127], a[252:255], v[180:183], a[124:127]
s_xor_b32 s39, s29, 0x1018000
ds_read_b64_tr_b16 a[236:237], v241 offset:57800
ds_read_b64_tr_b16 a[238:239], v241 offset:61928
v_accvgpr_read_b32 v212, a188
v_mfma_f32_16x16x32_bf16 a[92:95], a[252:255], v[176:179], a[92:95]
v_exp_f32_e64 v142, v142
v_mfma_f32_16x16x32_bf16 a[92:95], a[248:251], v[192:195], a[92:95]
ds_read_b64_tr_b16 a[240:241], v241 offset:49792
ds_read_b64_tr_b16 a[242:243], v241 offset:53920
v_accvgpr_read_b32 v213, a189
v_mfma_f32_16x16x32_bf16 v[144:147], a[192:195], v[32:35], -4.0
v_cvt_pk_bf16_f32 v166, v140, v141
v_accvgpr_read_b32 v214, a190
v_mfma_f32_16x16x32_bf16 v[144:147], a[196:199], v[36:39], v[144:147]
v_exp_f32 v143, v143
v_mfma_f32_16x16x32_bf16 v[144:147], a[200:203], v[40:43], v[144:147]
v_exp_f32 v136, v136
v_mfma_f32_16x16x32_bf16 v[144:147], a[204:207], v[44:47], v[144:147]
ds_read_b64_tr_b16 a[244:245], v241 offset:58048
ds_read_b64_tr_b16 a[246:247], v241 offset:62176
v_accvgpr_read_b32 v215, a191
v_mfma_f32_16x16x32_bf16 v[148:151], a[220:223], v[44:47], -4.0
s_add_u32 m0, s31, 0x8200
v_exp_f32 v137, v137
v_mfma_f32_16x16x32_bf16 v[148:151], a[216:219], v[40:43], v[148:151]
v_exp_f32 v138, v138
v_mfma_f32_16x16x32_bf16 v[148:151], a[212:215], v[36:39], v[148:151]
v_cvt_pk_bf16_f32 v167, v142, v143
v_cvt_pk_bf16_f32 v164, v136, v137
v_mfma_f32_16x16x32_bf16 v[148:151], a[208:211], v[32:35], v[148:151]
buffer_load_dwordx4 v243, s[12:15], s38 offen nt lds
v_mfma_f32_16x16x32_bf16 v[156:159], a[208:211], v[48:51], -4.0
v_exp_f32 v139, v139
v_mfma_f32_16x16x32_bf16 v[156:159], a[212:215], v[52:55], v[156:159]
v_exp_f32 v144, v144
v_mfma_f32_16x16x32_bf16 v[156:159], a[216:219], v[56:59], v[156:159]
v_exp_f32_e64 v145, v145
v_mfma_f32_16x16x32_bf16 v[156:159], a[220:223], v[60:63], v[156:159]
ds_read_b64_tr_b16 a[248:249], v241 offset:49800
v_cvt_pk_bf16_f32 v165, v138, v139
v_exp_f32_e64 v146, v146
v_cvt_pk_bf16_f32 v168, v144, v145
v_pk_mul_f32 v[214:215], v[214:215], v[252:253] op_sel:[0,1] op_sel_hi:[1,1]
v_pk_mul_f32 v[212:213], v[212:213], v[252:253] op_sel:[0,1] op_sel_hi:[1,1]
v_pk_mul_f32 v[210:211], v[210:211], v[252:253] op_sel:[0,1] op_sel_hi:[1,1]
v_pk_mul_f32 v[208:209], v[208:209], v[252:253] op_sel:[0,1] op_sel_hi:[1,1]
v_cvt_pk_bf16_f32 v208, v208, v209
v_mfma_f32_16x16x32_bf16 v[152:155], a[204:207], v[60:63], -4.0
v_cvt_pk_bf16_f32 v209, v210, v211
v_cvt_pk_bf16_f32 v210, v212, v213
v_mfma_f32_16x16x32_bf16 v[152:155], a[200:203], v[56:59], v[152:155]
v_exp_f32 v147, v147
v_mfma_f32_16x16x32_bf16 v[152:155], a[196:199], v[52:55], v[152:155]
v_exp_f32 v148, v148
v_mfma_f32_16x16x32_bf16 v[152:155], a[192:195], v[48:51], v[152:155]
ds_read_b64_tr_b16 a[250:251], v241 offset:53928
ds_read_b64_tr_b16 a[252:253], v241 offset:58056
v_smfmac_f32_16x16x64_bf16 v[216:219], v[224:227], v[184:191], v248
s_waitcnt lgkmcnt(3)
ds_read_b64_tr_b16 a[254:255], v241 offset:62184
v_mfma_f32_16x16x32_bf16 a[0:3], a[224:227], v[184:187], a[0:3]
s_add_u32 m0, s31, 0x8200
v_cvt_pk_bf16_f32 v169, v146, v147
v_cvt_pk_bf16_f32 v211, v214, v215
v_mfma_f32_16x16x32_bf16 a[0:3], a[228:231], v[160:163], a[0:3]
ds_read_b128 a[208:211], v240 offset:45760
ds_read_b128 a[212:215], v240 offset:46016
v_mfma_f32_16x16x32_bf16 a[32:35], a[228:231], v[164:167], a[32:35]
v_exp_f32 v149, v149
v_mfma_f32_16x16x32_bf16 a[32:35], a[224:227], v[188:191], a[32:35]
ds_read_b128 a[216:219], v240 offset:46272
ds_read_b128 a[220:223], v240 offset:46528
v_mov_b64_e64 v[212:213], v[200:201]
v_mfma_f32_16x16x32_bf16 a[36:39], a[232:235], v[188:191], a[36:39]
v_mov_b64 v[214:215], v[202:203]
v_mov_b32_dpp v200, v208 row_ror:8 row_mask:0xf bank_mask:0xc
v_mfma_f32_16x16x32_bf16 a[36:39], a[236:239], v[164:167], a[36:39]
ds_read_b128 a[204:207], v240 offset:42368
ds_read_b128 a[200:203], v240 offset:42112
v_mfma_f32_16x16x32_bf16 a[4:7], a[236:239], v[160:163], a[4:7]
v_exp_f32 v150, v150
v_mfma_f32_16x16x32_bf16 a[4:7], a[232:235], v[184:187], a[4:7]
L_pad12:
s_cbranch_vccnz L_pad16
ds_read_b128 a[196:199], v240 offset:41856
v_cvt_pk_bf16_f32 v170, v148, v149
v_mov_b32_dpp v201, v209 row_ror:8 row_mask:0xf bank_mask:0xc
v_mfma_f32_16x16x32_bf16 a[8:11], a[240:243], v[184:187], a[8:11]
ds_read_b128 a[192:195], v240 offset:41600
v_mov_b32_dpp v202, v210 row_ror:8 row_mask:0xf bank_mask:0xc
v_mfma_f32_16x16x32_bf16 a[8:11], a[244:247], v[160:163], a[8:11]
buffer_load_dwordx4 v243, s[12:15], s38 offen offset:1024 nt lds
v_mfma_f32_16x16x32_bf16 a[40:43], a[244:247], v[164:167], a[40:43]
v_exp_f32 v151, v151
v_mfma_f32_16x16x32_bf16 a[40:43], a[240:243], v[188:191], a[40:43]
s_waitcnt lgkmcnt(4)
v_mov_b32_dpp v203, v211 row_ror:8 row_mask:0xf bank_mask:0xc
v_mov_b32_dpp v208, v212 row_ror:8 row_mask:0xf bank_mask:0x3
v_mfma_f32_16x16x32_bf16 a[44:47], a[248:251], v[188:191], a[44:47]
v_exp_f32 v156, v156
v_mfma_f32_16x16x32_bf16 a[44:47], a[252:255], v[164:167], a[44:47]
v_cvt_pk_bf16_f32 v171, v150, v151
v_mov_b32_dpp v209, v213 row_ror:8 row_mask:0xf bank_mask:0x3
v_mov_b32_dpp v210, v214 row_ror:8 row_mask:0xf bank_mask:0x3
v_mfma_f32_16x16x32_bf16 a[12:15], a[252:255], v[160:163], a[12:15]
v_exp_f32 v157, v157
v_mfma_f32_16x16x32_bf16 a[12:15], a[248:251], v[184:187], a[12:15]
s_waitcnt lgkmcnt(0)
buffer_store_dwordx4 v[200:203], v249, s[20:23], s35 offen offset:128 sc1
v_mfma_f32_16x16x32_bf16 v[128:131], a[192:195], v[0:3], -4.0
v_exp_f32 v158, v158
v_mfma_f32_16x16x32_bf16 v[128:131], a[196:199], v[4:7], v[128:131]
v_cvt_pk_bf16_f32 v174, v156, v157
v_mov_b32_dpp v211, v215 row_ror:8 row_mask:0xf bank_mask:0x3
v_mfma_f32_16x16x32_bf16 v[128:131], a[200:203], v[8:11], v[128:131]
s_add_u32 m0, s32, 0x8100
v_exp_f32 v159, v159
v_mfma_f32_16x16x32_bf16 v[128:131], a[204:207], v[12:15], v[128:131]
ds_read_b128 v[202:205], v242 offset:4160
v_mfma_f32_16x16x32_bf16 v[132:135], a[220:223], v[12:15], -4.0
v_exp_f32 v152, v152
v_mfma_f32_16x16x32_bf16 v[132:135], a[216:219], v[8:11], v[132:135]
v_exp_f32 v153, v153
v_mfma_f32_16x16x32_bf16 v[132:135], a[212:215], v[4:7], v[132:135]
v_exp_f32_e64 v154, v154
v_mfma_f32_16x16x32_bf16 v[132:135], a[208:211], v[0:3], v[132:135]
v_cvt_pk_bf16_f32 v175, v158, v159
v_cvt_pk_bf16_f32 v172, v152, v153
v_mfma_f32_16x16x32_bf16 v[140:143], a[208:211], v[16:19], -4.0
v_exp_f32 v155, v155
v_mfma_f32_16x16x32_bf16 v[140:143], a[212:215], v[20:23], v[140:143]
v_exp_f32 v128, v128
v_mfma_f32_16x16x32_bf16 v[140:143], a[216:219], v[24:27], v[140:143]
s_waitcnt lgkmcnt(0)
v_cvt_pk_bf16_f32 v173, v154, v155
v_mov_b64 v[200:201], v[202:203]
v_mfma_f32_16x16x32_bf16 v[140:143], a[220:223], v[28:31], v[140:143]
buffer_load_dwordx4 v243, s[16:19], s39 offen nt lds
v_mfma_f32_16x16x32_bf16 v[136:139], a[204:207], v[28:31], -4.0
v_exp_f32 v129, v129
v_mfma_f32_16x16x32_bf16 v[136:139], a[200:203], v[24:27], v[136:139]
v_exp_f32 v130, v130
v_mfma_f32_16x16x32_bf16 v[136:139], a[196:199], v[20:23], v[136:139]
v_cvt_pk_bf16_f32 v176, v128, v129
v_mov_b64 v[206:207], v[204:205]
v_mfma_f32_16x16x32_bf16 v[136:139], a[192:195], v[16:19], v[136:139]
v_exp_f32 v131, v131
v_mfma_f32_16x16x32_bf16 v[200:203], v[236:239], v[200:203], 0
v_exp_f32 v132, v132
v_mfma_f32_16x16x32_bf16 v[204:207], v[236:239], v[204:207], 0
v_exp_f32 v133, v133
v_smfmac_f32_16x16x64_bf16 v[220:223], v[224:227], v[228:235], v248
buffer_store_dwordx4 v[208:211], v249, s[20:23], s35 offen offset:2176 sc1
v_mfma_f32_16x16x32_bf16 a[64:67], a[224:227], v[228:231], a[64:67]
s_xor_b32 s57, s28, 0x1000000
v_exp_f32_e64 v134, v134
v_mfma_f32_16x16x32_bf16 a[64:67], a[228:231], v[168:171], a[64:67]
s_xor_b32 s58, s28, 0x1001000
ds_read_b128 v[210:213], v242 offset:4416
v_cvt_pk_bf16_f32 v177, v130, v131
v_cvt_pk_bf16_f32 v200, v200, v201
v_mfma_f32_16x16x32_bf16 a[96:99], a[228:231], v[172:175], a[96:99]
v_cvt_pk_bf16_f32 v178, v132, v133
v_cvt_pk_bf16_f32 v201, v202, v203
v_mfma_f32_16x16x32_bf16 a[96:99], a[224:227], v[232:235], a[96:99]
s_add_u32 m0, s32, 0x8100
ds_read_b64_tr_b16 a[224:225], v241 offset:50048
ds_read_b64_tr_b16 a[226:227], v241 offset:54176
v_accvgpr_write_b32 a144, v200
v_mfma_f32_16x16x32_bf16 a[100:103], a[232:235], v[232:235], a[100:103]
v_accvgpr_write_b32 a145, v201
v_cvt_pk_bf16_f32 v204, v204, v205
v_mfma_f32_16x16x32_bf16 a[100:103], a[236:239], v[172:175], a[100:103]
ds_read_b64_tr_b16 a[228:229], v241 offset:58304
ds_read_b64_tr_b16 a[230:231], v241 offset:62432
v_cvt_pk_bf16_f32 v205, v206, v207
v_mfma_f32_16x16x32_bf16 a[68:71], a[236:239], v[168:171], a[68:71]
v_exp_f32_e64 v135, v135
v_mfma_f32_16x16x32_bf16 a[68:71], a[232:235], v[228:231], a[68:71]
ds_read_b64_tr_b16 a[232:233], v241 offset:50056
ds_read_b64_tr_b16 a[234:235], v241 offset:54184
v_accvgpr_write_b32 a146, v204
v_mfma_f32_16x16x32_bf16 a[72:75], a[240:243], v[228:231], a[72:75]
s_waitcnt lgkmcnt(6)
v_exp_f32 v140, v140
v_mfma_f32_16x16x32_bf16 a[72:75], a[244:247], v[168:171], a[72:75]
buffer_load_dwordx4 v243, s[24:27], s39 offen offset:1032 nt lds
v_mfma_f32_16x16x32_bf16 a[104:107], a[244:247], v[172:175], a[104:107]
s_xor_b32 s39, s29, 0x101a000
v_cvt_pk_bf16_f32 v179, v134, v135
v_mov_b64 v[208:209], v[210:211]
v_mfma_f32_16x16x32_bf16 a[104:107], a[240:243], v[232:235], a[104:107]
s_xor_b32 s38, s29, 0x101e000
ds_read_b64_tr_b16 a[236:237], v241 offset:58312
ds_read_b64_tr_b16 a[238:239], v241 offset:62440
v_mov_b64 v[214:215], v[212:213]
v_mfma_f32_16x16x32_bf16 a[108:111], a[248:251], v[232:235], a[108:111]
v_exp_f32_e64 v141, v141
v_mfma_f32_16x16x32_bf16 a[108:111], a[252:255], v[172:175], a[108:111]
ds_read_b64_tr_b16 a[240:241], v241 offset:50304
ds_read_b64_tr_b16 a[242:243], v241 offset:54432
v_accvgpr_write_b32 a147, v205
v_mfma_f32_16x16x32_bf16 a[76:79], a[252:255], v[168:171], a[76:79]
v_exp_f32_e64 v142, v142
v_mfma_f32_16x16x32_bf16 a[76:79], a[248:251], v[228:231], a[76:79]
ds_read_b64_tr_b16 a[244:245], v241 offset:58560
ds_read_b128 v[202:205], v242 offset:4672
v_mfma_f32_16x16x32_bf16 v[208:211], v[236:239], v[208:211], 0
ds_read_b64_tr_b16 a[246:247], v241 offset:62688
v_cvt_pk_bf16_f32 v182, v140, v141
v_mfma_f32_16x16x32_bf16 v[212:215], v[236:239], v[212:215], 0
ds_read_b64_tr_b16 a[248:249], v241 offset:50312
ds_read_b64_tr_b16 a[250:251], v241 offset:54440
v_mfma_f32_16x16x32_bf16 v[144:147], a[192:195], v[32:35], -4.0
v_exp_f32_e64 v143, v143
v_mfma_f32_16x16x32_bf16 v[144:147], a[196:199], v[36:39], v[144:147]
v_exp_f32_e64 v136, v136
v_mfma_f32_16x16x32_bf16 v[144:147], a[200:203], v[40:43], v[144:147]
s_add_u32 m0, s32, 0xa140
v_cvt_pk_bf16_f32 v183, v142, v143
v_cvt_pk_bf16_f32 v208, v208, v209
v_mfma_f32_16x16x32_bf16 v[144:147], a[204:207], v[44:47], v[144:147]
buffer_load_dwordx4 v243, s[16:19], s39 offen nt lds
v_mfma_f32_16x16x32_bf16 v[148:151], a[220:223], v[44:47], -4.0
v_exp_f32 v137, v137
v_mfma_f32_16x16x32_bf16 v[148:151], a[216:219], v[40:43], v[148:151]
v_exp_f32 v138, v138
v_mfma_f32_16x16x32_bf16 v[148:151], a[212:215], v[36:39], v[148:151]
s_waitcnt lgkmcnt(0)
v_cvt_pk_bf16_f32 v180, v136, v137
v_mov_b64 v[200:201], v[202:203]
v_mfma_f32_16x16x32_bf16 v[148:151], a[208:211], v[32:35], v[148:151]
ds_read_b64_tr_b16 a[252:253], v241 offset:58568
v_mov_b64 v[206:207], v[204:205]
v_cvt_pk_bf16_f32 v209, v210, v211
v_mfma_f32_16x16x32_bf16 v[156:159], a[208:211], v[48:51], -4.0
v_exp_f32 v139, v139
v_mfma_f32_16x16x32_bf16 v[156:159], a[212:215], v[52:55], v[156:159]
v_cvt_pk_bf16_f32 v181, v138, v139
v_accvgpr_write_b32 a148, v208
v_mfma_f32_16x16x32_bf16 v[156:159], a[216:219], v[56:59], v[156:159]
v_accvgpr_write_b32 a149, v209
v_cvt_pk_bf16_f32 v212, v212, v213
v_mfma_f32_16x16x32_bf16 v[156:159], a[220:223], v[60:63], v[156:159]
ds_read_b64_tr_b16 a[254:255], v241 offset:62696
ds_read_b128 a[208:211], v240 offset:54080
v_mfma_f32_16x16x32_bf16 v[152:155], a[204:207], v[60:63], -4.0
s_add_u32 m0, s32, 0xa140
v_exp_f32_e64 v144, v144
v_mfma_f32_16x16x32_bf16 v[152:155], a[200:203], v[56:59], v[152:155]
v_cvt_pk_bf16_f32 v213, v214, v215
v_accvgpr_write_b32 a150, v212
v_mfma_f32_16x16x32_bf16 v[152:155], a[196:199], v[52:55], v[152:155]
v_exp_f32_e64 v145, v145
v_mfma_f32_16x16x32_bf16 v[152:155], a[192:195], v[48:51], v[152:155]
buffer_load_dwordx4 v243, s[24:27], s39 offen offset:1032 nt lds
v_mfma_f32_16x16x32_bf16 v[200:203], v[236:239], v[200:203], 0
ds_read_b128 a[212:215], v240 offset:54336
ds_read_b128 a[216:219], v240 offset:54592
v_accvgpr_write_b32 a151, v213
v_mfma_f32_16x16x32_bf16 v[204:207], v[236:239], v[204:207], 0
ds_read_b128 a[220:223], v240 offset:54848
ds_read_b128 v[210:213], v242 offset:4928
v_smfmac_f32_16x16x64_bf16 v[216:219], v[224:227], v[160:167], v248
ds_read_b128 a[204:207], v240 offset:50688
v_mfma_f32_16x16x32_bf16 a[16:19], a[224:227], v[184:187], a[16:19]
v_exp_f32 v146, v146
v_mfma_f32_16x16x32_bf16 a[16:19], a[228:231], v[160:163], a[16:19]
ds_read_b128 a[200:203], v240 offset:50432
v_cvt_pk_bf16_f32 v192, v144, v145
v_mfma_f32_16x16x32_bf16 a[48:51], a[228:231], v[164:167], a[48:51]
v_exp_f32 v147, v147
v_mfma_f32_16x16x32_bf16 a[48:51], a[224:227], v[188:191], a[48:51]
ds_read_b128 a[196:199], v240 offset:50176
v_cvt_pk_bf16_f32 v200, v200, v201
v_mfma_f32_16x16x32_bf16 a[52:55], a[232:235], v[188:191], a[52:55]
v_exp_f32 v148, v148
v_mfma_f32_16x16x32_bf16 a[52:55], a[236:239], v[164:167], a[52:55]
s_waitcnt lgkmcnt(3)
ds_read_b128 a[192:195], v240 offset:49920
v_cvt_pk_bf16_f32 v193, v146, v147
v_mfma_f32_16x16x32_bf16 a[20:23], a[236:239], v[160:163], a[20:23]
s_add_u32 m0, s33, 0x1040
v_exp_f32_e64 v149, v149
v_mfma_f32_16x16x32_bf16 a[20:23], a[232:235], v[184:187], a[20:23]
buffer_load_dwordx4 v243, s[8:11], s56 offen nt lds
v_mfma_f32_16x16x32_bf16 a[24:27], a[240:243], v[184:187], a[24:27]
v_exp_f32 v150, v150
v_mfma_f32_16x16x32_bf16 a[24:27], a[244:247], v[160:163], a[24:27]
v_cvt_pk_bf16_f32 v194, v148, v149
v_mov_b64 v[208:209], v[210:211]
v_mov_b64 v[214:215], v[212:213]
v_mfma_f32_16x16x32_bf16 a[56:59], a[244:247], v[164:167], a[56:59]
v_exp_f32 v151, v151
v_mfma_f32_16x16x32_bf16 a[56:59], a[240:243], v[188:191], a[56:59]
v_cvt_pk_bf16_f32 v201, v202, v203
v_accvgpr_write_b32 a152, v200
v_accvgpr_write_b32 a153, v201
v_mfma_f32_16x16x32_bf16 a[60:63], a[248:251], v[188:191], a[60:63]
v_exp_f32_e64 v156, v156
v_mfma_f32_16x16x32_bf16 a[60:63], a[252:255], v[164:167], a[60:63]
v_cvt_pk_bf16_f32 v195, v150, v151
v_cvt_pk_bf16_f32 v204, v204, v205
v_mfma_f32_16x16x32_bf16 a[28:31], a[252:255], v[160:163], a[28:31]
v_exp_f32 v157, v157
v_mfma_f32_16x16x32_bf16 a[28:31], a[248:251], v[184:187], a[28:31]
v_exp_f32 v158, v158
v_mfma_f32_16x16x32_bf16 v[208:211], v[236:239], v[208:211], 0
v_cvt_pk_bf16_f32 v198, v156, v157
v_cvt_pk_bf16_f32 v205, v206, v207
v_mfma_f32_16x16x32_bf16 v[212:215], v[236:239], v[212:215], 0
s_waitcnt lgkmcnt(0)
v_exp_f32 v159, v159
v_mfma_f32_16x16x32_bf16 v[128:131], a[192:195], v[0:3], -4.0
v_exp_f32 v152, v152
v_mfma_f32_16x16x32_bf16 v[128:131], a[196:199], v[4:7], v[128:131]
v_cvt_pk_bf16_f32 v199, v158, v159
v_accvgpr_write_b32 a154, v204
v_mfma_f32_16x16x32_bf16 v[128:131], a[200:203], v[8:11], v[128:131]
v_exp_f32 v153, v153
v_mfma_f32_16x16x32_bf16 v[128:131], a[204:207], v[12:15], v[128:131]
v_exp_f32 v154, v154
v_mfma_f32_16x16x32_bf16 v[132:135], a[220:223], v[12:15], -4.0
v_cvt_pk_bf16_f32 v196, v152, v153
v_accvgpr_write_b32 a155, v205
v_mfma_f32_16x16x32_bf16 v[132:135], a[216:219], v[8:11], v[132:135]
v_exp_f32 v155, v155
v_mfma_f32_16x16x32_bf16 v[132:135], a[212:215], v[4:7], v[132:135]
v_cvt_pk_bf16_f32 v197, v154, v155
v_cvt_pk_bf16_f32 v208, v208, v209
v_mfma_f32_16x16x32_bf16 v[132:135], a[208:211], v[0:3], v[132:135]
v_exp_f32 v128, v128
v_mfma_f32_16x16x32_bf16 v[140:143], a[208:211], v[16:19], -4.0
v_exp_f32 v129, v129
v_mfma_f32_16x16x32_bf16 v[140:143], a[212:215], v[20:23], v[140:143]
v_exp_f32_e64 v130, v130
v_mfma_f32_16x16x32_bf16 v[140:143], a[216:219], v[24:27], v[140:143]
v_cvt_pk_bf16_f32 v160, v128, v129
v_cvt_pk_bf16_f32 v209, v210, v211
v_mfma_f32_16x16x32_bf16 v[140:143], a[220:223], v[28:31], v[140:143]
s_add_u32 m0, s31, 0xa280
v_exp_f32 v131, v131
v_mfma_f32_16x16x32_bf16 v[136:139], a[204:207], v[28:31], -4.0
v_exp_f32 v132, v132
v_mfma_f32_16x16x32_bf16 v[136:139], a[200:203], v[24:27], v[136:139]
v_cvt_pk_bf16_f32 v161, v130, v131
v_accvgpr_write_b32 a156, v208
v_mfma_f32_16x16x32_bf16 v[136:139], a[196:199], v[20:23], v[136:139]
s_waitcnt vmcnt(22)
v_exp_f32 v133, v133
v_mfma_f32_16x16x32_bf16 v[136:139], a[192:195], v[16:19], v[136:139]
s_barrier
v_smfmac_f32_16x16x64_bf16 v[220:223], v[224:227], v[168:175], v248
buffer_load_dwordx4 v243, s[12:15], s38 offen nt lds
v_mfma_f32_16x16x32_bf16 a[80:83], a[224:227], v[228:231], a[80:83]
v_exp_f32 v134, v134
v_mfma_f32_16x16x32_bf16 a[80:83], a[228:231], v[168:171], a[80:83]
v_cvt_pk_bf16_f32 v162, v132, v133
v_accvgpr_write_b32 a157, v209
v_mfma_f32_16x16x32_bf16 a[112:115], a[228:231], v[172:175], a[112:115]
v_exp_f32 v135, v135
v_mfma_f32_16x16x32_bf16 a[112:115], a[224:227], v[232:235], a[112:115]
ds_read_b64_tr_b16 a[224:225], v241
ds_read_b64_tr_b16 a[226:227], v241 offset:4128
v_mfma_f32_16x16x32_bf16 a[116:119], a[232:235], v[232:235], a[116:119]
v_exp_f32 v140, v140
v_mfma_f32_16x16x32_bf16 a[116:119], a[236:239], v[172:175], a[116:119]
ds_read_b64_tr_b16 a[228:229], v241 offset:8256
ds_read_b64_tr_b16 a[230:231], v241 offset:12384
v_mfma_f32_16x16x32_bf16 a[84:87], a[236:239], v[168:171], a[84:87]
v_cvt_pk_bf16_f32 v163, v134, v135
v_cvt_pk_bf16_f32 v212, v212, v213
v_mfma_f32_16x16x32_bf16 a[84:87], a[232:235], v[228:231], a[84:87]
ds_read_b64_tr_b16 a[232:233], v241 offset:8
ds_read_b64_tr_b16 a[234:235], v241 offset:4136
v_mfma_f32_16x16x32_bf16 a[88:91], a[240:243], v[228:231], a[88:91]
s_add_u32 m0, s31, 0xa280
v_exp_f32 v141, v141
v_mfma_f32_16x16x32_bf16 a[88:91], a[244:247], v[168:171], a[88:91]
buffer_load_dwordx4 v243, s[12:15], s38 offen offset:1024 nt lds
v_mfma_f32_16x16x32_bf16 a[120:123], a[244:247], v[172:175], a[120:123]
s_xor_b32 s38, s29, 0x1800000
v_exp_f32 v142, v142
v_mfma_f32_16x16x32_bf16 a[120:123], a[240:243], v[232:235], a[120:123]
s_xor_b32 s39, s29, 0x101c000
ds_read_b64_tr_b16 a[236:237], v241 offset:8264
ds_read_b64_tr_b16 a[238:239], v241 offset:12392
v_mfma_f32_16x16x32_bf16 a[124:127], a[248:251], v[232:235], a[124:127]
v_cvt_pk_bf16_f32 v166, v140, v141
v_cvt_pk_bf16_f32 v213, v214, v215
v_mfma_f32_16x16x32_bf16 a[124:127], a[252:255], v[172:175], a[124:127]
ds_read_b64_tr_b16 a[240:241], v241 offset:256
ds_read_b64_tr_b16 a[242:243], v241 offset:4384
v_mfma_f32_16x16x32_bf16 a[92:95], a[252:255], v[168:171], a[92:95]
v_exp_f32 v143, v143
v_mfma_f32_16x16x32_bf16 a[92:95], a[248:251], v[228:231], a[92:95]
ds_read_b64_tr_b16 a[244:245], v241 offset:8512
v_accvgpr_write_b32 a158, v212
v_mfma_f32_16x16x32_bf16 v[144:147], a[192:195], v[32:35], -4.0
v_exp_f32 v136, v136
v_mfma_f32_16x16x32_bf16 v[144:147], a[196:199], v[36:39], v[144:147]
s_add_u32 m0, s33, 0x1040
v_cvt_pk_bf16_f32 v167, v142, v143
v_accvgpr_write_b32 a159, v213
v_mfma_f32_16x16x32_bf16 v[144:147], a[200:203], v[40:43], v[144:147]
v_exp_f32_e64 v137, v137
v_mfma_f32_16x16x32_bf16 v[144:147], a[204:207], v[44:47], v[144:147]
buffer_load_dwordx4 v243, s[8:11], s56 offen offset:1024 nt lds
v_mfma_f32_16x16x32_bf16 v[148:151], a[220:223], v[44:47], -4.0
s_add_u32 m0, s31, 0xc300
v_exp_f32 v138, v138
v_mfma_f32_16x16x32_bf16 v[148:151], a[216:219], v[40:43], v[148:151]
v_exp_f32 v139, v139
v_mfma_f32_16x16x32_bf16 v[148:151], a[212:215], v[36:39], v[148:151]
v_cvt_pk_bf16_f32 v164, v136, v137
v_cvt_pk_bf16_f32 v165, v138, v139
v_mfma_f32_16x16x32_bf16 v[148:151], a[208:211], v[32:35], v[148:151]
ds_read_b64_tr_b16 a[246:247], v241 offset:12640
v_exp_f32 v144, v144
v_exp_f32 v145, v145
v_pk_mul_f32 v[70:71], v[70:71], v[250:251] op_sel:[0,0] op_sel_hi:[1,0]
v_pk_mul_f32 v[68:69], v[68:69], v[250:251] op_sel:[0,0] op_sel_hi:[1,0]
v_pk_mul_f32 v[66:67], v[66:67], v[250:251] op_sel:[0,0] op_sel_hi:[1,0]
v_pk_mul_f32 v[64:65], v[64:65], v[250:251] op_sel:[0,0] op_sel_hi:[1,0]
v_cvt_pk_bf16_f32 v64, v64, v65
v_mfma_f32_16x16x32_bf16 v[156:159], a[208:211], v[48:51], -4.0
v_exp_f32_e64 v146, v146
v_mfma_f32_16x16x32_bf16 v[156:159], a[212:215], v[52:55], v[156:159]
v_cvt_pk_bf16_f32 v184, v144, v145
v_cvt_pk_bf16_f32 v65, v66, v67
v_mfma_f32_16x16x32_bf16 v[156:159], a[216:219], v[56:59], v[156:159]
v_exp_f32 v147, v147
v_mfma_f32_16x16x32_bf16 v[156:159], a[220:223], v[60:63], v[156:159]
buffer_load_dwordx4 v243, s[12:15], s38 offen nt lds
v_mfma_f32_16x16x32_bf16 v[152:155], a[204:207], v[60:63], -4.0
v_exp_f32 v148, v148
v_mfma_f32_16x16x32_bf16 v[152:155], a[200:203], v[56:59], v[152:155]
v_cvt_pk_bf16_f32 v185, v146, v147
v_cvt_pk_bf16_f32 v66, v68, v69
v_mfma_f32_16x16x32_bf16 v[152:155], a[196:199], v[52:55], v[152:155]
ds_read_b64_tr_b16 a[248:249], v241 offset:264
v_cvt_pk_bf16_f32 v67, v70, v71
v_mfma_f32_16x16x32_bf16 v[152:155], a[192:195], v[48:51], v[152:155]
ds_read_b64_tr_b16 a[250:251], v241 offset:4392
v_exp_f32 v149, v149
v_exp_f32_e64 v150, v150
v_pk_mul_f32 v[78:79], v[78:79], v[250:251] op_sel:[0,0] op_sel_hi:[1,0]
v_pk_mul_f32 v[76:77], v[76:77], v[250:251] op_sel:[0,0] op_sel_hi:[1,0]
v_pk_mul_f32 v[74:75], v[74:75], v[250:251] op_sel:[0,0] op_sel_hi:[1,0]
v_pk_mul_f32 v[72:73], v[72:73], v[250:251] op_sel:[0,0] op_sel_hi:[1,0]
v_cvt_pk_bf16_f32 v72, v72, v73
v_smfmac_f32_16x16x64_bf16 v[216:219], v[224:227], v[176:183], v248
s_waitcnt lgkmcnt(2)
ds_read_b64_tr_b16 a[252:253], v241 offset:8520
v_mfma_f32_16x16x32_bf16 a[0:3], a[224:227], v[176:179], a[0:3]
ds_read_b64_tr_b16 a[254:255], v241 offset:12648
v_cvt_pk_bf16_f32 v186, v148, v149
v_mfma_f32_16x16x32_bf16 a[0:3], a[228:231], v[160:163], a[0:3]
ds_read_b128 a[208:211], v240 offset:4160
ds_read_b128 a[212:215], v240 offset:4416
v_mfma_f32_16x16x32_bf16 a[32:35], a[228:231], v[164:167], a[32:35]
v_exp_f32 v151, v151
v_mfma_f32_16x16x32_bf16 a[32:35], a[224:227], v[180:183], a[32:35]
s_add_u32 m0, s31, 0xc300
ds_read_b128 a[216:219], v240 offset:4672
ds_read_b128 a[220:223], v240 offset:4928
v_mfma_f32_16x16x32_bf16 a[36:39], a[232:235], v[180:183], a[36:39]
v_exp_f32 v156, v156
v_mfma_f32_16x16x32_bf16 a[36:39], a[236:239], v[164:167], a[36:39]
ds_read_b128 a[204:207], v240 offset:768
ds_read_b128 a[200:203], v240 offset:512
v_mfma_f32_16x16x32_bf16 a[4:7], a[236:239], v[160:163], a[4:7]
v_cvt_pk_bf16_f32 v187, v150, v151
v_cvt_pk_bf16_f32 v73, v74, v75
v_mfma_f32_16x16x32_bf16 a[4:7], a[232:235], v[176:179], a[4:7]
ds_read_b128 a[196:199], v240 offset:256
v_cvt_pk_bf16_f32 v74, v76, v77
v_mfma_f32_16x16x32_bf16 a[8:11], a[240:243], v[176:179], a[8:11]
ds_read_b128 a[192:195], v240
v_cvt_pk_bf16_f32 v75, v78, v79
v_mfma_f32_16x16x32_bf16 a[8:11], a[244:247], v[160:163], a[8:11]
buffer_load_dwordx4 v243, s[12:15], s38 offen offset:1024 nt lds
v_mfma_f32_16x16x32_bf16 a[40:43], a[244:247], v[164:167], a[40:43]
v_exp_f32 v157, v157
v_mfma_f32_16x16x32_bf16 a[40:43], a[240:243], v[180:183], a[40:43]
s_waitcnt lgkmcnt(4)
v_exp_f32_e64 v158, v158
v_mfma_f32_16x16x32_bf16 a[44:47], a[248:251], v[180:183], a[44:47]
v_cvt_pk_bf16_f32 v190, v156, v157
v_mov_b64 v[76:77], v[64:65]
v_mfma_f32_16x16x32_bf16 a[44:47], a[252:255], v[164:167], a[44:47]
v_exp_f32 v159, v159
v_mfma_f32_16x16x32_bf16 a[12:15], a[252:255], v[160:163], a[12:15]
v_exp_f32 v152, v152
v_mfma_f32_16x16x32_bf16 a[12:15], a[248:251], v[176:179], a[12:15]
s_waitcnt lgkmcnt(0)
v_cvt_pk_bf16_f32 v191, v158, v159
v_mov_b64 v[78:79], v[66:67]
v_mfma_f32_16x16x32_bf16 v[128:131], a[192:195], v[0:3], -4.0
v_exp_f32 v153, v153
v_mfma_f32_16x16x32_bf16 v[128:131], a[196:199], v[4:7], v[128:131]
v_exp_f32_e64 v154, v154
v_mfma_f32_16x16x32_bf16 v[128:131], a[200:203], v[8:11], v[128:131]
s_add_u32 m0, s32, 0xc180
v_cvt_pk_bf16_f32 v188, v152, v153
v_mov_b32_dpp v64, v72 row_ror:8 row_mask:0xf bank_mask:0xc
v_mfma_f32_16x16x32_bf16 v[128:131], a[204:207], v[12:15], v[128:131]
buffer_load_dwordx4 v243, s[16:19], s39 offen nt lds
v_mfma_f32_16x16x32_bf16 v[132:135], a[220:223], v[12:15], -4.0
v_exp_f32_e64 v155, v155
v_mfma_f32_16x16x32_bf16 v[132:135], a[216:219], v[8:11], v[132:135]
v_cvt_pk_bf16_f32 v189, v154, v155
v_mov_b32_dpp v65, v73 row_ror:8 row_mask:0xf bank_mask:0xc
v_mfma_f32_16x16x32_bf16 v[132:135], a[212:215], v[4:7], v[132:135]
v_mov_b32_dpp v66, v74 row_ror:8 row_mask:0xf bank_mask:0xc
v_mov_b32_dpp v67, v75 row_ror:8 row_mask:0xf bank_mask:0xc
v_mfma_f32_16x16x32_bf16 v[132:135], a[208:211], v[0:3], v[132:135]
v_exp_f32 v128, v128
v_mfma_f32_16x16x32_bf16 v[140:143], a[208:211], v[16:19], -4.0
v_exp_f32 v129, v129
v_mfma_f32_16x16x32_bf16 v[140:143], a[212:215], v[20:23], v[140:143]
v_exp_f32_e64 v130, v130
v_mfma_f32_16x16x32_bf16 v[140:143], a[216:219], v[24:27], v[140:143]
v_cvt_pk_bf16_f32 v168, v128, v129
v_mov_b32_dpp v72, v76 row_ror:8 row_mask:0xf bank_mask:0x3
v_mfma_f32_16x16x32_bf16 v[140:143], a[220:223], v[28:31], v[140:143]
buffer_store_dwordx4 v[64:67], v249, s[20:23], s57 offen sc1
v_mfma_f32_16x16x32_bf16 v[136:139], a[204:207], v[28:31], -4.0
s_add_u32 m0, s32, 0xc180
v_exp_f32 v131, v131
v_mfma_f32_16x16x32_bf16 v[136:139], a[200:203], v[24:27], v[136:139]
v_exp_f32 v132, v132
v_mfma_f32_16x16x32_bf16 v[136:139], a[196:199], v[20:23], v[136:139]
v_cvt_pk_bf16_f32 v169, v130, v131
v_mov_b32_dpp v73, v77 row_ror:8 row_mask:0xf bank_mask:0x3
v_mfma_f32_16x16x32_bf16 v[136:139], a[192:195], v[16:19], v[136:139]
v_exp_f32 v133, v133
v_smfmac_f32_16x16x64_bf16 v[220:223], v[224:227], v[192:199], v248
v_mov_b32_dpp v74, v78 row_ror:8 row_mask:0xf bank_mask:0x3
v_mfma_f32_16x16x32_bf16 a[64:67], a[224:227], v[192:195], a[64:67]
v_exp_f32 v134, v134
v_mfma_f32_16x16x32_bf16 a[64:67], a[228:231], v[184:187], a[64:67]
v_cvt_pk_bf16_f32 v170, v132, v133
v_mov_b32_dpp v75, v79 row_ror:8 row_mask:0xf bank_mask:0x3
v_mfma_f32_16x16x32_bf16 a[96:99], a[228:231], v[188:191], a[96:99]
v_exp_f32_e64 v135, v135
v_mfma_f32_16x16x32_bf16 a[96:99], a[224:227], v[196:199], a[96:99]
ds_read_b64_tr_b16 a[224:225], v241 offset:512
v_exp_f32_e64 v140, v140
v_cvt_pk_bf16_f32 v171, v134, v135
v_exp_f32_e64 v141, v141
v_pk_mul_f32 v[86:87], v[86:87], v[250:251] op_sel:[0,0] op_sel_hi:[1,0]
v_pk_mul_f32 v[84:85], v[84:85], v[250:251] op_sel:[0,0] op_sel_hi:[1,0]
v_pk_mul_f32 v[82:83], v[82:83], v[250:251] op_sel:[0,0] op_sel_hi:[1,0]
v_pk_mul_f32 v[80:81], v[80:81], v[250:251] op_sel:[0,0] op_sel_hi:[1,0]
v_cvt_pk_bf16_f32 v80, v80, v81
v_mfma_f32_16x16x32_bf16 a[100:103], a[232:235], v[196:199], a[100:103]
v_exp_f32 v142, v142
v_mfma_f32_16x16x32_bf16 a[100:103], a[236:239], v[188:191], a[100:103]
buffer_load_dwordx4 v243, s[24:27], s39 offen offset:1032 nt lds
v_mfma_f32_16x16x32_bf16 a[68:71], a[236:239], v[184:187], a[68:71]
s_add_u32 m0, s33, 0x1060
v_cvt_pk_bf16_f32 v174, v140, v141
v_cvt_pk_bf16_f32 v81, v82, v83
v_mfma_f32_16x16x32_bf16 a[68:71], a[232:235], v[192:195], a[68:71]
s_waitcnt vmcnt(18)
ds_read_b64_tr_b16 a[226:227], v241 offset:4640
ds_read_b64_tr_b16 a[228:229], v241 offset:8768
v_mfma_f32_16x16x32_bf16 a[72:75], a[240:243], v[192:195], a[72:75]
s_xor_b32 s39, s29, 0x101e000
v_exp_f32_e64 v143, v143
v_mfma_f32_16x16x32_bf16 a[72:75], a[244:247], v[184:187], a[72:75]
s_xor_b32 s38, s29, 0x1802000
ds_read_b64_tr_b16 a[230:231], v241 offset:12896
ds_read_b64_tr_b16 a[232:233], v241 offset:520
v_mfma_f32_16x16x32_bf16 a[104:107], a[244:247], v[188:191], a[104:107]
v_exp_f32_e64 v136, v136
v_mfma_f32_16x16x32_bf16 a[104:107], a[240:243], v[196:199], a[104:107]
buffer_load_dwordx4 v243, s[8:11], s56 offen offset:2048 nt lds
v_mfma_f32_16x16x32_bf16 a[108:111], a[248:251], v[196:199], a[108:111]
v_cvt_pk_bf16_f32 v175, v142, v143
v_cvt_pk_bf16_f32 v82, v84, v85
v_mfma_f32_16x16x32_bf16 a[108:111], a[252:255], v[188:191], a[108:111]
ds_read_b64_tr_b16 a[234:235], v241 offset:4648
ds_read_b64_tr_b16 a[236:237], v241 offset:8776
v_mfma_f32_16x16x32_bf16 a[76:79], a[252:255], v[184:187], a[76:79]
s_add_u32 m0, s32, 0xe1c0
v_exp_f32_e64 v137, v137
v_mfma_f32_16x16x32_bf16 a[76:79], a[248:251], v[192:195], a[76:79]
ds_read_b64_tr_b16 a[238:239], v241 offset:12904
ds_read_b64_tr_b16 a[240:241], v241 offset:768
v_mfma_f32_16x16x32_bf16 v[144:147], a[192:195], v[32:35], -4.0
v_exp_f32 v138, v138
v_mfma_f32_16x16x32_bf16 v[144:147], a[196:199], v[36:39], v[144:147]
v_cvt_pk_bf16_f32 v172, v136, v137
v_cvt_pk_bf16_f32 v83, v86, v87
v_mfma_f32_16x16x32_bf16 v[144:147], a[200:203], v[40:43], v[144:147]
v_exp_f32 v139, v139
v_mfma_f32_16x16x32_bf16 v[144:147], a[204:207], v[44:47], v[144:147]
buffer_load_dwordx4 v243, s[16:19], s39 offen nt lds
v_mfma_f32_16x16x32_bf16 v[148:151], a[220:223], v[44:47], -4.0
v_cvt_pk_bf16_f32 v173, v138, v139
v_mfma_f32_16x16x32_bf16 v[148:151], a[216:219], v[40:43], v[148:151]
ds_read_b64_tr_b16 a[242:243], v241 offset:4896
ds_read_b128 v[202:205], v242
v_mfma_f32_16x16x32_bf16 v[148:151], a[212:215], v[36:39], v[148:151]
ds_read_b64_tr_b16 a[244:245], v241 offset:9024
ds_read_b128 v[210:213], v242 offset:256
v_mfma_f32_16x16x32_bf16 v[148:151], a[208:211], v[32:35], v[148:151]
ds_read_b64_tr_b16 a[246:247], v241 offset:13152
v_exp_f32 v144, v144
v_exp_f32 v145, v145
v_pk_mul_f32 v[94:95], v[94:95], v[250:251] op_sel:[0,0] op_sel_hi:[1,0]
v_pk_mul_f32 v[92:93], v[92:93], v[250:251] op_sel:[0,0] op_sel_hi:[1,0]
v_pk_mul_f32 v[90:91], v[90:91], v[250:251] op_sel:[0,0] op_sel_hi:[1,0]
v_pk_mul_f32 v[88:89], v[88:89], v[250:251] op_sel:[0,0] op_sel_hi:[1,0]
v_cvt_pk_bf16_f32 v88, v88, v89
v_mfma_f32_16x16x32_bf16 v[156:159], a[208:211], v[48:51], -4.0
v_exp_f32 v146, v146
v_mfma_f32_16x16x32_bf16 v[156:159], a[212:215], v[52:55], v[156:159]
v_cvt_pk_bf16_f32 v228, v144, v145
v_cvt_pk_bf16_f32 v89, v90, v91
v_mfma_f32_16x16x32_bf16 v[156:159], a[216:219], v[56:59], v[156:159]
v_exp_f32 v147, v147
v_mfma_f32_16x16x32_bf16 v[156:159], a[220:223], v[60:63], v[156:159]
buffer_store_dwordx4 v[72:75], v249, s[20:23], s57 offen offset:2048 sc1
v_mfma_f32_16x16x32_bf16 v[152:155], a[204:207], v[60:63], -4.0
s_add_u32 m0, s32, 0xe1c0
v_exp_f32 v148, v148
v_mfma_f32_16x16x32_bf16 v[152:155], a[200:203], v[56:59], v[152:155]
s_waitcnt lgkmcnt(1)
v_cvt_pk_bf16_f32 v229, v146, v147
v_mov_b64_e64 v[200:201], v[202:203]
v_mfma_f32_16x16x32_bf16 v[152:155], a[196:199], v[52:55], v[152:155]
ds_read_b64_tr_b16 a[248:249], v241 offset:776
v_mov_b64_e64 v[206:207], v[204:205]
v_mfma_f32_16x16x32_bf16 v[152:155], a[192:195], v[48:51], v[152:155]
ds_read_b64_tr_b16 a[250:251], v241 offset:4904
ds_read_b64_tr_b16 a[252:253], v241 offset:9032
v_mfma_f32_16x16x32_bf16 v[200:203], v[236:239], v[200:203], 0
ds_read_b64_tr_b16 a[254:255], v241 offset:13160
ds_read_b128 a[208:211], v240 offset:12480
v_mfma_f32_16x16x32_bf16 v[204:207], v[236:239], v[204:207], 0
L_pad13:
s_cbranch_vccnz L_pad17
ds_read_b128 a[212:215], v240 offset:12736
ds_read_b128 a[216:219], v240 offset:12992
v_smfmac_f32_16x16x64_bf16 v[216:219], v[224:227], v[160:167], v248
ds_read_b128 a[220:223], v240 offset:13248
v_mfma_f32_16x16x32_bf16 a[16:19], a[224:227], v[176:179], a[16:19]
v_exp_f32 v149, v149
v_mfma_f32_16x16x32_bf16 a[16:19], a[228:231], v[160:163], a[16:19]
ds_read_b128 a[204:207], v240 offset:9088
v_mov_b64 v[208:209], v[210:211]
v_mfma_f32_16x16x32_bf16 a[48:51], a[228:231], v[164:167], a[48:51]
v_exp_f32 v150, v150
v_mfma_f32_16x16x32_bf16 a[48:51], a[224:227], v[180:183], a[48:51]
ds_read_b128 a[200:203], v240 offset:8832
v_cvt_pk_bf16_f32 v230, v148, v149
v_mfma_f32_16x16x32_bf16 a[52:55], a[232:235], v[180:183], a[52:55]
v_exp_f32_e64 v151, v151
v_mfma_f32_16x16x32_bf16 a[52:55], a[236:239], v[164:167], a[52:55]
buffer_load_dwordx4 v243, s[24:27], s39 offen offset:1032 nt lds
v_mfma_f32_16x16x32_bf16 a[20:23], a[236:239], v[160:163], a[20:23]
v_exp_f32 v156, v156
v_mfma_f32_16x16x32_bf16 a[20:23], a[232:235], v[176:179], a[20:23]
ds_read_b128 a[196:199], v240 offset:8576
v_cvt_pk_bf16_f32 v231, v150, v151
v_mov_b64 v[214:215], v[212:213]
v_mfma_f32_16x16x32_bf16 a[24:27], a[240:243], v[176:179], a[24:27]
s_waitcnt lgkmcnt(2)
ds_read_b128 a[192:195], v240 offset:8320
v_cvt_pk_bf16_f32 v90, v92, v93
v_mfma_f32_16x16x32_bf16 a[24:27], a[244:247], v[160:163], a[24:27]
v_exp_f32 v157, v157
v_mfma_f32_16x16x32_bf16 a[56:59], a[244:247], v[164:167], a[56:59]
v_exp_f32_e64 v158, v158
v_mfma_f32_16x16x32_bf16 a[56:59], a[240:243], v[180:183], a[56:59]
v_cvt_pk_bf16_f32 v234, v156, v157
v_cvt_pk_bf16_f32 v91, v94, v95
v_mfma_f32_16x16x32_bf16 a[60:63], a[248:251], v[180:183], a[60:63]
v_exp_f32 v159, v159
v_mfma_f32_16x16x32_bf16 a[60:63], a[252:255], v[164:167], a[60:63]
v_exp_f32 v152, v152
v_mfma_f32_16x16x32_bf16 a[28:31], a[252:255], v[160:163], a[28:31]
v_cvt_pk_bf16_f32 v235, v158, v159
v_mov_b64 v[92:93], v[80:81]
v_mfma_f32_16x16x32_bf16 a[28:31], a[248:251], v[176:179], a[28:31]
v_exp_f32 v153, v153
v_mfma_f32_16x16x32_bf16 v[208:211], v[236:239], v[208:211], 0
v_exp_f32 v154, v154
v_mfma_f32_16x16x32_bf16 v[212:215], v[236:239], v[212:215], 0
s_waitcnt lgkmcnt(0)
v_cvt_pk_bf16_f32 v232, v152, v153
v_mov_b64 v[94:95], v[82:83]
v_mfma_f32_16x16x32_bf16 v[128:131], a[192:195], v[0:3], -4.0
v_exp_f32 v155, v155
v_mfma_f32_16x16x32_bf16 v[128:131], a[196:199], v[4:7], v[128:131]
v_cvt_pk_bf16_f32 v233, v154, v155
v_mov_b32_dpp v80, v88 row_ror:8 row_mask:0xf bank_mask:0xc
v_mfma_f32_16x16x32_bf16 v[128:131], a[200:203], v[8:11], v[128:131]
v_mov_b32_dpp v81, v89 row_ror:8 row_mask:0xf bank_mask:0xc
v_mov_b32_dpp v82, v90 row_ror:8 row_mask:0xf bank_mask:0xc
v_mfma_f32_16x16x32_bf16 v[128:131], a[204:207], v[12:15], v[128:131]
v_mov_b32_dpp v83, v91 row_ror:8 row_mask:0xf bank_mask:0xc
v_mov_b32_dpp v88, v92 row_ror:8 row_mask:0xf bank_mask:0x3
v_mfma_f32_16x16x32_bf16 v[132:135], a[220:223], v[12:15], -4.0
v_mov_b32_dpp v89, v93 row_ror:8 row_mask:0xf bank_mask:0x3
v_mov_b32_dpp v90, v94 row_ror:8 row_mask:0xf bank_mask:0x3
v_mfma_f32_16x16x32_bf16 v[132:135], a[216:219], v[8:11], v[132:135]
s_add_u32 m0, s33, 0x1060
v_mov_b32_dpp v91, v95 row_ror:8 row_mask:0xf bank_mask:0x3
v_cvt_pk_bf16_f32 v200, v200, v201
v_mfma_f32_16x16x32_bf16 v[132:135], a[212:215], v[4:7], v[132:135]
v_exp_f32_e64 v128, v128
v_mfma_f32_16x16x32_bf16 v[132:135], a[208:211], v[0:3], v[132:135]
buffer_load_dwordx4 v243, s[8:11], s56 offen offset:3072 nt lds
v_mfma_f32_16x16x32_bf16 v[140:143], a[208:211], v[16:19], -4.0
v_exp_f32 v129, v129
v_mfma_f32_16x16x32_bf16 v[140:143], a[212:215], v[20:23], v[140:143]
v_exp_f32 v130, v130
v_mfma_f32_16x16x32_bf16 v[140:143], a[216:219], v[24:27], v[140:143]
v_cvt_pk_bf16_f32 v160, v128, v129
v_cvt_pk_bf16_f32 v201, v202, v203
v_mfma_f32_16x16x32_bf16 v[140:143], a[220:223], v[28:31], v[140:143]
s_add_u32 m0, s31, 0x0
v_exp_f32 v131, v131
v_mfma_f32_16x16x32_bf16 v[136:139], a[204:207], v[28:31], -4.0
v_exp_f32 v132, v132
v_mfma_f32_16x16x32_bf16 v[136:139], a[200:203], v[24:27], v[136:139]
v_cvt_pk_bf16_f32 v161, v130, v131
v_accvgpr_write_b32 a160, v200
v_mfma_f32_16x16x32_bf16 v[136:139], a[196:199], v[20:23], v[136:139]
s_waitcnt vmcnt(22)
v_exp_f32 v133, v133
v_mfma_f32_16x16x32_bf16 v[136:139], a[192:195], v[16:19], v[136:139]
s_barrier
v_smfmac_f32_16x16x64_bf16 v[220:223], v[224:227], v[184:191], v248
buffer_load_dwordx4 v243, s[12:15], s38 offen nt lds
v_mfma_f32_16x16x32_bf16 a[80:83], a[224:227], v[192:195], a[80:83]
v_exp_f32_e64 v134, v134
v_mfma_f32_16x16x32_bf16 a[80:83], a[228:231], v[184:187], a[80:83]
v_cvt_pk_bf16_f32 v162, v132, v133
v_accvgpr_write_b32 a161, v201
v_mfma_f32_16x16x32_bf16 a[112:115], a[228:231], v[188:191], a[112:115]
v_exp_f32 v135, v135
v_mfma_f32_16x16x32_bf16 a[112:115], a[224:227], v[196:199], a[112:115]
ds_read_b64_tr_b16 a[224:225], v241 offset:16512
ds_read_b64_tr_b16 a[226:227], v241 offset:20640
v_mfma_f32_16x16x32_bf16 a[116:119], a[232:235], v[196:199], a[116:119]
v_exp_f32 v140, v140
v_mfma_f32_16x16x32_bf16 a[116:119], a[236:239], v[188:191], a[116:119]
buffer_store_dwordx4 v[80:83], v249, s[20:23], s57 offen offset:128 sc1
v_mfma_f32_16x16x32_bf16 a[84:87], a[236:239], v[184:187], a[84:87]
v_cvt_pk_bf16_f32 v163, v134, v135
v_cvt_pk_bf16_f32 v204, v204, v205
v_mfma_f32_16x16x32_bf16 a[84:87], a[232:235], v[192:195], a[84:87]
ds_read_b64_tr_b16 a[228:229], v241 offset:24768
ds_read_b64_tr_b16 a[230:231], v241 offset:28896
v_mfma_f32_16x16x32_bf16 a[88:91], a[240:243], v[192:195], a[88:91]
s_add_u32 m0, s31, 0x0
v_exp_f32 v141, v141
v_mfma_f32_16x16x32_bf16 a[88:91], a[244:247], v[184:187], a[88:91]
ds_read_b64_tr_b16 a[232:233], v241 offset:16520
ds_read_b64_tr_b16 a[234:235], v241 offset:20648
v_mfma_f32_16x16x32_bf16 a[120:123], a[244:247], v[188:191], a[120:123]
v_exp_f32_e64 v142, v142
v_mfma_f32_16x16x32_bf16 a[120:123], a[240:243], v[196:199], a[120:123]
ds_read_b64_tr_b16 a[236:237], v241 offset:24776
ds_read_b64_tr_b16 a[238:239], v241 offset:28904
v_mfma_f32_16x16x32_bf16 a[124:127], a[248:251], v[196:199], a[124:127]
v_cvt_pk_bf16_f32 v166, v140, v141
v_cvt_pk_bf16_f32 v205, v206, v207
v_mfma_f32_16x16x32_bf16 a[124:127], a[252:255], v[188:191], a[124:127]
ds_read_b64_tr_b16 a[240:241], v241 offset:16768
ds_read_b64_tr_b16 a[242:243], v241 offset:20896
v_mfma_f32_16x16x32_bf16 a[92:95], a[252:255], v[184:187], a[92:95]
v_exp_f32 v143, v143
v_mfma_f32_16x16x32_bf16 a[92:95], a[248:251], v[192:195], a[92:95]
buffer_load_dwordx4 v243, s[12:15], s38 offen offset:1024 nt lds
v_mfma_f32_16x16x32_bf16 v[144:147], a[192:195], v[32:35], -4.0
s_xor_b32 s38, s29, 0x1804000
v_exp_f32 v136, v136
v_mfma_f32_16x16x32_bf16 v[144:147], a[196:199], v[36:39], v[144:147]
s_xor_b32 s39, s29, 0x1800000
v_cvt_pk_bf16_f32 v167, v142, v143
v_accvgpr_write_b32 a162, v204
v_mfma_f32_16x16x32_bf16 v[144:147], a[200:203], v[40:43], v[144:147]
v_exp_f32 v137, v137
v_mfma_f32_16x16x32_bf16 v[144:147], a[204:207], v[44:47], v[144:147]
ds_read_b64_tr_b16 a[244:245], v241 offset:25024
ds_read_b64_tr_b16 a[246:247], v241 offset:29152
v_mfma_f32_16x16x32_bf16 v[148:151], a[220:223], v[44:47], -4.0
v_exp_f32 v138, v138
v_mfma_f32_16x16x32_bf16 v[148:151], a[216:219], v[40:43], v[148:151]
v_cvt_pk_bf16_f32 v164, v136, v137
v_accvgpr_write_b32 a163, v205
v_mfma_f32_16x16x32_bf16 v[148:151], a[212:215], v[36:39], v[148:151]
v_exp_f32_e64 v139, v139
v_mfma_f32_16x16x32_bf16 v[148:151], a[208:211], v[32:35], v[148:151]
buffer_store_dwordx4 v[88:91], v249, s[20:23], s57 offen offset:2176 sc1
v_mfma_f32_16x16x32_bf16 v[156:159], a[208:211], v[48:51], -4.0
s_add_u32 m0, s31, 0x2080
v_cvt_pk_bf16_f32 v165, v138, v139
v_cvt_pk_bf16_f32 v208, v208, v209
v_mfma_f32_16x16x32_bf16 v[156:159], a[212:215], v[52:55], v[156:159]
v_exp_f32 v144, v144
v_mfma_f32_16x16x32_bf16 v[156:159], a[216:219], v[56:59], v[156:159]
v_exp_f32 v145, v145
v_mfma_f32_16x16x32_bf16 v[156:159], a[220:223], v[60:63], v[156:159]
ds_read_b64_tr_b16 a[248:249], v241 offset:16776
ds_read_b64_tr_b16 a[250:251], v241 offset:20904
v_mfma_f32_16x16x32_bf16 v[152:155], a[204:207], v[60:63], -4.0
v_exp_f32 v146, v146
v_mfma_f32_16x16x32_bf16 v[152:155], a[200:203], v[56:59], v[152:155]
v_cvt_pk_bf16_f32 v176, v144, v145
v_cvt_pk_bf16_f32 v209, v210, v211
v_mfma_f32_16x16x32_bf16 v[152:155], a[196:199], v[52:55], v[152:155]
v_exp_f32 v147, v147
v_mfma_f32_16x16x32_bf16 v[152:155], a[192:195], v[48:51], v[152:155]
ds_read_b64_tr_b16 a[252:253], v241 offset:25032
ds_read_b64_tr_b16 a[254:255], v241 offset:29160
v_accvgpr_write_b32 a164, v208
v_smfmac_f32_16x16x64_bf16 v[216:219], v[224:227], v[168:175], v248
s_waitcnt lgkmcnt(4)
ds_read_b128 a[208:211], v240 offset:20800
v_accvgpr_write_b32 a165, v209
v_mfma_f32_16x16x32_bf16 a[0:3], a[224:227], v[168:171], a[0:3]
v_exp_f32 v148, v148
v_mfma_f32_16x16x32_bf16 a[0:3], a[228:231], v[160:163], a[0:3]
buffer_load_dwordx4 v243, s[12:15], s38 offen nt lds
v_mfma_f32_16x16x32_bf16 a[32:35], a[228:231], v[164:167], a[32:35]
ds_read_b128 a[212:215], v240 offset:21056
v_cvt_pk_bf16_f32 v177, v146, v147
v_mfma_f32_16x16x32_bf16 a[32:35], a[224:227], v[172:175], a[32:35]
ds_read_b128 a[216:219], v240 offset:21312
ds_read_b128 a[220:223], v240 offset:21568
v_mfma_f32_16x16x32_bf16 a[36:39], a[232:235], v[172:175], a[36:39]
v_exp_f32 v149, v149
v_mfma_f32_16x16x32_bf16 a[36:39], a[236:239], v[164:167], a[36:39]
ds_read_b128 a[204:207], v240 offset:17408
ds_read_b128 a[200:203], v240 offset:17152
v_mfma_f32_16x16x32_bf16 a[4:7], a[236:239], v[160:163], a[4:7]
v_exp_f32 v150, v150
v_mfma_f32_16x16x32_bf16 a[4:7], a[232:235], v[168:171], a[4:7]
ds_read_b128 a[196:199], v240 offset:16896
v_cvt_pk_bf16_f32 v178, v148, v149
v_mfma_f32_16x16x32_bf16 a[8:11], a[240:243], v[168:171], a[8:11]
ds_read_b128 a[192:195], v240 offset:16640
ds_read_b128 v[202:205], v242 offset:512
v_mfma_f32_16x16x32_bf16 a[8:11], a[244:247], v[160:163], a[8:11]
v_cvt_pk_bf16_f32 v212, v212, v213
v_cvt_pk_bf16_f32 v213, v214, v215
v_mfma_f32_16x16x32_bf16 a[40:43], a[244:247], v[164:167], a[40:43]
s_add_u32 m0, s31, 0x2080
v_exp_f32 v151, v151
v_mfma_f32_16x16x32_bf16 a[40:43], a[240:243], v[172:175], a[40:43]
s_waitcnt lgkmcnt(5)
buffer_load_dwordx4 v243, s[12:15], s38 offen offset:1024 nt lds
v_mfma_f32_16x16x32_bf16 a[44:47], a[248:251], v[172:175], a[44:47]
v_exp_f32_e64 v156, v156
v_mfma_f32_16x16x32_bf16 a[44:47], a[252:255], v[164:167], a[44:47]
v_cvt_pk_bf16_f32 v179, v150, v151
v_accvgpr_write_b32 a166, v212
v_accvgpr_write_b32 a167, v213
v_mfma_f32_16x16x32_bf16 a[12:15], a[252:255], v[160:163], a[12:15]
v_exp_f32 v157, v157
v_mfma_f32_16x16x32_bf16 a[12:15], a[248:251], v[168:171], a[12:15]
s_waitcnt lgkmcnt(0)
ds_read_b128 v[210:213], v242 offset:768
v_mov_b64 v[200:201], v[202:203]
v_mfma_f32_16x16x32_bf16 v[128:131], a[192:195], v[0:3], -4.0
v_exp_f32 v158, v158
v_mfma_f32_16x16x32_bf16 v[128:131], a[196:199], v[4:7], v[128:131]
v_cvt_pk_bf16_f32 v182, v156, v157
v_mov_b64 v[206:207], v[204:205]
v_mfma_f32_16x16x32_bf16 v[128:131], a[200:203], v[8:11], v[128:131]
v_exp_f32 v159, v159
v_mfma_f32_16x16x32_bf16 v[128:131], a[204:207], v[12:15], v[128:131]
v_exp_f32 v152, v152
v_mfma_f32_16x16x32_bf16 v[132:135], a[220:223], v[12:15], -4.0
s_add_u32 m0, s32, 0x0
v_exp_f32 v153, v153
v_mfma_f32_16x16x32_bf16 v[132:135], a[216:219], v[8:11], v[132:135]
v_exp_f32 v154, v154
v_mfma_f32_16x16x32_bf16 v[132:135], a[212:215], v[4:7], v[132:135]
s_waitcnt lgkmcnt(0)
v_cvt_pk_bf16_f32 v183, v158, v159
v_cvt_pk_bf16_f32 v180, v152, v153
v_mfma_f32_16x16x32_bf16 v[132:135], a[208:211], v[0:3], v[132:135]
buffer_load_dwordx4 v243, s[16:19], s39 offen nt lds
v_mfma_f32_16x16x32_bf16 v[140:143], a[208:211], v[16:19], -4.0
v_mov_b64 v[208:209], v[210:211]
v_mov_b64_e64 v[214:215], v[212:213]
v_mfma_f32_16x16x32_bf16 v[140:143], a[212:215], v[20:23], v[140:143]
v_exp_f32 v155, v155
v_mfma_f32_16x16x32_bf16 v[140:143], a[216:219], v[24:27], v[140:143]
v_exp_f32 v128, v128
v_mfma_f32_16x16x32_bf16 v[140:143], a[220:223], v[28:31], v[140:143]
v_exp_f32 v129, v129
v_mfma_f32_16x16x32_bf16 v[136:139], a[204:207], v[28:31], -4.0
v_exp_f32 v130, v130
v_mfma_f32_16x16x32_bf16 v[136:139], a[200:203], v[24:27], v[136:139]
v_cvt_pk_bf16_f32 v181, v154, v155
v_cvt_pk_bf16_f32 v184, v128, v129
v_mfma_f32_16x16x32_bf16 v[136:139], a[196:199], v[20:23], v[136:139]
v_exp_f32_e64 v131, v131
v_mfma_f32_16x16x32_bf16 v[136:139], a[192:195], v[16:19], v[136:139]
v_exp_f32_e64 v132, v132
v_mfma_f32_16x16x32_bf16 v[200:203], v[236:239], v[200:203], 0
v_exp_f32_e64 v133, v133
v_mfma_f32_16x16x32_bf16 v[204:207], v[236:239], v[204:207], 0
v_exp_f32 v134, v134
v_smfmac_f32_16x16x64_bf16 v[220:223], v[224:227], v[228:235], v248
s_add_u32 m0, s32, 0x0
v_cvt_pk_bf16_f32 v185, v130, v131
v_mfma_f32_16x16x32_bf16 v[208:211], v[236:239], v[208:211], 0
buffer_load_dwordx4 v243, s[24:27], s39 offen offset:1032 nt lds
v_mfma_f32_16x16x32_bf16 v[212:215], v[236:239], v[212:215], 0
s_xor_b32 s39, s29, 0x1802000
v_cvt_pk_bf16_f32 v186, v132, v133
v_cvt_pk_bf16_f32 v200, v200, v201
v_cvt_pk_bf16_f32 v201, v202, v203
v_mfma_f32_16x16x32_bf16 a[64:67], a[224:227], v[228:231], a[64:67]
s_xor_b32 s38, s29, 0x1806000
v_accvgpr_write_b32 a168, v200
v_accvgpr_write_b32 a169, v201
v_mfma_f32_16x16x32_bf16 a[64:67], a[228:231], v[176:179], a[64:67]
v_cvt_pk_bf16_f32 v204, v204, v205
v_cvt_pk_bf16_f32 v205, v206, v207
v_mfma_f32_16x16x32_bf16 a[96:99], a[228:231], v[180:183], a[96:99]
v_exp_f32_e64 v135, v135
v_mfma_f32_16x16x32_bf16 a[96:99], a[224:227], v[232:235], a[96:99]
ds_read_b64_tr_b16 a[224:225], v241 offset:17024
ds_read_b64_tr_b16 a[226:227], v241 offset:21152
v_accvgpr_write_b32 a170, v204
v_mfma_f32_16x16x32_bf16 a[100:103], a[232:235], v[232:235], a[100:103]
v_accvgpr_write_b32 a171, v205
v_cvt_pk_bf16_f32 v208, v208, v209
v_mfma_f32_16x16x32_bf16 a[100:103], a[236:239], v[180:183], a[100:103]
ds_read_b64_tr_b16 a[228:229], v241 offset:25280
ds_read_b64_tr_b16 a[230:231], v241 offset:29408
v_mfma_f32_16x16x32_bf16 a[68:71], a[236:239], v[176:179], a[68:71]
v_exp_f32_e64 v140, v140
v_mfma_f32_16x16x32_bf16 a[68:71], a[232:235], v[228:231], a[68:71]
ds_read_b64_tr_b16 a[232:233], v241 offset:17032
ds_read_b64_tr_b16 a[234:235], v241 offset:21160
v_mfma_f32_16x16x32_bf16 a[72:75], a[240:243], v[228:231], a[72:75]
s_add_u32 m0, s32, 0x2040
v_cvt_pk_bf16_f32 v187, v134, v135
v_cvt_pk_bf16_f32 v209, v210, v211
v_mfma_f32_16x16x32_bf16 a[72:75], a[244:247], v[176:179], a[72:75]
buffer_load_dwordx4 v243, s[16:19], s39 offen nt lds
v_mfma_f32_16x16x32_bf16 a[104:107], a[244:247], v[180:183], a[104:107]
v_exp_f32 v141, v141
v_mfma_f32_16x16x32_bf16 a[104:107], a[240:243], v[232:235], a[104:107]
ds_read_b64_tr_b16 a[236:237], v241 offset:25288
ds_read_b64_tr_b16 a[238:239], v241 offset:29416
v_mfma_f32_16x16x32_bf16 a[108:111], a[248:251], v[232:235], a[108:111]
v_exp_f32 v142, v142
v_mfma_f32_16x16x32_bf16 a[108:111], a[252:255], v[180:183], a[108:111]
ds_read_b64_tr_b16 a[240:241], v241 offset:17280
ds_read_b64_tr_b16 a[242:243], v241 offset:21408
v_mfma_f32_16x16x32_bf16 a[76:79], a[252:255], v[176:179], a[76:79]
v_cvt_pk_bf16_f32 v190, v140, v141
v_accvgpr_write_b32 a172, v208
v_mfma_f32_16x16x32_bf16 a[76:79], a[248:251], v[228:231], a[76:79]
ds_read_b64_tr_b16 a[244:245], v241 offset:25536
v_accvgpr_write_b32 a173, v209
v_mfma_f32_16x16x32_bf16 v[144:147], a[192:195], v[32:35], -4.0
v_exp_f32 v143, v143
v_mfma_f32_16x16x32_bf16 v[144:147], a[196:199], v[36:39], v[144:147]
v_exp_f32 v136, v136
v_mfma_f32_16x16x32_bf16 v[144:147], a[200:203], v[40:43], v[144:147]
s_add_u32 m0, s32, 0x2040
v_cvt_pk_bf16_f32 v191, v142, v143
v_cvt_pk_bf16_f32 v212, v212, v213
v_mfma_f32_16x16x32_bf16 v[144:147], a[204:207], v[44:47], v[144:147]
buffer_load_dwordx4 v243, s[24:27], s39 offen offset:1032 nt lds
v_mfma_f32_16x16x32_bf16 v[148:151], a[220:223], v[44:47], -4.0
v_exp_f32 v137, v137
v_mfma_f32_16x16x32_bf16 v[148:151], a[216:219], v[40:43], v[148:151]
v_exp_f32 v138, v138
v_mfma_f32_16x16x32_bf16 v[148:151], a[212:215], v[36:39], v[148:151]
v_cvt_pk_bf16_f32 v188, v136, v137
v_cvt_pk_bf16_f32 v213, v214, v215
v_mfma_f32_16x16x32_bf16 v[148:151], a[208:211], v[32:35], v[148:151]
ds_read_b64_tr_b16 a[246:247], v241 offset:29664
ds_read_b64_tr_b16 a[248:249], v241 offset:17288
v_mfma_f32_16x16x32_bf16 v[156:159], a[208:211], v[48:51], -4.0
v_exp_f32 v139, v139
v_mfma_f32_16x16x32_bf16 v[156:159], a[212:215], v[52:55], v[156:159]
v_cvt_pk_bf16_f32 v189, v138, v139
v_accvgpr_write_b32 a174, v212
v_mfma_f32_16x16x32_bf16 v[156:159], a[216:219], v[56:59], v[156:159]
v_exp_f32 v144, v144
v_mfma_f32_16x16x32_bf16 v[156:159], a[220:223], v[60:63], v[156:159]
ds_read_b64_tr_b16 a[250:251], v241 offset:21416
ds_read_b64_tr_b16 a[252:253], v241 offset:25544
v_mfma_f32_16x16x32_bf16 v[152:155], a[204:207], v[60:63], -4.0
v_exp_f32 v145, v145
v_mfma_f32_16x16x32_bf16 v[152:155], a[200:203], v[56:59], v[152:155]
v_accvgpr_write_b32 a175, v213
v_mfma_f32_16x16x32_bf16 v[152:155], a[196:199], v[52:55], v[152:155]
v_exp_f32 v146, v146
v_mfma_f32_16x16x32_bf16 v[152:155], a[192:195], v[48:51], v[152:155]
ds_read_b64_tr_b16 a[254:255], v241 offset:29672
v_cvt_pk_bf16_f32 v192, v144, v145
v_exp_f32 v147, v147
v_exp_f32 v148, v148
v_pk_mul_f32 v[102:103], v[102:103], v[250:251] op_sel:[0,1] op_sel_hi:[1,1]
v_pk_mul_f32 v[100:101], v[100:101], v[250:251] op_sel:[0,1] op_sel_hi:[1,1]
v_pk_mul_f32 v[98:99], v[98:99], v[250:251] op_sel:[0,1] op_sel_hi:[1,1]
v_pk_mul_f32 v[96:97], v[96:97], v[250:251] op_sel:[0,1] op_sel_hi:[1,1]
v_cvt_pk_bf16_f32 v96, v96, v97
v_smfmac_f32_16x16x64_bf16 v[216:219], v[224:227], v[160:167], v248
s_waitcnt lgkmcnt(3)
ds_read_b128 a[208:211], v240 offset:29120
v_mfma_f32_16x16x32_bf16 a[16:19], a[224:227], v[168:171], a[16:19]
v_cvt_pk_bf16_f32 v193, v146, v147
v_cvt_pk_bf16_f32 v97, v98, v99
v_mfma_f32_16x16x32_bf16 a[16:19], a[228:231], v[160:163], a[16:19]
ds_read_b128 a[212:215], v240 offset:29376
ds_read_b128 a[216:219], v240 offset:29632
v_mfma_f32_16x16x32_bf16 a[48:51], a[228:231], v[164:167], a[48:51]
v_exp_f32 v149, v149
v_mfma_f32_16x16x32_bf16 a[48:51], a[224:227], v[172:175], a[48:51]
ds_read_b128 a[220:223], v240 offset:29888
ds_read_b128 a[204:207], v240 offset:25728
v_mfma_f32_16x16x32_bf16 a[52:55], a[232:235], v[172:175], a[52:55]
v_exp_f32_e64 v150, v150
v_mfma_f32_16x16x32_bf16 a[52:55], a[236:239], v[164:167], a[52:55]
ds_read_b128 a[200:203], v240 offset:25472
v_cvt_pk_bf16_f32 v194, v148, v149
v_mfma_f32_16x16x32_bf16 a[20:23], a[236:239], v[160:163], a[20:23]
v_exp_f32_e64 v151, v151
v_mfma_f32_16x16x32_bf16 a[20:23], a[232:235], v[168:171], a[20:23]
ds_read_b128 a[196:199], v240 offset:25216
v_cvt_pk_bf16_f32 v98, v100, v101
v_mfma_f32_16x16x32_bf16 a[24:27], a[240:243], v[168:171], a[24:27]
ds_read_b128 a[192:195], v240 offset:24960
v_cvt_pk_bf16_f32 v99, v102, v103
v_mfma_f32_16x16x32_bf16 a[24:27], a[244:247], v[160:163], a[24:27]
v_exp_f32 v156, v156
v_cvt_pk_bf16_f32 v195, v150, v151
v_exp_f32 v157, v157
v_pk_mul_f32 v[110:111], v[110:111], v[250:251] op_sel:[0,1] op_sel_hi:[1,1]
v_pk_mul_f32 v[108:109], v[108:109], v[250:251] op_sel:[0,1] op_sel_hi:[1,1]
v_pk_mul_f32 v[106:107], v[106:107], v[250:251] op_sel:[0,1] op_sel_hi:[1,1]
v_pk_mul_f32 v[104:105], v[104:105], v[250:251] op_sel:[0,1] op_sel_hi:[1,1]
v_cvt_pk_bf16_f32 v104, v104, v105
v_mfma_f32_16x16x32_bf16 a[56:59], a[244:247], v[164:167], a[56:59]
v_exp_f32 v158, v158
v_mfma_f32_16x16x32_bf16 a[56:59], a[240:243], v[172:175], a[56:59]
s_waitcnt lgkmcnt(3)
v_cvt_pk_bf16_f32 v198, v156, v157
v_cvt_pk_bf16_f32 v105, v106, v107
v_mfma_f32_16x16x32_bf16 a[60:63], a[248:251], v[172:175], a[60:63]
v_exp_f32 v159, v159
v_mfma_f32_16x16x32_bf16 a[60:63], a[252:255], v[164:167], a[60:63]
v_exp_f32 v152, v152
v_mfma_f32_16x16x32_bf16 a[28:31], a[252:255], v[160:163], a[28:31]
v_cvt_pk_bf16_f32 v199, v158, v159
v_cvt_pk_bf16_f32 v106, v108, v109
v_mfma_f32_16x16x32_bf16 a[28:31], a[248:251], v[168:171], a[28:31]
s_waitcnt lgkmcnt(0)
v_exp_f32 v153, v153
v_mfma_f32_16x16x32_bf16 v[128:131], a[192:195], v[0:3], -4.0
v_exp_f32 v154, v154
v_mfma_f32_16x16x32_bf16 v[128:131], a[196:199], v[4:7], v[128:131]
v_cvt_pk_bf16_f32 v196, v152, v153
v_cvt_pk_bf16_f32 v107, v110, v111
v_mfma_f32_16x16x32_bf16 v[128:131], a[200:203], v[8:11], v[128:131]
v_exp_f32 v155, v155
v_mfma_f32_16x16x32_bf16 v[128:131], a[204:207], v[12:15], v[128:131]
v_cvt_pk_bf16_f32 v197, v154, v155
v_mov_b64_e64 v[108:109], v[96:97]
v_mfma_f32_16x16x32_bf16 v[132:135], a[220:223], v[12:15], -4.0
v_mov_b64 v[110:111], v[98:99]
v_mov_b32_dpp v96, v104 row_ror:8 row_mask:0xf bank_mask:0xc
v_mfma_f32_16x16x32_bf16 v[132:135], a[216:219], v[8:11], v[132:135]
v_mov_b32_dpp v97, v105 row_ror:8 row_mask:0xf bank_mask:0xc
v_mov_b32_dpp v98, v106 row_ror:8 row_mask:0xf bank_mask:0xc
v_mfma_f32_16x16x32_bf16 v[132:135], a[212:215], v[4:7], v[132:135]
v_exp_f32 v128, v128
v_mfma_f32_16x16x32_bf16 v[132:135], a[208:211], v[0:3], v[132:135]
v_exp_f32 v129, v129
v_mfma_f32_16x16x32_bf16 v[140:143], a[208:211], v[16:19], -4.0
v_exp_f32 v130, v130
v_mfma_f32_16x16x32_bf16 v[140:143], a[212:215], v[20:23], v[140:143]
v_cvt_pk_bf16_f32 v160, v128, v129
v_mov_b32_dpp v99, v107 row_ror:8 row_mask:0xf bank_mask:0xc
v_mfma_f32_16x16x32_bf16 v[140:143], a[216:219], v[24:27], v[140:143]
v_exp_f32_e64 v131, v131
v_mfma_f32_16x16x32_bf16 v[140:143], a[220:223], v[28:31], v[140:143]
s_add_u32 m0, s31, 0x4100
v_exp_f32 v132, v132
v_mfma_f32_16x16x32_bf16 v[136:139], a[204:207], v[28:31], -4.0
v_cvt_pk_bf16_f32 v161, v130, v131
v_mov_b32_dpp v104, v108 row_ror:8 row_mask:0xf bank_mask:0x3
v_mfma_f32_16x16x32_bf16 v[136:139], a[200:203], v[24:27], v[136:139]
v_exp_f32 v133, v133
v_mfma_f32_16x16x32_bf16 v[136:139], a[196:199], v[20:23], v[136:139]
s_waitcnt vmcnt(21)
v_exp_f32 v134, v134
v_mfma_f32_16x16x32_bf16 v[136:139], a[192:195], v[16:19], v[136:139]
s_barrier
v_smfmac_f32_16x16x64_bf16 v[220:223], v[224:227], v[176:183], v248
buffer_load_dwordx4 v243, s[12:15], s38 offen nt lds
v_mfma_f32_16x16x32_bf16 a[80:83], a[224:227], v[228:231], a[80:83]
v_cvt_pk_bf16_f32 v162, v132, v133
v_mov_b32_dpp v105, v109 row_ror:8 row_mask:0xf bank_mask:0x3
v_mfma_f32_16x16x32_bf16 a[80:83], a[228:231], v[176:179], a[80:83]
v_exp_f32 v135, v135
v_mfma_f32_16x16x32_bf16 a[112:115], a[228:231], v[180:183], a[112:115]
v_exp_f32_e64 v140, v140
v_mfma_f32_16x16x32_bf16 a[112:115], a[224:227], v[232:235], a[112:115]
ds_read_b64_tr_b16 a[224:225], v241 offset:33024
ds_read_b64_tr_b16 a[226:227], v241 offset:37152
v_mfma_f32_16x16x32_bf16 a[116:119], a[232:235], v[232:235], a[116:119]
v_cvt_pk_bf16_f32 v163, v134, v135
v_mov_b32_dpp v106, v110 row_ror:8 row_mask:0xf bank_mask:0x3
v_mfma_f32_16x16x32_bf16 a[116:119], a[236:239], v[180:183], a[116:119]
buffer_store_dwordx4 v[96:99], v249, s[20:23], s58 offen sc1
v_mfma_f32_16x16x32_bf16 a[84:87], a[236:239], v[176:179], a[84:87]
v_exp_f32_e64 v141, v141
v_mfma_f32_16x16x32_bf16 a[84:87], a[232:235], v[228:231], a[84:87]
ds_read_b64_tr_b16 a[228:229], v241 offset:41280
ds_read_b64_tr_b16 a[230:231], v241 offset:45408
v_mfma_f32_16x16x32_bf16 a[88:91], a[240:243], v[228:231], a[88:91]
s_add_u32 m0, s31, 0x4100
v_exp_f32_e64 v142, v142
v_mfma_f32_16x16x32_bf16 a[88:91], a[244:247], v[176:179], a[88:91]
ds_read_b64_tr_b16 a[232:233], v241 offset:33032
ds_read_b64_tr_b16 a[234:235], v241 offset:37160
v_mfma_f32_16x16x32_bf16 a[120:123], a[244:247], v[180:183], a[120:123]
v_cvt_pk_bf16_f32 v166, v140, v141
v_mov_b32_dpp v107, v111 row_ror:8 row_mask:0xf bank_mask:0x3
v_mfma_f32_16x16x32_bf16 a[120:123], a[240:243], v[232:235], a[120:123]
ds_read_b64_tr_b16 a[236:237], v241 offset:41288
v_exp_f32 v143, v143
v_exp_f32 v136, v136
v_pk_mul_f32 v[118:119], v[118:119], v[250:251] op_sel:[0,1] op_sel_hi:[1,1]
v_pk_mul_f32 v[116:117], v[116:117], v[250:251] op_sel:[0,1] op_sel_hi:[1,1]
v_pk_mul_f32 v[114:115], v[114:115], v[250:251] op_sel:[0,1] op_sel_hi:[1,1]
v_pk_mul_f32 v[112:113], v[112:113], v[250:251] op_sel:[0,1] op_sel_hi:[1,1]
v_cvt_pk_bf16_f32 v112, v112, v113
v_mfma_f32_16x16x32_bf16 a[124:127], a[248:251], v[232:235], a[124:127]
v_cvt_pk_bf16_f32 v167, v142, v143
v_cvt_pk_bf16_f32 v113, v114, v115
v_mfma_f32_16x16x32_bf16 a[124:127], a[252:255], v[180:183], a[124:127]
ds_read_b64_tr_b16 a[238:239], v241 offset:45416
ds_read_b64_tr_b16 a[240:241], v241 offset:33280
v_mfma_f32_16x16x32_bf16 a[92:95], a[252:255], v[176:179], a[92:95]
v_exp_f32_e64 v137, v137
v_mfma_f32_16x16x32_bf16 a[92:95], a[248:251], v[228:231], a[92:95]
buffer_load_dwordx4 v243, s[12:15], s38 offen offset:1024 nt lds
v_mfma_f32_16x16x32_bf16 v[144:147], a[192:195], v[32:35], -4.0
s_xor_b32 s38, s29, 0x1808000
v_exp_f32_e64 v138, v138
v_mfma_f32_16x16x32_bf16 v[144:147], a[196:199], v[36:39], v[144:147]
s_xor_b32 s39, s29, 0x1804000
v_cvt_pk_bf16_f32 v164, v136, v137
v_cvt_pk_bf16_f32 v114, v116, v117
v_mfma_f32_16x16x32_bf16 v[144:147], a[200:203], v[40:43], v[144:147]
v_exp_f32_e64 v139, v139
v_mfma_f32_16x16x32_bf16 v[144:147], a[204:207], v[44:47], v[144:147]
ds_read_b64_tr_b16 a[242:243], v241 offset:37408
ds_read_b64_tr_b16 a[244:245], v241 offset:41536
v_mfma_f32_16x16x32_bf16 v[148:151], a[220:223], v[44:47], -4.0
v_cvt_pk_bf16_f32 v165, v138, v139
v_cvt_pk_bf16_f32 v115, v118, v119
v_mfma_f32_16x16x32_bf16 v[148:151], a[216:219], v[40:43], v[148:151]
ds_read_b64_tr_b16 a[246:247], v241 offset:45664
ds_read_b64_tr_b16 a[248:249], v241 offset:33288
v_mfma_f32_16x16x32_bf16 v[148:151], a[212:215], v[36:39], v[148:151]
v_exp_f32_e64 v144, v144
v_mfma_f32_16x16x32_bf16 v[148:151], a[208:211], v[32:35], v[148:151]
buffer_store_dwordx4 v[104:107], v249, s[20:23], s58 offen offset:2048 sc1
v_mfma_f32_16x16x32_bf16 v[156:159], a[208:211], v[48:51], -4.0
s_add_u32 m0, s31, 0x6180
v_exp_f32 v145, v145
v_mfma_f32_16x16x32_bf16 v[156:159], a[212:215], v[52:55], v[156:159]
v_exp_f32 v146, v146
v_mfma_f32_16x16x32_bf16 v[156:159], a[216:219], v[56:59], v[156:159]
v_exp_f32_e64 v147, v147
v_mfma_f32_16x16x32_bf16 v[156:159], a[220:223], v[60:63], v[156:159]
ds_read_b64_tr_b16 a[250:251], v241 offset:37416
v_cvt_pk_bf16_f32 v168, v144, v145
v_exp_f32_e64 v148, v148
v_cvt_pk_bf16_f32 v169, v146, v147
v_pk_mul_f32 v[126:127], v[126:127], v[250:251] op_sel:[0,1] op_sel_hi:[1,1]
v_pk_mul_f32 v[124:125], v[124:125], v[250:251] op_sel:[0,1] op_sel_hi:[1,1]
v_pk_mul_f32 v[122:123], v[122:123], v[250:251] op_sel:[0,1] op_sel_hi:[1,1]
v_pk_mul_f32 v[120:121], v[120:121], v[250:251] op_sel:[0,1] op_sel_hi:[1,1]
v_cvt_pk_bf16_f32 v120, v120, v121
v_mfma_f32_16x16x32_bf16 v[152:155], a[204:207], v[60:63], -4.0
v_exp_f32 v149, v149
v_mfma_f32_16x16x32_bf16 v[152:155], a[200:203], v[56:59], v[152:155]
v_exp_f32 v150, v150
v_mfma_f32_16x16x32_bf16 v[152:155], a[196:199], v[52:55], v[152:155]
v_cvt_pk_bf16_f32 v170, v148, v149
v_cvt_pk_bf16_f32 v121, v122, v123
v_mfma_f32_16x16x32_bf16 v[152:155], a[192:195], v[48:51], v[152:155]
ds_read_b64_tr_b16 a[252:253], v241 offset:41544
ds_read_b64_tr_b16 a[254:255], v241 offset:45672
v_smfmac_f32_16x16x64_bf16 v[216:219], v[224:227], v[184:191], v248
L_pad14:
s_cbranch_vccnz L_pad18
s_waitcnt lgkmcnt(3)
ds_read_b128 a[208:211], v240 offset:37440
v_mfma_f32_16x16x32_bf16 a[0:3], a[224:227], v[184:187], a[0:3]
v_exp_f32_e64 v151, v151
v_mfma_f32_16x16x32_bf16 a[0:3], a[228:231], v[160:163], a[0:3]
buffer_load_dwordx4 v243, s[12:15], s38 offen nt lds
v_mfma_f32_16x16x32_bf16 a[32:35], a[228:231], v[164:167], a[32:35]
ds_read_b128 a[212:215], v240 offset:37696
v_cvt_pk_bf16_f32 v122, v124, v125
v_mfma_f32_16x16x32_bf16 a[32:35], a[224:227], v[188:191], a[32:35]
ds_read_b128 a[216:219], v240 offset:37952
ds_read_b128 a[220:223], v240 offset:38208
v_mfma_f32_16x16x32_bf16 a[36:39], a[232:235], v[188:191], a[36:39]
v_exp_f32_e64 v156, v156
v_mfma_f32_16x16x32_bf16 a[36:39], a[236:239], v[164:167], a[36:39]
ds_read_b128 a[204:207], v240 offset:34048
ds_read_b128 a[200:203], v240 offset:33792
v_mfma_f32_16x16x32_bf16 a[4:7], a[236:239], v[160:163], a[4:7]
v_cvt_pk_bf16_f32 v171, v150, v151
v_cvt_pk_bf16_f32 v123, v126, v127
v_mfma_f32_16x16x32_bf16 a[4:7], a[232:235], v[184:187], a[4:7]
ds_read_b128 a[196:199], v240 offset:33536
v_mov_b64 v[124:125], v[112:113]
v_mfma_f32_16x16x32_bf16 a[8:11], a[240:243], v[184:187], a[8:11]
ds_read_b128 a[192:195], v240 offset:33280
v_mov_b64 v[126:127], v[114:115]
v_mfma_f32_16x16x32_bf16 a[8:11], a[244:247], v[160:163], a[8:11]
v_exp_f32 v157, v157
v_mfma_f32_16x16x32_bf16 a[40:43], a[244:247], v[164:167], a[40:43]
s_add_u32 m0, s31, 0x6180
v_exp_f32 v158, v158
v_mfma_f32_16x16x32_bf16 a[40:43], a[240:243], v[188:191], a[40:43]
s_waitcnt lgkmcnt(4)
buffer_load_dwordx4 v243, s[12:15], s38 offen offset:1024 nt lds
v_mfma_f32_16x16x32_bf16 a[44:47], a[248:251], v[188:191], a[44:47]
v_cvt_pk_bf16_f32 v174, v156, v157
v_mov_b32_dpp v112, v120 row_ror:8 row_mask:0xf bank_mask:0xc
v_mfma_f32_16x16x32_bf16 a[44:47], a[252:255], v[164:167], a[44:47]
v_exp_f32 v159, v159
v_mfma_f32_16x16x32_bf16 a[12:15], a[252:255], v[160:163], a[12:15]
v_exp_f32_e64 v152, v152
v_mfma_f32_16x16x32_bf16 a[12:15], a[248:251], v[184:187], a[12:15]
s_waitcnt lgkmcnt(0)
v_cvt_pk_bf16_f32 v175, v158, v159
v_mov_b32_dpp v113, v121 row_ror:8 row_mask:0xf bank_mask:0xc
v_mfma_f32_16x16x32_bf16 v[128:131], a[192:195], v[0:3], -4.0
v_exp_f32 v153, v153
v_mfma_f32_16x16x32_bf16 v[128:131], a[196:199], v[4:7], v[128:131]
v_exp_f32_e64 v154, v154
v_mfma_f32_16x16x32_bf16 v[128:131], a[200:203], v[8:11], v[128:131]
v_cvt_pk_bf16_f32 v172, v152, v153
v_mov_b32_dpp v114, v122 row_ror:8 row_mask:0xf bank_mask:0xc
v_mfma_f32_16x16x32_bf16 v[128:131], a[204:207], v[12:15], v[128:131]
v_exp_f32_e64 v155, v155
v_mfma_f32_16x16x32_bf16 v[132:135], a[220:223], v[12:15], -4.0
s_add_u32 m0, s32, 0x4080
v_cvt_pk_bf16_f32 v173, v154, v155
v_mov_b32_dpp v115, v123 row_ror:8 row_mask:0xf bank_mask:0xc
v_mfma_f32_16x16x32_bf16 v[132:135], a[216:219], v[8:11], v[132:135]
v_mov_b32_dpp v120, v124 row_ror:8 row_mask:0xf bank_mask:0x3
v_mov_b32_dpp v121, v125 row_ror:8 row_mask:0xf bank_mask:0x3
v_mfma_f32_16x16x32_bf16 v[132:135], a[212:215], v[4:7], v[132:135]
v_exp_f32 v128, v128
v_mfma_f32_16x16x32_bf16 v[132:135], a[208:211], v[0:3], v[132:135]
buffer_load_dwordx4 v243, s[16:19], s39 offen nt lds
v_mfma_f32_16x16x32_bf16 v[140:143], a[208:211], v[16:19], -4.0
v_exp_f32 v129, v129
v_mfma_f32_16x16x32_bf16 v[140:143], a[212:215], v[20:23], v[140:143]
s_waitcnt vmcnt(17)
v_exp_f32 v130, v130
v_mfma_f32_16x16x32_bf16 v[140:143], a[216:219], v[24:27], v[140:143]
v_cvt_pk_bf16_f32 v176, v128, v129
v_mov_b32_dpp v122, v126 row_ror:8 row_mask:0xf bank_mask:0x3
v_mfma_f32_16x16x32_bf16 v[140:143], a[220:223], v[28:31], v[140:143]
ds_read_b128 v[202:205], v242 offset:4160
v_mov_b32_dpp v123, v127 row_ror:8 row_mask:0xf bank_mask:0x3
v_mfma_f32_16x16x32_bf16 v[136:139], a[204:207], v[28:31], -4.0
v_exp_f32 v131, v131
v_mfma_f32_16x16x32_bf16 v[136:139], a[200:203], v[24:27], v[136:139]
v_exp_f32 v132, v132
v_mfma_f32_16x16x32_bf16 v[136:139], a[196:199], v[20:23], v[136:139]
v_exp_f32_e64 v133, v133
v_mfma_f32_16x16x32_bf16 v[136:139], a[192:195], v[16:19], v[136:139]
buffer_store_dwordx4 v[112:115], v249, s[20:23], s58 offen offset:128 sc1
v_smfmac_f32_16x16x64_bf16 v[220:223], v[224:227], v[192:199], v248
s_add_u32 m0, s32, 0x4080
ds_read_b128 v[210:213], v242 offset:4416
v_mfma_f32_16x16x32_bf16 a[64:67], a[224:227], v[192:195], a[64:67]
v_exp_f32 v134, v134
v_mfma_f32_16x16x32_bf16 a[64:67], a[228:231], v[168:171], a[64:67]
s_waitcnt lgkmcnt(1)
v_cvt_pk_bf16_f32 v177, v130, v131
v_cvt_pk_bf16_f32 v178, v132, v133
v_mfma_f32_16x16x32_bf16 a[96:99], a[228:231], v[172:175], a[96:99]
v_exp_f32 v135, v135
v_mfma_f32_16x16x32_bf16 a[96:99], a[224:227], v[196:199], a[96:99]
ds_read_b64_tr_b16 a[224:225], v241 offset:33536
ds_read_b64_tr_b16 a[226:227], v241 offset:37664
v_mfma_f32_16x16x32_bf16 a[100:103], a[232:235], v[196:199], a[100:103]
v_exp_f32 v140, v140
v_mfma_f32_16x16x32_bf16 a[100:103], a[236:239], v[172:175], a[100:103]
ds_read_b64_tr_b16 a[228:229], v241 offset:41792
ds_read_b64_tr_b16 a[230:231], v241 offset:45920
v_mfma_f32_16x16x32_bf16 a[68:71], a[236:239], v[168:171], a[68:71]
s_waitcnt lgkmcnt(4)
v_cvt_pk_bf16_f32 v179, v134, v135
v_mov_b64 v[200:201], v[202:203]
v_mfma_f32_16x16x32_bf16 a[68:71], a[232:235], v[192:195], a[68:71]
ds_read_b64_tr_b16 a[232:233], v241 offset:33544
ds_read_b64_tr_b16 a[234:235], v241 offset:37672
v_mfma_f32_16x16x32_bf16 a[72:75], a[240:243], v[192:195], a[72:75]
v_exp_f32_e64 v141, v141
v_mfma_f32_16x16x32_bf16 a[72:75], a[244:247], v[168:171], a[72:75]
buffer_load_dwordx4 v243, s[24:27], s39 offen offset:1032 nt lds
v_mfma_f32_16x16x32_bf16 a[104:107], a[244:247], v[172:175], a[104:107]
s_xor_b32 s39, s29, 0x1806000
v_exp_f32_e64 v142, v142
v_mfma_f32_16x16x32_bf16 a[104:107], a[240:243], v[196:199], a[104:107]
s_xor_b32 s38, s29, 0x180a000
ds_read_b64_tr_b16 a[236:237], v241 offset:41800
ds_read_b64_tr_b16 a[238:239], v241 offset:45928
v_mfma_f32_16x16x32_bf16 a[108:111], a[248:251], v[196:199], a[108:111]
v_cvt_pk_bf16_f32 v182, v140, v141
v_mov_b64 v[206:207], v[204:205]
v_mfma_f32_16x16x32_bf16 a[108:111], a[252:255], v[172:175], a[108:111]
ds_read_b64_tr_b16 a[240:241], v241 offset:33792
ds_read_b64_tr_b16 a[242:243], v241 offset:37920
v_mfma_f32_16x16x32_bf16 a[76:79], a[252:255], v[168:171], a[76:79]
v_exp_f32 v143, v143
v_mfma_f32_16x16x32_bf16 a[76:79], a[248:251], v[192:195], a[76:79]
buffer_store_dwordx4 v[120:123], v249, s[20:23], s58 offen offset:2176 sc1
v_mfma_f32_16x16x32_bf16 v[200:203], v[236:239], v[200:203], 0
s_xor_b32 s57, s28, 0x2000000
ds_read_b64_tr_b16 a[244:245], v241 offset:42048
v_mov_b64_e64 v[208:209], v[210:211]
v_mfma_f32_16x16x32_bf16 v[204:207], v[236:239], v[204:207], 0
s_xor_b32 s58, s28, 0x2001000
ds_read_b64_tr_b16 a[246:247], v241 offset:46176
v_mov_b64 v[214:215], v[212:213]
v_mfma_f32_16x16x32_bf16 v[144:147], a[192:195], v[32:35], -4.0
v_exp_f32 v136, v136
v_mfma_f32_16x16x32_bf16 v[144:147], a[196:199], v[36:39], v[144:147]
v_cvt_pk_bf16_f32 v183, v142, v143
v_cvt_pk_bf16_f32 v200, v200, v201
v_mfma_f32_16x16x32_bf16 v[144:147], a[200:203], v[40:43], v[144:147]
s_add_u32 m0, s32, 0x60c0
v_exp_f32 v137, v137
v_mfma_f32_16x16x32_bf16 v[144:147], a[204:207], v[44:47], v[144:147]
ds_read_b64_tr_b16 a[248:249], v241 offset:33800
v_cvt_pk_bf16_f32 v201, v202, v203
v_accvgpr_write_b32 a176, v200
v_mfma_f32_16x16x32_bf16 v[148:151], a[220:223], v[44:47], -4.0
v_exp_f32 v138, v138
v_mfma_f32_16x16x32_bf16 v[148:151], a[216:219], v[40:43], v[148:151]
v_cvt_pk_bf16_f32 v180, v136, v137
v_accvgpr_write_b32 a177, v201
v_mfma_f32_16x16x32_bf16 v[148:151], a[212:215], v[36:39], v[148:151]
v_exp_f32_e64 v139, v139
v_mfma_f32_16x16x32_bf16 v[148:151], a[208:211], v[32:35], v[148:151]
ds_read_b64_tr_b16 a[250:251], v241 offset:37928
ds_read_b64_tr_b16 a[252:253], v241 offset:42056
v_mfma_f32_16x16x32_bf16 v[156:159], a[208:211], v[48:51], -4.0
v_cvt_pk_bf16_f32 v181, v138, v139
v_cvt_pk_bf16_f32 v204, v204, v205
v_mfma_f32_16x16x32_bf16 v[156:159], a[212:215], v[52:55], v[156:159]
v_exp_f32 v144, v144
v_mfma_f32_16x16x32_bf16 v[156:159], a[216:219], v[56:59], v[156:159]
v_exp_f32 v145, v145
v_mfma_f32_16x16x32_bf16 v[156:159], a[220:223], v[60:63], v[156:159]
buffer_load_dwordx4 v243, s[16:19], s39 offen nt lds
v_mfma_f32_16x16x32_bf16 v[152:155], a[204:207], v[60:63], -4.0
v_exp_f32_e64 v146, v146
v_mfma_f32_16x16x32_bf16 v[152:155], a[200:203], v[56:59], v[152:155]
v_cvt_pk_bf16_f32 v228, v144, v145
v_cvt_pk_bf16_f32 v205, v206, v207
v_mfma_f32_16x16x32_bf16 v[152:155], a[196:199], v[52:55], v[152:155]
v_exp_f32 v147, v147
v_mfma_f32_16x16x32_bf16 v[152:155], a[192:195], v[48:51], v[152:155]
ds_read_b64_tr_b16 a[254:255], v241 offset:46184
ds_read_b128 a[208:211], v240 offset:45760
v_mfma_f32_16x16x32_bf16 v[208:211], v[236:239], v[208:211], 0
ds_read_b128 a[212:215], v240 offset:46016
ds_read_b128 a[216:219], v240 offset:46272
v_mfma_f32_16x16x32_bf16 v[212:215], v[236:239], v[212:215], 0
ds_read_b128 a[220:223], v240 offset:46528
v_accvgpr_write_b32 a178, v204
v_smfmac_f32_16x16x64_bf16 v[216:219], v[224:227], v[160:167], v248
s_waitcnt lgkmcnt(5)
ds_read_b128 a[204:207], v240 offset:42368
v_mfma_f32_16x16x32_bf16 a[16:19], a[224:227], v[184:187], a[16:19]
v_accvgpr_write_b32 a179, v205
v_cvt_pk_bf16_f32 v208, v208, v209
v_mfma_f32_16x16x32_bf16 a[16:19], a[228:231], v[160:163], a[16:19]
ds_read_b128 a[200:203], v240 offset:42112
v_cvt_pk_bf16_f32 v209, v210, v211
v_mfma_f32_16x16x32_bf16 a[48:51], a[228:231], v[164:167], a[48:51]
v_exp_f32_e64 v148, v148
v_mfma_f32_16x16x32_bf16 a[48:51], a[224:227], v[188:191], a[48:51]
s_add_u32 m0, s32, 0x60c0
ds_read_b128 a[196:199], v240 offset:41856
v_cvt_pk_bf16_f32 v229, v146, v147
v_mfma_f32_16x16x32_bf16 a[52:55], a[232:235], v[188:191], a[52:55]
v_exp_f32_e64 v149, v149
v_mfma_f32_16x16x32_bf16 a[52:55], a[236:239], v[164:167], a[52:55]
buffer_load_dwordx4 v243, s[24:27], s39 offen offset:1032 nt lds
v_mfma_f32_16x16x32_bf16 a[20:23], a[236:239], v[160:163], a[20:23]
v_exp_f32 v150, v150
v_mfma_f32_16x16x32_bf16 a[20:23], a[232:235], v[184:187], a[20:23]
ds_read_b128 a[192:195], v240 offset:41600
v_cvt_pk_bf16_f32 v230, v148, v149
v_mfma_f32_16x16x32_bf16 a[24:27], a[240:243], v[184:187], a[24:27]
v_exp_f32 v151, v151
v_mfma_f32_16x16x32_bf16 a[24:27], a[244:247], v[160:163], a[24:27]
ds_read_b128 v[202:205], v242 offset:4672
v_accvgpr_write_b32 a180, v208
v_mfma_f32_16x16x32_bf16 a[56:59], a[244:247], v[164:167], a[56:59]
v_exp_f32 v156, v156
v_mfma_f32_16x16x32_bf16 a[56:59], a[240:243], v[188:191], a[56:59]
v_cvt_pk_bf16_f32 v231, v150, v151
v_accvgpr_write_b32 a181, v209
v_mfma_f32_16x16x32_bf16 a[60:63], a[248:251], v[188:191], a[60:63]
s_waitcnt lgkmcnt(2)
v_exp_f32_e64 v157, v157
v_mfma_f32_16x16x32_bf16 a[60:63], a[252:255], v[164:167], a[60:63]
v_exp_f32 v158, v158
v_mfma_f32_16x16x32_bf16 a[28:31], a[252:255], v[160:163], a[28:31]
v_cvt_pk_bf16_f32 v234, v156, v157
v_cvt_pk_bf16_f32 v212, v212, v213
v_mfma_f32_16x16x32_bf16 a[28:31], a[248:251], v[184:187], a[28:31]
s_waitcnt lgkmcnt(1)
v_exp_f32 v159, v159
v_mfma_f32_16x16x32_bf16 v[128:131], a[192:195], v[0:3], -4.0
s_waitcnt lgkmcnt(0)
v_exp_f32 v152, v152
v_mfma_f32_16x16x32_bf16 v[128:131], a[196:199], v[4:7], v[128:131]
v_cvt_pk_bf16_f32 v235, v158, v159
v_mov_b64 v[200:201], v[202:203]
v_mfma_f32_16x16x32_bf16 v[128:131], a[200:203], v[8:11], v[128:131]
v_exp_f32 v153, v153
v_mfma_f32_16x16x32_bf16 v[128:131], a[204:207], v[12:15], v[128:131]
v_exp_f32 v154, v154
v_mfma_f32_16x16x32_bf16 v[132:135], a[220:223], v[12:15], -4.0
v_cvt_pk_bf16_f32 v232, v152, v153
v_mov_b64 v[206:207], v[204:205]
v_mfma_f32_16x16x32_bf16 v[132:135], a[216:219], v[8:11], v[132:135]
v_exp_f32 v155, v155
v_mfma_f32_16x16x32_bf16 v[132:135], a[212:215], v[4:7], v[132:135]
v_cvt_pk_bf16_f32 v233, v154, v155
v_cvt_pk_bf16_f32 v213, v214, v215
v_mfma_f32_16x16x32_bf16 v[132:135], a[208:211], v[0:3], v[132:135]
v_exp_f32_e64 v128, v128
v_mfma_f32_16x16x32_bf16 v[140:143], a[208:211], v[16:19], -4.0
v_accvgpr_write_b32 a182, v212
v_accvgpr_write_b32 a183, v213
v_mfma_f32_16x16x32_bf16 v[140:143], a[212:215], v[20:23], v[140:143]
v_exp_f32 v129, v129
v_mfma_f32_16x16x32_bf16 v[140:143], a[216:219], v[24:27], v[140:143]
v_exp_f32 v130, v130
v_mfma_f32_16x16x32_bf16 v[140:143], a[220:223], v[28:31], v[140:143]
s_add_u32 m0, s31, 0x8200
ds_read_b128 v[210:213], v242 offset:4928
v_cvt_pk_bf16_f32 v160, v128, v129
v_mfma_f32_16x16x32_bf16 v[136:139], a[204:207], v[28:31], -4.0
v_exp_f32 v131, v131
v_mfma_f32_16x16x32_bf16 v[136:139], a[200:203], v[24:27], v[136:139]
v_exp_f32 v132, v132
v_mfma_f32_16x16x32_bf16 v[136:139], a[196:199], v[20:23], v[136:139]
s_waitcnt vmcnt(19)
v_exp_f32_e64 v133, v133
v_mfma_f32_16x16x32_bf16 v[136:139], a[192:195], v[16:19], v[136:139]
s_barrier
v_smfmac_f32_16x16x64_bf16 v[220:223], v[224:227], v[168:175], v248
buffer_load_dwordx4 v243, s[12:15], s38 offen nt lds
v_mfma_f32_16x16x32_bf16 v[200:203], v[236:239], v[200:203], 0
v_exp_f32 v134, v134
v_mfma_f32_16x16x32_bf16 v[204:207], v[236:239], v[204:207], 0
v_cvt_pk_bf16_f32 v161, v130, v131
v_cvt_pk_bf16_f32 v162, v132, v133
v_mfma_f32_16x16x32_bf16 a[80:83], a[224:227], v[192:195], a[80:83]
v_exp_f32 v135, v135
v_mfma_f32_16x16x32_bf16 a[80:83], a[228:231], v[168:171], a[80:83]
s_waitcnt lgkmcnt(0)
v_mov_b64 v[208:209], v[210:211]
v_mov_b64_e64 v[214:215], v[212:213]
v_cvt_pk_bf16_f32 v200, v200, v201
v_mfma_f32_16x16x32_bf16 a[112:115], a[228:231], v[172:175], a[112:115]
v_cvt_pk_bf16_f32 v201, v202, v203
v_accvgpr_write_b32 a184, v200
v_mfma_f32_16x16x32_bf16 a[112:115], a[224:227], v[196:199], a[112:115]
ds_read_b64_tr_b16 a[224:225], v241 offset:49536
ds_read_b64_tr_b16 a[226:227], v241 offset:53664
v_mfma_f32_16x16x32_bf16 a[116:119], a[232:235], v[196:199], a[116:119]
v_exp_f32_e64 v140, v140
v_mfma_f32_16x16x32_bf16 a[116:119], a[236:239], v[172:175], a[116:119]
ds_read_b64_tr_b16 a[228:229], v241 offset:57792
ds_read_b64_tr_b16 a[230:231], v241 offset:61920
v_accvgpr_write_b32 a185, v201
v_mfma_f32_16x16x32_bf16 a[84:87], a[236:239], v[168:171], a[84:87]
v_cvt_pk_bf16_f32 v163, v134, v135
v_cvt_pk_bf16_f32 v204, v204, v205
v_mfma_f32_16x16x32_bf16 a[84:87], a[232:235], v[192:195], a[84:87]
ds_read_b64_tr_b16 a[232:233], v241 offset:49544
ds_read_b64_tr_b16 a[234:235], v241 offset:53672
v_mfma_f32_16x16x32_bf16 a[88:91], a[240:243], v[192:195], a[88:91]
s_add_u32 m0, s31, 0x8200
v_exp_f32 v141, v141
v_mfma_f32_16x16x32_bf16 a[88:91], a[244:247], v[168:171], a[88:91]
buffer_load_dwordx4 v243, s[12:15], s38 offen offset:1024 nt lds
v_mfma_f32_16x16x32_bf16 a[120:123], a[244:247], v[172:175], a[120:123]
s_xor_b32 s38, s29, 0x180c000
v_exp_f32 v142, v142
v_mfma_f32_16x16x32_bf16 a[120:123], a[240:243], v[196:199], a[120:123]
s_xor_b32 s39, s29, 0x1808000
ds_read_b64_tr_b16 a[236:237], v241 offset:57800
ds_read_b64_tr_b16 a[238:239], v241 offset:61928
v_mfma_f32_16x16x32_bf16 a[124:127], a[248:251], v[196:199], a[124:127]
v_cvt_pk_bf16_f32 v166, v140, v141
v_cvt_pk_bf16_f32 v205, v206, v207
v_mfma_f32_16x16x32_bf16 a[124:127], a[252:255], v[172:175], a[124:127]
ds_read_b64_tr_b16 a[240:241], v241 offset:49792
ds_read_b64_tr_b16 a[242:243], v241 offset:53920
v_mfma_f32_16x16x32_bf16 a[92:95], a[252:255], v[168:171], a[92:95]
v_exp_f32_e64 v143, v143
v_mfma_f32_16x16x32_bf16 a[92:95], a[248:251], v[192:195], a[92:95]
ds_read_b64_tr_b16 a[244:245], v241 offset:58048
v_accvgpr_write_b32 a186, v204
v_mfma_f32_16x16x32_bf16 v[208:211], v[236:239], v[208:211], 0
ds_read_b64_tr_b16 a[246:247], v241 offset:62176
v_accvgpr_write_b32 a187, v205
v_mfma_f32_16x16x32_bf16 v[212:215], v[236:239], v[212:215], 0
ds_read_b64_tr_b16 a[248:249], v241 offset:49800
ds_read_b64_tr_b16 a[250:251], v241 offset:53928
v_mfma_f32_16x16x32_bf16 v[144:147], a[192:195], v[32:35], -4.0
v_exp_f32_e64 v136, v136
v_mfma_f32_16x16x32_bf16 v[144:147], a[196:199], v[36:39], v[144:147]
v_cvt_pk_bf16_f32 v167, v142, v143
v_cvt_pk_bf16_f32 v208, v208, v209
v_mfma_f32_16x16x32_bf16 v[144:147], a[200:203], v[40:43], v[144:147]
s_add_u32 m0, s31, 0xa280
v_exp_f32 v137, v137
v_mfma_f32_16x16x32_bf16 v[144:147], a[204:207], v[44:47], v[144:147]
buffer_load_dwordx4 v243, s[12:15], s38 offen nt lds
v_mfma_f32_16x16x32_bf16 v[148:151], a[220:223], v[44:47], -4.0
v_exp_f32 v138, v138
v_mfma_f32_16x16x32_bf16 v[148:151], a[216:219], v[40:43], v[148:151]
v_cvt_pk_bf16_f32 v164, v136, v137
v_cvt_pk_bf16_f32 v209, v210, v211
v_mfma_f32_16x16x32_bf16 v[148:151], a[212:215], v[36:39], v[148:151]
v_exp_f32 v139, v139
v_mfma_f32_16x16x32_bf16 v[148:151], a[208:211], v[32:35], v[148:151]
ds_read_b64_tr_b16 a[252:253], v241 offset:58056
v_cvt_pk_bf16_f32 v165, v138, v139
v_mfma_f32_16x16x32_bf16 v[156:159], a[208:211], v[48:51], -4.0
v_exp_f32 v144, v144
v_mfma_f32_16x16x32_bf16 v[156:159], a[212:215], v[52:55], v[156:159]
v_exp_f32_e64 v145, v145
v_mfma_f32_16x16x32_bf16 v[156:159], a[216:219], v[56:59], v[156:159]
v_exp_f32_e64 v146, v146
v_mfma_f32_16x16x32_bf16 v[156:159], a[220:223], v[60:63], v[156:159]
ds_read_b64_tr_b16 a[254:255], v241 offset:62184
ds_read_b128 a[208:211], v240 offset:54080
v_mfma_f32_16x16x32_bf16 v[152:155], a[204:207], v[60:63], -4.0
s_add_u32 m0, s31, 0xa280
v_cvt_pk_bf16_f32 v184, v144, v145
v_accvgpr_write_b32 a188, v208
v_mfma_f32_16x16x32_bf16 v[152:155], a[200:203], v[56:59], v[152:155]
v_exp_f32_e64 v147, v147
v_mfma_f32_16x16x32_bf16 v[152:155], a[196:199], v[52:55], v[152:155]
v_accvgpr_write_b32 a189, v209
v_cvt_pk_bf16_f32 v212, v212, v213
v_mfma_f32_16x16x32_bf16 v[152:155], a[192:195], v[48:51], v[152:155]
buffer_load_dwordx4 v243, s[12:15], s38 offen offset:1024 nt lds
v_smfmac_f32_16x16x64_bf16 v[216:219], v[224:227], v[176:183], v248
s_waitcnt lgkmcnt(2)
ds_read_b128 a[212:215], v240 offset:54336
v_mfma_f32_16x16x32_bf16 a[0:3], a[224:227], v[176:179], a[0:3]
v_exp_f32 v148, v148
v_mfma_f32_16x16x32_bf16 a[0:3], a[228:231], v[160:163], a[0:3]
ds_read_b128 a[216:219], v240 offset:54592
ds_read_b128 a[220:223], v240 offset:54848
v_mfma_f32_16x16x32_bf16 a[32:35], a[228:231], v[164:167], a[32:35]
v_cvt_pk_bf16_f32 v185, v146, v147
v_cvt_pk_bf16_f32 v213, v214, v215
v_mfma_f32_16x16x32_bf16 a[32:35], a[224:227], v[180:183], a[32:35]
ds_read_b128 a[204:207], v240 offset:50688
v_accvgpr_write_b32 a190, v212
v_mfma_f32_16x16x32_bf16 a[36:39], a[232:235], v[180:183], a[36:39]
v_exp_f32_e64 v149, v149
v_mfma_f32_16x16x32_bf16 a[36:39], a[236:239], v[164:167], a[36:39]
ds_read_b128 a[200:203], v240 offset:50432
v_accvgpr_write_b32 a191, v213
v_mfma_f32_16x16x32_bf16 a[4:7], a[236:239], v[160:163], a[4:7]
v_exp_f32_e64 v150, v150
v_mfma_f32_16x16x32_bf16 a[4:7], a[232:235], v[176:179], a[4:7]
s_add_u32 m0, s32, 0x8100
ds_read_b128 a[196:199], v240 offset:50176
v_cvt_pk_bf16_f32 v186, v148, v149
v_mfma_f32_16x16x32_bf16 a[8:11], a[240:243], v[176:179], a[8:11]
ds_read_b128 a[192:195], v240 offset:49920
v_mfma_f32_16x16x32_bf16 a[8:11], a[244:247], v[160:163], a[8:11]
buffer_load_dwordx4 v243, s[16:19], s39 offen nt lds
v_mfma_f32_16x16x32_bf16 a[40:43], a[244:247], v[164:167], a[40:43]
v_exp_f32 v151, v151
v_mfma_f32_16x16x32_bf16 a[40:43], a[240:243], v[180:183], a[40:43]
v_exp_f32 v156, v156
v_mfma_f32_16x16x32_bf16 a[44:47], a[248:251], v[180:183], a[44:47]
s_waitcnt lgkmcnt(2)
v_exp_f32 v157, v157
v_mfma_f32_16x16x32_bf16 a[44:47], a[252:255], v[164:167], a[44:47]
v_exp_f32 v158, v158
v_mfma_f32_16x16x32_bf16 a[12:15], a[252:255], v[160:163], a[12:15]
v_cvt_pk_bf16_f32 v187, v150, v151
v_cvt_pk_bf16_f32 v190, v156, v157
v_mfma_f32_16x16x32_bf16 a[12:15], a[248:251], v[176:179], a[12:15]
s_waitcnt lgkmcnt(0)
v_exp_f32_e64 v159, v159
v_mfma_f32_16x16x32_bf16 v[128:131], a[192:195], a[128:131], -4.0
v_exp_f32 v152, v152
v_mfma_f32_16x16x32_bf16 v[128:131], a[196:199], a[132:135], v[128:131]
v_exp_f32 v153, v153
v_mfma_f32_16x16x32_bf16 v[128:131], a[200:203], a[136:139], v[128:131]
s_add_u32 m0, s32, 0x8100
v_exp_f32_e64 v154, v154
v_mfma_f32_16x16x32_bf16 v[128:131], a[204:207], a[140:143], v[128:131]
buffer_load_dwordx4 v243, s[24:27], s39 offen offset:1032 nt lds
v_mfma_f32_16x16x32_bf16 v[132:135], a[220:223], a[140:143], -4.0
s_xor_b32 s39, s29, 0x180a000
v_cvt_pk_bf16_f32 v191, v158, v159
v_cvt_pk_bf16_f32 v188, v152, v153
v_mfma_f32_16x16x32_bf16 v[132:135], a[216:219], a[136:139], v[132:135]
s_xor_b32 s38, s29, 0x180e000
v_exp_f32 v155, v155
v_mfma_f32_16x16x32_bf16 v[132:135], a[212:215], a[132:135], v[132:135]
v_exp_f32 v128, v128
v_mfma_f32_16x16x32_bf16 v[132:135], a[208:211], a[128:131], v[132:135]
v_exp_f32 v129, v129
v_mfma_f32_16x16x32_bf16 v[140:143], a[208:211], a[144:147], -4.0
v_exp_f32 v130, v130
v_mfma_f32_16x16x32_bf16 v[140:143], a[212:215], a[148:151], v[140:143]
v_cvt_pk_bf16_f32 v189, v154, v155
v_cvt_pk_bf16_f32 v168, v128, v129
v_mfma_f32_16x16x32_bf16 v[140:143], a[216:219], a[152:155], v[140:143]
v_exp_f32_e64 v131, v131
v_mfma_f32_16x16x32_bf16 v[140:143], a[220:223], a[156:159], v[140:143]
v_exp_f32 v132, v132
v_mfma_f32_16x16x32_bf16 v[136:139], a[204:207], a[156:159], -4.0
s_add_u32 m0, s32, 0xa140
v_exp_f32 v133, v133
v_mfma_f32_16x16x32_bf16 v[136:139], a[200:203], a[152:155], v[136:139]
v_exp_f32_e64 v134, v134
v_mfma_f32_16x16x32_bf16 v[136:139], a[196:199], a[148:151], v[136:139]
v_cvt_pk_bf16_f32 v169, v130, v131
v_cvt_pk_bf16_f32 v170, v132, v133
v_mfma_f32_16x16x32_bf16 v[136:139], a[192:195], a[144:147], v[136:139]
buffer_load_dwordx4 v243, s[16:19], s39 offen nt lds
v_smfmac_f32_16x16x64_bf16 v[220:223], v[224:227], v[228:235], v248
v_mfma_f32_16x16x32_bf16 a[64:67], a[224:227], v[228:231], a[64:67]
v_exp_f32 v135, v135
v_mfma_f32_16x16x32_bf16 a[64:67], a[228:231], v[184:187], a[64:67]
v_exp_f32 v140, v140
v_mfma_f32_16x16x32_bf16 a[96:99], a[228:231], v[188:191], a[96:99]
v_exp_f32 v141, v141
v_mfma_f32_16x16x32_bf16 a[96:99], a[224:227], v[232:235], a[96:99]
ds_read_b64_tr_b16 a[224:225], v241 offset:50048
ds_read_b64_tr_b16 a[226:227], v241 offset:54176
v_mfma_f32_16x16x32_bf16 a[100:103], a[232:235], v[232:235], a[100:103]
v_exp_f32 v142, v142
v_mfma_f32_16x16x32_bf16 a[100:103], a[236:239], v[188:191], a[100:103]
ds_read_b64_tr_b16 a[228:229], v241 offset:58304
ds_read_b64_tr_b16 a[230:231], v241 offset:62432
v_mfma_f32_16x16x32_bf16 a[68:71], a[236:239], v[184:187], a[68:71]
v_cvt_pk_bf16_f32 v171, v134, v135
v_cvt_pk_bf16_f32 v174, v140, v141
v_mfma_f32_16x16x32_bf16 a[68:71], a[232:235], v[228:231], a[68:71]
s_add_u32 m0, s32, 0xa140
ds_read_b64_tr_b16 a[232:233], v241 offset:50056
ds_read_b64_tr_b16 a[234:235], v241 offset:54184
v_mfma_f32_16x16x32_bf16 a[72:75], a[240:243], v[228:231], a[72:75]
v_exp_f32 v143, v143
v_mfma_f32_16x16x32_bf16 a[72:75], a[244:247], v[184:187], a[72:75]
buffer_load_dwordx4 v243, s[24:27], s39 offen offset:1032 nt lds
v_mfma_f32_16x16x32_bf16 a[104:107], a[244:247], v[188:191], a[104:107]
v_exp_f32 v136, v136
v_mfma_f32_16x16x32_bf16 a[104:107], a[240:243], v[232:235], a[104:107]
ds_read_b64_tr_b16 a[236:237], v241 offset:58312
ds_read_b64_tr_b16 a[238:239], v241 offset:62440
v_mfma_f32_16x16x32_bf16 a[108:111], a[248:251], v[232:235], a[108:111]
v_exp_f32 v137, v137
v_mfma_f32_16x16x32_bf16 a[108:111], a[252:255], v[188:191], a[108:111]
ds_read_b64_tr_b16 a[240:241], v241 offset:50304
ds_read_b64_tr_b16 a[242:243], v241 offset:54432
v_mfma_f32_16x16x32_bf16 a[76:79], a[252:255], v[184:187], a[76:79]
v_exp_f32 v138, v138
v_mfma_f32_16x16x32_bf16 a[76:79], a[248:251], v[228:231], a[76:79]
ds_read_b64_tr_b16 a[244:245], v241 offset:58560
v_cvt_pk_bf16_f32 v175, v142, v143
v_mfma_f32_16x16x32_bf16 v[144:147], a[192:195], a[160:163], -4.0
v_exp_f32_e64 v139, v139
v_mfma_f32_16x16x32_bf16 v[144:147], a[196:199], a[164:167], v[144:147]
v_cvt_pk_bf16_f32 v172, v136, v137
v_cvt_pk_bf16_f32 v173, v138, v139
v_mfma_f32_16x16x32_bf16 v[144:147], a[200:203], a[168:171], v[144:147]
ds_read_b64_tr_b16 a[246:247], v241 offset:62688
ds_read_b64_tr_b16 a[248:249], v241 offset:50312
v_mfma_f32_16x16x32_bf16 v[144:147], a[204:207], a[172:175], v[144:147]
ds_read_b64_tr_b16 a[250:251], v241 offset:54440
ds_read_b64_tr_b16 a[252:253], v241 offset:58568
v_mfma_f32_16x16x32_bf16 v[148:151], a[220:223], a[172:175], -4.0
ds_read_b64_tr_b16 a[254:255], v241 offset:62696
v_mfma_f32_16x16x32_bf16 v[148:151], a[216:219], a[168:171], v[148:151]
v_mfma_f32_16x16x32_bf16 v[148:151], a[212:215], a[164:167], v[148:151]
v_mfma_f32_16x16x32_bf16 v[148:151], a[208:211], a[160:163], v[148:151]
v_mfma_f32_16x16x32_bf16 v[156:159], a[208:211], a[176:179], -4.0
v_exp_f32 v144, v144
v_mfma_f32_16x16x32_bf16 v[156:159], a[212:215], a[180:183], v[156:159]
v_exp_f32 v145, v145
v_mfma_f32_16x16x32_bf16 v[156:159], a[216:219], a[184:187], v[156:159]
v_exp_f32_e64 v146, v146
v_mfma_f32_16x16x32_bf16 v[156:159], a[220:223], a[188:191], v[156:159]
ds_read_b128 a[208:211], v240 offset:4160
v_cvt_pk_bf16_f32 v192, v144, v145
v_mfma_f32_16x16x32_bf16 v[152:155], a[204:207], a[188:191], -4.0
v_exp_f32 v147, v147
v_mfma_f32_16x16x32_bf16 v[152:155], a[200:203], a[184:187], v[152:155]
v_exp_f32 v148, v148
v_mfma_f32_16x16x32_bf16 v[152:155], a[196:199], a[180:183], v[152:155]
v_exp_f32_e64 v149, v149
v_mfma_f32_16x16x32_bf16 v[152:155], a[192:195], a[176:179], v[152:155]
ds_read_b128 a[212:215], v240 offset:4416
ds_read_b128 a[216:219], v240 offset:4672
v_smfmac_f32_16x16x64_bf16 v[216:219], v[224:227], v[160:167], v248
s_waitcnt lgkmcnt(3)
ds_read_b128 a[220:223], v240 offset:4928
v_mfma_f32_16x16x32_bf16 a[16:19], a[224:227], v[176:179], a[16:19]
v_exp_f32 v150, v150
v_mfma_f32_16x16x32_bf16 a[16:19], a[228:231], v[160:163], a[16:19]
ds_read_b128 a[204:207], v240 offset:768
v_cvt_pk_bf16_f32 v193, v146, v147
v_mfma_f32_16x16x32_bf16 a[48:51], a[228:231], v[164:167], a[48:51]
v_add_f32 v250, v216, v217
v_add_f32 v251, v218, v219
v_mfma_f32_16x16x32_bf16 a[48:51], a[224:227], v[180:183], a[48:51]
ds_read_b128 a[200:203], v240 offset:512
v_subrev_u32 v216, s36, v250
v_mfma_f32_16x16x32_bf16 a[52:55], a[232:235], v[180:183], a[52:55]
v_subrev_u32 v217, s36, v251
v_max_u32 v216, v216, v217
v_mfma_f32_16x16x32_bf16 a[52:55], a[236:239], v[164:167], a[52:55]
ds_read_b128 a[196:199], v240 offset:256
v_rcp_f32 v250, v250
v_mfma_f32_16x16x32_bf16 a[20:23], a[236:239], v[160:163], a[20:23]
v_rcp_f32 v251, v251
v_mfma_f32_16x16x32_bf16 a[20:23], a[232:235], v[176:179], a[20:23]
ds_read_b128 a[192:195], v240
v_cmp_le_u32 s[48:49], s37, v216
v_mfma_f32_16x16x32_bf16 a[24:27], a[240:243], v[176:179], a[24:27]
v_mov_b64 v[216:217], 0
v_mov_b64_e64 v[218:219], 0
v_mfma_f32_16x16x32_bf16 a[24:27], a[244:247], v[160:163], a[24:27]
L_pad15:
s_cbranch_vccnz L_pad19
v_cvt_pk_bf16_f32 v194, v148, v149
v_accvgpr_read_b32 v200, a0
v_mfma_f32_16x16x32_bf16 a[56:59], a[244:247], v[164:167], a[56:59]
v_exp_f32 v151, v151
v_mfma_f32_16x16x32_bf16 a[56:59], a[240:243], v[180:183], a[56:59]
v_exp_f32_e64 v156, v156
v_mfma_f32_16x16x32_bf16 a[60:63], a[248:251], v[180:183], a[60:63]
v_cvt_pk_bf16_f32 v195, v150, v151
v_accvgpr_read_b32 v201, a1
v_mfma_f32_16x16x32_bf16 a[60:63], a[252:255], v[164:167], a[60:63]
v_exp_f32 v157, v157
v_mfma_f32_16x16x32_bf16 a[28:31], a[252:255], v[160:163], a[28:31]
v_exp_f32_e64 v158, v158
v_mfma_f32_16x16x32_bf16 a[28:31], a[248:251], v[176:179], a[28:31]
s_waitcnt lgkmcnt(0)
v_cvt_pk_bf16_f32 v198, v156, v157
v_accvgpr_read_b32 v202, a2
v_mfma_f32_16x16x32_bf16 v[128:131], a[192:195], a[128:131], -4.0
v_exp_f32 v159, v159
v_mfma_f32_16x16x32_bf16 v[128:131], a[196:199], a[132:135], v[128:131]
v_exp_f32 v152, v152
v_mfma_f32_16x16x32_bf16 v[128:131], a[200:203], a[136:139], v[128:131]
v_cvt_pk_bf16_f32 v199, v158, v159
v_accvgpr_read_b32 v203, a3
v_mfma_f32_16x16x32_bf16 v[128:131], a[204:207], a[140:143], v[128:131]
v_exp_f32_e64 v153, v153
v_mfma_f32_16x16x32_bf16 v[132:135], a[220:223], a[140:143], -4.0
v_exp_f32 v154, v154
v_mfma_f32_16x16x32_bf16 v[132:135], a[216:219], a[136:139], v[132:135]
v_cvt_pk_bf16_f32 v196, v152, v153
v_accvgpr_read_b32 v204, a4
v_mfma_f32_16x16x32_bf16 v[132:135], a[212:215], a[132:135], v[132:135]
v_exp_f32 v155, v155
v_mfma_f32_16x16x32_bf16 v[132:135], a[208:211], a[128:131], v[132:135]
v_cvt_pk_bf16_f32 v197, v154, v155
v_accvgpr_read_b32 v205, a5
v_mfma_f32_16x16x32_bf16 v[140:143], a[208:211], a[144:147], -4.0
v_exp_f32 v128, v128
v_mfma_f32_16x16x32_bf16 v[140:143], a[212:215], a[148:151], v[140:143]
v_exp_f32 v129, v129
v_mfma_f32_16x16x32_bf16 v[140:143], a[216:219], a[152:155], v[140:143]
v_exp_f32_e64 v130, v130
v_mfma_f32_16x16x32_bf16 v[140:143], a[220:223], a[156:159], v[140:143]
s_add_u32 m0, s31, 0xc300
v_cvt_pk_bf16_f32 v160, v128, v129
v_accvgpr_read_b32 v206, a6
v_mfma_f32_16x16x32_bf16 v[136:139], a[204:207], a[156:159], -4.0
v_exp_f32 v131, v131
v_mfma_f32_16x16x32_bf16 v[136:139], a[200:203], a[152:155], v[136:139]
v_exp_f32_e64 v132, v132
v_mfma_f32_16x16x32_bf16 v[136:139], a[196:199], a[148:151], v[136:139]
s_waitcnt vmcnt(17)
v_cvt_pk_bf16_f32 v161, v130, v131
v_accvgpr_read_b32 v207, a7
v_mfma_f32_16x16x32_bf16 v[136:139], a[192:195], a[144:147], v[136:139]
s_barrier
v_smfmac_f32_16x16x64_bf16 v[220:223], v[224:227], v[184:191], v248
buffer_load_dwordx4 v243, s[12:15], s38 offen nt lds
v_mfma_f32_16x16x32_bf16 a[80:83], a[224:227], v[228:231], a[80:83]
v_exp_f32 v133, v133
v_mfma_f32_16x16x32_bf16 a[80:83], a[228:231], v[184:187], a[80:83]
v_exp_f32_e64 v134, v134
v_mfma_f32_16x16x32_bf16 a[112:115], a[228:231], v[188:191], a[112:115]
v_exp_f32 v135, v135
v_mfma_f32_16x16x32_bf16 a[112:115], a[224:227], v[232:235], a[112:115]
ds_read_b64_tr_b16 a[224:225], v241
ds_read_b64_tr_b16 a[226:227], v241 offset:4128
v_mfma_f32_16x16x32_bf16 a[116:119], a[232:235], v[232:235], a[116:119]
v_add_f32 v252, v220, v221
v_add_f32_e64 v253, v222, v223
v_mfma_f32_16x16x32_bf16 a[116:119], a[236:239], v[188:191], a[116:119]
ds_read_b64_tr_b16 a[228:229], v241 offset:8256
ds_read_b64_tr_b16 a[230:231], v241 offset:12384
v_mfma_f32_16x16x32_bf16 a[84:87], a[236:239], v[184:187], a[84:87]
v_subrev_u32 v220, s36, v252
v_subrev_u32 v221, s36, v253
v_mfma_f32_16x16x32_bf16 a[84:87], a[232:235], v[228:231], a[84:87]
ds_read_b64_tr_b16 a[232:233], v241 offset:8
ds_read_b64_tr_b16 a[234:235], v241 offset:4136
v_mfma_f32_16x16x32_bf16 a[88:91], a[240:243], v[228:231], a[88:91]
s_add_u32 m0, s31, 0xc300
v_max_u32 v220, v220, v221
v_rcp_f32 v252, v252
v_mfma_f32_16x16x32_bf16 a[88:91], a[244:247], v[184:187], a[88:91]
buffer_load_dwordx4 v243, s[12:15], s38 offen offset:1024 nt lds
v_mfma_f32_16x16x32_bf16 a[120:123], a[244:247], v[188:191], a[120:123]
s_xor_b32 s38, s29, 0x1810000
v_rcp_f32_e64 v253, v253
v_mfma_f32_16x16x32_bf16 a[120:123], a[240:243], v[232:235], a[120:123]
s_xor_b32 s39, s29, 0x180c000
ds_read_b64_tr_b16 a[236:237], v241 offset:8264
ds_read_b64_tr_b16 a[238:239], v241 offset:12392
v_mfma_f32_16x16x32_bf16 a[124:127], a[248:251], v[232:235], a[124:127]
v_cmp_le_u32 s[50:51], s37, v220
v_mov_b64_e64 v[220:221], 0
v_mfma_f32_16x16x32_bf16 a[124:127], a[252:255], v[188:191], a[124:127]
ds_read_b64_tr_b16 a[240:241], v241 offset:256
ds_read_b64_tr_b16 a[242:243], v241 offset:4384
v_mfma_f32_16x16x32_bf16 a[92:95], a[252:255], v[184:187], a[92:95]
v_mov_b64 v[222:223], 0
v_cvt_pk_bf16_f32 v162, v132, v133
v_mfma_f32_16x16x32_bf16 a[92:95], a[248:251], v[228:231], a[92:95]
ds_read_b64_tr_b16 a[244:245], v241 offset:8512
ds_read_b64_tr_b16 a[246:247], v241 offset:12640
v_mfma_f32_16x16x32_bf16 v[144:147], a[192:195], a[160:163], -4.0
v_exp_f32 v140, v140
v_mfma_f32_16x16x32_bf16 v[144:147], a[196:199], a[164:167], v[144:147]
v_exp_f32 v141, v141
v_mfma_f32_16x16x32_bf16 v[144:147], a[200:203], a[168:171], v[144:147]
s_add_u32 m0, s31, 0x0
v_exp_f32_e64 v142, v142
v_mfma_f32_16x16x32_bf16 v[144:147], a[204:207], a[172:175], v[144:147]
buffer_load_dwordx4 v243, s[12:15], s38 offen nt lds
v_mfma_f32_16x16x32_bf16 v[148:151], a[220:223], a[172:175], -4.0
v_cvt_pk_bf16_f32 v163, v134, v135
v_cvt_pk_bf16_f32 v166, v140, v141
v_mfma_f32_16x16x32_bf16 v[148:151], a[216:219], a[168:171], v[148:151]
v_exp_f32 v143, v143
v_mfma_f32_16x16x32_bf16 v[148:151], a[212:215], a[164:167], v[148:151]
v_exp_f32 v136, v136
v_mfma_f32_16x16x32_bf16 v[148:151], a[208:211], a[160:163], v[148:151]
ds_read_b64_tr_b16 a[248:249], v241 offset:264
ds_read_b64_tr_b16 a[250:251], v241 offset:4392
v_mfma_f32_16x16x32_bf16 v[156:159], a[208:211], a[176:179], -4.0
v_exp_f32 v137, v137
v_mfma_f32_16x16x32_bf16 v[156:159], a[212:215], a[180:183], v[156:159]
v_exp_f32 v138, v138
v_mfma_f32_16x16x32_bf16 v[156:159], a[216:219], a[184:187], v[156:159]
v_cvt_pk_bf16_f32 v167, v142, v143
v_cvt_pk_bf16_f32 v164, v136, v137
v_mfma_f32_16x16x32_bf16 v[156:159], a[220:223], a[188:191], v[156:159]
ds_read_b64_tr_b16 a[252:253], v241 offset:8520
v_exp_f32_e64 v139, v139
v_mfma_f32_16x16x32_bf16 v[152:155], a[204:207], a[188:191], -4.0
s_add_u32 m0, s31, 0x0
v_exp_f32 v144, v144
v_mfma_f32_16x16x32_bf16 v[152:155], a[200:203], a[184:187], v[152:155]
v_exp_f32 v145, v145
v_mfma_f32_16x16x32_bf16 v[152:155], a[196:199], a[180:183], v[152:155]
v_exp_f32 v146, v146
v_mfma_f32_16x16x32_bf16 v[152:155], a[192:195], a[176:179], v[152:155]
buffer_load_dwordx4 v243, s[12:15], s38 offen offset:1024 nt lds
v_smfmac_f32_16x16x64_bf16 v[216:219], v[224:227], v[168:175], v248
s_waitcnt lgkmcnt(1)
ds_read_b64_tr_b16 a[254:255], v241 offset:12648
v_cvt_pk_bf16_f32 v165, v138, v139
v_cvt_pk_bf16_f32 v176, v144, v145
v_exp_f32 v147, v147
v_pk_mul_f32 v[206:207], v[206:207], v[250:251] op_sel:[0,0] op_sel_hi:[1,0]
v_pk_mul_f32 v[204:205], v[204:205], v[250:251] op_sel:[0,0] op_sel_hi:[1,0]
v_pk_mul_f32 v[202:203], v[202:203], v[250:251] op_sel:[0,0] op_sel_hi:[1,0]
v_pk_mul_f32 v[200:201], v[200:201], v[250:251] op_sel:[0,0] op_sel_hi:[1,0]
v_cvt_pk_bf16_f32 v200, v200, v201
v_mfma_f32_16x16x32_bf16 v[0:3], a[224:227], v[168:171], 0
v_exp_f32_e64 v148, v148
v_mfma_f32_16x16x32_bf16 v[0:3], a[228:231], v[160:163], v[0:3]
ds_read_b128 a[208:211], v240 offset:12480
ds_read_b128 a[212:215], v240 offset:12736
v_mfma_f32_16x16x32_bf16 v[32:35], a[228:231], v[164:167], 0
v_cvt_pk_bf16_f32 v177, v146, v147
v_cvt_pk_bf16_f32 v201, v202, v203
v_mfma_f32_16x16x32_bf16 v[32:35], a[224:227], v[172:175], v[32:35]
ds_read_b128 a[216:219], v240 offset:12992
ds_read_b128 a[220:223], v240 offset:13248
v_mfma_f32_16x16x32_bf16 v[36:39], a[232:235], v[172:175], 0
v_exp_f32_e64 v149, v149
v_mfma_f32_16x16x32_bf16 v[36:39], a[236:239], v[164:167], v[36:39]
ds_read_b128 a[204:207], v240 offset:9088
ds_read_b128 a[200:203], v240 offset:8832
v_mfma_f32_16x16x32_bf16 v[4:7], a[236:239], v[160:163], 0
v_exp_f32_e64 v150, v150
v_mfma_f32_16x16x32_bf16 v[4:7], a[232:235], v[168:171], v[4:7]
s_add_u32 m0, s32, 0xc180
ds_read_b128 a[196:199], v240 offset:8576
v_cvt_pk_bf16_f32 v178, v148, v149
v_mfma_f32_16x16x32_bf16 v[8:11], a[240:243], v[168:171], 0
ds_read_b128 a[192:195], v240 offset:8320
v_cvt_pk_bf16_f32 v202, v204, v205
v_mfma_f32_16x16x32_bf16 v[8:11], a[244:247], v[160:163], v[8:11]
buffer_load_dwordx4 v243, s[16:19], s39 offen nt lds
v_mfma_f32_16x16x32_bf16 v[40:43], a[244:247], v[164:167], 0
v_exp_f32 v151, v151
v_mfma_f32_16x16x32_bf16 v[40:43], a[240:243], v[172:175], v[40:43]
v_exp_f32 v156, v156
v_mfma_f32_16x16x32_bf16 v[44:47], a[248:251], v[172:175], 0
s_waitcnt lgkmcnt(2)
v_cvt_pk_bf16_f32 v179, v150, v151
v_cvt_pk_bf16_f32 v203, v206, v207
v_mfma_f32_16x16x32_bf16 v[44:47], a[252:255], v[164:167], v[44:47]
v_exp_f32 v157, v157
v_mfma_f32_16x16x32_bf16 v[12:15], a[252:255], v[160:163], 0
v_exp_f32 v158, v158
v_mfma_f32_16x16x32_bf16 v[12:15], a[248:251], v[168:171], v[12:15]
s_waitcnt lgkmcnt(0)
v_cvt_pk_bf16_f32 v182, v156, v157
v_accvgpr_read_b32 v208, a8
v_mfma_f32_16x16x32_bf16 v[128:131], a[192:195], a[128:131], -4.0
v_exp_f32 v159, v159
v_mfma_f32_16x16x32_bf16 v[128:131], a[196:199], a[132:135], v[128:131]
v_exp_f32 v152, v152
v_mfma_f32_16x16x32_bf16 v[128:131], a[200:203], a[136:139], v[128:131]
s_add_u32 m0, s32, 0xc180
v_cvt_pk_bf16_f32 v183, v158, v159
v_accvgpr_read_b32 v209, a9
v_mfma_f32_16x16x32_bf16 v[128:131], a[204:207], a[140:143], v[128:131]
buffer_load_dwordx4 v243, s[24:27], s39 offen offset:1032 nt lds
v_mfma_f32_16x16x32_bf16 v[132:135], a[220:223], a[140:143], -4.0
s_xor_b32 s39, s29, 0x180e000
v_exp_f32 v153, v153
v_mfma_f32_16x16x32_bf16 v[132:135], a[216:219], a[136:139], v[132:135]
s_xor_b32 s38, s29, 0x1812000
v_exp_f32 v154, v154
v_mfma_f32_16x16x32_bf16 v[132:135], a[212:215], a[132:135], v[132:135]
v_cvt_pk_bf16_f32 v180, v152, v153
v_accvgpr_read_b32 v210, a10
v_mfma_f32_16x16x32_bf16 v[132:135], a[208:211], a[128:131], v[132:135]
v_exp_f32 v155, v155
v_mfma_f32_16x16x32_bf16 v[140:143], a[208:211], a[144:147], -4.0
v_cvt_pk_bf16_f32 v181, v154, v155
v_accvgpr_read_b32 v211, a11
v_mfma_f32_16x16x32_bf16 v[140:143], a[212:215], a[148:151], v[140:143]
v_exp_f32 v128, v128
v_mfma_f32_16x16x32_bf16 v[140:143], a[216:219], a[152:155], v[140:143]
v_exp_f32 v129, v129
v_mfma_f32_16x16x32_bf16 v[140:143], a[220:223], a[156:159], v[140:143]
v_exp_f32 v130, v130
v_mfma_f32_16x16x32_bf16 v[136:139], a[204:207], a[156:159], -4.0
s_add_u32 m0, s32, 0xe1c0
v_cvt_pk_bf16_f32 v184, v128, v129
v_accvgpr_read_b32 v212, a12
v_mfma_f32_16x16x32_bf16 v[136:139], a[200:203], a[152:155], v[136:139]
v_exp_f32 v131, v131
v_mfma_f32_16x16x32_bf16 v[136:139], a[196:199], a[148:151], v[136:139]
v_exp_f32 v132, v132
v_mfma_f32_16x16x32_bf16 v[136:139], a[192:195], a[144:147], v[136:139]
buffer_load_dwordx4 v243, s[16:19], s39 offen nt lds
v_smfmac_f32_16x16x64_bf16 v[220:223], v[224:227], v[192:199], v248
v_cvt_pk_bf16_f32 v185, v130, v131
v_mfma_f32_16x16x32_bf16 v[64:67], a[224:227], v[192:195], 0
v_exp_f32_e64 v133, v133
v_mfma_f32_16x16x32_bf16 v[64:67], a[228:231], v[176:179], v[64:67]
v_exp_f32_e64 v134, v134
v_mfma_f32_16x16x32_bf16 v[96:99], a[228:231], v[180:183], 0
v_cvt_pk_bf16_f32 v186, v132, v133
v_accvgpr_read_b32 v213, a13
v_mfma_f32_16x16x32_bf16 v[96:99], a[224:227], v[196:199], v[96:99]
ds_read_b64_tr_b16 a[224:225], v241 offset:512
ds_read_b64_tr_b16 a[226:227], v241 offset:4640
v_mfma_f32_16x16x32_bf16 v[100:103], a[232:235], v[196:199], 0
v_exp_f32 v135, v135
v_mfma_f32_16x16x32_bf16 v[100:103], a[236:239], v[180:183], v[100:103]
ds_read_b64_tr_b16 a[228:229], v241 offset:8768
ds_read_b64_tr_b16 a[230:231], v241 offset:12896
v_mfma_f32_16x16x32_bf16 v[68:71], a[236:239], v[176:179], 0
v_exp_f32 v140, v140
v_mfma_f32_16x16x32_bf16 v[68:71], a[232:235], v[192:195], v[68:71]
s_add_u32 m0, s32, 0xe1c0
ds_read_b64_tr_b16 a[232:233], v241 offset:520
ds_read_b64_tr_b16 a[234:235], v241 offset:4648
v_mfma_f32_16x16x32_bf16 v[72:75], a[240:243], v[192:195], 0
v_cvt_pk_bf16_f32 v187, v134, v135
v_accvgpr_read_b32 v214, a14
v_mfma_f32_16x16x32_bf16 v[72:75], a[244:247], v[176:179], v[72:75]
buffer_load_dwordx4 v243, s[24:27], s39 offen offset:1032 nt lds
v_mfma_f32_16x16x32_bf16 v[104:107], a[244:247], v[180:183], 0
v_exp_f32 v141, v141
v_mfma_f32_16x16x32_bf16 v[104:107], a[240:243], v[196:199], v[104:107]
ds_read_b64_tr_b16 a[236:237], v241 offset:8776
ds_read_b64_tr_b16 a[238:239], v241 offset:12904
v_mfma_f32_16x16x32_bf16 v[108:111], a[248:251], v[196:199], 0
v_exp_f32 v142, v142
v_mfma_f32_16x16x32_bf16 v[108:111], a[252:255], v[180:183], v[108:111]
ds_read_b64_tr_b16 a[240:241], v241 offset:768
ds_read_b64_tr_b16 a[242:243], v241 offset:4896
v_mfma_f32_16x16x32_bf16 v[76:79], a[252:255], v[176:179], 0
v_cvt_pk_bf16_f32 v190, v140, v141
v_accvgpr_read_b32 v215, a15
v_mfma_f32_16x16x32_bf16 v[76:79], a[248:251], v[192:195], v[76:79]
ds_read_b64_tr_b16 a[244:245], v241 offset:9024
v_exp_f32 v143, v143
v_exp_f32 v136, v136
v_pk_mul_f32 v[214:215], v[214:215], v[250:251] op_sel:[0,0] op_sel_hi:[1,0]
v_pk_mul_f32 v[212:213], v[212:213], v[250:251] op_sel:[0,0] op_sel_hi:[1,0]
v_pk_mul_f32 v[210:211], v[210:211], v[250:251] op_sel:[0,0] op_sel_hi:[1,0]
v_pk_mul_f32 v[208:209], v[208:209], v[250:251] op_sel:[0,0] op_sel_hi:[1,0]
v_cvt_pk_bf16_f32 v208, v208, v209
v_mfma_f32_16x16x32_bf16 v[144:147], a[192:195], a[160:163], -4.0
v_cvt_pk_bf16_f32 v191, v142, v143
v_cvt_pk_bf16_f32 v209, v210, v211
v_mfma_f32_16x16x32_bf16 v[144:147], a[196:199], a[164:167], v[144:147]
v_exp_f32_e64 v137, v137
v_mfma_f32_16x16x32_bf16 v[144:147], a[200:203], a[168:171], v[144:147]
v_exp_f32_e64 v138, v138
v_mfma_f32_16x16x32_bf16 v[144:147], a[204:207], a[172:175], v[144:147]
ds_read_b64_tr_b16 a[246:247], v241 offset:13152
ds_read_b64_tr_b16 a[248:249], v241 offset:776
v_mfma_f32_16x16x32_bf16 v[148:151], a[220:223], a[172:175], -4.0
v_cvt_pk_bf16_f32 v188, v136, v137
v_cvt_pk_bf16_f32 v210, v212, v213
v_mfma_f32_16x16x32_bf16 v[148:151], a[216:219], a[168:171], v[148:151]
v_exp_f32_e64 v139, v139
v_mfma_f32_16x16x32_bf16 v[148:151], a[212:215], a[164:167], v[148:151]
v_cvt_pk_bf16_f32 v189, v138, v139
v_cvt_pk_bf16_f32 v211, v214, v215
v_mfma_f32_16x16x32_bf16 v[148:151], a[208:211], a[160:163], v[148:151]
ds_read_b64_tr_b16 a[250:251], v241 offset:4904
ds_read_b64_tr_b16 a[252:253], v241 offset:9032
v_mfma_f32_16x16x32_bf16 v[156:159], a[208:211], a[176:179], -4.0
v_exp_f32 v144, v144
v_mfma_f32_16x16x32_bf16 v[156:159], a[212:215], a[180:183], v[156:159]
v_exp_f32 v145, v145
v_mfma_f32_16x16x32_bf16 v[156:159], a[216:219], a[184:187], v[156:159]
v_exp_f32_e64 v146, v146
v_mfma_f32_16x16x32_bf16 v[156:159], a[220:223], a[188:191], v[156:159]
ds_read_b64_tr_b16 a[254:255], v241 offset:13160
ds_read_b128 a[208:211], v240 offset:20800
v_mfma_f32_16x16x32_bf16 v[152:155], a[204:207], a[188:191], -4.0
v_cvt_pk_bf16_f32 v228, v144, v145
v_mov_b64 v[212:213], v[200:201]
v_mfma_f32_16x16x32_bf16 v[152:155], a[200:203], a[184:187], v[152:155]
v_exp_f32 v147, v147
v_mfma_f32_16x16x32_bf16 v[152:155], a[196:199], a[180:183], v[152:155]
v_exp_f32_e64 v148, v148
v_mfma_f32_16x16x32_bf16 v[152:155], a[192:195], a[176:179], v[152:155]
ds_read_b128 a[212:215], v240 offset:21056
ds_read_b128 a[216:219], v240 offset:21312
v_smfmac_f32_16x16x64_bf16 v[216:219], v[224:227], v[160:167], v248
s_waitcnt lgkmcnt(4)
ds_read_b128 a[220:223], v240 offset:21568
v_mfma_f32_16x16x32_bf16 v[16:19], a[224:227], v[168:171], 0
v_cvt_pk_bf16_f32 v229, v146, v147
v_mov_b64 v[214:215], v[202:203]
v_mfma_f32_16x16x32_bf16 v[16:19], a[228:231], v[160:163], v[16:19]
ds_read_b128 a[204:207], v240 offset:17408
v_mov_b32_dpp v200, v208 row_ror:8 row_mask:0xf bank_mask:0xc
v_mfma_f32_16x16x32_bf16 v[48:51], a[228:231], v[164:167], 0
v_exp_f32 v149, v149
v_mfma_f32_16x16x32_bf16 v[48:51], a[224:227], v[172:175], v[48:51]
ds_read_b128 a[200:203], v240 offset:17152
v_mov_b32_dpp v201, v209 row_ror:8 row_mask:0xf bank_mask:0xc
v_mfma_f32_16x16x32_bf16 v[52:55], a[232:235], v[172:175], 0
v_exp_f32 v150, v150
v_mfma_f32_16x16x32_bf16 v[52:55], a[236:239], v[164:167], v[52:55]
ds_read_b128 a[196:199], v240 offset:16896
v_cvt_pk_bf16_f32 v230, v148, v149
v_mfma_f32_16x16x32_bf16 v[20:23], a[236:239], v[160:163], 0
v_exp_f32 v151, v151
v_mfma_f32_16x16x32_bf16 v[20:23], a[232:235], v[168:171], v[20:23]
ds_read_b128 a[192:195], v240 offset:16640
v_mov_b32_dpp v202, v210 row_ror:8 row_mask:0xf bank_mask:0xc
v_mfma_f32_16x16x32_bf16 v[24:27], a[240:243], v[168:171], 0
v_exp_f32 v156, v156
v_mfma_f32_16x16x32_bf16 v[24:27], a[244:247], v[160:163], v[24:27]
v_cvt_pk_bf16_f32 v231, v150, v151
v_mov_b32_dpp v203, v211 row_ror:8 row_mask:0xf bank_mask:0xc
v_mfma_f32_16x16x32_bf16 v[56:59], a[244:247], v[164:167], 0
v_exp_f32 v157, v157
v_mfma_f32_16x16x32_bf16 v[56:59], a[240:243], v[172:175], v[56:59]
buffer_store_dwordx4 v[200:203], v249, s[20:23], s57 offen sc1
v_mfma_f32_16x16x32_bf16 v[60:63], a[248:251], v[172:175], 0
s_waitcnt lgkmcnt(1)
v_exp_f32 v158, v158
v_mfma_f32_16x16x32_bf16 v[60:63], a[252:255], v[164:167], v[60:63]
v_cvt_pk_bf16_f32 v234, v156, v157
v_mov_b32_dpp v208, v212 row_ror:8 row_mask:0xf bank_mask:0x3
v_mfma_f32_16x16x32_bf16 v[28:31], a[252:255], v[160:163], 0
v_exp_f32 v159, v159
v_mfma_f32_16x16x32_bf16 v[28:31], a[248:251], v[168:171], v[28:31]
s_waitcnt lgkmcnt(0)
v_exp_f32 v152, v152
v_mfma_f32_16x16x32_bf16 v[128:131], a[192:195], a[128:131], -4.0
v_cvt_pk_bf16_f32 v235, v158, v159
v_mov_b32_dpp v209, v213 row_ror:8 row_mask:0xf bank_mask:0x3
v_mfma_f32_16x16x32_bf16 v[128:131], a[196:199], a[132:135], v[128:131]
v_exp_f32 v153, v153
v_mfma_f32_16x16x32_bf16 v[128:131], a[200:203], a[136:139], v[128:131]
v_exp_f32 v154, v154
v_mfma_f32_16x16x32_bf16 v[128:131], a[204:207], a[140:143], v[128:131]
v_cvt_pk_bf16_f32 v232, v152, v153
v_mov_b32_dpp v210, v214 row_ror:8 row_mask:0xf bank_mask:0x3
v_mfma_f32_16x16x32_bf16 v[132:135], a[220:223], a[140:143], -4.0
v_exp_f32 v155, v155
v_mfma_f32_16x16x32_bf16 v[132:135], a[216:219], a[136:139], v[132:135]
v_cvt_pk_bf16_f32 v233, v154, v155
v_mov_b32_dpp v211, v215 row_ror:8 row_mask:0xf bank_mask:0x3
v_mfma_f32_16x16x32_bf16 v[132:135], a[212:215], a[132:135], v[132:135]
v_exp_f32 v128, v128
v_mfma_f32_16x16x32_bf16 v[132:135], a[208:211], a[128:131], v[132:135]
buffer_store_dwordx4 v[208:211], v249, s[20:23], s57 offen offset:2048 sc1
v_mfma_f32_16x16x32_bf16 v[140:143], a[208:211], a[144:147], -4.0
v_exp_f32 v129, v129
v_mfma_f32_16x16x32_bf16 v[140:143], a[212:215], a[148:151], v[140:143]
v_exp_f32 v130, v130
v_mfma_f32_16x16x32_bf16 v[140:143], a[216:219], a[152:155], v[140:143]
v_cvt_pk_bf16_f32 v160, v128, v129
v_accvgpr_read_b32 v200, a16
v_mfma_f32_16x16x32_bf16 v[140:143], a[220:223], a[156:159], v[140:143]
s_add_u32 m0, s31, 0x2080
v_exp_f32 v131, v131
v_mfma_f32_16x16x32_bf16 v[136:139], a[204:207], a[156:159], -4.0
v_exp_f32 v132, v132
v_mfma_f32_16x16x32_bf16 v[136:139], a[200:203], a[152:155], v[136:139]
v_cvt_pk_bf16_f32 v161, v130, v131
v_accvgpr_read_b32 v201, a17
v_mfma_f32_16x16x32_bf16 v[136:139], a[196:199], a[148:151], v[136:139]
s_waitcnt vmcnt(16)
v_exp_f32 v133, v133
v_mfma_f32_16x16x32_bf16 v[136:139], a[192:195], a[144:147], v[136:139]
s_barrier
v_smfmac_f32_16x16x64_bf16 v[220:223], v[224:227], v[176:183], v248
v_accvgpr_read_b32 v202, a18
v_mfma_f32_16x16x32_bf16 v[80:83], a[224:227], v[192:195], 0
v_exp_f32 v134, v134
v_mfma_f32_16x16x32_bf16 v[80:83], a[228:231], v[176:179], v[80:83]
buffer_load_dwordx4 v243, s[12:15], s38 offen nt lds
v_mfma_f32_16x16x32_bf16 v[112:115], a[228:231], v[180:183], 0
v_cvt_pk_bf16_f32 v162, v132, v133
v_accvgpr_read_b32 v203, a19
v_mfma_f32_16x16x32_bf16 v[112:115], a[224:227], v[196:199], v[112:115]
ds_read_b64_tr_b16 a[224:225], v241 offset:16512
ds_read_b64_tr_b16 a[226:227], v241 offset:20640
v_mfma_f32_16x16x32_bf16 v[116:119], a[232:235], v[196:199], 0
v_exp_f32_e64 v135, v135
v_mfma_f32_16x16x32_bf16 v[116:119], a[236:239], v[180:183], v[116:119]
ds_read_b64_tr_b16 a[228:229], v241 offset:24768
ds_read_b64_tr_b16 a[230:231], v241 offset:28896
v_mfma_f32_16x16x32_bf16 v[84:87], a[236:239], v[176:179], 0
v_exp_f32_e64 v140, v140
v_mfma_f32_16x16x32_bf16 v[84:87], a[232:235], v[192:195], v[84:87]
ds_read_b64_tr_b16 a[232:233], v241 offset:16520
ds_read_b64_tr_b16 a[234:235], v241 offset:20648
v_mfma_f32_16x16x32_bf16 v[88:91], a[240:243], v[192:195], 0
v_cvt_pk_bf16_f32 v163, v134, v135
v_accvgpr_read_b32 v204, a20
v_mfma_f32_16x16x32_bf16 v[88:91], a[244:247], v[176:179], v[88:91]
ds_read_b64_tr_b16 a[236:237], v241 offset:24776
ds_read_b64_tr_b16 a[238:239], v241 offset:28904
v_mfma_f32_16x16x32_bf16 v[120:123], a[244:247], v[180:183], 0
s_add_u32 m0, s31, 0x2080
v_exp_f32_e64 v141, v141
v_mfma_f32_16x16x32_bf16 v[120:123], a[240:243], v[196:199], v[120:123]
buffer_load_dwordx4 v243, s[12:15], s38 offen offset:1024 nt lds
v_mfma_f32_16x16x32_bf16 v[124:127], a[248:251], v[196:199], 0
s_xor_b32 s38, s29, 0x1814000
v_exp_f32_e64 v142, v142
v_mfma_f32_16x16x32_bf16 v[124:127], a[252:255], v[180:183], v[124:127]
s_xor_b32 s39, s29, 0x1810000
ds_read_b64_tr_b16 a[240:241], v241 offset:16768
ds_read_b64_tr_b16 a[242:243], v241 offset:20896
v_accvgpr_read_b32 v205, a21
v_mfma_f32_16x16x32_bf16 v[92:95], a[252:255], v[176:179], 0
v_cvt_pk_bf16_f32 v166, v140, v141
v_accvgpr_read_b32 v206, a22
v_mfma_f32_16x16x32_bf16 v[92:95], a[248:251], v[192:195], v[92:95]
ds_read_b64_tr_b16 a[244:245], v241 offset:25024
v_accvgpr_read_b32 v207, a23
v_mfma_f32_16x16x32_bf16 v[144:147], a[192:195], a[160:163], -4.0
v_exp_f32 v143, v143
v_mfma_f32_16x16x32_bf16 v[144:147], a[196:199], a[164:167], v[144:147]
v_exp_f32 v136, v136
v_mfma_f32_16x16x32_bf16 v[144:147], a[200:203], a[168:171], v[144:147]
v_exp_f32 v137, v137
v_mfma_f32_16x16x32_bf16 v[144:147], a[204:207], a[172:175], v[144:147]
ds_read_b64_tr_b16 a[246:247], v241 offset:29152
v_cvt_pk_bf16_f32 v167, v142, v143
v_exp_f32 v138, v138
v_cvt_pk_bf16_f32 v164, v136, v137
v_pk_mul_f32 v[206:207], v[206:207], v[250:251] op_sel:[0,0] op_sel_hi:[1,0]
v_pk_mul_f32 v[204:205], v[204:205], v[250:251] op_sel:[0,0] op_sel_hi:[1,0]
v_pk_mul_f32 v[202:203], v[202:203], v[250:251] op_sel:[0,0] op_sel_hi:[1,0]
v_pk_mul_f32 v[200:201], v[200:201], v[250:251] op_sel:[0,0] op_sel_hi:[1,0]
v_cvt_pk_bf16_f32 v200, v200, v201
v_mfma_f32_16x16x32_bf16 v[148:151], a[220:223], a[172:175], -4.0
s_add_u32 m0, s31, 0x4100
v_exp_f32_e64 v139, v139
v_mfma_f32_16x16x32_bf16 v[148:151], a[216:219], a[168:171], v[148:151]
v_cvt_pk_bf16_f32 v165, v138, v139
v_cvt_pk_bf16_f32 v201, v202, v203
v_mfma_f32_16x16x32_bf16 v[148:151], a[212:215], a[164:167], v[148:151]
v_exp_f32 v144, v144
v_mfma_f32_16x16x32_bf16 v[148:151], a[208:211], a[160:163], v[148:151]
buffer_load_dwordx4 v243, s[12:15], s38 offen nt lds
v_mfma_f32_16x16x32_bf16 v[156:159], a[208:211], a[176:179], -4.0
v_exp_f32 v145, v145
v_mfma_f32_16x16x32_bf16 v[156:159], a[212:215], a[180:183], v[156:159]
v_exp_f32_e64 v146, v146
v_mfma_f32_16x16x32_bf16 v[156:159], a[216:219], a[184:187], v[156:159]
v_cvt_pk_bf16_f32 v168, v144, v145
v_cvt_pk_bf16_f32 v202, v204, v205
v_mfma_f32_16x16x32_bf16 v[156:159], a[220:223], a[188:191], v[156:159]
ds_read_b64_tr_b16 a[248:249], v241 offset:16776
ds_read_b64_tr_b16 a[250:251], v241 offset:20904
v_mfma_f32_16x16x32_bf16 v[152:155], a[204:207], a[188:191], -4.0
v_exp_f32 v147, v147
v_mfma_f32_16x16x32_bf16 v[152:155], a[200:203], a[184:187], v[152:155]
v_exp_f32 v148, v148
v_mfma_f32_16x16x32_bf16 v[152:155], a[196:199], a[180:183], v[152:155]
v_cvt_pk_bf16_f32 v169, v146, v147
v_cvt_pk_bf16_f32 v203, v206, v207
v_mfma_f32_16x16x32_bf16 v[152:155], a[192:195], a[176:179], v[152:155]
ds_read_b64_tr_b16 a[252:253], v241 offset:25032
ds_read_b64_tr_b16 a[254:255], v241 offset:29160
v_smfmac_f32_16x16x64_bf16 v[216:219], v[224:227], v[184:191], v248
s_waitcnt lgkmcnt(4)
ds_read_b128 a[208:211], v240 offset:29120
v_mfma_f32_16x16x32_bf16 v[0:3], a[224:227], v[184:187], v[0:3]
s_add_u32 m0, s31, 0x4100
v_exp_f32 v149, v149
v_mfma_f32_16x16x32_bf16 v[0:3], a[228:231], v[160:163], v[0:3]
buffer_load_dwordx4 v243, s[12:15], s38 offen offset:1024 nt lds
v_mfma_f32_16x16x32_bf16 v[32:35], a[228:231], v[164:167], v[32:35]
ds_read_b128 a[212:215], v240 offset:29376
v_accvgpr_read_b32 v208, a24
v_mfma_f32_16x16x32_bf16 v[32:35], a[224:227], v[188:191], v[32:35]
ds_read_b128 a[216:219], v240 offset:29632
ds_read_b128 a[220:223], v240 offset:29888
v_mfma_f32_16x16x32_bf16 v[36:39], a[232:235], v[188:191], v[36:39]
v_exp_f32_e64 v150, v150
v_mfma_f32_16x16x32_bf16 v[36:39], a[236:239], v[164:167], v[36:39]
ds_read_b128 a[204:207], v240 offset:25728
ds_read_b128 a[200:203], v240 offset:25472
v_mfma_f32_16x16x32_bf16 v[4:7], a[236:239], v[160:163], v[4:7]
v_cvt_pk_bf16_f32 v170, v148, v149
v_accvgpr_read_b32 v209, a25
v_mfma_f32_16x16x32_bf16 v[4:7], a[232:235], v[184:187], v[4:7]
ds_read_b128 a[196:199], v240 offset:25216
v_accvgpr_read_b32 v210, a26
v_mfma_f32_16x16x32_bf16 v[8:11], a[240:243], v[184:187], v[8:11]
ds_read_b128 a[192:195], v240 offset:24960
v_accvgpr_read_b32 v211, a27
v_mfma_f32_16x16x32_bf16 v[8:11], a[244:247], v[160:163], v[8:11]
v_exp_f32 v151, v151
v_mfma_f32_16x16x32_bf16 v[40:43], a[244:247], v[164:167], v[40:43]
s_add_u32 m0, s32, 0x0
v_exp_f32_e64 v156, v156
v_mfma_f32_16x16x32_bf16 v[40:43], a[240:243], v[188:191], v[40:43]
s_waitcnt lgkmcnt(4)
buffer_load_dwordx4 v243, s[16:19], s39 offen nt lds
v_mfma_f32_16x16x32_bf16 v[44:47], a[248:251], v[188:191], v[44:47]
v_cvt_pk_bf16_f32 v171, v150, v151
v_accvgpr_read_b32 v212, a28
v_mfma_f32_16x16x32_bf16 v[44:47], a[252:255], v[164:167], v[44:47]
v_exp_f32 v157, v157
v_mfma_f32_16x16x32_bf16 v[12:15], a[252:255], v[160:163], v[12:15]
v_exp_f32 v158, v158
v_mfma_f32_16x16x32_bf16 v[12:15], a[248:251], v[184:187], v[12:15]
s_waitcnt lgkmcnt(0)
v_cvt_pk_bf16_f32 v174, v156, v157
v_accvgpr_read_b32 v213, a29
v_mfma_f32_16x16x32_bf16 v[128:131], a[192:195], a[128:131], -4.0
v_exp_f32_e64 v159, v159
v_mfma_f32_16x16x32_bf16 v[128:131], a[196:199], a[132:135], v[128:131]
v_accvgpr_read_b32 v214, a30
v_accvgpr_read_b32 v215, a31
v_mfma_f32_16x16x32_bf16 v[128:131], a[200:203], a[136:139], v[128:131]
v_exp_f32 v152, v152
v_mfma_f32_16x16x32_bf16 v[128:131], a[204:207], a[140:143], v[128:131]
v_cvt_pk_bf16_f32 v175, v158, v159
v_exp_f32 v153, v153
v_exp_f32_e64 v154, v154
v_pk_mul_f32 v[214:215], v[214:215], v[250:251] op_sel:[0,0] op_sel_hi:[1,0]
v_pk_mul_f32 v[212:213], v[212:213], v[250:251] op_sel:[0,0] op_sel_hi:[1,0]
v_pk_mul_f32 v[210:211], v[210:211], v[250:251] op_sel:[0,0] op_sel_hi:[1,0]
v_pk_mul_f32 v[208:209], v[208:209], v[250:251] op_sel:[0,0] op_sel_hi:[1,0]
v_cvt_pk_bf16_f32 v208, v208, v209
v_mfma_f32_16x16x32_bf16 v[132:135], a[220:223], a[140:143], -4.0
L_pad16:
s_cbranch_vccnz L_pad20
s_add_u32 m0, s32, 0x0
v_cvt_pk_bf16_f32 v172, v152, v153
v_cvt_pk_bf16_f32 v209, v210, v211
v_mfma_f32_16x16x32_bf16 v[132:135], a[216:219], a[136:139], v[132:135]
v_exp_f32 v155, v155
v_mfma_f32_16x16x32_bf16 v[132:135], a[212:215], a[132:135], v[132:135]
v_cvt_pk_bf16_f32 v173, v154, v155
v_cvt_pk_bf16_f32 v210, v212, v213
v_mfma_f32_16x16x32_bf16 v[132:135], a[208:211], a[128:131], v[132:135]
buffer_load_dwordx4 v243, s[24:27], s39 offen offset:1032 nt lds
v_mfma_f32_16x16x32_bf16 v[140:143], a[208:211], a[144:147], -4.0
s_xor_b32 s39, s29, 0x1812000
v_exp_f32 v128, v128
v_mfma_f32_16x16x32_bf16 v[140:143], a[212:215], a[148:151], v[140:143]
s_xor_b32 s38, s29, 0x1816000
v_exp_f32 v129, v129
v_mfma_f32_16x16x32_bf16 v[140:143], a[216:219], a[152:155], v[140:143]
v_exp_f32 v130, v130
v_mfma_f32_16x16x32_bf16 v[140:143], a[220:223], a[156:159], v[140:143]
v_cvt_pk_bf16_f32 v176, v128, v129
v_cvt_pk_bf16_f32 v211, v214, v215
v_mfma_f32_16x16x32_bf16 v[136:139], a[204:207], a[156:159], -4.0
v_exp_f32 v131, v131
v_mfma_f32_16x16x32_bf16 v[136:139], a[200:203], a[152:155], v[136:139]
v_exp_f32 v132, v132
v_mfma_f32_16x16x32_bf16 v[136:139], a[196:199], a[148:151], v[136:139]
v_cvt_pk_bf16_f32 v177, v130, v131
v_mov_b64 v[212:213], v[200:201]
v_mfma_f32_16x16x32_bf16 v[136:139], a[192:195], a[144:147], v[136:139]
v_exp_f32 v133, v133
v_smfmac_f32_16x16x64_bf16 v[220:223], v[224:227], v[228:235], v248
s_add_u32 m0, s32, 0x2040
v_mov_b64 v[214:215], v[202:203]
v_mfma_f32_16x16x32_bf16 v[64:67], a[224:227], v[228:231], v[64:67]
v_exp_f32 v134, v134
v_mfma_f32_16x16x32_bf16 v[64:67], a[228:231], v[168:171], v[64:67]
buffer_load_dwordx4 v243, s[16:19], s39 offen nt lds
v_mfma_f32_16x16x32_bf16 v[96:99], a[228:231], v[172:175], v[96:99]
v_cvt_pk_bf16_f32 v178, v132, v133
v_mov_b32_dpp v200, v208 row_ror:8 row_mask:0xf bank_mask:0xc
v_mfma_f32_16x16x32_bf16 v[96:99], a[224:227], v[232:235], v[96:99]
ds_read_b64_tr_b16 a[224:225], v241 offset:17024
ds_read_b64_tr_b16 a[226:227], v241 offset:21152
v_mfma_f32_16x16x32_bf16 v[100:103], a[232:235], v[232:235], v[100:103]
v_exp_f32 v135, v135
v_mfma_f32_16x16x32_bf16 v[100:103], a[236:239], v[172:175], v[100:103]
ds_read_b64_tr_b16 a[228:229], v241 offset:25280
ds_read_b64_tr_b16 a[230:231], v241 offset:29408
v_mfma_f32_16x16x32_bf16 v[68:71], a[236:239], v[168:171], v[68:71]
v_exp_f32 v140, v140
v_mfma_f32_16x16x32_bf16 v[68:71], a[232:235], v[228:231], v[68:71]
ds_read_b64_tr_b16 a[232:233], v241 offset:17032
ds_read_b64_tr_b16 a[234:235], v241 offset:21160
v_mfma_f32_16x16x32_bf16 v[72:75], a[240:243], v[228:231], v[72:75]
v_cvt_pk_bf16_f32 v179, v134, v135
v_mov_b32_dpp v201, v209 row_ror:8 row_mask:0xf bank_mask:0xc
v_mfma_f32_16x16x32_bf16 v[72:75], a[244:247], v[168:171], v[72:75]
ds_read_b64_tr_b16 a[236:237], v241 offset:25288
ds_read_b64_tr_b16 a[238:239], v241 offset:29416
v_mfma_f32_16x16x32_bf16 v[104:107], a[244:247], v[172:175], v[104:107]
s_add_u32 m0, s32, 0x2040
v_exp_f32 v141, v141
v_mfma_f32_16x16x32_bf16 v[104:107], a[240:243], v[232:235], v[104:107]
buffer_load_dwordx4 v243, s[24:27], s39 offen offset:1032 nt lds
v_mfma_f32_16x16x32_bf16 v[108:111], a[248:251], v[232:235], v[108:111]
v_exp_f32 v142, v142
v_mfma_f32_16x16x32_bf16 v[108:111], a[252:255], v[172:175], v[108:111]
ds_read_b64_tr_b16 a[240:241], v241 offset:17280
ds_read_b64_tr_b16 a[242:243], v241 offset:21408
v_mfma_f32_16x16x32_bf16 v[76:79], a[252:255], v[168:171], v[76:79]
v_cvt_pk_bf16_f32 v182, v140, v141
v_mov_b32_dpp v202, v210 row_ror:8 row_mask:0xf bank_mask:0xc
v_mfma_f32_16x16x32_bf16 v[76:79], a[248:251], v[228:231], v[76:79]
ds_read_b64_tr_b16 a[244:245], v241 offset:25536
v_mov_b32_dpp v203, v211 row_ror:8 row_mask:0xf bank_mask:0xc
v_mfma_f32_16x16x32_bf16 v[144:147], a[192:195], a[160:163], -4.0
v_exp_f32 v143, v143
v_mfma_f32_16x16x32_bf16 v[144:147], a[196:199], a[164:167], v[144:147]
v_exp_f32 v136, v136
v_mfma_f32_16x16x32_bf16 v[144:147], a[200:203], a[168:171], v[144:147]
v_cvt_pk_bf16_f32 v183, v142, v143
v_mov_b32_dpp v208, v212 row_ror:8 row_mask:0xf bank_mask:0x3
v_mfma_f32_16x16x32_bf16 v[144:147], a[204:207], a[172:175], v[144:147]
buffer_store_dwordx4 v[200:203], v249, s[20:23], s57 offen offset:128 sc1
v_mfma_f32_16x16x32_bf16 v[148:151], a[220:223], a[172:175], -4.0
v_exp_f32 v137, v137
v_mfma_f32_16x16x32_bf16 v[148:151], a[216:219], a[168:171], v[148:151]
v_exp_f32 v138, v138
v_mfma_f32_16x16x32_bf16 v[148:151], a[212:215], a[164:167], v[148:151]
v_cvt_pk_bf16_f32 v180, v136, v137
v_mov_b32_dpp v209, v213 row_ror:8 row_mask:0xf bank_mask:0x3
v_mfma_f32_16x16x32_bf16 v[148:151], a[208:211], a[160:163], v[148:151]
ds_read_b64_tr_b16 a[246:247], v241 offset:29664
ds_read_b64_tr_b16 a[248:249], v241 offset:17288
v_mfma_f32_16x16x32_bf16 v[156:159], a[208:211], a[176:179], -4.0
v_exp_f32 v139, v139
v_mfma_f32_16x16x32_bf16 v[156:159], a[212:215], a[180:183], v[156:159]
v_cvt_pk_bf16_f32 v181, v138, v139
v_mov_b32_dpp v210, v214 row_ror:8 row_mask:0xf bank_mask:0x3
v_mfma_f32_16x16x32_bf16 v[156:159], a[216:219], a[184:187], v[156:159]
v_exp_f32 v144, v144
v_mfma_f32_16x16x32_bf16 v[156:159], a[220:223], a[188:191], v[156:159]
ds_read_b64_tr_b16 a[250:251], v241 offset:21416
ds_read_b64_tr_b16 a[252:253], v241 offset:25544
v_mov_b32_dpp v211, v215 row_ror:8 row_mask:0xf bank_mask:0x3
v_mfma_f32_16x16x32_bf16 v[152:155], a[204:207], a[188:191], -4.0
v_exp_f32_e64 v145, v145
v_mfma_f32_16x16x32_bf16 v[152:155], a[200:203], a[184:187], v[152:155]
v_accvgpr_read_b32 v200, a32
v_accvgpr_read_b32 v201, a33
v_mfma_f32_16x16x32_bf16 v[152:155], a[196:199], a[180:183], v[152:155]
v_exp_f32 v146, v146
v_mfma_f32_16x16x32_bf16 v[152:155], a[192:195], a[176:179], v[152:155]
buffer_store_dwordx4 v[208:211], v249, s[20:23], s57 offen offset:2176 sc1
v_smfmac_f32_16x16x64_bf16 v[216:219], v[224:227], v[160:167], v248
s_waitcnt lgkmcnt(2)
ds_read_b64_tr_b16 a[254:255], v241 offset:29672
v_accvgpr_read_b32 v202, a34
v_mfma_f32_16x16x32_bf16 v[16:19], a[224:227], v[184:187], v[16:19]
v_cvt_pk_bf16_f32 v192, v144, v145
v_accvgpr_read_b32 v203, a35
v_mfma_f32_16x16x32_bf16 v[16:19], a[228:231], v[160:163], v[16:19]
ds_read_b128 a[208:211], v240 offset:37440
ds_read_b128 a[212:215], v240 offset:37696
v_mfma_f32_16x16x32_bf16 v[48:51], a[228:231], v[164:167], v[48:51]
v_exp_f32_e64 v147, v147
v_mfma_f32_16x16x32_bf16 v[48:51], a[224:227], v[188:191], v[48:51]
ds_read_b128 a[216:219], v240 offset:37952
ds_read_b128 a[220:223], v240 offset:38208
v_accvgpr_read_b32 v204, a36
v_mfma_f32_16x16x32_bf16 v[52:55], a[232:235], v[188:191], v[52:55]
v_exp_f32_e64 v148, v148
v_mfma_f32_16x16x32_bf16 v[52:55], a[236:239], v[164:167], v[52:55]
ds_read_b128 a[204:207], v240 offset:34048
ds_read_b128 a[200:203], v240 offset:33792
v_accvgpr_read_b32 v205, a37
v_mfma_f32_16x16x32_bf16 v[20:23], a[236:239], v[160:163], v[20:23]
v_cvt_pk_bf16_f32 v193, v146, v147
v_accvgpr_read_b32 v206, a38
v_mfma_f32_16x16x32_bf16 v[20:23], a[232:235], v[184:187], v[20:23]
ds_read_b128 a[196:199], v240 offset:33536
v_accvgpr_read_b32 v207, a39
v_mfma_f32_16x16x32_bf16 v[24:27], a[240:243], v[184:187], v[24:27]
ds_read_b128 a[192:195], v240 offset:33280
v_mfma_f32_16x16x32_bf16 v[24:27], a[244:247], v[160:163], v[24:27]
v_exp_f32 v149, v149
v_exp_f32 v150, v150
v_cvt_pk_bf16_f32 v194, v148, v149
v_pk_mul_f32 v[206:207], v[206:207], v[250:251] op_sel:[0,1] op_sel_hi:[1,1]
v_pk_mul_f32 v[204:205], v[204:205], v[250:251] op_sel:[0,1] op_sel_hi:[1,1]
v_pk_mul_f32 v[202:203], v[202:203], v[250:251] op_sel:[0,1] op_sel_hi:[1,1]
v_pk_mul_f32 v[200:201], v[200:201], v[250:251] op_sel:[0,1] op_sel_hi:[1,1]
v_cvt_pk_bf16_f32 v200, v200, v201
v_mfma_f32_16x16x32_bf16 v[56:59], a[244:247], v[164:167], v[56:59]
v_exp_f32 v151, v151
v_mfma_f32_16x16x32_bf16 v[56:59], a[240:243], v[188:191], v[56:59]
s_waitcnt lgkmcnt(4)
v_exp_f32_e64 v156, v156
v_mfma_f32_16x16x32_bf16 v[60:63], a[248:251], v[188:191], v[60:63]
v_cvt_pk_bf16_f32 v195, v150, v151
v_cvt_pk_bf16_f32 v201, v202, v203
v_mfma_f32_16x16x32_bf16 v[60:63], a[252:255], v[164:167], v[60:63]
v_exp_f32 v157, v157
v_mfma_f32_16x16x32_bf16 v[28:31], a[252:255], v[160:163], v[28:31]
v_exp_f32 v158, v158
v_mfma_f32_16x16x32_bf16 v[28:31], a[248:251], v[184:187], v[28:31]
s_waitcnt lgkmcnt(0)
v_cvt_pk_bf16_f32 v198, v156, v157
v_cvt_pk_bf16_f32 v202, v204, v205
v_mfma_f32_16x16x32_bf16 v[128:131], a[192:195], a[128:131], -4.0
v_exp_f32 v159, v159
v_mfma_f32_16x16x32_bf16 v[128:131], a[196:199], a[132:135], v[128:131]
v_exp_f32 v152, v152
v_mfma_f32_16x16x32_bf16 v[128:131], a[200:203], a[136:139], v[128:131]
v_cvt_pk_bf16_f32 v199, v158, v159
v_cvt_pk_bf16_f32 v203, v206, v207
v_mfma_f32_16x16x32_bf16 v[128:131], a[204:207], a[140:143], v[128:131]
v_exp_f32 v153, v153
v_mfma_f32_16x16x32_bf16 v[132:135], a[220:223], a[140:143], -4.0
v_exp_f32_e64 v154, v154
v_mfma_f32_16x16x32_bf16 v[132:135], a[216:219], a[136:139], v[132:135]
v_cvt_pk_bf16_f32 v196, v152, v153
v_accvgpr_read_b32 v208, a40
v_mfma_f32_16x16x32_bf16 v[132:135], a[212:215], a[132:135], v[132:135]
v_exp_f32_e64 v155, v155
v_mfma_f32_16x16x32_bf16 v[132:135], a[208:211], a[128:131], v[132:135]
v_cvt_pk_bf16_f32 v197, v154, v155
v_accvgpr_read_b32 v209, a41
v_mfma_f32_16x16x32_bf16 v[140:143], a[208:211], a[144:147], -4.0
v_exp_f32 v128, v128
v_mfma_f32_16x16x32_bf16 v[140:143], a[212:215], a[148:151], v[140:143]
v_exp_f32 v129, v129
v_mfma_f32_16x16x32_bf16 v[140:143], a[216:219], a[152:155], v[140:143]
v_exp_f32_e64 v130, v130
v_mfma_f32_16x16x32_bf16 v[140:143], a[220:223], a[156:159], v[140:143]
s_add_u32 m0, s31, 0x6180
v_cvt_pk_bf16_f32 v160, v128, v129
v_accvgpr_read_b32 v210, a42
v_mfma_f32_16x16x32_bf16 v[136:139], a[204:207], a[156:159], -4.0
v_exp_f32 v131, v131
v_mfma_f32_16x16x32_bf16 v[136:139], a[200:203], a[152:155], v[136:139]
v_exp_f32_e64 v132, v132
v_mfma_f32_16x16x32_bf16 v[136:139], a[196:199], a[148:151], v[136:139]
s_waitcnt vmcnt(18)
v_cvt_pk_bf16_f32 v161, v130, v131
v_accvgpr_read_b32 v211, a43
v_mfma_f32_16x16x32_bf16 v[136:139], a[192:195], a[144:147], v[136:139]
s_barrier
v_smfmac_f32_16x16x64_bf16 v[220:223], v[224:227], v[168:175], v248
buffer_load_dwordx4 v243, s[12:15], s38 offen nt lds
v_mfma_f32_16x16x32_bf16 v[80:83], a[224:227], v[228:231], v[80:83]
v_exp_f32 v133, v133
v_mfma_f32_16x16x32_bf16 v[80:83], a[228:231], v[168:171], v[80:83]
v_exp_f32_e64 v134, v134
v_mfma_f32_16x16x32_bf16 v[112:115], a[228:231], v[172:175], v[112:115]
v_cvt_pk_bf16_f32 v162, v132, v133
v_accvgpr_read_b32 v212, a44
v_mfma_f32_16x16x32_bf16 v[112:115], a[224:227], v[232:235], v[112:115]
ds_read_b64_tr_b16 a[224:225], v241 offset:33024
ds_read_b64_tr_b16 a[226:227], v241 offset:37152
v_mfma_f32_16x16x32_bf16 v[116:119], a[232:235], v[232:235], v[116:119]
v_exp_f32_e64 v135, v135
v_mfma_f32_16x16x32_bf16 v[116:119], a[236:239], v[172:175], v[116:119]
ds_read_b64_tr_b16 a[228:229], v241 offset:41280
ds_read_b64_tr_b16 a[230:231], v241 offset:45408
v_mfma_f32_16x16x32_bf16 v[84:87], a[236:239], v[168:171], v[84:87]
v_exp_f32_e64 v140, v140
v_mfma_f32_16x16x32_bf16 v[84:87], a[232:235], v[228:231], v[84:87]
ds_read_b64_tr_b16 a[232:233], v241 offset:33032
ds_read_b64_tr_b16 a[234:235], v241 offset:37160
v_mfma_f32_16x16x32_bf16 v[88:91], a[240:243], v[228:231], v[88:91]
s_add_u32 m0, s31, 0x6180
v_cvt_pk_bf16_f32 v163, v134, v135
v_accvgpr_read_b32 v213, a45
v_mfma_f32_16x16x32_bf16 v[88:91], a[244:247], v[168:171], v[88:91]
buffer_load_dwordx4 v243, s[12:15], s38 offen offset:1024 nt lds
v_mfma_f32_16x16x32_bf16 v[120:123], a[244:247], v[172:175], v[120:123]
s_xor_b32 s38, s29, 0x1818000
v_exp_f32_e64 v141, v141
v_mfma_f32_16x16x32_bf16 v[120:123], a[240:243], v[232:235], v[120:123]
s_xor_b32 s39, s29, 0x1814000
ds_read_b64_tr_b16 a[236:237], v241 offset:41288
ds_read_b64_tr_b16 a[238:239], v241 offset:45416
v_accvgpr_read_b32 v214, a46
v_mfma_f32_16x16x32_bf16 v[124:127], a[248:251], v[232:235], v[124:127]
v_exp_f32_e64 v142, v142
v_mfma_f32_16x16x32_bf16 v[124:127], a[252:255], v[172:175], v[124:127]
ds_read_b64_tr_b16 a[240:241], v241 offset:33280
ds_read_b64_tr_b16 a[242:243], v241 offset:37408
v_accvgpr_read_b32 v215, a47
v_mfma_f32_16x16x32_bf16 v[92:95], a[252:255], v[168:171], v[92:95]
v_exp_f32 v143, v143
v_mfma_f32_16x16x32_bf16 v[92:95], a[248:251], v[228:231], v[92:95]
ds_read_b64_tr_b16 a[244:245], v241 offset:41536
v_cvt_pk_bf16_f32 v166, v140, v141
v_exp_f32 v136, v136
v_cvt_pk_bf16_f32 v167, v142, v143
v_pk_mul_f32 v[214:215], v[214:215], v[250:251] op_sel:[0,1] op_sel_hi:[1,1]
v_pk_mul_f32 v[212:213], v[212:213], v[250:251] op_sel:[0,1] op_sel_hi:[1,1]
v_pk_mul_f32 v[210:211], v[210:211], v[250:251] op_sel:[0,1] op_sel_hi:[1,1]
v_pk_mul_f32 v[208:209], v[208:209], v[250:251] op_sel:[0,1] op_sel_hi:[1,1]
v_cvt_pk_bf16_f32 v208, v208, v209
v_mfma_f32_16x16x32_bf16 v[144:147], a[192:195], a[160:163], -4.0
v_exp_f32_e64 v137, v137
v_mfma_f32_16x16x32_bf16 v[144:147], a[196:199], a[164:167], v[144:147]
v_exp_f32_e64 v138, v138
v_mfma_f32_16x16x32_bf16 v[144:147], a[200:203], a[168:171], v[144:147]
s_add_u32 m0, s31, 0x8200
v_cvt_pk_bf16_f32 v164, v136, v137
v_cvt_pk_bf16_f32 v209, v210, v211
v_mfma_f32_16x16x32_bf16 v[144:147], a[204:207], a[172:175], v[144:147]
buffer_load_dwordx4 v243, s[12:15], s38 offen nt lds
v_mfma_f32_16x16x32_bf16 v[148:151], a[220:223], a[172:175], -4.0
v_exp_f32 v139, v139
v_mfma_f32_16x16x32_bf16 v[148:151], a[216:219], a[168:171], v[148:151]
v_cvt_pk_bf16_f32 v165, v138, v139
v_cvt_pk_bf16_f32 v210, v212, v213
v_mfma_f32_16x16x32_bf16 v[148:151], a[212:215], a[164:167], v[148:151]
v_cvt_pk_bf16_f32 v211, v214, v215
v_mov_b64 v[212:213], v[200:201]
v_mfma_f32_16x16x32_bf16 v[148:151], a[208:211], a[160:163], v[148:151]
ds_read_b64_tr_b16 a[246:247], v241 offset:45664
ds_read_b64_tr_b16 a[248:249], v241 offset:33288
v_mfma_f32_16x16x32_bf16 v[156:159], a[208:211], a[176:179], -4.0
v_exp_f32 v144, v144
v_mfma_f32_16x16x32_bf16 v[156:159], a[212:215], a[180:183], v[156:159]
v_exp_f32 v145, v145
v_mfma_f32_16x16x32_bf16 v[156:159], a[216:219], a[184:187], v[156:159]
v_exp_f32_e64 v146, v146
v_mfma_f32_16x16x32_bf16 v[156:159], a[220:223], a[188:191], v[156:159]
ds_read_b64_tr_b16 a[250:251], v241 offset:37416
ds_read_b64_tr_b16 a[252:253], v241 offset:41544
v_mfma_f32_16x16x32_bf16 v[152:155], a[204:207], a[188:191], -4.0
s_add_u32 m0, s31, 0x8200
v_cvt_pk_bf16_f32 v184, v144, v145
v_mov_b64 v[214:215], v[202:203]
v_mfma_f32_16x16x32_bf16 v[152:155], a[200:203], a[184:187], v[152:155]
v_exp_f32 v147, v147
v_mfma_f32_16x16x32_bf16 v[152:155], a[196:199], a[180:183], v[152:155]
v_exp_f32 v148, v148
v_mfma_f32_16x16x32_bf16 v[152:155], a[192:195], a[176:179], v[152:155]
buffer_load_dwordx4 v243, s[12:15], s38 offen offset:1024 nt lds
v_smfmac_f32_16x16x64_bf16 v[216:219], v[224:227], v[176:183], v248
s_waitcnt lgkmcnt(2)
ds_read_b64_tr_b16 a[254:255], v241 offset:45672
v_mfma_f32_16x16x32_bf16 v[0:3], a[224:227], v[176:179], v[0:3]
v_cvt_pk_bf16_f32 v185, v146, v147
v_mov_b32_dpp v200, v208 row_ror:8 row_mask:0xf bank_mask:0xc
v_mfma_f32_16x16x32_bf16 v[0:3], a[228:231], v[160:163], v[0:3]
ds_read_b128 a[208:211], v240 offset:45760
ds_read_b128 a[212:215], v240 offset:46016
v_mfma_f32_16x16x32_bf16 v[32:35], a[228:231], v[164:167], v[32:35]
v_exp_f32_e64 v149, v149
v_mfma_f32_16x16x32_bf16 v[32:35], a[224:227], v[180:183], v[32:35]
ds_read_b128 a[216:219], v240 offset:46272
ds_read_b128 a[220:223], v240 offset:46528
v_mfma_f32_16x16x32_bf16 v[36:39], a[232:235], v[180:183], v[36:39]
v_exp_f32_e64 v150, v150
v_mfma_f32_16x16x32_bf16 v[36:39], a[236:239], v[164:167], v[36:39]
ds_read_b128 a[204:207], v240 offset:42368
ds_read_b128 a[200:203], v240 offset:42112
v_mfma_f32_16x16x32_bf16 v[4:7], a[236:239], v[160:163], v[4:7]
v_cvt_pk_bf16_f32 v186, v148, v149
v_mov_b32_dpp v201, v209 row_ror:8 row_mask:0xf bank_mask:0xc
v_mfma_f32_16x16x32_bf16 v[4:7], a[232:235], v[176:179], v[4:7]
s_add_u32 m0, s32, 0x4080
ds_read_b128 a[196:199], v240 offset:41856
v_mov_b32_dpp v202, v210 row_ror:8 row_mask:0xf bank_mask:0xc
v_mfma_f32_16x16x32_bf16 v[8:11], a[240:243], v[176:179], v[8:11]
ds_read_b128 a[192:195], v240 offset:41600
v_mov_b32_dpp v203, v211 row_ror:8 row_mask:0xf bank_mask:0xc
v_mfma_f32_16x16x32_bf16 v[8:11], a[244:247], v[160:163], v[8:11]
buffer_load_dwordx4 v243, s[16:19], s39 offen nt lds
v_mfma_f32_16x16x32_bf16 v[40:43], a[244:247], v[164:167], v[40:43]
v_exp_f32 v151, v151
v_mfma_f32_16x16x32_bf16 v[40:43], a[240:243], v[180:183], v[40:43]
s_waitcnt lgkmcnt(4)
v_exp_f32_e64 v156, v156
v_mfma_f32_16x16x32_bf16 v[44:47], a[248:251], v[180:183], v[44:47]
v_cvt_pk_bf16_f32 v187, v150, v151
v_mov_b32_dpp v208, v212 row_ror:8 row_mask:0xf bank_mask:0x3
v_mfma_f32_16x16x32_bf16 v[44:47], a[252:255], v[164:167], v[44:47]
v_exp_f32 v157, v157
v_mfma_f32_16x16x32_bf16 v[12:15], a[252:255], v[160:163], v[12:15]
v_exp_f32_e64 v158, v158
v_mfma_f32_16x16x32_bf16 v[12:15], a[248:251], v[176:179], v[12:15]
s_waitcnt lgkmcnt(0)
buffer_store_dwordx4 v[200:203], v249, s[20:23], s58 offen sc1
v_mfma_f32_16x16x32_bf16 v[128:131], a[192:195], a[128:131], -4.0
v_cvt_pk_bf16_f32 v190, v156, v157
v_mov_b32_dpp v209, v213 row_ror:8 row_mask:0xf bank_mask:0x3
v_mfma_f32_16x16x32_bf16 v[128:131], a[196:199], a[132:135], v[128:131]
v_exp_f32 v159, v159
v_mfma_f32_16x16x32_bf16 v[128:131], a[200:203], a[136:139], v[128:131]
s_add_u32 m0, s32, 0x4080
v_exp_f32 v152, v152
v_mfma_f32_16x16x32_bf16 v[128:131], a[204:207], a[140:143], v[128:131]
v_cvt_pk_bf16_f32 v191, v158, v159
v_mov_b32_dpp v210, v214 row_ror:8 row_mask:0xf bank_mask:0x3
v_mfma_f32_16x16x32_bf16 v[132:135], a[220:223], a[140:143], -4.0
v_exp_f32 v153, v153
v_mfma_f32_16x16x32_bf16 v[132:135], a[216:219], a[136:139], v[132:135]
v_mov_b32_dpp v211, v215 row_ror:8 row_mask:0xf bank_mask:0x3
v_accvgpr_read_b32 v200, a48
v_mfma_f32_16x16x32_bf16 v[132:135], a[212:215], a[132:135], v[132:135]
v_exp_f32 v154, v154
v_mfma_f32_16x16x32_bf16 v[132:135], a[208:211], a[128:131], v[132:135]
v_cvt_pk_bf16_f32 v188, v152, v153
v_accvgpr_read_b32 v201, a49
v_mfma_f32_16x16x32_bf16 v[140:143], a[208:211], a[144:147], -4.0
v_exp_f32 v155, v155
v_mfma_f32_16x16x32_bf16 v[140:143], a[212:215], a[148:151], v[140:143]
v_cvt_pk_bf16_f32 v189, v154, v155
v_accvgpr_read_b32 v202, a50
v_mfma_f32_16x16x32_bf16 v[140:143], a[216:219], a[152:155], v[140:143]
v_exp_f32 v128, v128
v_mfma_f32_16x16x32_bf16 v[140:143], a[220:223], a[156:159], v[140:143]
buffer_load_dwordx4 v243, s[24:27], s39 offen offset:1032 nt lds
v_mfma_f32_16x16x32_bf16 v[136:139], a[204:207], a[156:159], -4.0
s_xor_b32 s39, s29, 0x1816000
v_exp_f32 v129, v129
v_mfma_f32_16x16x32_bf16 v[136:139], a[200:203], a[152:155], v[136:139]
s_xor_b32 s38, s29, 0x181a000
v_exp_f32 v130, v130
v_mfma_f32_16x16x32_bf16 v[136:139], a[196:199], a[148:151], v[136:139]
v_cvt_pk_bf16_f32 v168, v128, v129
v_accvgpr_read_b32 v203, a51
v_mfma_f32_16x16x32_bf16 v[136:139], a[192:195], a[144:147], v[136:139]
v_exp_f32 v131, v131
v_accvgpr_read_b32 v204, a52
v_smfmac_f32_16x16x64_bf16 v[220:223], v[224:227], v[192:199], v248
buffer_store_dwordx4 v[208:211], v249, s[20:23], s58 offen offset:2048 sc1
v_mfma_f32_16x16x32_bf16 v[64:67], a[224:227], v[192:195], v[64:67]
v_exp_f32 v132, v132
v_mfma_f32_16x16x32_bf16 v[64:67], a[228:231], v[184:187], v[64:67]
v_cvt_pk_bf16_f32 v169, v130, v131
v_accvgpr_read_b32 v205, a53
v_accvgpr_read_b32 v206, a54
v_mfma_f32_16x16x32_bf16 v[96:99], a[228:231], v[188:191], v[96:99]
v_exp_f32_e64 v133, v133
v_mfma_f32_16x16x32_bf16 v[96:99], a[224:227], v[196:199], v[96:99]
s_add_u32 m0, s32, 0x60c0
ds_read_b64_tr_b16 a[224:225], v241 offset:33536
ds_read_b64_tr_b16 a[226:227], v241 offset:37664
v_accvgpr_read_b32 v207, a55
v_mfma_f32_16x16x32_bf16 v[100:103], a[232:235], v[196:199], v[100:103]
v_exp_f32 v134, v134
v_mfma_f32_16x16x32_bf16 v[100:103], a[236:239], v[188:191], v[100:103]
ds_read_b64_tr_b16 a[228:229], v241 offset:41792
v_cvt_pk_bf16_f32 v170, v132, v133
v_exp_f32 v135, v135
v_exp_f32_e64 v140, v140
v_pk_mul_f32 v[206:207], v[206:207], v[250:251] op_sel:[0,1] op_sel_hi:[1,1]
v_pk_mul_f32 v[204:205], v[204:205], v[250:251] op_sel:[0,1] op_sel_hi:[1,1]
v_pk_mul_f32 v[202:203], v[202:203], v[250:251] op_sel:[0,1] op_sel_hi:[1,1]
v_pk_mul_f32 v[200:201], v[200:201], v[250:251] op_sel:[0,1] op_sel_hi:[1,1]
v_cvt_pk_bf16_f32 v200, v200, v201
v_mfma_f32_16x16x32_bf16 v[68:71], a[236:239], v[184:187], v[68:71]
v_cvt_pk_bf16_f32 v171, v134, v135
v_cvt_pk_bf16_f32 v201, v202, v203
v_mfma_f32_16x16x32_bf16 v[68:71], a[232:235], v[192:195], v[68:71]
ds_read_b64_tr_b16 a[230:231], v241 offset:45920
ds_read_b64_tr_b16 a[232:233], v241 offset:33544
v_mfma_f32_16x16x32_bf16 v[72:75], a[240:243], v[192:195], v[72:75]
v_exp_f32 v141, v141
v_mfma_f32_16x16x32_bf16 v[72:75], a[244:247], v[184:187], v[72:75]
buffer_load_dwordx4 v243, s[16:19], s39 offen nt lds
v_mfma_f32_16x16x32_bf16 v[104:107], a[244:247], v[188:191], v[104:107]
v_exp_f32 v142, v142
v_mfma_f32_16x16x32_bf16 v[104:107], a[240:243], v[196:199], v[104:107]
ds_read_b64_tr_b16 a[234:235], v241 offset:37672
ds_read_b64_tr_b16 a[236:237], v241 offset:41800
v_mfma_f32_16x16x32_bf16 v[108:111], a[248:251], v[196:199], v[108:111]
v_cvt_pk_bf16_f32 v174, v140, v141
v_cvt_pk_bf16_f32 v202, v204, v205
v_mfma_f32_16x16x32_bf16 v[108:111], a[252:255], v[188:191], v[108:111]
ds_read_b64_tr_b16 a[238:239], v241 offset:45928
ds_read_b64_tr_b16 a[240:241], v241 offset:33792
v_mfma_f32_16x16x32_bf16 v[76:79], a[252:255], v[184:187], v[76:79]
v_exp_f32 v143, v143
v_mfma_f32_16x16x32_bf16 v[76:79], a[248:251], v[192:195], v[76:79]
ds_read_b64_tr_b16 a[242:243], v241 offset:37920
ds_read_b64_tr_b16 a[244:245], v241 offset:42048
v_mfma_f32_16x16x32_bf16 v[144:147], a[192:195], a[160:163], -4.0
v_exp_f32 v136, v136
v_mfma_f32_16x16x32_bf16 v[144:147], a[196:199], a[164:167], v[144:147]
v_cvt_pk_bf16_f32 v175, v142, v143
v_cvt_pk_bf16_f32 v203, v206, v207
v_mfma_f32_16x16x32_bf16 v[144:147], a[200:203], a[168:171], v[144:147]
s_add_u32 m0, s32, 0x60c0
v_exp_f32 v137, v137
v_mfma_f32_16x16x32_bf16 v[144:147], a[204:207], a[172:175], v[144:147]
buffer_load_dwordx4 v243, s[24:27], s39 offen offset:1032 nt lds
v_mfma_f32_16x16x32_bf16 v[148:151], a[220:223], a[172:175], -4.0
v_exp_f32 v138, v138
v_mfma_f32_16x16x32_bf16 v[148:151], a[216:219], a[168:171], v[148:151]
v_cvt_pk_bf16_f32 v172, v136, v137
v_accvgpr_read_b32 v208, a56
v_mfma_f32_16x16x32_bf16 v[148:151], a[212:215], a[164:167], v[148:151]
v_exp_f32_e64 v139, v139
v_mfma_f32_16x16x32_bf16 v[148:151], a[208:211], a[160:163], v[148:151]
ds_read_b64_tr_b16 a[246:247], v241 offset:46176
ds_read_b64_tr_b16 a[248:249], v241 offset:33800
v_mfma_f32_16x16x32_bf16 v[156:159], a[208:211], a[176:179], -4.0
v_cvt_pk_bf16_f32 v173, v138, v139
v_accvgpr_read_b32 v209, a57
v_mfma_f32_16x16x32_bf16 v[156:159], a[212:215], a[180:183], v[156:159]
v_exp_f32 v144, v144
v_mfma_f32_16x16x32_bf16 v[156:159], a[216:219], a[184:187], v[156:159]
v_exp_f32 v145, v145
v_mfma_f32_16x16x32_bf16 v[156:159], a[220:223], a[188:191], v[156:159]
ds_read_b64_tr_b16 a[250:251], v241 offset:37928
ds_read_b64_tr_b16 a[252:253], v241 offset:42056
v_mfma_f32_16x16x32_bf16 v[152:155], a[204:207], a[188:191], -4.0
v_exp_f32 v146, v146
v_mfma_f32_16x16x32_bf16 v[152:155], a[200:203], a[184:187], v[152:155]
v_cvt_pk_bf16_f32 v228, v144, v145
v_accvgpr_read_b32 v210, a58
v_mfma_f32_16x16x32_bf16 v[152:155], a[196:199], a[180:183], v[152:155]
v_exp_f32 v147, v147
v_mfma_f32_16x16x32_bf16 v[152:155], a[192:195], a[176:179], v[152:155]
ds_read_b64_tr_b16 a[254:255], v241 offset:46184
ds_read_b128 a[208:211], v240 offset:54080
v_smfmac_f32_16x16x64_bf16 v[216:219], v[224:227], v[160:167], v248
s_waitcnt lgkmcnt(4)
ds_read_b128 a[212:215], v240 offset:54336
v_accvgpr_read_b32 v211, a59
v_mfma_f32_16x16x32_bf16 v[16:19], a[224:227], v[176:179], v[16:19]
v_exp_f32 v148, v148
v_mfma_f32_16x16x32_bf16 v[16:19], a[228:231], v[160:163], v[16:19]
ds_read_b128 a[216:219], v240 offset:54592
ds_read_b128 a[220:223], v240 offset:54848
v_accvgpr_read_b32 v212, a60
v_mfma_f32_16x16x32_bf16 v[48:51], a[228:231], v[164:167], v[48:51]
v_cvt_pk_bf16_f32 v229, v146, v147
v_accvgpr_read_b32 v213, a61
v_mfma_f32_16x16x32_bf16 v[48:51], a[224:227], v[180:183], v[48:51]
ds_read_b128 a[204:207], v240 offset:50688
v_accvgpr_read_b32 v214, a62
v_mfma_f32_16x16x32_bf16 v[52:55], a[232:235], v[180:183], v[52:55]
v_exp_f32 v149, v149
v_mfma_f32_16x16x32_bf16 v[52:55], a[236:239], v[164:167], v[52:55]
ds_read_b128 a[200:203], v240 offset:50432
v_accvgpr_read_b32 v215, a63
v_mfma_f32_16x16x32_bf16 v[20:23], a[236:239], v[160:163], v[20:23]
v_exp_f32 v150, v150
v_mfma_f32_16x16x32_bf16 v[20:23], a[232:235], v[176:179], v[20:23]
ds_read_b128 a[196:199], v240 offset:50176
v_cvt_pk_bf16_f32 v230, v148, v149
v_exp_f32 v151, v151
v_exp_f32 v156, v156
v_pk_mul_f32 v[214:215], v[214:215], v[250:251] op_sel:[0,1] op_sel_hi:[1,1]
v_pk_mul_f32 v[212:213], v[212:213], v[250:251] op_sel:[0,1] op_sel_hi:[1,1]
v_pk_mul_f32 v[210:211], v[210:211], v[250:251] op_sel:[0,1] op_sel_hi:[1,1]
v_pk_mul_f32 v[208:209], v[208:209], v[250:251] op_sel:[0,1] op_sel_hi:[1,1]
v_cvt_pk_bf16_f32 v208, v208, v209
v_mfma_f32_16x16x32_bf16 v[24:27], a[240:243], v[176:179], v[24:27]
ds_read_b128 a[192:195], v240 offset:49920
v_cvt_pk_bf16_f32 v231, v150, v151
v_mfma_f32_16x16x32_bf16 v[24:27], a[244:247], v[160:163], v[24:27]
v_exp_f32 v157, v157
v_mfma_f32_16x16x32_bf16 v[56:59], a[244:247], v[164:167], v[56:59]
v_exp_f32_e64 v158, v158
v_mfma_f32_16x16x32_bf16 v[56:59], a[240:243], v[180:183], v[56:59]
s_waitcnt lgkmcnt(3)
v_cvt_pk_bf16_f32 v234, v156, v157
v_cvt_pk_bf16_f32 v209, v210, v211
v_mfma_f32_16x16x32_bf16 v[60:63], a[248:251], v[180:183], v[60:63]
v_exp_f32 v159, v159
v_mfma_f32_16x16x32_bf16 v[60:63], a[252:255], v[164:167], v[60:63]
v_exp_f32 v152, v152
v_mfma_f32_16x16x32_bf16 v[28:31], a[252:255], v[160:163], v[28:31]
v_cvt_pk_bf16_f32 v235, v158, v159
v_cvt_pk_bf16_f32 v210, v212, v213
v_mfma_f32_16x16x32_bf16 v[28:31], a[248:251], v[176:179], v[28:31]
s_waitcnt lgkmcnt(0)
v_exp_f32 v153, v153
v_mfma_f32_16x16x32_bf16 v[128:131], a[192:195], a[128:131], -4.0
v_exp_f32 v154, v154
v_mfma_f32_16x16x32_bf16 v[128:131], a[196:199], a[132:135], v[128:131]
v_cvt_pk_bf16_f32 v232, v152, v153
v_cvt_pk_bf16_f32 v211, v214, v215
v_mfma_f32_16x16x32_bf16 v[128:131], a[200:203], a[136:139], v[128:131]
v_exp_f32 v155, v155
v_mfma_f32_16x16x32_bf16 v[128:131], a[204:207], a[140:143], v[128:131]
v_cvt_pk_bf16_f32 v233, v154, v155
v_mov_b64 v[212:213], v[200:201]
v_mfma_f32_16x16x32_bf16 v[132:135], a[220:223], a[140:143], -4.0
v_mov_b64 v[214:215], v[202:203]
v_mov_b32_dpp v200, v208 row_ror:8 row_mask:0xf bank_mask:0xc
v_mfma_f32_16x16x32_bf16 v[132:135], a[216:219], a[136:139], v[132:135]
v_mov_b32_dpp v201, v209 row_ror:8 row_mask:0xf bank_mask:0xc
v_mov_b32_dpp v202, v210 row_ror:8 row_mask:0xf bank_mask:0xc
v_mfma_f32_16x16x32_bf16 v[132:135], a[212:215], a[132:135], v[132:135]
L_pad17:
s_cbranch_vccnz L_back0
v_exp_f32 v128, v128
v_mfma_f32_16x16x32_bf16 v[132:135], a[208:211], a[128:131], v[132:135]
v_exp_f32 v129, v129
v_mfma_f32_16x16x32_bf16 v[140:143], a[208:211], a[144:147], -4.0
v_exp_f32 v130, v130
v_mfma_f32_16x16x32_bf16 v[140:143], a[212:215], a[148:151], v[140:143]
v_cvt_pk_bf16_f32 v160, v128, v129
v_mov_b32_dpp v203, v211 row_ror:8 row_mask:0xf bank_mask:0xc
v_mfma_f32_16x16x32_bf16 v[140:143], a[216:219], a[152:155], v[140:143]
v_exp_f32 v131, v131
v_mfma_f32_16x16x32_bf16 v[140:143], a[220:223], a[156:159], v[140:143]
s_add_u32 m0, s31, 0xa280
v_exp_f32 v132, v132
v_mfma_f32_16x16x32_bf16 v[136:139], a[204:207], a[156:159], -4.0
v_cvt_pk_bf16_f32 v161, v130, v131
v_mov_b32_dpp v208, v212 row_ror:8 row_mask:0xf bank_mask:0x3
v_mfma_f32_16x16x32_bf16 v[136:139], a[200:203], a[152:155], v[136:139]
v_exp_f32 v133, v133
v_mfma_f32_16x16x32_bf16 v[136:139], a[196:199], a[148:151], v[136:139]
s_waitcnt vmcnt(18)
v_exp_f32 v134, v134
v_mfma_f32_16x16x32_bf16 v[136:139], a[192:195], a[144:147], v[136:139]
s_barrier
v_smfmac_f32_16x16x64_bf16 v[220:223], v[224:227], v[184:191], v248
buffer_load_dwordx4 v243, s[12:15], s38 offen nt lds
v_mfma_f32_16x16x32_bf16 v[80:83], a[224:227], v[192:195], v[80:83]
v_cvt_pk_bf16_f32 v162, v132, v133
v_mov_b32_dpp v209, v213 row_ror:8 row_mask:0xf bank_mask:0x3
v_mfma_f32_16x16x32_bf16 v[80:83], a[228:231], v[184:187], v[80:83]
v_exp_f32 v135, v135
v_mfma_f32_16x16x32_bf16 v[112:115], a[228:231], v[188:191], v[112:115]
v_exp_f32 v140, v140
v_mfma_f32_16x16x32_bf16 v[112:115], a[224:227], v[196:199], v[112:115]
ds_read_b64_tr_b16 a[224:225], v241 offset:49536
ds_read_b64_tr_b16 a[226:227], v241 offset:53664
v_mfma_f32_16x16x32_bf16 v[116:119], a[232:235], v[196:199], v[116:119]
v_cvt_pk_bf16_f32 v163, v134, v135
v_mov_b32_dpp v210, v214 row_ror:8 row_mask:0xf bank_mask:0x3
v_mfma_f32_16x16x32_bf16 v[116:119], a[236:239], v[188:191], v[116:119]
buffer_store_dwordx4 v[200:203], v249, s[20:23], s58 offen offset:128 sc1
v_mfma_f32_16x16x32_bf16 v[84:87], a[236:239], v[184:187], v[84:87]
v_exp_f32_e64 v141, v141
v_mfma_f32_16x16x32_bf16 v[84:87], a[232:235], v[192:195], v[84:87]
ds_read_b64_tr_b16 a[228:229], v241 offset:57792
ds_read_b64_tr_b16 a[230:231], v241 offset:61920
v_mfma_f32_16x16x32_bf16 v[88:91], a[240:243], v[192:195], v[88:91]
s_add_u32 m0, s31, 0xa280
v_exp_f32_e64 v142, v142
v_mfma_f32_16x16x32_bf16 v[88:91], a[244:247], v[184:187], v[88:91]
ds_read_b64_tr_b16 a[232:233], v241 offset:49544
ds_read_b64_tr_b16 a[234:235], v241 offset:53672
v_mfma_f32_16x16x32_bf16 v[120:123], a[244:247], v[188:191], v[120:123]
v_cvt_pk_bf16_f32 v166, v140, v141
v_mov_b32_dpp v211, v215 row_ror:8 row_mask:0xf bank_mask:0x3
v_mfma_f32_16x16x32_bf16 v[120:123], a[240:243], v[196:199], v[120:123]
ds_read_b64_tr_b16 a[236:237], v241 offset:57800
ds_read_b64_tr_b16 a[238:239], v241 offset:61928
v_mfma_f32_16x16x32_bf16 v[124:127], a[248:251], v[196:199], v[124:127]
v_exp_f32_e64 v143, v143
v_mfma_f32_16x16x32_bf16 v[124:127], a[252:255], v[188:191], v[124:127]
ds_read_b64_tr_b16 a[240:241], v241 offset:49792
ds_read_b64_tr_b16 a[242:243], v241 offset:53920
v_mfma_f32_16x16x32_bf16 v[92:95], a[252:255], v[184:187], v[92:95]
v_exp_f32_e64 v136, v136
v_mfma_f32_16x16x32_bf16 v[92:95], a[248:251], v[192:195], v[92:95]
buffer_load_dwordx4 v243, s[12:15], s38 offen offset:1024 nt lds
v_mfma_f32_16x16x32_bf16 v[144:147], a[192:195], a[160:163], -4.0
s_xor_b32 s38, s29, 0x181c000
v_cvt_pk_bf16_f32 v167, v142, v143
v_accvgpr_read_b32 v200, a64
v_mfma_f32_16x16x32_bf16 v[144:147], a[196:199], a[164:167], v[144:147]
s_xor_b32 s39, s29, 0x1818000
v_accvgpr_read_b32 v201, a65
v_accvgpr_read_b32 v202, a66
v_mfma_f32_16x16x32_bf16 v[144:147], a[200:203], a[168:171], v[144:147]
v_exp_f32_e64 v137, v137
v_mfma_f32_16x16x32_bf16 v[144:147], a[204:207], a[172:175], v[144:147]
ds_read_b64_tr_b16 a[244:245], v241 offset:58048
ds_read_b64_tr_b16 a[246:247], v241 offset:62176
v_mfma_f32_16x16x32_bf16 v[148:151], a[220:223], a[172:175], -4.0
v_exp_f32_e64 v138, v138
v_mfma_f32_16x16x32_bf16 v[148:151], a[216:219], a[168:171], v[148:151]
v_cvt_pk_bf16_f32 v164, v136, v137
v_accvgpr_read_b32 v203, a67
v_mfma_f32_16x16x32_bf16 v[148:151], a[212:215], a[164:167], v[148:151]
v_exp_f32_e64 v139, v139
v_mfma_f32_16x16x32_bf16 v[148:151], a[208:211], a[160:163], v[148:151]
buffer_store_dwordx4 v[208:211], v249, s[20:23], s58 offen offset:2176 sc1
v_mfma_f32_16x16x32_bf16 v[156:159], a[208:211], a[176:179], -4.0
s_add_u32 m0, s31, 0xc300
v_cvt_pk_bf16_f32 v165, v138, v139
v_accvgpr_read_b32 v204, a68
v_mfma_f32_16x16x32_bf16 v[156:159], a[212:215], a[180:183], v[156:159]
s_xor_b32 s59, s28, 0x2002000
v_accvgpr_read_b32 v205, a69
v_accvgpr_read_b32 v206, a70
v_mfma_f32_16x16x32_bf16 v[156:159], a[216:219], a[184:187], v[156:159]
s_xor_b32 s35, s28, 0x2003000
v_accvgpr_read_b32 v207, a71
v_mfma_f32_16x16x32_bf16 v[156:159], a[220:223], a[188:191], v[156:159]
ds_read_b64_tr_b16 a[248:249], v241 offset:49800
v_exp_f32 v144, v144
v_exp_f32 v145, v145
v_pk_mul_f32 v[206:207], v[206:207], v[252:253] op_sel:[0,0] op_sel_hi:[1,0]
v_pk_mul_f32 v[204:205], v[204:205], v[252:253] op_sel:[0,0] op_sel_hi:[1,0]
v_pk_mul_f32 v[202:203], v[202:203], v[252:253] op_sel:[0,0] op_sel_hi:[1,0]
v_pk_mul_f32 v[200:201], v[200:201], v[252:253] op_sel:[0,0] op_sel_hi:[1,0]
v_cvt_pk_bf16_f32 v200, v200, v201
v_mfma_f32_16x16x32_bf16 v[152:155], a[204:207], a[188:191], -4.0
v_exp_f32 v146, v146
v_mfma_f32_16x16x32_bf16 v[152:155], a[200:203], a[184:187], v[152:155]
v_cvt_pk_bf16_f32 v176, v144, v145
v_cvt_pk_bf16_f32 v201, v202, v203
v_mfma_f32_16x16x32_bf16 v[152:155], a[196:199], a[180:183], v[152:155]
v_exp_f32 v147, v147
v_mfma_f32_16x16x32_bf16 v[152:155], a[192:195], a[176:179], v[152:155]
ds_read_b64_tr_b16 a[250:251], v241 offset:53928
ds_read_b64_tr_b16 a[252:253], v241 offset:58056
v_smfmac_f32_16x16x64_bf16 v[216:219], v[224:227], v[168:175], v248
s_waitcnt lgkmcnt(3)
ds_read_b64_tr_b16 a[254:255], v241 offset:62184
v_mfma_f32_16x16x32_bf16 v[0:3], a[224:227], v[168:171], v[0:3]
v_exp_f32 v148, v148
v_mfma_f32_16x16x32_bf16 v[0:3], a[228:231], v[160:163], v[0:3]
ds_read_b128 a[208:211], v240 offset:4160
ds_read_b128 a[212:215], v240 offset:4416
v_mfma_f32_16x16x32_bf16 v[32:35], a[228:231], v[164:167], v[32:35]
v_cvt_pk_bf16_f32 v177, v146, v147
v_cvt_pk_bf16_f32 v202, v204, v205
v_mfma_f32_16x16x32_bf16 v[32:35], a[224:227], v[172:175], v[32:35]
ds_read_b128 a[216:219], v240 offset:4672
ds_read_b128 a[220:223], v240 offset:4928
v_mfma_f32_16x16x32_bf16 v[36:39], a[232:235], v[172:175], v[36:39]
v_exp_f32_e64 v149, v149
v_mfma_f32_16x16x32_bf16 v[36:39], a[236:239], v[164:167], v[36:39]
ds_read_b128 a[204:207], v240 offset:768
ds_read_b128 a[200:203], v240 offset:512
v_mfma_f32_16x16x32_bf16 v[4:7], a[236:239], v[160:163], v[4:7]
v_exp_f32_e64 v150, v150
v_mfma_f32_16x16x32_bf16 v[4:7], a[232:235], v[168:171], v[4:7]
ds_read_b128 a[196:199], v240 offset:256
v_cvt_pk_bf16_f32 v178, v148, v149
v_mfma_f32_16x16x32_bf16 v[8:11], a[240:243], v[168:171], v[8:11]
ds_read_b128 a[192:195], v240
v_cvt_pk_bf16_f32 v203, v206, v207
v_mfma_f32_16x16x32_bf16 v[8:11], a[244:247], v[160:163], v[8:11]
buffer_load_dwordx4 v243, s[12:15], s38 offen nt lds
v_mfma_f32_16x16x32_bf16 v[40:43], a[244:247], v[164:167], v[40:43]
v_exp_f32 v151, v151
v_mfma_f32_16x16x32_bf16 v[40:43], a[240:243], v[172:175], v[40:43]
s_waitcnt lgkmcnt(4)
v_exp_f32_e64 v156, v156
v_mfma_f32_16x16x32_bf16 v[44:47], a[248:251], v[172:175], v[44:47]
v_cvt_pk_bf16_f32 v179, v150, v151
v_accvgpr_read_b32 v208, a72
v_mfma_f32_16x16x32_bf16 v[44:47], a[252:255], v[164:167], v[44:47]
v_exp_f32 v157, v157
v_mfma_f32_16x16x32_bf16 v[12:15], a[252:255], v[160:163], v[12:15]
v_exp_f32_e64 v158, v158
v_mfma_f32_16x16x32_bf16 v[12:15], a[248:251], v[168:171], v[12:15]
s_waitcnt lgkmcnt(0)
v_cvt_pk_bf16_f32 v182, v156, v157
v_accvgpr_read_b32 v209, a73
v_mfma_f32_16x16x32_bf16 v[128:131], a[192:195], a[128:131], -4.0
v_exp_f32 v159, v159
v_mfma_f32_16x16x32_bf16 v[128:131], a[196:199], a[132:135], v[128:131]
v_exp_f32 v152, v152
v_mfma_f32_16x16x32_bf16 v[128:131], a[200:203], a[136:139], v[128:131]
s_add_u32 m0, s31, 0xc300
v_cvt_pk_bf16_f32 v183, v158, v159
v_accvgpr_read_b32 v210, a74
v_mfma_f32_16x16x32_bf16 v[128:131], a[204:207], a[140:143], v[128:131]
buffer_load_dwordx4 v243, s[12:15], s38 offen offset:1024 nt lds
v_mfma_f32_16x16x32_bf16 v[132:135], a[220:223], a[140:143], -4.0
v_exp_f32 v153, v153
v_mfma_f32_16x16x32_bf16 v[132:135], a[216:219], a[136:139], v[132:135]
v_exp_f32 v154, v154
v_mfma_f32_16x16x32_bf16 v[132:135], a[212:215], a[132:135], v[132:135]
v_cvt_pk_bf16_f32 v180, v152, v153
v_accvgpr_read_b32 v211, a75
v_mfma_f32_16x16x32_bf16 v[132:135], a[208:211], a[128:131], v[132:135]
v_exp_f32 v155, v155
v_mfma_f32_16x16x32_bf16 v[140:143], a[208:211], a[144:147], -4.0
v_cvt_pk_bf16_f32 v181, v154, v155
v_accvgpr_read_b32 v212, a76
v_mfma_f32_16x16x32_bf16 v[140:143], a[212:215], a[148:151], v[140:143]
v_exp_f32 v128, v128
v_mfma_f32_16x16x32_bf16 v[140:143], a[216:219], a[152:155], v[140:143]
v_exp_f32 v129, v129
v_mfma_f32_16x16x32_bf16 v[140:143], a[220:223], a[156:159], v[140:143]
v_exp_f32 v130, v130
v_mfma_f32_16x16x32_bf16 v[136:139], a[204:207], a[156:159], -4.0
s_add_u32 m0, s32, 0x8100
v_cvt_pk_bf16_f32 v184, v128, v129
v_accvgpr_read_b32 v213, a77
v_mfma_f32_16x16x32_bf16 v[136:139], a[200:203], a[152:155], v[136:139]
v_exp_f32_e64 v131, v131
v_mfma_f32_16x16x32_bf16 v[136:139], a[196:199], a[148:151], v[136:139]
v_accvgpr_read_b32 v214, a78
v_accvgpr_read_b32 v215, a79
v_mfma_f32_16x16x32_bf16 v[136:139], a[192:195], a[144:147], v[136:139]
buffer_load_dwordx4 v243, s[16:19], s39 offen nt lds
v_smfmac_f32_16x16x64_bf16 v[220:223], v[224:227], v[228:235], v248
v_exp_f32 v132, v132
v_cvt_pk_bf16_f32 v185, v130, v131
v_exp_f32 v133, v133
v_pk_mul_f32 v[214:215], v[214:215], v[252:253] op_sel:[0,0] op_sel_hi:[1,0]
v_pk_mul_f32 v[212:213], v[212:213], v[252:253] op_sel:[0,0] op_sel_hi:[1,0]
v_pk_mul_f32 v[210:211], v[210:211], v[252:253] op_sel:[0,0] op_sel_hi:[1,0]
v_pk_mul_f32 v[208:209], v[208:209], v[252:253] op_sel:[0,0] op_sel_hi:[1,0]
v_cvt_pk_bf16_f32 v208, v208, v209
v_mfma_f32_16x16x32_bf16 v[64:67], a[224:227], v[228:231], v[64:67]
v_exp_f32_e64 v134, v134
v_mfma_f32_16x16x32_bf16 v[64:67], a[228:231], v[176:179], v[64:67]
v_cvt_pk_bf16_f32 v186, v132, v133
v_cvt_pk_bf16_f32 v209, v210, v211
v_mfma_f32_16x16x32_bf16 v[96:99], a[228:231], v[180:183], v[96:99]
v_exp_f32 v135, v135
v_mfma_f32_16x16x32_bf16 v[96:99], a[224:227], v[232:235], v[96:99]
ds_read_b64_tr_b16 a[224:225], v241 offset:50048
ds_read_b64_tr_b16 a[226:227], v241 offset:54176
v_mfma_f32_16x16x32_bf16 v[100:103], a[232:235], v[232:235], v[100:103]
v_exp_f32 v140, v140
v_mfma_f32_16x16x32_bf16 v[100:103], a[236:239], v[180:183], v[100:103]
ds_read_b64_tr_b16 a[228:229], v241 offset:58304
ds_read_b64_tr_b16 a[230:231], v241 offset:62432
v_mfma_f32_16x16x32_bf16 v[68:71], a[236:239], v[176:179], v[68:71]
v_cvt_pk_bf16_f32 v187, v134, v135
v_cvt_pk_bf16_f32 v210, v212, v213
v_mfma_f32_16x16x32_bf16 v[68:71], a[232:235], v[228:231], v[68:71]
s_add_u32 m0, s32, 0x8100
ds_read_b64_tr_b16 a[232:233], v241 offset:50056
ds_read_b64_tr_b16 a[234:235], v241 offset:54184
v_mfma_f32_16x16x32_bf16 v[72:75], a[240:243], v[228:231], v[72:75]
v_exp_f32 v141, v141
v_mfma_f32_16x16x32_bf16 v[72:75], a[244:247], v[176:179], v[72:75]
buffer_load_dwordx4 v243, s[24:27], s39 offen offset:1032 nt lds
v_mfma_f32_16x16x32_bf16 v[104:107], a[244:247], v[180:183], v[104:107]
s_xor_b32 s39, s29, 0x181a000
v_exp_f32 v142, v142
v_mfma_f32_16x16x32_bf16 v[104:107], a[240:243], v[232:235], v[104:107]
s_xor_b32 s38, s29, 0x181e000
ds_read_b64_tr_b16 a[236:237], v241 offset:58312
ds_read_b64_tr_b16 a[238:239], v241 offset:62440
v_mfma_f32_16x16x32_bf16 v[108:111], a[248:251], v[232:235], v[108:111]
v_cvt_pk_bf16_f32 v190, v140, v141
v_cvt_pk_bf16_f32 v211, v214, v215
v_mfma_f32_16x16x32_bf16 v[108:111], a[252:255], v[180:183], v[108:111]
ds_read_b64_tr_b16 a[240:241], v241 offset:50304
ds_read_b64_tr_b16 a[242:243], v241 offset:54432
v_mfma_f32_16x16x32_bf16 v[76:79], a[252:255], v[176:179], v[76:79]
v_exp_f32 v143, v143
v_mfma_f32_16x16x32_bf16 v[76:79], a[248:251], v[228:231], v[76:79]
ds_read_b64_tr_b16 a[244:245], v241 offset:58560
v_mov_b64 v[212:213], v[200:201]
v_mfma_f32_16x16x32_bf16 v[144:147], a[192:195], a[160:163], -4.0
v_exp_f32_e64 v136, v136
v_mfma_f32_16x16x32_bf16 v[144:147], a[196:199], a[164:167], v[144:147]
v_cvt_pk_bf16_f32 v191, v142, v143
v_mov_b64 v[214:215], v[202:203]
v_mfma_f32_16x16x32_bf16 v[144:147], a[200:203], a[168:171], v[144:147]
s_add_u32 m0, s32, 0xa140
v_exp_f32 v137, v137
v_mfma_f32_16x16x32_bf16 v[144:147], a[204:207], a[172:175], v[144:147]
buffer_load_dwordx4 v243, s[16:19], s39 offen nt lds
v_mfma_f32_16x16x32_bf16 v[148:151], a[220:223], a[172:175], -4.0
v_exp_f32 v138, v138
v_mfma_f32_16x16x32_bf16 v[148:151], a[216:219], a[168:171], v[148:151]
v_cvt_pk_bf16_f32 v188, v136, v137
v_mov_b32_dpp v200, v208 row_ror:8 row_mask:0xf bank_mask:0xc
v_mfma_f32_16x16x32_bf16 v[148:151], a[212:215], a[164:167], v[148:151]
v_exp_f32 v139, v139
v_mfma_f32_16x16x32_bf16 v[148:151], a[208:211], a[160:163], v[148:151]
ds_read_b64_tr_b16 a[246:247], v241 offset:62688
ds_read_b64_tr_b16 a[248:249], v241 offset:50312
v_mfma_f32_16x16x32_bf16 v[156:159], a[208:211], a[176:179], -4.0
v_cvt_pk_bf16_f32 v189, v138, v139
v_mov_b32_dpp v201, v209 row_ror:8 row_mask:0xf bank_mask:0xc
v_mfma_f32_16x16x32_bf16 v[156:159], a[212:215], a[180:183], v[156:159]
v_exp_f32 v144, v144
v_mfma_f32_16x16x32_bf16 v[156:159], a[216:219], a[184:187], v[156:159]
v_exp_f32 v145, v145
v_mfma_f32_16x16x32_bf16 v[156:159], a[220:223], a[188:191], v[156:159]
ds_read_b64_tr_b16 a[250:251], v241 offset:54440
ds_read_b64_tr_b16 a[252:253], v241 offset:58568
v_mfma_f32_16x16x32_bf16 v[152:155], a[204:207], a[188:191], -4.0
s_add_u32 m0, s32, 0xa140
v_exp_f32 v146, v146
v_mfma_f32_16x16x32_bf16 v[152:155], a[200:203], a[184:187], v[152:155]
v_cvt_pk_bf16_f32 v192, v144, v145
v_mov_b32_dpp v202, v210 row_ror:8 row_mask:0xf bank_mask:0xc
v_mfma_f32_16x16x32_bf16 v[152:155], a[196:199], a[180:183], v[152:155]
v_exp_f32 v147, v147
v_mfma_f32_16x16x32_bf16 v[152:155], a[192:195], a[176:179], v[152:155]
buffer_load_dwordx4 v243, s[24:27], s39 offen offset:1032 nt lds
v_smfmac_f32_16x16x64_bf16 v[216:219], v[224:227], v[160:167], v248
s_waitcnt lgkmcnt(2)
ds_read_b64_tr_b16 a[254:255], v241 offset:62696
v_mfma_f32_16x16x32_bf16 v[16:19], a[224:227], v[168:171], v[16:19]
s_xor_b32 s39, s29, 0x181c000
v_exp_f32 v148, v148
v_mfma_f32_16x16x32_bf16 v[16:19], a[228:231], v[160:163], v[16:19]
ds_read_b128 a[208:211], v240 offset:12480
ds_read_b128 a[212:215], v240 offset:12736
v_mov_b32_dpp v203, v211 row_ror:8 row_mask:0xf bank_mask:0xc
v_mfma_f32_16x16x32_bf16 v[48:51], a[228:231], v[164:167], v[48:51]
v_cvt_pk_bf16_f32 v193, v146, v147
v_mov_b32_dpp v208, v212 row_ror:8 row_mask:0xf bank_mask:0x3
v_mfma_f32_16x16x32_bf16 v[48:51], a[224:227], v[172:175], v[48:51]
ds_read_b128 a[216:219], v240 offset:12992
ds_read_b128 a[220:223], v240 offset:13248
v_mfma_f32_16x16x32_bf16 v[52:55], a[232:235], v[172:175], v[52:55]
v_mov_b32_dpp v209, v213 row_ror:8 row_mask:0xf bank_mask:0x3
v_mov_b32_dpp v210, v214 row_ror:8 row_mask:0xf bank_mask:0x3
v_mfma_f32_16x16x32_bf16 v[52:55], a[236:239], v[164:167], v[52:55]
ds_read_b128 a[204:207], v240 offset:9088
ds_read_b128 a[200:203], v240 offset:8832
v_mfma_f32_16x16x32_bf16 v[20:23], a[236:239], v[160:163], v[20:23]
v_exp_f32_e64 v149, v149
v_mfma_f32_16x16x32_bf16 v[20:23], a[232:235], v[168:171], v[20:23]
ds_read_b128 a[196:199], v240 offset:8576
v_mov_b32_dpp v211, v215 row_ror:8 row_mask:0xf bank_mask:0x3
v_mfma_f32_16x16x32_bf16 v[24:27], a[240:243], v[168:171], v[24:27]
ds_read_b128 a[192:195], v240 offset:8320
v_mfma_f32_16x16x32_bf16 v[24:27], a[244:247], v[160:163], v[24:27]
buffer_store_dwordx4 v[200:203], v249, s[20:23], s59 offen sc1
v_mfma_f32_16x16x32_bf16 v[56:59], a[244:247], v[164:167], v[56:59]
v_exp_f32 v150, v150
v_mfma_f32_16x16x32_bf16 v[56:59], a[240:243], v[172:175], v[56:59]
s_waitcnt lgkmcnt(4)
v_cvt_pk_bf16_f32 v194, v148, v149
v_accvgpr_read_b32 v200, a80
v_accvgpr_read_b32 v201, a81
v_mfma_f32_16x16x32_bf16 v[60:63], a[248:251], v[172:175], v[60:63]
v_exp_f32_e64 v151, v151
v_mfma_f32_16x16x32_bf16 v[60:63], a[252:255], v[164:167], v[60:63]
v_exp_f32 v156, v156
v_accvgpr_read_b32 v202, a82
v_mfma_f32_16x16x32_bf16 v[28:31], a[252:255], v[160:163], v[28:31]
v_cvt_pk_bf16_f32 v195, v150, v151
v_accvgpr_read_b32 v203, a83
v_mfma_f32_16x16x32_bf16 v[28:31], a[248:251], v[168:171], v[28:31]
s_waitcnt lgkmcnt(0)
v_exp_f32_e64 v157, v157
v_accvgpr_read_b32 v204, a84
v_mfma_f32_16x16x32_bf16 v[128:131], a[192:195], a[128:131], -4.0
v_exp_f32 v158, v158
v_mfma_f32_16x16x32_bf16 v[128:131], a[196:199], a[132:135], v[128:131]
v_cvt_pk_bf16_f32 v198, v156, v157
v_accvgpr_read_b32 v205, a85
v_mfma_f32_16x16x32_bf16 v[128:131], a[200:203], a[136:139], v[128:131]
v_exp_f32 v159, v159
v_mfma_f32_16x16x32_bf16 v[128:131], a[204:207], a[140:143], v[128:131]
buffer_store_dwordx4 v[208:211], v249, s[20:23], s59 offen offset:2048 sc1
v_mfma_f32_16x16x32_bf16 v[132:135], a[220:223], a[140:143], -4.0
v_exp_f32 v152, v152
v_mfma_f32_16x16x32_bf16 v[132:135], a[216:219], a[136:139], v[132:135]
v_cvt_pk_bf16_f32 v199, v158, v159
v_accvgpr_read_b32 v206, a86
v_mfma_f32_16x16x32_bf16 v[132:135], a[212:215], a[132:135], v[132:135]
v_exp_f32 v153, v153
v_mfma_f32_16x16x32_bf16 v[132:135], a[208:211], a[128:131], v[132:135]
v_accvgpr_read_b32 v207, a87
v_exp_f32 v154, v154
v_mfma_f32_16x16x32_bf16 v[140:143], a[208:211], a[144:147], -4.0
v_exp_f32 v155, v155
v_mfma_f32_16x16x32_bf16 v[140:143], a[212:215], a[148:151], v[140:143]
v_cvt_pk_bf16_f32 v196, v152, v153
v_cvt_pk_bf16_f32 v197, v154, v155
v_mfma_f32_16x16x32_bf16 v[140:143], a[216:219], a[152:155], v[140:143]
v_exp_f32_e64 v128, v128
v_mfma_f32_16x16x32_bf16 v[140:143], a[220:223], a[156:159], v[140:143]
s_add_u32 m0, s31, 0x0
v_exp_f32 v129, v129
v_exp_f32_e64 v130, v130
v_cvt_pk_bf16_f32 v160, v128, v129
v_pk_mul_f32 v[206:207], v[206:207], v[252:253] op_sel:[0,0] op_sel_hi:[1,0]
v_pk_mul_f32 v[204:205], v[204:205], v[252:253] op_sel:[0,0] op_sel_hi:[1,0]
v_pk_mul_f32 v[202:203], v[202:203], v[252:253] op_sel:[0,0] op_sel_hi:[1,0]
v_pk_mul_f32 v[200:201], v[200:201], v[252:253] op_sel:[0,0] op_sel_hi:[1,0]
v_cvt_pk_bf16_f32 v200, v200, v201
v_mfma_f32_16x16x32_bf16 v[136:139], a[204:207], a[156:159], -4.0
v_exp_f32 v131, v131
v_mfma_f32_16x16x32_bf16 v[136:139], a[200:203], a[152:155], v[136:139]
v_exp_f32_e64 v132, v132
v_mfma_f32_16x16x32_bf16 v[136:139], a[196:199], a[148:151], v[136:139]
s_waitcnt vmcnt(24)
v_cvt_pk_bf16_f32 v161, v130, v131
v_cvt_pk_bf16_f32 v201, v202, v203
v_mfma_f32_16x16x32_bf16 v[136:139], a[192:195], a[144:147], v[136:139]
s_barrier
v_smfmac_f32_16x16x64_bf16 v[220:223], v[224:227], v[176:183], v248
buffer_load_dwordx4 v243, s[12:15], s38 offen nt lds
v_mfma_f32_16x16x32_bf16 v[80:83], a[224:227], v[228:231], v[80:83]
v_exp_f32 v133, v133
v_mfma_f32_16x16x32_bf16 v[80:83], a[228:231], v[176:179], v[80:83]
v_exp_f32_e64 v134, v134
v_mfma_f32_16x16x32_bf16 v[112:115], a[228:231], v[180:183], v[112:115]
v_cvt_pk_bf16_f32 v162, v132, v133
v_cvt_pk_bf16_f32 v202, v204, v205
v_mfma_f32_16x16x32_bf16 v[112:115], a[224:227], v[232:235], v[112:115]
ds_read_b64_tr_b16 a[224:225], v241
ds_read_b64_tr_b16 a[226:227], v241 offset:4128
v_mfma_f32_16x16x32_bf16 v[116:119], a[232:235], v[232:235], v[116:119]
v_exp_f32_e64 v135, v135
v_mfma_f32_16x16x32_bf16 v[116:119], a[236:239], v[180:183], v[116:119]
ds_read_b64_tr_b16 a[228:229], v241 offset:8256
ds_read_b64_tr_b16 a[230:231], v241 offset:12384
v_mfma_f32_16x16x32_bf16 v[84:87], a[236:239], v[176:179], v[84:87]
v_exp_f32 v140, v140
v_mfma_f32_16x16x32_bf16 v[84:87], a[232:235], v[228:231], v[84:87]
ds_read_b64_tr_b16 a[232:233], v241 offset:8
ds_read_b64_tr_b16 a[234:235], v241 offset:4136
v_mfma_f32_16x16x32_bf16 v[88:91], a[240:243], v[228:231], v[88:91]
s_add_u32 m0, s31, 0x0
v_cvt_pk_bf16_f32 v163, v134, v135
v_cvt_pk_bf16_f32 v203, v206, v207
v_mfma_f32_16x16x32_bf16 v[88:91], a[244:247], v[176:179], v[88:91]
buffer_load_dwordx4 v243, s[12:15], s38 offen offset:1024 nt lds
v_mfma_f32_16x16x32_bf16 v[120:123], a[244:247], v[180:183], v[120:123]
v_exp_f32_e64 v141, v141
v_mfma_f32_16x16x32_bf16 v[120:123], a[240:243], v[232:235], v[120:123]
ds_read_b64_tr_b16 a[236:237], v241 offset:8264
ds_read_b64_tr_b16 a[238:239], v241 offset:12392
v_mfma_f32_16x16x32_bf16 v[124:127], a[248:251], v[232:235], v[124:127]
v_exp_f32_e64 v142, v142
v_mfma_f32_16x16x32_bf16 v[124:127], a[252:255], v[180:183], v[124:127]
ds_read_b64_tr_b16 a[240:241], v241 offset:256
ds_read_b64_tr_b16 a[242:243], v241 offset:4384
v_mfma_f32_16x16x32_bf16 v[92:95], a[252:255], v[176:179], v[92:95]
v_cvt_pk_bf16_f32 v166, v140, v141
v_accvgpr_read_b32 v208, a88
v_mfma_f32_16x16x32_bf16 v[92:95], a[248:251], v[228:231], v[92:95]
ds_read_b64_tr_b16 a[244:245], v241 offset:8512
v_accvgpr_read_b32 v209, a89
v_mfma_f32_16x16x32_bf16 v[144:147], a[192:195], a[160:163], -4.0
v_exp_f32 v143, v143
v_mfma_f32_16x16x32_bf16 v[144:147], a[196:199], a[164:167], v[144:147]
v_exp_f32 v136, v136
v_mfma_f32_16x16x32_bf16 v[144:147], a[200:203], a[168:171], v[144:147]
s_add_u32 m0, s32, 0xc180
v_cvt_pk_bf16_f32 v167, v142, v143
v_accvgpr_read_b32 v210, a90
v_mfma_f32_16x16x32_bf16 v[144:147], a[204:207], a[172:175], v[144:147]
buffer_load_dwordx4 v243, s[16:19], s39 offen nt lds
v_mfma_f32_16x16x32_bf16 v[148:151], a[220:223], a[172:175], -4.0
v_exp_f32 v137, v137
v_mfma_f32_16x16x32_bf16 v[148:151], a[216:219], a[168:171], v[148:151]
v_exp_f32 v138, v138
v_mfma_f32_16x16x32_bf16 v[148:151], a[212:215], a[164:167], v[148:151]
v_cvt_pk_bf16_f32 v164, v136, v137
v_accvgpr_read_b32 v211, a91
v_mfma_f32_16x16x32_bf16 v[148:151], a[208:211], a[160:163], v[148:151]
ds_read_b64_tr_b16 a[246:247], v241 offset:12640
ds_read_b64_tr_b16 a[248:249], v241 offset:264
v_accvgpr_read_b32 v212, a92
v_mfma_f32_16x16x32_bf16 v[156:159], a[208:211], a[176:179], -4.0
v_exp_f32_e64 v139, v139
v_mfma_f32_16x16x32_bf16 v[156:159], a[212:215], a[180:183], v[156:159]
v_cvt_pk_bf16_f32 v165, v138, v139
v_accvgpr_read_b32 v213, a93
v_mfma_f32_16x16x32_bf16 v[156:159], a[216:219], a[184:187], v[156:159]
v_accvgpr_read_b32 v214, a94
v_accvgpr_read_b32 v215, a95
v_mfma_f32_16x16x32_bf16 v[156:159], a[220:223], a[188:191], v[156:159]
ds_read_b64_tr_b16 a[250:251], v241 offset:4392
v_exp_f32 v144, v144
v_exp_f32 v145, v145
v_pk_mul_f32 v[214:215], v[214:215], v[252:253] op_sel:[0,0] op_sel_hi:[1,0]
v_pk_mul_f32 v[212:213], v[212:213], v[252:253] op_sel:[0,0] op_sel_hi:[1,0]
v_pk_mul_f32 v[210:211], v[210:211], v[252:253] op_sel:[0,0] op_sel_hi:[1,0]
v_pk_mul_f32 v[208:209], v[208:209], v[252:253] op_sel:[0,0] op_sel_hi:[1,0]
v_cvt_pk_bf16_f32 v208, v208, v209
v_mfma_f32_16x16x32_bf16 v[152:155], a[204:207], a[188:191], -4.0
s_add_u32 m0, s32, 0xc180
v_exp_f32 v146, v146
v_mfma_f32_16x16x32_bf16 v[152:155], a[200:203], a[184:187], v[152:155]
v_cvt_pk_bf16_f32 v168, v144, v145
v_cvt_pk_bf16_f32 v209, v210, v211
v_mfma_f32_16x16x32_bf16 v[152:155], a[196:199], a[180:183], v[152:155]
v_exp_f32 v147, v147
v_mfma_f32_16x16x32_bf16 v[152:155], a[192:195], a[176:179], v[152:155]
buffer_load_dwordx4 v243, s[24:27], s39 offen offset:1032 nt lds
v_smfmac_f32_16x16x64_bf16 v[216:219], v[224:227], v[184:191], v248
s_waitcnt lgkmcnt(1)
ds_read_b64_tr_b16 a[252:253], v241 offset:8520
v_mfma_f32_16x16x32_bf16 v[0:3], a[224:227], v[184:187], v[0:3]
s_xor_b32 s39, s29, 0x181e000
ds_read_b64_tr_b16 a[254:255], v241 offset:12648
v_cvt_pk_bf16_f32 v210, v212, v213
v_mfma_f32_16x16x32_bf16 v[0:3], a[228:231], v[160:163], v[0:3]
ds_read_b128 a[208:211], v240 offset:20800
ds_read_b128 a[212:215], v240 offset:21056
v_mfma_f32_16x16x32_bf16 v[32:35], a[228:231], v[164:167], v[32:35]
v_exp_f32 v148, v148
v_mfma_f32_16x16x32_bf16 v[32:35], a[224:227], v[188:191], v[32:35]
ds_read_b128 a[216:219], v240 offset:21312
ds_read_b128 a[220:223], v240 offset:21568
v_mfma_f32_16x16x32_bf16 v[36:39], a[232:235], v[188:191], v[36:39]
v_cvt_pk_bf16_f32 v169, v146, v147
v_cvt_pk_bf16_f32 v211, v214, v215
v_mfma_f32_16x16x32_bf16 v[36:39], a[236:239], v[164:167], v[36:39]
ds_read_b128 a[204:207], v240 offset:17408
ds_read_b128 a[200:203], v240 offset:17152
v_mfma_f32_16x16x32_bf16 v[4:7], a[236:239], v[160:163], v[4:7]
v_exp_f32_e64 v149, v149
v_mfma_f32_16x16x32_bf16 v[4:7], a[232:235], v[184:187], v[4:7]
s_add_u32 m0, s32, 0xe1c0
ds_read_b128 a[196:199], v240 offset:16896
v_mov_b64 v[212:213], v[200:201]
v_mfma_f32_16x16x32_bf16 v[8:11], a[240:243], v[184:187], v[8:11]
ds_read_b128 a[192:195], v240 offset:16640
v_mov_b64 v[214:215], v[202:203]
v_mfma_f32_16x16x32_bf16 v[8:11], a[244:247], v[160:163], v[8:11]
buffer_load_dwordx4 v243, s[16:19], s39 offen nt lds
v_mfma_f32_16x16x32_bf16 v[40:43], a[244:247], v[164:167], v[40:43]
v_exp_f32_e64 v150, v150
v_mfma_f32_16x16x32_bf16 v[40:43], a[240:243], v[188:191], v[40:43]
s_waitcnt lgkmcnt(4)
v_cvt_pk_bf16_f32 v170, v148, v149
v_mov_b32_dpp v200, v208 row_ror:8 row_mask:0xf bank_mask:0xc
v_mfma_f32_16x16x32_bf16 v[44:47], a[248:251], v[188:191], v[44:47]
v_exp_f32 v151, v151
v_mfma_f32_16x16x32_bf16 v[44:47], a[252:255], v[164:167], v[44:47]
v_exp_f32_e64 v156, v156
v_mfma_f32_16x16x32_bf16 v[12:15], a[252:255], v[160:163], v[12:15]
v_cvt_pk_bf16_f32 v171, v150, v151
v_mov_b32_dpp v201, v209 row_ror:8 row_mask:0xf bank_mask:0xc
v_mfma_f32_16x16x32_bf16 v[12:15], a[248:251], v[184:187], v[12:15]
s_waitcnt lgkmcnt(0)
v_exp_f32 v157, v157
v_mfma_f32_16x16x32_bf16 v[128:131], a[192:195], a[128:131], -4.0
v_exp_f32_e64 v158, v158
v_mfma_f32_16x16x32_bf16 v[128:131], a[196:199], a[132:135], v[128:131]
v_cvt_pk_bf16_f32 v174, v156, v157
v_mov_b32_dpp v202, v210 row_ror:8 row_mask:0xf bank_mask:0xc
v_mfma_f32_16x16x32_bf16 v[128:131], a[200:203], a[136:139], v[128:131]
s_add_u32 m0, s32, 0xe1c0
v_exp_f32 v159, v159
v_mfma_f32_16x16x32_bf16 v[128:131], a[204:207], a[140:143], v[128:131]
buffer_load_dwordx4 v243, s[24:27], s39 offen offset:1032 nt lds
v_mfma_f32_16x16x32_bf16 v[132:135], a[220:223], a[140:143], -4.0
v_exp_f32 v152, v152
v_mfma_f32_16x16x32_bf16 v[132:135], a[216:219], a[136:139], v[132:135]
v_cvt_pk_bf16_f32 v175, v158, v159
v_mov_b32_dpp v203, v211 row_ror:8 row_mask:0xf bank_mask:0xc
v_mfma_f32_16x16x32_bf16 v[132:135], a[212:215], a[132:135], v[132:135]
v_exp_f32 v153, v153
v_mfma_f32_16x16x32_bf16 v[132:135], a[208:211], a[128:131], v[132:135]
v_exp_f32 v154, v154
v_mfma_f32_16x16x32_bf16 v[140:143], a[208:211], a[144:147], -4.0
v_cvt_pk_bf16_f32 v172, v152, v153
v_mov_b32_dpp v208, v212 row_ror:8 row_mask:0xf bank_mask:0x3
v_mfma_f32_16x16x32_bf16 v[140:143], a[212:215], a[148:151], v[140:143]
L_pad18:
s_cbranch_vccnz L_back0
v_exp_f32 v155, v155
v_mfma_f32_16x16x32_bf16 v[140:143], a[216:219], a[152:155], v[140:143]
v_cvt_pk_bf16_f32 v173, v154, v155
v_mov_b32_dpp v209, v213 row_ror:8 row_mask:0xf bank_mask:0x3
v_mfma_f32_16x16x32_bf16 v[140:143], a[220:223], a[156:159], v[140:143]
v_exp_f32 v128, v128
v_mfma_f32_16x16x32_bf16 v[136:139], a[204:207], a[156:159], -4.0
v_exp_f32 v129, v129
v_mfma_f32_16x16x32_bf16 v[136:139], a[200:203], a[152:155], v[136:139]
v_exp_f32_e64 v130, v130
v_mfma_f32_16x16x32_bf16 v[136:139], a[196:199], a[148:151], v[136:139]
s_waitcnt vmcnt(26)
v_cvt_pk_bf16_f32 v176, v128, v129
v_mov_b32_dpp v210, v214 row_ror:8 row_mask:0xf bank_mask:0x3
v_mfma_f32_16x16x32_bf16 v[136:139], a[192:195], a[144:147], v[136:139]
s_barrier
v_smfmac_f32_16x16x64_bf16 v[220:223], v[224:227], v[192:199], v248
buffer_store_dwordx4 v[200:203], v249, s[20:23], s59 offen offset:128 sc1
v_mfma_f32_16x16x32_bf16 v[64:67], a[224:227], v[192:195], v[64:67]
v_exp_f32 v131, v131
v_mfma_f32_16x16x32_bf16 v[64:67], a[228:231], v[168:171], v[64:67]
v_exp_f32 v132, v132
v_mov_b32_dpp v211, v215 row_ror:8 row_mask:0xf bank_mask:0x3
v_mfma_f32_16x16x32_bf16 v[96:99], a[228:231], v[172:175], v[96:99]
v_cvt_pk_bf16_f32 v177, v130, v131
v_accvgpr_read_b32 v200, a96
v_mfma_f32_16x16x32_bf16 v[96:99], a[224:227], v[196:199], v[96:99]
ds_read_b64_tr_b16 a[224:225], v241 offset:512
ds_read_b64_tr_b16 a[226:227], v241 offset:4640
v_mfma_f32_16x16x32_bf16 v[100:103], a[232:235], v[196:199], v[100:103]
v_exp_f32_e64 v133, v133
v_mfma_f32_16x16x32_bf16 v[100:103], a[236:239], v[172:175], v[100:103]
ds_read_b64_tr_b16 a[228:229], v241 offset:8768
ds_read_b64_tr_b16 a[230:231], v241 offset:12896
v_accvgpr_read_b32 v201, a97
v_mfma_f32_16x16x32_bf16 v[68:71], a[236:239], v[168:171], v[68:71]
v_exp_f32_e64 v134, v134
v_mfma_f32_16x16x32_bf16 v[68:71], a[232:235], v[192:195], v[68:71]
ds_read_b64_tr_b16 a[232:233], v241 offset:520
ds_read_b64_tr_b16 a[234:235], v241 offset:4648
v_accvgpr_read_b32 v202, a98
v_mfma_f32_16x16x32_bf16 v[72:75], a[240:243], v[192:195], v[72:75]
v_cvt_pk_bf16_f32 v178, v132, v133
v_accvgpr_read_b32 v203, a99
v_mfma_f32_16x16x32_bf16 v[72:75], a[244:247], v[168:171], v[72:75]
buffer_store_dwordx4 v[208:211], v249, s[20:23], s59 offen offset:2176 sc1
v_mfma_f32_16x16x32_bf16 v[104:107], a[244:247], v[172:175], v[104:107]
v_exp_f32_e64 v135, v135
v_mfma_f32_16x16x32_bf16 v[104:107], a[240:243], v[196:199], v[104:107]
ds_read_b64_tr_b16 a[236:237], v241 offset:8776
ds_read_b64_tr_b16 a[238:239], v241 offset:12904
v_accvgpr_read_b32 v204, a100
v_mfma_f32_16x16x32_bf16 v[108:111], a[248:251], v[196:199], v[108:111]
v_exp_f32_e64 v140, v140
v_mfma_f32_16x16x32_bf16 v[108:111], a[252:255], v[172:175], v[108:111]
ds_read_b64_tr_b16 a[240:241], v241 offset:768
ds_read_b64_tr_b16 a[242:243], v241 offset:4896
v_accvgpr_read_b32 v205, a101
v_mfma_f32_16x16x32_bf16 v[76:79], a[252:255], v[168:171], v[76:79]
v_cvt_pk_bf16_f32 v179, v134, v135
v_accvgpr_read_b32 v206, a102
v_mfma_f32_16x16x32_bf16 v[76:79], a[248:251], v[192:195], v[76:79]
ds_read_b64_tr_b16 a[244:245], v241 offset:9024
v_accvgpr_read_b32 v207, a103
v_mfma_f32_16x16x32_bf16 v[144:147], a[192:195], a[160:163], -4.0
v_exp_f32_e64 v141, v141
v_mfma_f32_16x16x32_bf16 v[144:147], a[196:199], a[164:167], v[144:147]
v_exp_f32 v142, v142
v_mfma_f32_16x16x32_bf16 v[144:147], a[200:203], a[168:171], v[144:147]
v_exp_f32 v143, v143
v_mfma_f32_16x16x32_bf16 v[144:147], a[204:207], a[172:175], v[144:147]
ds_read_b64_tr_b16 a[246:247], v241 offset:13152
v_cvt_pk_bf16_f32 v182, v140, v141
v_exp_f32_e64 v136, v136
v_cvt_pk_bf16_f32 v183, v142, v143
v_pk_mul_f32 v[206:207], v[206:207], v[252:253] op_sel:[0,1] op_sel_hi:[1,1]
v_pk_mul_f32 v[204:205], v[204:205], v[252:253] op_sel:[0,1] op_sel_hi:[1,1]
v_pk_mul_f32 v[202:203], v[202:203], v[252:253] op_sel:[0,1] op_sel_hi:[1,1]
v_pk_mul_f32 v[200:201], v[200:201], v[252:253] op_sel:[0,1] op_sel_hi:[1,1]
v_cvt_pk_bf16_f32 v200, v200, v201
v_mfma_f32_16x16x32_bf16 v[148:151], a[220:223], a[172:175], -4.0
v_exp_f32 v137, v137
v_mfma_f32_16x16x32_bf16 v[148:151], a[216:219], a[168:171], v[148:151]
v_exp_f32 v138, v138
v_mfma_f32_16x16x32_bf16 v[148:151], a[212:215], a[164:167], v[148:151]
v_cvt_pk_bf16_f32 v180, v136, v137
v_cvt_pk_bf16_f32 v201, v202, v203
v_mfma_f32_16x16x32_bf16 v[148:151], a[208:211], a[160:163], v[148:151]
ds_read_b64_tr_b16 a[248:249], v241 offset:776
ds_read_b64_tr_b16 a[250:251], v241 offset:4904
v_mfma_f32_16x16x32_bf16 v[156:159], a[208:211], a[176:179], -4.0
v_exp_f32_e64 v139, v139
v_mfma_f32_16x16x32_bf16 v[156:159], a[212:215], a[180:183], v[156:159]
v_cvt_pk_bf16_f32 v181, v138, v139
v_cvt_pk_bf16_f32 v202, v204, v205
v_mfma_f32_16x16x32_bf16 v[156:159], a[216:219], a[184:187], v[156:159]
v_exp_f32_e64 v144, v144
v_mfma_f32_16x16x32_bf16 v[156:159], a[220:223], a[188:191], v[156:159]
ds_read_b64_tr_b16 a[252:253], v241 offset:9032
ds_read_b64_tr_b16 a[254:255], v241 offset:13160
v_mfma_f32_16x16x32_bf16 v[152:155], a[204:207], a[188:191], -4.0
v_exp_f32 v145, v145
v_mfma_f32_16x16x32_bf16 v[152:155], a[200:203], a[184:187], v[152:155]
v_exp_f32 v146, v146
v_mfma_f32_16x16x32_bf16 v[152:155], a[196:199], a[180:183], v[152:155]
v_cvt_pk_bf16_f32 v228, v144, v145
v_cvt_pk_bf16_f32 v203, v206, v207
v_mfma_f32_16x16x32_bf16 v[152:155], a[192:195], a[176:179], v[152:155]
ds_read_b128 a[208:211], v240 offset:29120
ds_read_b128 a[212:215], v240 offset:29376
v_smfmac_f32_16x16x64_bf16 v[216:219], v[224:227], v[160:167], v248
s_waitcnt lgkmcnt(4)
ds_read_b128 a[216:219], v240 offset:29632
v_mfma_f32_16x16x32_bf16 v[16:19], a[224:227], v[184:187], v[16:19]
v_exp_f32 v147, v147
v_mfma_f32_16x16x32_bf16 v[16:19], a[228:231], v[160:163], v[16:19]
ds_read_b128 a[220:223], v240 offset:29888
v_accvgpr_read_b32 v208, a104
v_mfma_f32_16x16x32_bf16 v[48:51], a[228:231], v[164:167], v[48:51]
v_exp_f32 v148, v148
v_mfma_f32_16x16x32_bf16 v[48:51], a[224:227], v[188:191], v[48:51]
ds_read_b128 a[204:207], v240 offset:25728
v_cvt_pk_bf16_f32 v229, v146, v147
v_mfma_f32_16x16x32_bf16 v[52:55], a[232:235], v[188:191], v[52:55]
v_exp_f32 v149, v149
v_mfma_f32_16x16x32_bf16 v[52:55], a[236:239], v[164:167], v[52:55]
ds_read_b128 a[200:203], v240 offset:25472
v_accvgpr_read_b32 v209, a105
v_mfma_f32_16x16x32_bf16 v[20:23], a[236:239], v[160:163], v[20:23]
v_exp_f32_e64 v150, v150
v_mfma_f32_16x16x32_bf16 v[20:23], a[232:235], v[184:187], v[20:23]
ds_read_b128 a[196:199], v240 offset:25216
v_cvt_pk_bf16_f32 v230, v148, v149
v_mfma_f32_16x16x32_bf16 v[24:27], a[240:243], v[184:187], v[24:27]
ds_read_b128 a[192:195], v240 offset:24960
v_accvgpr_read_b32 v210, a106
v_mfma_f32_16x16x32_bf16 v[24:27], a[244:247], v[160:163], v[24:27]
v_exp_f32 v151, v151
v_mfma_f32_16x16x32_bf16 v[56:59], a[244:247], v[164:167], v[56:59]
v_exp_f32 v156, v156
v_mfma_f32_16x16x32_bf16 v[56:59], a[240:243], v[188:191], v[56:59]
v_cvt_pk_bf16_f32 v231, v150, v151
v_accvgpr_read_b32 v211, a107
v_mfma_f32_16x16x32_bf16 v[60:63], a[248:251], v[188:191], v[60:63]
s_waitcnt lgkmcnt(2)
v_exp_f32 v157, v157
v_mfma_f32_16x16x32_bf16 v[60:63], a[252:255], v[164:167], v[60:63]
v_exp_f32 v158, v158
v_mfma_f32_16x16x32_bf16 v[28:31], a[252:255], v[160:163], v[28:31]
v_cvt_pk_bf16_f32 v234, v156, v157
v_accvgpr_read_b32 v212, a108
v_mfma_f32_16x16x32_bf16 v[28:31], a[248:251], v[184:187], v[28:31]
s_waitcnt lgkmcnt(0)
v_accvgpr_read_b32 v213, a109
v_accvgpr_read_b32 v214, a110
v_mfma_f32_16x16x32_bf16 v[128:131], a[192:195], a[128:131], -4.0
v_exp_f32 v159, v159
v_mfma_f32_16x16x32_bf16 v[128:131], a[196:199], a[132:135], v[128:131]
v_exp_f32 v152, v152
v_mfma_f32_16x16x32_bf16 v[128:131], a[200:203], a[136:139], v[128:131]
v_cvt_pk_bf16_f32 v235, v158, v159
v_accvgpr_read_b32 v215, a111
v_mfma_f32_16x16x32_bf16 v[128:131], a[204:207], a[140:143], v[128:131]
v_exp_f32 v153, v153
v_exp_f32 v154, v154
v_cvt_pk_bf16_f32 v232, v152, v153
v_pk_mul_f32 v[214:215], v[214:215], v[252:253] op_sel:[0,1] op_sel_hi:[1,1]
v_pk_mul_f32 v[212:213], v[212:213], v[252:253] op_sel:[0,1] op_sel_hi:[1,1]
v_pk_mul_f32 v[210:211], v[210:211], v[252:253] op_sel:[0,1] op_sel_hi:[1,1]
v_pk_mul_f32 v[208:209], v[208:209], v[252:253] op_sel:[0,1] op_sel_hi:[1,1]
v_cvt_pk_bf16_f32 v208, v208, v209
v_mfma_f32_16x16x32_bf16 v[132:135], a[220:223], a[140:143], -4.0
v_exp_f32 v155, v155
v_mfma_f32_16x16x32_bf16 v[132:135], a[216:219], a[136:139], v[132:135]
v_cvt_pk_bf16_f32 v233, v154, v155
v_cvt_pk_bf16_f32 v209, v210, v211
v_mfma_f32_16x16x32_bf16 v[132:135], a[212:215], a[132:135], v[132:135]
v_exp_f32 v128, v128
v_mfma_f32_16x16x32_bf16 v[132:135], a[208:211], a[128:131], v[132:135]
v_exp_f32 v129, v129
v_mfma_f32_16x16x32_bf16 v[140:143], a[208:211], a[144:147], -4.0
v_exp_f32 v130, v130
v_mfma_f32_16x16x32_bf16 v[140:143], a[212:215], a[148:151], v[140:143]
v_cvt_pk_bf16_f32 v160, v128, v129
v_cvt_pk_bf16_f32 v210, v212, v213
v_mfma_f32_16x16x32_bf16 v[140:143], a[216:219], a[152:155], v[140:143]
v_exp_f32 v131, v131
v_mfma_f32_16x16x32_bf16 v[140:143], a[220:223], a[156:159], v[140:143]
v_exp_f32 v132, v132
v_mfma_f32_16x16x32_bf16 v[136:139], a[204:207], a[156:159], -4.0
v_cvt_pk_bf16_f32 v161, v130, v131
v_cvt_pk_bf16_f32 v211, v214, v215
v_mfma_f32_16x16x32_bf16 v[136:139], a[200:203], a[152:155], v[136:139]
v_exp_f32 v133, v133
v_mfma_f32_16x16x32_bf16 v[136:139], a[196:199], a[148:151], v[136:139]
s_waitcnt vmcnt(20)
v_exp_f32 v134, v134
v_mfma_f32_16x16x32_bf16 v[136:139], a[192:195], a[144:147], v[136:139]
s_barrier
v_smfmac_f32_16x16x64_bf16 v[220:223], v[224:227], v[168:175], v248
v_cvt_pk_bf16_f32 v162, v132, v133
v_mfma_f32_16x16x32_bf16 v[80:83], a[224:227], v[192:195], v[80:83]
v_exp_f32 v135, v135
v_mfma_f32_16x16x32_bf16 v[80:83], a[228:231], v[168:171], v[80:83]
v_exp_f32 v140, v140
v_mfma_f32_16x16x32_bf16 v[112:115], a[228:231], v[172:175], v[112:115]
v_cvt_pk_bf16_f32 v163, v134, v135
v_mov_b64_e64 v[212:213], v[200:201]
v_mfma_f32_16x16x32_bf16 v[112:115], a[224:227], v[196:199], v[112:115]
ds_read_b64_tr_b16 a[224:225], v241 offset:16512
ds_read_b64_tr_b16 a[226:227], v241 offset:20640
v_mfma_f32_16x16x32_bf16 v[116:119], a[232:235], v[196:199], v[116:119]
v_exp_f32 v141, v141
v_mfma_f32_16x16x32_bf16 v[116:119], a[236:239], v[172:175], v[116:119]
ds_read_b64_tr_b16 a[228:229], v241 offset:24768
ds_read_b64_tr_b16 a[230:231], v241 offset:28896
v_mfma_f32_16x16x32_bf16 v[84:87], a[236:239], v[168:171], v[84:87]
v_exp_f32 v142, v142
v_mfma_f32_16x16x32_bf16 v[84:87], a[232:235], v[192:195], v[84:87]
ds_read_b64_tr_b16 a[232:233], v241 offset:16520
ds_read_b64_tr_b16 a[234:235], v241 offset:20648
v_mfma_f32_16x16x32_bf16 v[88:91], a[240:243], v[192:195], v[88:91]
v_cvt_pk_bf16_f32 v166, v140, v141
v_mov_b64_e64 v[214:215], v[202:203]
v_mfma_f32_16x16x32_bf16 v[88:91], a[244:247], v[168:171], v[88:91]
ds_read_b64_tr_b16 a[236:237], v241 offset:24776
ds_read_b64_tr_b16 a[238:239], v241 offset:28904
v_mfma_f32_16x16x32_bf16 v[120:123], a[244:247], v[172:175], v[120:123]
v_exp_f32 v143, v143
v_mfma_f32_16x16x32_bf16 v[120:123], a[240:243], v[196:199], v[120:123]
ds_read_b64_tr_b16 a[240:241], v241 offset:16768
v_mov_b32_dpp v200, v208 row_ror:8 row_mask:0xf bank_mask:0xc
v_mfma_f32_16x16x32_bf16 v[124:127], a[248:251], v[196:199], v[124:127]
v_exp_f32 v136, v136
v_mfma_f32_16x16x32_bf16 v[124:127], a[252:255], v[172:175], v[124:127]
ds_read_b64_tr_b16 a[242:243], v241 offset:20896
v_cvt_pk_bf16_f32 v167, v142, v143
v_mfma_f32_16x16x32_bf16 v[92:95], a[252:255], v[168:171], v[92:95]
v_exp_f32 v137, v137
v_mfma_f32_16x16x32_bf16 v[92:95], a[248:251], v[192:195], v[92:95]
ds_read_b64_tr_b16 a[244:245], v241 offset:25024
v_mov_b32_dpp v201, v209 row_ror:8 row_mask:0xf bank_mask:0xc
v_mfma_f32_16x16x32_bf16 v[144:147], a[192:195], a[160:163], -4.0
v_exp_f32 v138, v138
v_mfma_f32_16x16x32_bf16 v[144:147], a[196:199], a[164:167], v[144:147]
v_cvt_pk_bf16_f32 v164, v136, v137
v_mov_b32_dpp v202, v210 row_ror:8 row_mask:0xf bank_mask:0xc
v_mfma_f32_16x16x32_bf16 v[144:147], a[200:203], a[168:171], v[144:147]
v_exp_f32_e64 v139, v139
v_mfma_f32_16x16x32_bf16 v[144:147], a[204:207], a[172:175], v[144:147]
ds_read_b64_tr_b16 a[246:247], v241 offset:29152
ds_read_b64_tr_b16 a[248:249], v241 offset:16776
v_mfma_f32_16x16x32_bf16 v[148:151], a[220:223], a[172:175], -4.0
v_cvt_pk_bf16_f32 v165, v138, v139
v_mov_b32_dpp v203, v211 row_ror:8 row_mask:0xf bank_mask:0xc
v_mfma_f32_16x16x32_bf16 v[148:151], a[216:219], a[168:171], v[148:151]
v_mov_b32_dpp v208, v212 row_ror:8 row_mask:0xf bank_mask:0x3
v_mov_b32_dpp v209, v213 row_ror:8 row_mask:0xf bank_mask:0x3
v_mfma_f32_16x16x32_bf16 v[148:151], a[212:215], a[164:167], v[148:151]
v_exp_f32_e64 v144, v144
v_mfma_f32_16x16x32_bf16 v[148:151], a[208:211], a[160:163], v[148:151]
buffer_store_dwordx4 v[200:203], v249, s[20:23], s35 offen sc1
v_mfma_f32_16x16x32_bf16 v[156:159], a[208:211], a[176:179], -4.0
v_exp_f32 v145, v145
v_mfma_f32_16x16x32_bf16 v[156:159], a[212:215], a[180:183], v[156:159]
v_exp_f32 v146, v146
v_mfma_f32_16x16x32_bf16 v[156:159], a[216:219], a[184:187], v[156:159]
v_cvt_pk_bf16_f32 v184, v144, v145
v_mov_b32_dpp v210, v214 row_ror:8 row_mask:0xf bank_mask:0x3
v_mfma_f32_16x16x32_bf16 v[156:159], a[220:223], a[188:191], v[156:159]
ds_read_b64_tr_b16 a[250:251], v241 offset:20904
ds_read_b64_tr_b16 a[252:253], v241 offset:25032
v_mov_b32_dpp v211, v215 row_ror:8 row_mask:0xf bank_mask:0x3
v_mfma_f32_16x16x32_bf16 v[152:155], a[204:207], a[188:191], -4.0
v_exp_f32_e64 v147, v147
v_mfma_f32_16x16x32_bf16 v[152:155], a[200:203], a[184:187], v[152:155]
v_accvgpr_read_b32 v200, a112
v_accvgpr_read_b32 v201, a113
v_mfma_f32_16x16x32_bf16 v[152:155], a[196:199], a[180:183], v[152:155]
v_exp_f32 v148, v148
v_mfma_f32_16x16x32_bf16 v[152:155], a[192:195], a[176:179], v[152:155]
ds_read_b64_tr_b16 a[254:255], v241 offset:29160
ds_read_b128 a[208:211], v240 offset:37440
v_smfmac_f32_16x16x64_bf16 v[216:219], v[224:227], v[176:183], v248
s_waitcnt lgkmcnt(4)
ds_read_b128 a[212:215], v240 offset:37696
v_accvgpr_read_b32 v202, a114
v_mfma_f32_16x16x32_bf16 v[0:3], a[224:227], v[176:179], v[0:3]
v_cvt_pk_bf16_f32 v185, v146, v147
v_accvgpr_read_b32 v203, a115
v_mfma_f32_16x16x32_bf16 v[0:3], a[228:231], v[160:163], v[0:3]
buffer_store_dwordx4 v[208:211], v249, s[20:23], s35 offen offset:2048 sc1
v_mfma_f32_16x16x32_bf16 v[32:35], a[228:231], v[164:167], v[32:35]
v_accvgpr_read_b32 v204, a116
v_accvgpr_read_b32 v205, a117
v_mfma_f32_16x16x32_bf16 v[32:35], a[224:227], v[180:183], v[32:35]
ds_read_b128 a[216:219], v240 offset:37952
ds_read_b128 a[220:223], v240 offset:38208
v_mfma_f32_16x16x32_bf16 v[36:39], a[232:235], v[180:183], v[36:39]
v_exp_f32_e64 v149, v149
v_mfma_f32_16x16x32_bf16 v[36:39], a[236:239], v[164:167], v[36:39]
ds_read_b128 a[204:207], v240 offset:34048
ds_read_b128 a[200:203], v240 offset:33792
v_accvgpr_read_b32 v206, a118
v_mfma_f32_16x16x32_bf16 v[4:7], a[236:239], v[160:163], v[4:7]
v_accvgpr_read_b32 v207, a119
v_mfma_f32_16x16x32_bf16 v[4:7], a[232:235], v[176:179], v[4:7]
ds_read_b128 a[196:199], v240 offset:33536
v_exp_f32 v150, v150
v_cvt_pk_bf16_f32 v186, v148, v149
v_exp_f32 v151, v151
v_pk_mul_f32 v[206:207], v[206:207], v[252:253] op_sel:[0,1] op_sel_hi:[1,1]
v_pk_mul_f32 v[204:205], v[204:205], v[252:253] op_sel:[0,1] op_sel_hi:[1,1]
v_pk_mul_f32 v[202:203], v[202:203], v[252:253] op_sel:[0,1] op_sel_hi:[1,1]
v_pk_mul_f32 v[200:201], v[200:201], v[252:253] op_sel:[0,1] op_sel_hi:[1,1]
v_cvt_pk_bf16_f32 v200, v200, v201
v_mfma_f32_16x16x32_bf16 v[8:11], a[240:243], v[176:179], v[8:11]
ds_read_b128 a[192:195], v240 offset:33280
v_cvt_pk_bf16_f32 v201, v202, v203
v_mfma_f32_16x16x32_bf16 v[8:11], a[244:247], v[160:163], v[8:11]
v_exp_f32 v156, v156
v_mfma_f32_16x16x32_bf16 v[40:43], a[244:247], v[164:167], v[40:43]
v_cvt_pk_bf16_f32 v187, v150, v151
v_cvt_pk_bf16_f32 v202, v204, v205
v_mfma_f32_16x16x32_bf16 v[40:43], a[240:243], v[180:183], v[40:43]
s_waitcnt lgkmcnt(4)
v_exp_f32 v157, v157
v_mfma_f32_16x16x32_bf16 v[44:47], a[248:251], v[180:183], v[44:47]
v_exp_f32 v158, v158
v_mfma_f32_16x16x32_bf16 v[44:47], a[252:255], v[164:167], v[44:47]
v_cvt_pk_bf16_f32 v190, v156, v157
v_cvt_pk_bf16_f32 v203, v206, v207
v_mfma_f32_16x16x32_bf16 v[12:15], a[252:255], v[160:163], v[12:15]
v_exp_f32 v159, v159
v_mfma_f32_16x16x32_bf16 v[12:15], a[248:251], v[176:179], v[12:15]
s_waitcnt lgkmcnt(0)
v_exp_f32_e64 v152, v152
v_mfma_f32_16x16x32_bf16 v[128:131], a[192:195], a[128:131], -4.0
v_cvt_pk_bf16_f32 v191, v158, v159
v_accvgpr_read_b32 v208, a120
v_mfma_f32_16x16x32_bf16 v[128:131], a[196:199], a[132:135], v[128:131]
v_exp_f32 v153, v153
v_mfma_f32_16x16x32_bf16 v[128:131], a[200:203], a[136:139], v[128:131]
v_exp_f32 v154, v154
v_mfma_f32_16x16x32_bf16 v[128:131], a[204:207], a[140:143], v[128:131]
v_cvt_pk_bf16_f32 v188, v152, v153
v_accvgpr_read_b32 v209, a121
v_mfma_f32_16x16x32_bf16 v[132:135], a[220:223], a[140:143], -4.0
v_exp_f32 v155, v155
v_mfma_f32_16x16x32_bf16 v[132:135], a[216:219], a[136:139], v[132:135]
v_cvt_pk_bf16_f32 v189, v154, v155
v_accvgpr_read_b32 v210, a122
v_mfma_f32_16x16x32_bf16 v[132:135], a[212:215], a[132:135], v[132:135]
s_waitcnt vmcnt(19)
v_exp_f32 v128, v128
v_mfma_f32_16x16x32_bf16 v[132:135], a[208:211], a[128:131], v[132:135]
s_barrier
v_mfma_f32_16x16x32_bf16 v[140:143], a[208:211], a[144:147], -4.0
v_exp_f32 v129, v129
v_mfma_f32_16x16x32_bf16 v[140:143], a[212:215], a[148:151], v[140:143]
v_exp_f32 v130, v130
v_mfma_f32_16x16x32_bf16 v[140:143], a[216:219], a[152:155], v[140:143]
v_cvt_pk_bf16_f32 v168, v128, v129
v_accvgpr_read_b32 v211, a123
v_mfma_f32_16x16x32_bf16 v[140:143], a[220:223], a[156:159], v[140:143]
ds_read_b128 a[208:211], v240 offset:45760
ds_read_b128 a[212:215], v240 offset:46016
v_mfma_f32_16x16x32_bf16 v[136:139], a[204:207], a[156:159], -4.0
v_exp_f32 v131, v131
v_mfma_f32_16x16x32_bf16 v[136:139], a[200:203], a[152:155], v[136:139]
v_exp_f32 v132, v132
v_mfma_f32_16x16x32_bf16 v[136:139], a[196:199], a[148:151], v[136:139]
v_cvt_pk_bf16_f32 v169, v130, v131
v_accvgpr_read_b32 v212, a124
v_mfma_f32_16x16x32_bf16 v[136:139], a[192:195], a[144:147], v[136:139]
ds_read_b128 a[216:219], v240 offset:46272
ds_read_b128 a[220:223], v240 offset:46528
v_smfmac_f32_16x16x64_bf16 v[220:223], v[224:227], v[228:235], v248
ds_read_b128 a[204:207], v240 offset:42368
v_mfma_f32_16x16x32_bf16 v[64:67], a[224:227], v[228:231], v[64:67]
v_exp_f32_e64 v133, v133
v_mfma_f32_16x16x32_bf16 v[64:67], a[228:231], v[184:187], v[64:67]
ds_read_b128 a[200:203], v240 offset:42112
ds_read_b128 a[196:199], v240 offset:41856
v_mfma_f32_16x16x32_bf16 v[96:99], a[228:231], v[188:191], v[96:99]
v_exp_f32_e64 v134, v134
v_mfma_f32_16x16x32_bf16 v[96:99], a[224:227], v[232:235], v[96:99]
ds_read_b128 a[192:195], v240 offset:41600
ds_read_b64_tr_b16 a[224:225], v241 offset:17024
v_mfma_f32_16x16x32_bf16 v[100:103], a[232:235], v[232:235], v[100:103]
v_cvt_pk_bf16_f32 v170, v132, v133
v_accvgpr_read_b32 v213, a125
v_mfma_f32_16x16x32_bf16 v[100:103], a[236:239], v[188:191], v[100:103]
ds_read_b64_tr_b16 a[226:227], v241 offset:21152
ds_read_b64_tr_b16 a[228:229], v241 offset:25280
v_mfma_f32_16x16x32_bf16 v[68:71], a[236:239], v[184:187], v[68:71]
v_exp_f32_e64 v135, v135
v_mfma_f32_16x16x32_bf16 v[68:71], a[232:235], v[228:231], v[68:71]
ds_read_b64_tr_b16 a[230:231], v241 offset:29408
ds_read_b64_tr_b16 a[232:233], v241 offset:17032
v_mfma_f32_16x16x32_bf16 v[72:75], a[240:243], v[228:231], v[72:75]
v_exp_f32_e64 v140, v140
v_mfma_f32_16x16x32_bf16 v[72:75], a[244:247], v[184:187], v[72:75]
ds_read_b64_tr_b16 a[234:235], v241 offset:21160
ds_read_b64_tr_b16 a[236:237], v241 offset:25288
v_mfma_f32_16x16x32_bf16 v[104:107], a[244:247], v[188:191], v[104:107]
v_cvt_pk_bf16_f32 v171, v134, v135
v_accvgpr_read_b32 v214, a126
v_mfma_f32_16x16x32_bf16 v[104:107], a[240:243], v[232:235], v[104:107]
ds_read_b64_tr_b16 a[238:239], v241 offset:29416
ds_read_b64_tr_b16 a[240:241], v241 offset:17280
v_mfma_f32_16x16x32_bf16 v[108:111], a[248:251], v[232:235], v[108:111]
v_exp_f32_e64 v141, v141
v_mfma_f32_16x16x32_bf16 v[108:111], a[252:255], v[188:191], v[108:111]
ds_read_b64_tr_b16 a[242:243], v241 offset:21408
v_accvgpr_read_b32 v215, a127
v_mfma_f32_16x16x32_bf16 v[76:79], a[252:255], v[184:187], v[76:79]
v_exp_f32 v142, v142
v_mfma_f32_16x16x32_bf16 v[76:79], a[248:251], v[228:231], v[76:79]
s_waitcnt lgkmcnt(5)
ds_read_b64_tr_b16 a[244:245], v241 offset:25536
v_cvt_pk_bf16_f32 v174, v140, v141
v_exp_f32 v143, v143
v_exp_f32 v136, v136
v_pk_mul_f32 v[214:215], v[214:215], v[252:253] op_sel:[0,1] op_sel_hi:[1,1]
v_pk_mul_f32 v[212:213], v[212:213], v[252:253] op_sel:[0,1] op_sel_hi:[1,1]
v_pk_mul_f32 v[210:211], v[210:211], v[252:253] op_sel:[0,1] op_sel_hi:[1,1]
v_pk_mul_f32 v[208:209], v[208:209], v[252:253] op_sel:[0,1] op_sel_hi:[1,1]
v_cvt_pk_bf16_f32 v208, v208, v209
v_mfma_f32_16x16x32_bf16 v[144:147], a[192:195], a[128:131], -4.0
v_cvt_pk_bf16_f32 v175, v142, v143
v_cvt_pk_bf16_f32 v209, v210, v211
v_mfma_f32_16x16x32_bf16 v[144:147], a[196:199], a[132:135], v[144:147]
v_exp_f32_e64 v137, v137
v_mfma_f32_16x16x32_bf16 v[144:147], a[200:203], a[136:139], v[144:147]
v_exp_f32_e64 v138, v138
v_mfma_f32_16x16x32_bf16 v[144:147], a[204:207], a[140:143], v[144:147]
ds_read_b64_tr_b16 a[246:247], v241 offset:29664
ds_read_b64_tr_b16 a[248:249], v241 offset:17288
v_mfma_f32_16x16x32_bf16 v[148:151], a[220:223], a[140:143], -4.0
v_cvt_pk_bf16_f32 v172, v136, v137
v_cvt_pk_bf16_f32 v210, v212, v213
v_mfma_f32_16x16x32_bf16 v[148:151], a[216:219], a[136:139], v[148:151]
v_exp_f32 v139, v139
v_mfma_f32_16x16x32_bf16 v[148:151], a[212:215], a[132:135], v[148:151]
s_waitcnt vmcnt(16) lgkmcnt(2)
v_cvt_pk_bf16_f32 v173, v138, v139
v_cvt_pk_bf16_f32 v211, v214, v215
v_mfma_f32_16x16x32_bf16 v[148:151], a[208:211], a[128:131], v[148:151]
s_barrier
v_mfma_f32_16x16x32_bf16 v[156:159], a[208:211], a[144:147], -4.0
v_exp_f32 v144, v144
v_mfma_f32_16x16x32_bf16 v[156:159], a[212:215], a[148:151], v[156:159]
v_exp_f32 v145, v145
v_mfma_f32_16x16x32_bf16 v[156:159], a[216:219], a[152:155], v[156:159]
v_exp_f32 v146, v146
v_mfma_f32_16x16x32_bf16 v[156:159], a[220:223], a[156:159], v[156:159]
ds_read_b64_tr_b16 a[250:251], v241 offset:21416
ds_read_b64_tr_b16 a[252:253], v241 offset:25544
v_mfma_f32_16x16x32_bf16 v[152:155], a[204:207], a[156:159], -4.0
v_cvt_pk_bf16_f32 v192, v144, v145
v_mov_b64 v[212:213], v[200:201]
v_mfma_f32_16x16x32_bf16 v[152:155], a[200:203], a[152:155], v[152:155]
v_exp_f32 v147, v147
v_mfma_f32_16x16x32_bf16 v[152:155], a[196:199], a[148:151], v[152:155]
v_exp_f32_e64 v148, v148
v_mfma_f32_16x16x32_bf16 v[152:155], a[192:195], a[144:147], v[152:155]
ds_read_b64_tr_b16 a[254:255], v241 offset:29672
ds_read_b128 a[208:211], v240 offset:54080
v_smfmac_f32_16x16x64_bf16 v[216:219], v[224:227], v[160:167], v248
ds_read_b128 a[212:215], v240 offset:54336
v_mfma_f32_16x16x32_bf16 v[16:19], a[224:227], v[176:179], v[16:19]
v_cvt_pk_bf16_f32 v193, v146, v147
v_mov_b64 v[214:215], v[202:203]
v_mfma_f32_16x16x32_bf16 v[16:19], a[228:231], v[160:163], v[16:19]
ds_read_b128 a[216:219], v240 offset:54592
ds_read_b128 a[220:223], v240 offset:54848
v_mfma_f32_16x16x32_bf16 v[48:51], a[228:231], v[164:167], v[48:51]
v_exp_f32 v149, v149
v_mfma_f32_16x16x32_bf16 v[48:51], a[224:227], v[180:183], v[48:51]
ds_read_b128 a[204:207], v240 offset:50688
v_mov_b32_dpp v200, v208 row_ror:8 row_mask:0xf bank_mask:0xc
v_mfma_f32_16x16x32_bf16 v[52:55], a[232:235], v[180:183], v[52:55]
v_exp_f32_e64 v150, v150
v_mfma_f32_16x16x32_bf16 v[52:55], a[236:239], v[164:167], v[52:55]
ds_read_b128 a[200:203], v240 offset:50432
v_cvt_pk_bf16_f32 v194, v148, v149
v_mfma_f32_16x16x32_bf16 v[20:23], a[236:239], v[160:163], v[20:23]
v_exp_f32 v151, v151
v_mfma_f32_16x16x32_bf16 v[20:23], a[232:235], v[176:179], v[20:23]
ds_read_b128 a[196:199], v240 offset:50176
v_mov_b32_dpp v201, v209 row_ror:8 row_mask:0xf bank_mask:0xc
v_mfma_f32_16x16x32_bf16 v[24:27], a[240:243], v[176:179], v[24:27]
s_waitcnt lgkmcnt(3)
ds_read_b128 a[192:195], v240 offset:49920
v_mov_b32_dpp v202, v210 row_ror:8 row_mask:0xf bank_mask:0xc
v_mfma_f32_16x16x32_bf16 v[24:27], a[244:247], v[160:163], v[24:27]
v_exp_f32 v156, v156
v_mfma_f32_16x16x32_bf16 v[56:59], a[244:247], v[164:167], v[56:59]
v_cvt_pk_bf16_f32 v195, v150, v151
v_mov_b32_dpp v203, v211 row_ror:8 row_mask:0xf bank_mask:0xc
v_mfma_f32_16x16x32_bf16 v[56:59], a[240:243], v[180:183], v[56:59]
buffer_store_dwordx4 v[200:203], v249, s[20:23], s35 offen offset:128 sc1
v_mfma_f32_16x16x32_bf16 v[60:63], a[248:251], v[180:183], v[60:63]
v_exp_f32 v157, v157
v_mfma_f32_16x16x32_bf16 v[60:63], a[252:255], v[164:167], v[60:63]
v_exp_f32 v158, v158
v_mfma_f32_16x16x32_bf16 v[28:31], a[252:255], v[160:163], v[28:31]
v_cvt_pk_bf16_f32 v198, v156, v157
v_mov_b32_dpp v208, v212 row_ror:8 row_mask:0xf bank_mask:0x3
v_mfma_f32_16x16x32_bf16 v[28:31], a[248:251], v[176:179], v[28:31]
s_waitcnt lgkmcnt(0)
v_exp_f32 v159, v159
v_mfma_f32_16x16x32_bf16 v[128:131], a[192:195], a[128:131], -4.0
v_exp_f32 v152, v152
v_mfma_f32_16x16x32_bf16 v[128:131], a[196:199], a[132:135], v[128:131]
v_cvt_pk_bf16_f32 v199, v158, v159
v_mov_b32_dpp v209, v213 row_ror:8 row_mask:0xf bank_mask:0x3
v_mfma_f32_16x16x32_bf16 v[128:131], a[200:203], a[136:139], v[128:131]
v_exp_f32_e64 v153, v153
v_mfma_f32_16x16x32_bf16 v[128:131], a[204:207], a[140:143], v[128:131]
v_mov_b32_dpp v210, v214 row_ror:8 row_mask:0xf bank_mask:0x3
v_mov_b32_dpp v211, v215 row_ror:8 row_mask:0xf bank_mask:0x3
v_mfma_f32_16x16x32_bf16 v[132:135], a[220:223], a[140:143], -4.0
v_exp_f32 v154, v154
v_mfma_f32_16x16x32_bf16 v[132:135], a[216:219], a[136:139], v[132:135]
v_exp_f32 v155, v155
v_mfma_f32_16x16x32_bf16 v[132:135], a[212:215], a[132:135], v[132:135]
s_waitcnt vmcnt(9)
v_cvt_pk_bf16_f32 v196, v152, v153
v_cvt_pk_bf16_f32 v197, v154, v155
v_mfma_f32_16x16x32_bf16 v[132:135], a[208:211], a[128:131], v[132:135]
s_barrier
v_mfma_f32_16x16x32_bf16 v[140:143], a[208:211], a[144:147], -4.0
v_exp_f32 v128, v128
v_mfma_f32_16x16x32_bf16 v[140:143], a[212:215], a[148:151], v[140:143]
v_exp_f32 v129, v129
v_mfma_f32_16x16x32_bf16 v[140:143], a[216:219], a[152:155], v[140:143]
v_exp_f32_e64 v130, v130
v_mfma_f32_16x16x32_bf16 v[140:143], a[220:223], a[156:159], v[140:143]
buffer_store_dwordx4 v[208:211], v249, s[20:23], s35 offen offset:2176 sc1
v_mfma_f32_16x16x32_bf16 v[136:139], a[204:207], a[156:159], -4.0
s_xor_b32 s57, s28, 0x3000000
v_exp_f32 v131, v131
v_mfma_f32_16x16x32_bf16 v[136:139], a[200:203], a[152:155], v[136:139]
s_xor_b32 s58, s28, 0x3001000
v_exp_f32 v132, v132
v_mfma_f32_16x16x32_bf16 v[136:139], a[196:199], a[148:151], v[136:139]
v_cvt_pk_bf16_f32 v160, v128, v129
v_cvt_pk_bf16_f32 v161, v130, v131
v_mfma_f32_16x16x32_bf16 v[136:139], a[192:195], a[144:147], v[136:139]
ds_read_b128 a[208:211], v240 offset:4160
ds_read_b128 a[212:215], v240 offset:4416
v_smfmac_f32_16x16x64_bf16 v[220:223], v[224:227], v[184:191], v248
ds_read_b128 a[216:219], v240 offset:4672
v_mfma_f32_16x16x32_bf16 v[80:83], a[224:227], v[228:231], v[80:83]
v_exp_f32_e64 v133, v133
v_mfma_f32_16x16x32_bf16 v[80:83], a[228:231], v[184:187], v[80:83]
ds_read_b128 a[220:223], v240 offset:4928
ds_read_b128 a[204:207], v240 offset:768
v_mfma_f32_16x16x32_bf16 v[112:115], a[228:231], v[188:191], v[112:115]
L_pad19:
s_cbranch_vccnz L_back0
v_exp_f32 v134, v134
v_mfma_f32_16x16x32_bf16 v[112:115], a[224:227], v[232:235], v[112:115]
ds_read_b128 a[200:203], v240 offset:512
ds_read_b128 a[196:199], v240 offset:256
v_mfma_f32_16x16x32_bf16 v[116:119], a[232:235], v[232:235], v[116:119]
v_exp_f32_e64 v135, v135
v_mfma_f32_16x16x32_bf16 v[116:119], a[236:239], v[188:191], v[116:119]
ds_read_b128 a[192:195], v240
ds_read_b64_tr_b16 a[224:225], v241 offset:33024
v_mfma_f32_16x16x32_bf16 v[84:87], a[236:239], v[184:187], v[84:87]
v_exp_f32_e64 v140, v140
v_mfma_f32_16x16x32_bf16 v[84:87], a[232:235], v[228:231], v[84:87]
ds_read_b64_tr_b16 a[226:227], v241 offset:37152
ds_read_b64_tr_b16 a[228:229], v241 offset:41280
v_mfma_f32_16x16x32_bf16 v[88:91], a[240:243], v[228:231], v[88:91]
v_cvt_pk_bf16_f32 v162, v132, v133
v_cvt_pk_bf16_f32 v163, v134, v135
v_mfma_f32_16x16x32_bf16 v[88:91], a[244:247], v[184:187], v[88:91]
ds_read_b64_tr_b16 a[230:231], v241 offset:45408
ds_read_b64_tr_b16 a[232:233], v241 offset:33032
v_mfma_f32_16x16x32_bf16 v[120:123], a[244:247], v[188:191], v[120:123]
v_exp_f32_e64 v141, v141
v_mfma_f32_16x16x32_bf16 v[120:123], a[240:243], v[232:235], v[120:123]
ds_read_b64_tr_b16 a[234:235], v241 offset:37160
ds_read_b64_tr_b16 a[236:237], v241 offset:41288
v_mfma_f32_16x16x32_bf16 v[124:127], a[248:251], v[232:235], v[124:127]
v_exp_f32_e64 v142, v142
v_mfma_f32_16x16x32_bf16 v[124:127], a[252:255], v[188:191], v[124:127]
ds_read_b64_tr_b16 a[238:239], v241 offset:45416
ds_read_b64_tr_b16 a[240:241], v241 offset:33280
v_mfma_f32_16x16x32_bf16 v[92:95], a[252:255], v[184:187], v[92:95]
v_exp_f32 v143, v143
v_mfma_f32_16x16x32_bf16 v[92:95], a[248:251], v[228:231], v[92:95]
s_waitcnt lgkmcnt(6)
ds_read_b64_tr_b16 a[242:243], v241 offset:37408
v_cvt_pk_bf16_f32 v166, v140, v141
v_mfma_f32_16x16x32_bf16 v[144:147], a[192:195], a[128:131], -4.0
v_exp_f32 v136, v136
v_mfma_f32_16x16x32_bf16 v[144:147], a[196:199], a[132:135], v[144:147]
v_exp_f32 v137, v137
v_mfma_f32_16x16x32_bf16 v[144:147], a[200:203], a[136:139], v[144:147]
v_exp_f32_e64 v138, v138
v_mfma_f32_16x16x32_bf16 v[144:147], a[204:207], a[140:143], v[144:147]
ds_read_b64_tr_b16 a[244:245], v241 offset:41536
ds_read_b64_tr_b16 a[246:247], v241 offset:45664
v_mfma_f32_16x16x32_bf16 v[148:151], a[220:223], a[140:143], -4.0
v_cvt_pk_bf16_f32 v167, v142, v143
v_cvt_pk_bf16_f32 v164, v136, v137
v_mfma_f32_16x16x32_bf16 v[148:151], a[216:219], a[136:139], v[148:151]
v_exp_f32 v139, v139
v_mfma_f32_16x16x32_bf16 v[148:151], a[212:215], a[132:135], v[148:151]
s_waitcnt vmcnt(6) lgkmcnt(2)
v_exp_f32 v144, v144
v_mfma_f32_16x16x32_bf16 v[148:151], a[208:211], a[128:131], v[148:151]
s_barrier
v_mfma_f32_16x16x32_bf16 v[156:159], a[208:211], a[144:147], -4.0
v_exp_f32 v145, v145
v_mfma_f32_16x16x32_bf16 v[156:159], a[212:215], a[148:151], v[156:159]
v_exp_f32 v146, v146
v_mfma_f32_16x16x32_bf16 v[156:159], a[216:219], a[152:155], v[156:159]
v_cvt_pk_bf16_f32 v165, v138, v139
v_cvt_pk_bf16_f32 v176, v144, v145
v_mfma_f32_16x16x32_bf16 v[156:159], a[220:223], a[156:159], v[156:159]
ds_read_b64_tr_b16 a[248:249], v241 offset:33288
ds_read_b64_tr_b16 a[250:251], v241 offset:37416
v_mfma_f32_16x16x32_bf16 v[152:155], a[204:207], a[156:159], -4.0
v_exp_f32_e64 v147, v147
v_mfma_f32_16x16x32_bf16 v[152:155], a[200:203], a[152:155], v[152:155]
v_exp_f32 v148, v148
v_mfma_f32_16x16x32_bf16 v[152:155], a[196:199], a[148:151], v[152:155]
v_exp_f32 v149, v149
v_mfma_f32_16x16x32_bf16 v[152:155], a[192:195], a[144:147], v[152:155]
ds_read_b64_tr_b16 a[252:253], v241 offset:41544
ds_read_b64_tr_b16 a[254:255], v241 offset:45672
v_smfmac_f32_16x16x64_bf16 v[216:219], v[224:227], v[168:175], v248
v_cvt_pk_bf16_f32 v177, v146, v147
v_smfmac_f32_16x16x64_bf16 v[216:219], v[224:227], v[192:199], v248
ds_read_b128 a[208:211], v240 offset:37440
v_mfma_f32_16x16x32_bf16 v[0:3], a[224:227], v[168:171], v[0:3]
v_exp_f32 v150, v150
v_mfma_f32_16x16x32_bf16 v[0:3], a[228:231], v[192:195], v[0:3]
ds_read_b128 a[212:215], v240 offset:37696
ds_read_b128 a[216:219], v240 offset:37952
v_mfma_f32_16x16x32_bf16 v[32:35], a[228:231], v[196:199], v[32:35]
v_exp_f32 v151, v151
v_mfma_f32_16x16x32_bf16 v[32:35], a[224:227], v[172:175], v[32:35]
ds_read_b128 a[220:223], v240 offset:38208
ds_read_b128 a[204:207], v240 offset:34048
v_mfma_f32_16x16x32_bf16 v[36:39], a[232:235], v[172:175], v[36:39]
v_exp_f32_e64 v156, v156
v_mfma_f32_16x16x32_bf16 v[36:39], a[236:239], v[196:199], v[36:39]
ds_read_b128 a[200:203], v240 offset:33792
ds_read_b128 a[196:199], v240 offset:33536
v_mfma_f32_16x16x32_bf16 v[4:7], a[236:239], v[192:195], v[4:7]
v_cvt_pk_bf16_f32 v178, v148, v149
v_cvt_pk_bf16_f32 v179, v150, v151
v_mfma_f32_16x16x32_bf16 v[4:7], a[232:235], v[168:171], v[4:7]
ds_read_b128 a[192:195], v240 offset:33280
ds_read_b64_tr_b16 a[224:225], v241 offset:49536
v_mfma_f32_16x16x32_bf16 v[8:11], a[240:243], v[168:171], v[8:11]
s_waitcnt lgkmcnt(6)
v_exp_f32 v157, v157
v_mfma_f32_16x16x32_bf16 v[8:11], a[244:247], v[192:195], v[8:11]
ds_read_b64_tr_b16 a[226:227], v241 offset:53664
ds_read_b64_tr_b16 a[228:229], v241 offset:57792
v_mfma_f32_16x16x32_bf16 v[40:43], a[244:247], v[196:199], v[40:43]
v_exp_f32_e64 v158, v158
v_mfma_f32_16x16x32_bf16 v[40:43], a[240:243], v[172:175], v[40:43]
ds_read_b64_tr_b16 a[230:231], v241 offset:61920
ds_read_b64_tr_b16 a[232:233], v241 offset:49544
v_mfma_f32_16x16x32_bf16 v[44:47], a[248:251], v[172:175], v[44:47]
v_exp_f32 v159, v159
v_mfma_f32_16x16x32_bf16 v[44:47], a[252:255], v[196:199], v[44:47]
ds_read_b64_tr_b16 a[234:235], v241 offset:53672
ds_read_b64_tr_b16 a[236:237], v241 offset:57800
v_mfma_f32_16x16x32_bf16 v[12:15], a[252:255], v[192:195], v[12:15]
v_exp_f32_e64 v152, v152
v_mfma_f32_16x16x32_bf16 v[12:15], a[248:251], v[168:171], v[12:15]
s_waitcnt lgkmcnt(6)
ds_read_b64_tr_b16 a[238:239], v241 offset:61928
ds_read_b64_tr_b16 a[240:241], v241 offset:49792
v_mfma_f32_16x16x32_bf16 v[128:131], a[192:195], a[160:163], -4.0
v_cvt_pk_bf16_f32 v182, v156, v157
v_cvt_pk_bf16_f32 v183, v158, v159
v_mfma_f32_16x16x32_bf16 v[128:131], a[196:199], a[164:167], v[128:131]
v_exp_f32 v153, v153
v_mfma_f32_16x16x32_bf16 v[128:131], a[200:203], a[168:171], v[128:131]
v_exp_f32 v154, v154
v_mfma_f32_16x16x32_bf16 v[128:131], a[204:207], a[172:175], v[128:131]
ds_read_b64_tr_b16 a[242:243], v241 offset:53920
ds_read_b64_tr_b16 a[244:245], v241 offset:58048
v_mfma_f32_16x16x32_bf16 v[132:135], a[220:223], a[172:175], -4.0
v_exp_f32_e64 v155, v155
v_mfma_f32_16x16x32_bf16 v[132:135], a[216:219], a[168:171], v[132:135]
v_cvt_pk_bf16_f32 v180, v152, v153
v_cvt_pk_bf16_f32 v181, v154, v155
v_mfma_f32_16x16x32_bf16 v[132:135], a[212:215], a[164:167], v[132:135]
v_exp_f32 v128, v128
v_mfma_f32_16x16x32_bf16 v[132:135], a[208:211], a[160:163], v[132:135]
ds_read_b64_tr_b16 a[246:247], v241 offset:62176
ds_read_b64_tr_b16 a[248:249], v241 offset:49800
v_mfma_f32_16x16x32_bf16 v[140:143], a[208:211], a[176:179], -4.0
v_exp_f32 v129, v129
v_mfma_f32_16x16x32_bf16 v[140:143], a[212:215], a[180:183], v[140:143]
v_exp_f32_e64 v130, v130
v_mfma_f32_16x16x32_bf16 v[140:143], a[216:219], a[184:187], v[140:143]
v_exp_f32 v131, v131
v_mfma_f32_16x16x32_bf16 v[140:143], a[220:223], a[188:191], v[140:143]
ds_read_b64_tr_b16 a[250:251], v241 offset:53928
ds_read_b64_tr_b16 a[252:253], v241 offset:58056
v_mfma_f32_16x16x32_bf16 v[136:139], a[204:207], a[188:191], -4.0
v_exp_f32 v132, v132
v_mfma_f32_16x16x32_bf16 v[136:139], a[200:203], a[184:187], v[136:139]
v_cvt_pk_bf16_f32 v184, v128, v129
v_cvt_pk_bf16_f32 v185, v130, v131
v_mfma_f32_16x16x32_bf16 v[136:139], a[196:199], a[180:183], v[136:139]
v_exp_f32 v133, v133
v_mfma_f32_16x16x32_bf16 v[136:139], a[192:195], a[176:179], v[136:139]
ds_read_b64_tr_b16 a[254:255], v241 offset:62184
ds_read_b128 a[208:211], v240 offset:45760
v_smfmac_f32_16x16x64_bf16 v[216:219], v[224:227], v[160:167], v248
ds_read_b128 a[212:215], v240 offset:46016
v_smfmac_f32_16x16x64_bf16 v[216:219], v[224:227], v[176:183], v248
s_waitcnt lgkmcnt(5)
ds_read_b128 a[216:219], v240 offset:46272
v_mfma_f32_16x16x32_bf16 v[0:3], a[224:227], v[160:163], v[0:3]
ds_read_b128 a[220:223], v240 offset:46528
ds_read_b128 a[204:207], v240 offset:42368
v_mfma_f32_16x16x32_bf16 v[0:3], a[228:231], v[176:179], v[0:3]
ds_read_b128 a[200:203], v240 offset:42112
ds_read_b128 a[196:199], v240 offset:41856
v_mfma_f32_16x16x32_bf16 v[32:35], a[228:231], v[180:183], v[32:35]
ds_read_b128 a[192:195], v240 offset:41600
v_add_f32_e64 v250, v216, v217
v_mfma_f32_16x16x32_bf16 v[32:35], a[224:227], v[164:167], v[32:35]
ds_read_b64_tr_b16 a[224:225], v241 offset:33536
ds_read_b64_tr_b16 a[226:227], v241 offset:37664
v_mfma_f32_16x16x32_bf16 v[36:39], a[232:235], v[164:167], v[36:39]
ds_read_b64_tr_b16 a[228:229], v241 offset:41792
ds_read_b64_tr_b16 a[230:231], v241 offset:45920
v_mfma_f32_16x16x32_bf16 v[36:39], a[236:239], v[180:183], v[36:39]
v_add_f32 v251, v218, v219
v_subrev_u32 v216, s36, v250
v_mfma_f32_16x16x32_bf16 v[4:7], a[236:239], v[176:179], v[4:7]
v_subrev_u32 v217, s36, v251
v_max_u32 v216, v216, v217
v_mfma_f32_16x16x32_bf16 v[4:7], a[232:235], v[160:163], v[4:7]
ds_read_b64_tr_b16 a[232:233], v241 offset:33544
ds_read_b64_tr_b16 a[234:235], v241 offset:37672
v_mfma_f32_16x16x32_bf16 v[8:11], a[240:243], v[160:163], v[8:11]
ds_read_b64_tr_b16 a[236:237], v241 offset:41800
ds_read_b64_tr_b16 a[238:239], v241 offset:45928
v_mfma_f32_16x16x32_bf16 v[8:11], a[244:247], v[176:179], v[8:11]
v_rcp_f32 v250, v250
v_mfma_f32_16x16x32_bf16 v[40:43], a[244:247], v[180:183], v[40:43]
v_rcp_f32_e64 v251, v251
v_mfma_f32_16x16x32_bf16 v[40:43], a[240:243], v[164:167], v[40:43]
s_waitcnt lgkmcnt(4)
ds_read_b64_tr_b16 a[240:241], v241 offset:33792
v_cmp_le_u32 s[52:53], s37, v216
v_mfma_f32_16x16x32_bf16 v[44:47], a[248:251], v[164:167], v[44:47]
ds_read_b64_tr_b16 a[242:243], v241 offset:37920
v_exp_f32 v134, v134
v_cvt_pk_bf16_f32 v186, v132, v133
v_exp_f32 v135, v135
v_pk_mul_f32 v[38:39], v[38:39], v[250:251] op_sel:[0,1] op_sel_hi:[1,1]
v_pk_mul_f32 v[36:37], v[36:37], v[250:251] op_sel:[0,1] op_sel_hi:[1,1]
v_pk_mul_f32 v[34:35], v[34:35], v[250:251] op_sel:[0,1] op_sel_hi:[1,1]
v_pk_mul_f32 v[32:33], v[32:33], v[250:251] op_sel:[0,1] op_sel_hi:[1,1]
v_cvt_pk_bf16_f32 v32, v32, v33
v_mfma_f32_16x16x32_bf16 v[44:47], a[252:255], v[180:183], v[44:47]
v_exp_f32_e64 v140, v140
v_cvt_pk_bf16_f32 v33, v34, v35
v_cvt_pk_bf16_f32 v34, v36, v37
v_mfma_f32_16x16x32_bf16 v[12:15], a[252:255], v[176:179], v[12:15]
ds_read_b64_tr_b16 a[244:245], v241 offset:42048
v_cvt_pk_bf16_f32 v187, v134, v135
v_mfma_f32_16x16x32_bf16 v[12:15], a[248:251], v[160:163], v[12:15]
v_exp_f32 v141, v141
v_cvt_pk_bf16_f32 v35, v38, v39
v_mfma_f32_16x16x32_bf16 v[144:147], a[192:195], a[160:163], -4.0
ds_read_b64_tr_b16 a[246:247], v241 offset:46176
v_exp_f32 v142, v142
v_cvt_pk_bf16_f32 v190, v140, v141
v_exp_f32 v143, v143
v_pk_mul_f32 v[46:47], v[46:47], v[250:251] op_sel:[0,1] op_sel_hi:[1,1]
v_pk_mul_f32 v[44:45], v[44:45], v[250:251] op_sel:[0,1] op_sel_hi:[1,1]
v_pk_mul_f32 v[42:43], v[42:43], v[250:251] op_sel:[0,1] op_sel_hi:[1,1]
v_pk_mul_f32 v[40:41], v[40:41], v[250:251] op_sel:[0,1] op_sel_hi:[1,1]
v_cvt_pk_bf16_f32 v40, v40, v41
v_mfma_f32_16x16x32_bf16 v[144:147], a[196:199], a[164:167], v[144:147]
v_exp_f32 v136, v136
v_mfma_f32_16x16x32_bf16 v[144:147], a[200:203], a[168:171], v[144:147]
ds_read_b64_tr_b16 a[248:249], v241 offset:33800
v_cvt_pk_bf16_f32 v191, v142, v143
v_mfma_f32_16x16x32_bf16 v[144:147], a[204:207], a[172:175], v[144:147]
v_exp_f32_e64 v137, v137
v_mfma_f32_16x16x32_bf16 v[148:151], a[220:223], a[172:175], -4.0
ds_read_b64_tr_b16 a[250:251], v241 offset:37928
v_cvt_pk_bf16_f32 v41, v42, v43
v_cvt_pk_bf16_f32 v42, v44, v45
v_mfma_f32_16x16x32_bf16 v[148:151], a[216:219], a[168:171], v[148:151]
v_exp_f32 v138, v138
v_mfma_f32_16x16x32_bf16 v[148:151], a[212:215], a[164:167], v[148:151]
ds_read_b64_tr_b16 a[252:253], v241 offset:42056
v_cvt_pk_bf16_f32 v188, v136, v137
v_mfma_f32_16x16x32_bf16 v[148:151], a[208:211], a[160:163], v[148:151]
ds_read_b64_tr_b16 a[254:255], v241 offset:46184
v_cvt_pk_bf16_f32 v43, v46, v47
v_mov_b64 v[44:45], v[32:33]
v_mfma_f32_16x16x32_bf16 v[156:159], a[208:211], a[176:179], -4.0
ds_read_b128 a[208:211], v240 offset:54080
v_mov_b64_e64 v[46:47], v[34:35]
v_mov_b32_dpp v32, v40 row_ror:8 row_mask:0xf bank_mask:0xc
v_mfma_f32_16x16x32_bf16 v[156:159], a[212:215], a[180:183], v[156:159]
ds_read_b128 a[212:215], v240 offset:54336
v_mov_b32_dpp v33, v41 row_ror:8 row_mask:0xf bank_mask:0xc
v_mov_b32_dpp v34, v42 row_ror:8 row_mask:0xf bank_mask:0xc
v_mfma_f32_16x16x32_bf16 v[156:159], a[216:219], a[184:187], v[156:159]
v_exp_f32_e64 v139, v139
v_mov_b32_dpp v35, v43 row_ror:8 row_mask:0xf bank_mask:0xc
v_mov_b32_dpp v40, v44 row_ror:8 row_mask:0xf bank_mask:0x3
v_mfma_f32_16x16x32_bf16 v[156:159], a[220:223], a[188:191], v[156:159]
buffer_store_dwordx4 v[32:35], v249, s[20:23], s58 offen sc1
v_mfma_f32_16x16x32_bf16 v[152:155], a[204:207], a[188:191], -4.0
ds_read_b128 a[216:219], v240 offset:54592
v_cvt_pk_bf16_f32 v189, v138, v139
v_mov_b32_dpp v41, v45 row_ror:8 row_mask:0xf bank_mask:0x3
v_mov_b32_dpp v42, v46 row_ror:8 row_mask:0xf bank_mask:0x3
v_mov_b32_dpp v43, v47 row_ror:8 row_mask:0xf bank_mask:0x3
v_mfma_f32_16x16x32_bf16 v[152:155], a[200:203], a[184:187], v[152:155]
ds_read_b128 a[220:223], v240 offset:54848
v_exp_f32 v144, v144
v_exp_f32 v145, v145
v_pk_mul_f32 v[6:7], v[6:7], v[250:251] op_sel:[0,0] op_sel_hi:[1,0]
v_pk_mul_f32 v[4:5], v[4:5], v[250:251] op_sel:[0,0] op_sel_hi:[1,0]
v_pk_mul_f32 v[2:3], v[2:3], v[250:251] op_sel:[0,0] op_sel_hi:[1,0]
v_pk_mul_f32 v[0:1], v[0:1], v[250:251] op_sel:[0,0] op_sel_hi:[1,0]
v_cvt_pk_bf16_f32 v0, v0, v1
v_mfma_f32_16x16x32_bf16 v[152:155], a[196:199], a[180:183], v[152:155]
ds_read_b128 a[204:207], v240 offset:50688
ds_read_b128 a[200:203], v240 offset:50432
v_mfma_f32_16x16x32_bf16 v[152:155], a[192:195], a[176:179], v[152:155]
ds_read_b128 a[196:199], v240 offset:50176
ds_read_b128 a[192:195], v240 offset:49920
v_mfma_f32_16x16x32_bf16 v[16:19], a[224:227], v[168:171], v[16:19]
v_cvt_pk_bf16_f32 v1, v2, v3
v_cvt_pk_bf16_f32 v2, v4, v5
v_mfma_f32_16x16x32_bf16 v[16:19], a[228:231], v[192:195], v[16:19]
v_exp_f32_e64 v146, v146
v_mfma_f32_16x16x32_bf16 v[48:51], a[228:231], v[196:199], v[48:51]
v_cvt_pk_bf16_f32 v228, v144, v145
v_cvt_pk_bf16_f32 v3, v6, v7
v_mfma_f32_16x16x32_bf16 v[48:51], a[224:227], v[172:175], v[48:51]
s_waitcnt lgkmcnt(5)
ds_read_b64_tr_b16 a[224:225], v241 offset:50048
v_exp_f32 v147, v147
v_exp_f32_e64 v148, v148
v_pk_mul_f32 v[14:15], v[14:15], v[250:251] op_sel:[0,0] op_sel_hi:[1,0]
v_pk_mul_f32 v[12:13], v[12:13], v[250:251] op_sel:[0,0] op_sel_hi:[1,0]
v_pk_mul_f32 v[10:11], v[10:11], v[250:251] op_sel:[0,0] op_sel_hi:[1,0]
v_pk_mul_f32 v[8:9], v[8:9], v[250:251] op_sel:[0,0] op_sel_hi:[1,0]
v_cvt_pk_bf16_f32 v8, v8, v9
v_mfma_f32_16x16x32_bf16 v[52:55], a[232:235], v[172:175], v[52:55]
ds_read_b64_tr_b16 a[226:227], v241 offset:54176
ds_read_b64_tr_b16 a[228:229], v241 offset:58304
v_mfma_f32_16x16x32_bf16 v[52:55], a[236:239], v[196:199], v[52:55]
buffer_store_dwordx4 v[40:43], v249, s[20:23], s58 offen offset:2048 sc1
v_mfma_f32_16x16x32_bf16 v[20:23], a[236:239], v[192:195], v[20:23]
ds_read_b64_tr_b16 a[230:231], v241 offset:62432
v_cvt_pk_bf16_f32 v229, v146, v147
v_mfma_f32_16x16x32_bf16 v[20:23], a[232:235], v[168:171], v[20:23]
ds_read_b64_tr_b16 a[232:233], v241 offset:50056
ds_read_b64_tr_b16 a[234:235], v241 offset:54184
v_mfma_f32_16x16x32_bf16 v[24:27], a[240:243], v[168:171], v[24:27]
ds_read_b64_tr_b16 a[236:237], v241 offset:58312
ds_read_b64_tr_b16 a[238:239], v241 offset:62440
v_cvt_pk_bf16_f32 v9, v10, v11
v_cvt_pk_bf16_f32 v10, v12, v13
v_mfma_f32_16x16x32_bf16 v[24:27], a[244:247], v[192:195], v[24:27]
v_exp_f32 v149, v149
v_mfma_f32_16x16x32_bf16 v[56:59], a[244:247], v[196:199], v[56:59]
v_exp_f32 v150, v150
v_mfma_f32_16x16x32_bf16 v[56:59], a[240:243], v[172:175], v[56:59]
ds_read_b64_tr_b16 a[240:241], v241 offset:50304
v_cvt_pk_bf16_f32 v230, v148, v149
v_cvt_pk_bf16_f32 v11, v14, v15
v_mov_b64_e64 v[12:13], v[0:1]
v_mfma_f32_16x16x32_bf16 v[60:63], a[248:251], v[172:175], v[60:63]
ds_read_b64_tr_b16 a[242:243], v241 offset:54432
v_mov_b64_e64 v[14:15], v[2:3]
v_mov_b32_dpp v0, v8 row_ror:8 row_mask:0xf bank_mask:0xc
v_mfma_f32_16x16x32_bf16 v[60:63], a[252:255], v[196:199], v[60:63]
v_exp_f32 v151, v151
v_mov_b32_dpp v1, v9 row_ror:8 row_mask:0xf bank_mask:0xc
v_mov_b32_dpp v2, v10 row_ror:8 row_mask:0xf bank_mask:0xc
v_mfma_f32_16x16x32_bf16 v[28:31], a[252:255], v[192:195], v[28:31]
ds_read_b64_tr_b16 a[244:245], v241 offset:58560
v_mov_b32_dpp v3, v11 row_ror:8 row_mask:0xf bank_mask:0xc
v_mov_b32_dpp v8, v12 row_ror:8 row_mask:0xf bank_mask:0x3
v_mfma_f32_16x16x32_bf16 v[28:31], a[248:251], v[168:171], v[28:31]
s_waitcnt lgkmcnt(3)
buffer_store_dwordx4 v[0:3], v249, s[20:23], s57 offen sc1
v_mfma_f32_16x16x32_bf16 v[128:131], a[192:195], a[160:163], -4.0
ds_read_b64_tr_b16 a[246:247], v241 offset:62688
v_mov_b32_dpp v9, v13 row_ror:8 row_mask:0xf bank_mask:0x3
v_mov_b32_dpp v10, v14 row_ror:8 row_mask:0xf bank_mask:0x3
v_mov_b32_dpp v11, v15 row_ror:8 row_mask:0xf bank_mask:0x3
v_mfma_f32_16x16x32_bf16 v[128:131], a[196:199], a[164:167], v[128:131]
v_exp_f32_e64 v156, v156
v_mfma_f32_16x16x32_bf16 v[128:131], a[200:203], a[168:171], v[128:131]
ds_read_b64_tr_b16 a[248:249], v241 offset:50312
v_cvt_pk_bf16_f32 v231, v150, v151
v_mfma_f32_16x16x32_bf16 v[128:131], a[204:207], a[172:175], v[128:131]
v_exp_f32_e64 v157, v157
v_mfma_f32_16x16x32_bf16 v[132:135], a[220:223], a[172:175], -4.0
ds_read_b64_tr_b16 a[250:251], v241 offset:54440
ds_read_b64_tr_b16 a[252:253], v241 offset:58568
v_mfma_f32_16x16x32_bf16 v[132:135], a[216:219], a[168:171], v[132:135]
v_exp_f32 v158, v158
v_mfma_f32_16x16x32_bf16 v[132:135], a[212:215], a[164:167], v[132:135]
ds_read_b64_tr_b16 a[254:255], v241 offset:62696
v_cvt_pk_bf16_f32 v234, v156, v157
v_mfma_f32_16x16x32_bf16 v[132:135], a[208:211], a[160:163], v[132:135]
v_exp_f32 v159, v159
v_mfma_f32_16x16x32_bf16 v[140:143], a[208:211], a[176:179], -4.0
v_exp_f32_e64 v152, v152
v_mfma_f32_16x16x32_bf16 v[140:143], a[212:215], a[180:183], v[140:143]
buffer_store_dwordx4 v[8:11], v249, s[20:23], s57 offen offset:2048 sc1
v_mfma_f32_16x16x32_bf16 v[140:143], a[216:219], a[184:187], v[140:143]
ds_read_b128 a[208:211], v240 offset:4160
v_cvt_pk_bf16_f32 v235, v158, v159
v_mfma_f32_16x16x32_bf16 v[140:143], a[220:223], a[188:191], v[140:143]
ds_read_b128 a[212:215], v240 offset:4416
ds_read_b128 a[216:219], v240 offset:4672
v_mfma_f32_16x16x32_bf16 v[136:139], a[204:207], a[188:191], -4.0
v_exp_f32 v153, v153
v_mfma_f32_16x16x32_bf16 v[136:139], a[200:203], a[184:187], v[136:139]
v_exp_f32 v154, v154
v_mfma_f32_16x16x32_bf16 v[136:139], a[196:199], a[180:183], v[136:139]
ds_read_b128 a[220:223], v240 offset:4928
v_cvt_pk_bf16_f32 v232, v152, v153
v_mfma_f32_16x16x32_bf16 v[136:139], a[192:195], a[176:179], v[136:139]
ds_read_b128 a[204:207], v240 offset:768
ds_read_b128 a[200:203], v240 offset:512
v_mfma_f32_16x16x32_bf16 v[16:19], a[224:227], v[160:163], v[16:19]
v_exp_f32 v155, v155
v_mfma_f32_16x16x32_bf16 v[16:19], a[228:231], v[176:179], v[16:19]
ds_read_b128 a[196:199], v240 offset:256
v_cvt_pk_bf16_f32 v233, v154, v155
v_mfma_f32_16x16x32_bf16 v[48:51], a[228:231], v[180:183], v[48:51]
v_exp_f32 v128, v128
v_mfma_f32_16x16x32_bf16 v[48:51], a[224:227], v[164:167], v[48:51]
ds_read_b128 a[192:195], v240
ds_read_b64_tr_b16 a[224:225], v241 offset:33024
v_mfma_f32_16x16x32_bf16 v[52:55], a[232:235], v[164:167], v[52:55]
v_exp_f32_e64 v129, v129
v_mfma_f32_16x16x32_bf16 v[52:55], a[236:239], v[180:183], v[52:55]
ds_read_b64_tr_b16 a[226:227], v241 offset:37152
ds_read_b64_tr_b16 a[228:229], v241 offset:41280
v_mfma_f32_16x16x32_bf16 v[20:23], a[236:239], v[176:179], v[20:23]
ds_read_b64_tr_b16 a[230:231], v241 offset:45408
v_exp_f32 v130, v130
v_cvt_pk_bf16_f32 v168, v128, v129
v_exp_f32_e64 v131, v131
s_nop 0
v_pk_mul_f32 v[54:55], v[54:55], v[250:251] op_sel:[0,1] op_sel_hi:[1,1]
v_pk_mul_f32 v[52:53], v[52:53], v[250:251] op_sel:[0,1] op_sel_hi:[1,1]
v_pk_mul_f32 v[50:51], v[50:51], v[250:251] op_sel:[0,1] op_sel_hi:[1,1]
v_pk_mul_f32 v[48:49], v[48:49], v[250:251] op_sel:[0,1] op_sel_hi:[1,1]
v_cvt_pk_bf16_f32 v48, v48, v49
v_mfma_f32_16x16x32_bf16 v[20:23], a[232:235], v[160:163], v[20:23]
s_waitcnt lgkmcnt(6)
ds_read_b64_tr_b16 a[232:233], v241 offset:33032
v_cvt_pk_bf16_f32 v49, v50, v51
v_cvt_pk_bf16_f32 v50, v52, v53
v_cvt_pk_bf16_f32 v51, v54, v55
v_mfma_f32_16x16x32_bf16 v[24:27], a[240:243], v[160:163], v[24:27]
v_exp_f32 v132, v132
v_mfma_f32_16x16x32_bf16 v[24:27], a[244:247], v[176:179], v[24:27]
ds_read_b64_tr_b16 a[234:235], v241 offset:37160
v_cvt_pk_bf16_f32 v169, v130, v131
v_mfma_f32_16x16x32_bf16 v[56:59], a[244:247], v[180:183], v[56:59]
ds_read_b64_tr_b16 a[236:237], v241 offset:41288
ds_read_b64_tr_b16 a[238:239], v241 offset:45416
v_mfma_f32_16x16x32_bf16 v[56:59], a[240:243], v[164:167], v[56:59]
ds_read_b64_tr_b16 a[240:241], v241 offset:33280
ds_read_b64_tr_b16 a[242:243], v241 offset:37408
v_exp_f32 v133, v133
v_mfma_f32_16x16x32_bf16 v[60:63], a[248:251], v[164:167], v[60:63]
v_exp_f32 v134, v134
v_mfma_f32_16x16x32_bf16 v[60:63], a[252:255], v[180:183], v[60:63]
ds_read_b64_tr_b16 a[244:245], v241 offset:41536
v_cvt_pk_bf16_f32 v170, v132, v133
v_mfma_f32_16x16x32_bf16 v[28:31], a[252:255], v[176:179], v[28:31]
ds_read_b64_tr_b16 a[246:247], v241 offset:45664
v_exp_f32 v135, v135
v_exp_f32 v140, v140
s_nop 1
v_pk_mul_f32 v[62:63], v[62:63], v[250:251] op_sel:[0,1] op_sel_hi:[1,1]
v_pk_mul_f32 v[60:61], v[60:61], v[250:251] op_sel:[0,1] op_sel_hi:[1,1]
v_pk_mul_f32 v[58:59], v[58:59], v[250:251] op_sel:[0,1] op_sel_hi:[1,1]
v_pk_mul_f32 v[56:57], v[56:57], v[250:251] op_sel:[0,1] op_sel_hi:[1,1]
v_cvt_pk_bf16_f32 v56, v56, v57
v_mfma_f32_16x16x32_bf16 v[28:31], a[248:251], v[160:163], v[28:31]
s_waitcnt lgkmcnt(7)
ds_read_b64_tr_b16 a[248:249], v241 offset:33288
v_cvt_pk_bf16_f32 v171, v134, v135
v_cvt_pk_bf16_f32 v57, v58, v59
v_cvt_pk_bf16_f32 v58, v60, v61
v_cvt_pk_bf16_f32 v59, v62, v63
v_mov_b64 v[60:61], v[48:49]
v_mfma_f32_16x16x32_bf16 v[144:147], a[192:195], a[160:163], -4.0
v_exp_f32 v141, v141
v_mov_b64_e64 v[62:63], v[50:51]
v_mov_b32_dpp v48, v56 row_ror:8 row_mask:0xf bank_mask:0xc
v_mov_b32_dpp v49, v57 row_ror:8 row_mask:0xf bank_mask:0xc
v_mov_b32_dpp v50, v58 row_ror:8 row_mask:0xf bank_mask:0xc
v_mfma_f32_16x16x32_bf16 v[144:147], a[196:199], a[164:167], v[144:147]
ds_read_b64_tr_b16 a[250:251], v241 offset:37416
v_mov_b32_dpp v51, v59 row_ror:8 row_mask:0xf bank_mask:0xc
v_exp_f32_e64 v142, v142
v_cvt_pk_bf16_f32 v174, v140, v141
v_mov_b32_dpp v56, v60 row_ror:8 row_mask:0xf bank_mask:0x3
v_mov_b32_dpp v57, v61 row_ror:8 row_mask:0xf bank_mask:0x3
v_mfma_f32_16x16x32_bf16 v[144:147], a[200:203], a[168:171], v[144:147]
buffer_store_dwordx4 v[48:51], v249, s[20:23], s58 offen offset:128 sc1
v_mfma_f32_16x16x32_bf16 v[144:147], a[204:207], a[172:175], v[144:147]
ds_read_b64_tr_b16 a[252:253], v241 offset:41544
ds_read_b64_tr_b16 a[254:255], v241 offset:45672
v_exp_f32_e64 v143, v143
v_mov_b32_dpp v58, v62 row_ror:8 row_mask:0xf bank_mask:0x3
v_mov_b32_dpp v59, v63 row_ror:8 row_mask:0xf bank_mask:0x3
v_mfma_f32_16x16x32_bf16 v[148:151], a[220:223], a[172:175], -4.0
v_exp_f32 v136, v136
v_cvt_pk_bf16_f32 v175, v142, v143
v_exp_f32 v137, v137
v_pk_mul_f32 v[22:23], v[22:23], v[250:251] op_sel:[0,0] op_sel_hi:[1,0]
v_pk_mul_f32 v[20:21], v[20:21], v[250:251] op_sel:[0,0] op_sel_hi:[1,0]
v_pk_mul_f32 v[18:19], v[18:19], v[250:251] op_sel:[0,0] op_sel_hi:[1,0]
v_pk_mul_f32 v[16:17], v[16:17], v[250:251] op_sel:[0,0] op_sel_hi:[1,0]
v_cvt_pk_bf16_f32 v16, v16, v17
v_mfma_f32_16x16x32_bf16 v[148:151], a[216:219], a[168:171], v[148:151]
v_exp_f32_e64 v138, v138
v_cvt_pk_bf16_f32 v17, v18, v19
v_cvt_pk_bf16_f32 v18, v20, v21
v_cvt_pk_bf16_f32 v19, v22, v23
v_mfma_f32_16x16x32_bf16 v[148:151], a[212:215], a[164:167], v[148:151]
v_cvt_pk_bf16_f32 v172, v136, v137
v_exp_f32 v139, v139
v_mfma_f32_16x16x32_bf16 v[148:151], a[208:211], a[160:163], v[148:151]
v_cvt_pk_bf16_f32 v173, v138, v139
v_exp_f32 v144, v144
v_exp_f32_e64 v145, v145
v_pk_mul_f32 v[30:31], v[30:31], v[250:251] op_sel:[0,0] op_sel_hi:[1,0]
v_pk_mul_f32 v[28:29], v[28:29], v[250:251] op_sel:[0,0] op_sel_hi:[1,0]
v_pk_mul_f32 v[26:27], v[26:27], v[250:251] op_sel:[0,0] op_sel_hi:[1,0]
v_pk_mul_f32 v[24:25], v[24:25], v[250:251] op_sel:[0,0] op_sel_hi:[1,0]
v_cvt_pk_bf16_f32 v24, v24, v25
v_mfma_f32_16x16x32_bf16 v[156:159], a[208:211], a[176:179], -4.0
v_exp_f32 v146, v146
v_cvt_pk_bf16_f32 v25, v26, v27
v_cvt_pk_bf16_f32 v26, v28, v29
v_cvt_pk_bf16_f32 v27, v30, v31
v_mov_b64 v[28:29], v[16:17]
v_mfma_f32_16x16x32_bf16 v[156:159], a[212:215], a[180:183], v[156:159]
v_cvt_pk_bf16_f32 v192, v144, v145
v_mov_b64 v[30:31], v[18:19]
v_mov_b32_dpp v16, v24 row_ror:8 row_mask:0xf bank_mask:0xc
v_mov_b32_dpp v17, v25 row_ror:8 row_mask:0xf bank_mask:0xc
v_mov_b32_dpp v18, v26 row_ror:8 row_mask:0xf bank_mask:0xc
v_mov_b32_dpp v19, v27 row_ror:8 row_mask:0xf bank_mask:0xc
v_mfma_f32_16x16x32_bf16 v[156:159], a[216:219], a[184:187], v[156:159]
v_exp_f32 v147, v147
v_mov_b32_dpp v24, v28 row_ror:8 row_mask:0xf bank_mask:0x3
v_mov_b32_dpp v25, v29 row_ror:8 row_mask:0xf bank_mask:0x3
v_mov_b32_dpp v26, v30 row_ror:8 row_mask:0xf bank_mask:0x3
v_mov_b32_dpp v27, v31 row_ror:8 row_mask:0xf bank_mask:0x3
v_mfma_f32_16x16x32_bf16 v[156:159], a[220:223], a[188:191], v[156:159]
v_exp_f32 v148, v148
v_mfma_f32_16x16x32_bf16 v[152:155], a[204:207], a[188:191], -4.0
buffer_store_dwordx4 v[56:59], v249, s[20:23], s58 offen offset:2176 sc1
v_mfma_f32_16x16x32_bf16 v[152:155], a[200:203], a[184:187], v[152:155]
v_exp_f32 v149, v149
v_mfma_f32_16x16x32_bf16 v[152:155], a[196:199], a[180:183], v[152:155]
v_exp_f32 v150, v150
v_mfma_f32_16x16x32_bf16 v[152:155], a[192:195], a[176:179], v[152:155]
v_cvt_pk_bf16_f32 v193, v146, v147
v_cvt_pk_bf16_f32 v194, v148, v149
v_smfmac_f32_16x16x64_bf16 v[220:223], v[224:227], v[184:191], v248
v_exp_f32 v151, v151
v_smfmac_f32_16x16x64_bf16 v[220:223], v[224:227], v[228:235], v248
v_exp_f32_e64 v156, v156
v_mfma_f32_16x16x32_bf16 v[64:67], a[224:227], v[184:187], v[64:67]
v_exp_f32 v157, v157
v_mfma_f32_16x16x32_bf16 v[64:67], a[228:231], v[228:231], v[64:67]
v_exp_f32_e64 v158, v158
v_mfma_f32_16x16x32_bf16 v[96:99], a[228:231], v[232:235], v[96:99]
v_cvt_pk_bf16_f32 v195, v150, v151
v_cvt_pk_bf16_f32 v198, v156, v157
v_mfma_f32_16x16x32_bf16 v[96:99], a[224:227], v[188:191], v[96:99]
s_waitcnt lgkmcnt(0)
ds_read_b64_tr_b16 a[224:225], v241 offset:49536
ds_read_b64_tr_b16 a[226:227], v241 offset:53664
v_mfma_f32_16x16x32_bf16 v[100:103], a[232:235], v[188:191], v[100:103]
buffer_store_dwordx4 v[16:19], v249, s[20:23], s57 offen offset:128 sc1
v_mfma_f32_16x16x32_bf16 v[100:103], a[236:239], v[232:235], v[100:103]
ds_read_b64_tr_b16 a[228:229], v241 offset:57792
ds_read_b64_tr_b16 a[230:231], v241 offset:61920
v_mfma_f32_16x16x32_bf16 v[68:71], a[236:239], v[228:231], v[68:71]
L_pad20:
s_cbranch_vccnz L_back0
v_exp_f32 v159, v159
v_mfma_f32_16x16x32_bf16 v[68:71], a[232:235], v[184:187], v[68:71]
ds_read_b64_tr_b16 a[232:233], v241 offset:49544
ds_read_b64_tr_b16 a[234:235], v241 offset:53672
v_mfma_f32_16x16x32_bf16 v[72:75], a[240:243], v[184:187], v[72:75]
ds_read_b64_tr_b16 a[236:237], v241 offset:57800
ds_read_b64_tr_b16 a[238:239], v241 offset:61928
v_mfma_f32_16x16x32_bf16 v[72:75], a[244:247], v[228:231], v[72:75]
v_exp_f32 v152, v152
v_mfma_f32_16x16x32_bf16 v[104:107], a[244:247], v[232:235], v[104:107]
v_exp_f32 v153, v153
v_mfma_f32_16x16x32_bf16 v[104:107], a[240:243], v[188:191], v[104:107]
ds_read_b64_tr_b16 a[240:241], v241 offset:49792
ds_read_b64_tr_b16 a[242:243], v241 offset:53920
v_mfma_f32_16x16x32_bf16 v[108:111], a[248:251], v[188:191], v[108:111]
ds_read_b64_tr_b16 a[244:245], v241 offset:58048
ds_read_b64_tr_b16 a[246:247], v241 offset:62176
v_mfma_f32_16x16x32_bf16 v[108:111], a[252:255], v[232:235], v[108:111]
v_exp_f32_e64 v154, v154
v_mfma_f32_16x16x32_bf16 v[76:79], a[252:255], v[228:231], v[76:79]
buffer_store_dwordx4 v[24:27], v249, s[20:23], s57 offen offset:2176 sc1
v_mfma_f32_16x16x32_bf16 v[76:79], a[248:251], v[184:187], v[76:79]
s_xor_b32 s59, s28, 0x3002000
ds_read_b64_tr_b16 a[248:249], v241 offset:49800
ds_read_b64_tr_b16 a[250:251], v241 offset:53928
v_smfmac_f32_16x16x64_bf16 v[220:223], v[224:227], v[168:175], v248
s_xor_b32 s35, s28, 0x3003000
ds_read_b64_tr_b16 a[252:253], v241 offset:58056
v_cvt_pk_bf16_f32 v199, v158, v159
v_cvt_pk_bf16_f32 v196, v152, v153
v_exp_f32_e64 v155, v155
s_nop 0
v_cvt_pk_bf16_f32 v197, v154, v155
s_nop 1
v_smfmac_f32_16x16x64_bf16 v[220:223], v[224:227], v[192:199], v248
s_waitcnt lgkmcnt(7)
ds_read_b64_tr_b16 a[254:255], v241 offset:62184
v_mfma_f32_16x16x32_bf16 v[64:67], a[224:227], v[168:171], v[64:67]
s_nop 1
v_mfma_f32_16x16x32_bf16 v[64:67], a[228:231], v[192:195], v[64:67]
s_nop 1
v_mfma_f32_16x16x32_bf16 v[96:99], a[228:231], v[196:199], v[96:99]
v_add_f32 v252, v220, v221
v_add_f32_e64 v253, v222, v223
v_mfma_f32_16x16x32_bf16 v[96:99], a[224:227], v[172:175], v[96:99]
ds_read_b64_tr_b16 a[224:225], v241 offset:33536
ds_read_b64_tr_b16 a[226:227], v241 offset:37664
v_mfma_f32_16x16x32_bf16 v[100:103], a[232:235], v[172:175], v[100:103]
ds_read_b64_tr_b16 a[228:229], v241 offset:41792
ds_read_b64_tr_b16 a[230:231], v241 offset:45920
v_mfma_f32_16x16x32_bf16 v[100:103], a[236:239], v[196:199], v[100:103]
v_subrev_u32 v220, s36, v252
v_subrev_u32 v221, s36, v253
v_mfma_f32_16x16x32_bf16 v[68:71], a[236:239], v[192:195], v[68:71]
v_max_u32 v220, v220, v221
v_rcp_f32_e64 v252, v252
v_mfma_f32_16x16x32_bf16 v[68:71], a[232:235], v[168:171], v[68:71]
s_waitcnt lgkmcnt(4)
ds_read_b64_tr_b16 a[232:233], v241 offset:33544
ds_read_b64_tr_b16 a[234:235], v241 offset:37672
v_mfma_f32_16x16x32_bf16 v[72:75], a[240:243], v[168:171], v[72:75]
ds_read_b64_tr_b16 a[236:237], v241 offset:41800
ds_read_b64_tr_b16 a[238:239], v241 offset:45928
v_mfma_f32_16x16x32_bf16 v[72:75], a[244:247], v[192:195], v[72:75]
v_rcp_f32 v253, v253
v_mfma_f32_16x16x32_bf16 v[104:107], a[244:247], v[196:199], v[104:107]
v_cmp_le_u32 s[54:55], s37, v220
v_mfma_f32_16x16x32_bf16 v[104:107], a[240:243], v[172:175], v[104:107]
ds_read_b64_tr_b16 a[240:241], v241 offset:33792
v_mul_f32 v96, v253, v96
v_mfma_f32_16x16x32_bf16 v[108:111], a[248:251], v[172:175], v[108:111]
ds_read_b64_tr_b16 a[242:243], v241 offset:37920
ds_read_b64_tr_b16 a[244:245], v241 offset:42048
v_mul_f32 v97, v253, v97
v_mul_f32 v98, v253, v98
v_mfma_f32_16x16x32_bf16 v[108:111], a[252:255], v[196:199], v[108:111]
ds_read_b64_tr_b16 a[246:247], v241 offset:46176
v_mul_f32 v99, v253, v99
v_mul_f32 v100, v253, v100
v_mul_f32 v101, v253, v101
v_mul_f32 v102, v253, v102
v_mfma_f32_16x16x32_bf16 v[76:79], a[252:255], v[192:195], v[76:79]
v_mul_f32 v103, v253, v103
v_cvt_pk_bf16_f32 v96, v96, v97
v_cvt_pk_bf16_f32 v97, v98, v99
v_cvt_pk_bf16_f32 v98, v100, v101
v_mfma_f32_16x16x32_bf16 v[76:79], a[248:251], v[168:171], v[76:79]
s_waitcnt lgkmcnt(4)
ds_read_b64_tr_b16 a[248:249], v241 offset:33800
ds_read_b64_tr_b16 a[250:251], v241 offset:37928
v_mfma_f32_16x16x32_bf16 v[80:83], a[224:227], v[184:187], v[80:83]
ds_read_b64_tr_b16 a[252:253], v241 offset:42056
ds_read_b64_tr_b16 a[254:255], v241 offset:46184
v_mfma_f32_16x16x32_bf16 v[80:83], a[228:231], v[228:231], v[80:83]
v_cvt_pk_bf16_f32 v99, v102, v103
v_mfma_f32_16x16x32_bf16 v[112:115], a[228:231], v[232:235], v[112:115]
ds_write_b128 v244, v[96:99]
v_mfma_f32_16x16x32_bf16 v[112:115], a[224:227], v[188:191], v[112:115]
ds_read_b64_tr_b16 a[224:225], v241 offset:50048
v_mul_f32 v104, v253, v104
v_mul_f32 v105, v253, v105
v_mul_f32 v106, v253, v106
v_mul_f32 v107, v253, v107
v_mul_f32 v108, v253, v108
v_mfma_f32_16x16x32_bf16 v[116:119], a[232:235], v[188:191], v[116:119]
ds_read_b64_tr_b16 a[226:227], v241 offset:54176
ds_read_b64_tr_b16 a[228:229], v241 offset:58304
v_mul_f32 v109, v253, v109
v_mul_f32_e64 v110, v253, v110
v_mul_f32_e64 v111, v253, v111
v_cvt_pk_bf16_f32 v104, v104, v105
v_mfma_f32_16x16x32_bf16 v[116:119], a[236:239], v[232:235], v[116:119]
ds_read_b64_tr_b16 a[230:231], v241 offset:62432
v_cvt_pk_bf16_f32 v105, v106, v107
v_cvt_pk_bf16_f32 v106, v108, v109
v_mfma_f32_16x16x32_bf16 v[84:87], a[236:239], v[228:231], v[84:87]
v_cvt_pk_bf16_f32 v107, v110, v111
v_mfma_f32_16x16x32_bf16 v[84:87], a[232:235], v[184:187], v[84:87]
s_waitcnt lgkmcnt(5)
ds_write_b128 v247, v[104:107]
v_mfma_f32_16x16x32_bf16 v[88:91], a[240:243], v[184:187], v[88:91]
ds_read_b64_tr_b16 a[232:233], v241 offset:50056
ds_read_b128 v[236:239], v245
v_mul_f32 v64, v252, v64
v_mul_f32 v65, v252, v65
v_mul_f32 v66, v252, v66
v_mfma_f32_16x16x32_bf16 v[88:91], a[244:247], v[228:231], v[88:91]
ds_read_b64_tr_b16 a[234:235], v241 offset:54184
ds_read_b64_tr_b16 a[236:237], v241 offset:58312
v_mul_f32 v67, v252, v67
v_mul_f32 v68, v252, v68
v_mul_f32 v69, v252, v69
v_mul_f32 v70, v252, v70
v_mfma_f32_16x16x32_bf16 v[120:123], a[244:247], v[232:235], v[120:123]
ds_read_b64_tr_b16 a[238:239], v241 offset:62440
ds_read_b128 v[200:203], v245 offset:1024
v_mul_f32_e64 v71, v252, v71
v_cvt_pk_bf16_f32 v64, v64, v65
v_cvt_pk_bf16_f32 v65, v66, v67
v_cvt_pk_bf16_f32 v66, v68, v69
v_mfma_f32_16x16x32_bf16 v[120:123], a[240:243], v[188:191], v[120:123]
ds_read_b64_tr_b16 a[240:241], v241 offset:50304
ds_read_b64_tr_b16 a[242:243], v241 offset:54432
v_mfma_f32_16x16x32_bf16 v[124:127], a[248:251], v[188:191], v[124:127]
ds_read_b64_tr_b16 a[244:245], v241 offset:58560
v_cvt_pk_bf16_f32 v67, v70, v71
v_mfma_f32_16x16x32_bf16 v[124:127], a[252:255], v[232:235], v[124:127]
ds_write_b128 v244, v[64:67] offset:2048
v_mfma_f32_16x16x32_bf16 v[92:95], a[252:255], v[228:231], v[92:95]
ds_read_b64_tr_b16 a[246:247], v241 offset:62688
v_mul_f32 v72, v252, v72
v_mul_f32 v73, v252, v73
v_mul_f32 v74, v252, v74
v_mfma_f32_16x16x32_bf16 v[92:95], a[248:251], v[184:187], v[92:95]
s_waitcnt lgkmcnt(9)
buffer_store_dwordx4 v[236:239], v246, s[20:23], s35 offen sc1
v_mfma_f32_16x16x32_bf16 v[80:83], a[224:227], v[168:171], v[80:83]
ds_read_b64_tr_b16 a[248:249], v241 offset:50312
v_mul_f32 v75, v252, v75
v_mul_f32 v76, v252, v76
v_mul_f32 v77, v252, v77
v_mul_f32 v78, v252, v78
v_mul_f32 v79, v252, v79
v_mfma_f32_16x16x32_bf16 v[80:83], a[228:231], v[192:195], v[80:83]
s_waitcnt lgkmcnt(6)
buffer_store_dwordx4 v[200:203], v246, s[20:23], s35 offen offset:2048 sc1
v_mfma_f32_16x16x32_bf16 v[112:115], a[228:231], v[196:199], v[112:115]
ds_read_b64_tr_b16 a[250:251], v241 offset:54440
v_cvt_pk_bf16_f32 v72, v72, v73
v_cvt_pk_bf16_f32 v73, v74, v75
v_cvt_pk_bf16_f32 v74, v76, v77
v_mfma_f32_16x16x32_bf16 v[112:115], a[224:227], v[172:175], v[112:115]
ds_read_b64_tr_b16 a[252:253], v241 offset:58568
v_cvt_pk_bf16_f32 v75, v78, v79
v_mfma_f32_16x16x32_bf16 v[116:119], a[232:235], v[172:175], v[116:119]
ds_write_b128 v247, v[72:75] offset:2048
v_mfma_f32_16x16x32_bf16 v[116:119], a[236:239], v[196:199], v[116:119]
ds_read_b64_tr_b16 a[254:255], v241 offset:62696
ds_read_b128 v[204:207], v245 offset:2048
v_mfma_f32_16x16x32_bf16 v[84:87], a[236:239], v[192:195], v[84:87]
ds_read_b128 v[208:211], v245 offset:3072
v_mul_f32 v112, v253, v112
v_mfma_f32_16x16x32_bf16 v[84:87], a[232:235], v[168:171], v[84:87]
s_waitcnt lgkmcnt(6)
v_mul_f32 v113, v253, v113
v_mul_f32 v114, v253, v114
v_mfma_f32_16x16x32_bf16 v[88:91], a[240:243], v[168:171], v[88:91]
v_mul_f32 v115, v253, v115
v_mul_f32 v116, v253, v116
v_mfma_f32_16x16x32_bf16 v[88:91], a[244:247], v[192:195], v[88:91]
v_mul_f32_e64 v117, v253, v117
v_mul_f32_e64 v118, v253, v118
v_mfma_f32_16x16x32_bf16 v[120:123], a[244:247], v[196:199], v[120:123]
v_mul_f32_e64 v119, v253, v119
v_cvt_pk_bf16_f32 v112, v112, v113
v_mfma_f32_16x16x32_bf16 v[120:123], a[240:243], v[172:175], v[120:123]
s_waitcnt lgkmcnt(3)
v_cvt_pk_bf16_f32 v113, v114, v115
v_cvt_pk_bf16_f32 v114, v116, v117
v_mfma_f32_16x16x32_bf16 v[124:127], a[248:251], v[172:175], v[124:127]
s_waitcnt lgkmcnt(1)
buffer_store_dwordx4 v[204:207], v246, s[20:23], s59 offen sc1
v_mfma_f32_16x16x32_bf16 v[124:127], a[252:255], v[196:199], v[124:127]
s_waitcnt lgkmcnt(0)
v_cvt_pk_bf16_f32 v115, v118, v119
v_mul_f32 v120, v253, v120
v_mfma_f32_16x16x32_bf16 v[92:95], a[252:255], v[192:195], v[92:95]
buffer_store_dwordx4 v[208:211], v246, s[20:23], s59 offen offset:2048 sc1
v_mfma_f32_16x16x32_bf16 v[92:95], a[248:251], v[168:171], v[92:95]
ds_write_b128 v244, v[112:115] offset:4096
v_mul_f32 v121, v253, v121
v_mul_f32 v122, v253, v122
v_mul_f32 v123, v253, v123
v_mul_f32 v124, v253, v124
v_mul_f32 v125, v253, v125
v_mul_f32 v126, v253, v126
v_mul_f32_e64 v127, v253, v127
v_cvt_pk_bf16_f32 v120, v120, v121
v_cvt_pk_bf16_f32 v121, v122, v123
v_cvt_pk_bf16_f32 v122, v124, v125
v_cvt_pk_bf16_f32 v123, v126, v127
ds_write_b128 v247, v[120:123] offset:4096
ds_read_b128 v[212:215], v245 offset:4096
ds_read_b128 v[236:239], v245 offset:5120
v_pk_mul_f32 v[86:87], v[86:87], v[252:253] op_sel:[0,0] op_sel_hi:[1,0]
v_pk_mul_f32 v[84:85], v[84:85], v[252:253] op_sel:[0,0] op_sel_hi:[1,0]
v_pk_mul_f32 v[82:83], v[82:83], v[252:253] op_sel:[0,0] op_sel_hi:[1,0]
v_pk_mul_f32 v[80:81], v[80:81], v[252:253] op_sel:[0,0] op_sel_hi:[1,0]
v_cvt_pk_bf16_f32 v80, v80, v81
v_cvt_pk_bf16_f32 v81, v82, v83
v_cvt_pk_bf16_f32 v82, v84, v85
v_cvt_pk_bf16_f32 v83, v86, v87
ds_write_b128 v244, v[80:83] offset:6144
v_pk_mul_f32 v[94:95], v[94:95], v[252:253] op_sel:[0,0] op_sel_hi:[1,0]
v_pk_mul_f32 v[92:93], v[92:93], v[252:253] op_sel:[0,0] op_sel_hi:[1,0]
s_waitcnt lgkmcnt(2)
buffer_store_dwordx4 v[212:215], v246, s[20:23], s35 offen offset:128 sc1
s_waitcnt lgkmcnt(1)
buffer_store_dwordx4 v[236:239], v246, s[20:23], s35 offen offset:2176 sc1
v_pk_mul_f32 v[90:91], v[90:91], v[252:253] op_sel:[0,0] op_sel_hi:[1,0]
v_pk_mul_f32 v[88:89], v[88:89], v[252:253] op_sel:[0,0] op_sel_hi:[1,0]
v_cvt_pk_bf16_f32 v88, v88, v89
v_cvt_pk_bf16_f32 v89, v90, v91
v_cvt_pk_bf16_f32 v90, v92, v93
v_cvt_pk_bf16_f32 v91, v94, v95
ds_write_b128 v247, v[88:91] offset:6144
ds_read_b128 v[200:203], v245 offset:6144
ds_read_b128 v[204:207], v245 offset:7168
s_waitcnt lgkmcnt(1)
buffer_store_dwordx4 v[200:203], v246, s[20:23], s59 offen offset:128 sc1
s_waitcnt lgkmcnt(0)
buffer_store_dwordx4 v[204:207], v246, s[20:23], s59 offen offset:2176 sc1
    s_or_b64 s[62:63], s[42:43], s[40:41]
    s_or_b64 s[62:63], s[44:45], s[62:63]
    s_or_b64 s[62:63], s[46:47], s[62:63]
    s_or_b64 s[62:63], s[48:49], s[62:63]
    s_or_b64 s[62:63], s[50:51], s[62:63]
    s_or_b64 s[62:63], s[52:53], s[62:63]
    s_or_b64 s[62:63], s[54:55], s[62:63]
    s_cbranch_scc1 L_slow
    s_endpgm
L_slow:
    s_mov_b32 s64, 0
    s_cmp_lg_u64 s[40:41], 0
    s_cselect_b32 s65, 1, 0
    s_or_b32 s64, s64, s65
    s_cmp_lg_u64 s[42:43], 0
    s_cselect_b32 s65, 2, 0
    s_or_b32 s64, s64, s65
    s_cmp_lg_u64 s[44:45], 0
    s_cselect_b32 s65, 4, 0
    s_or_b32 s64, s64, s65
    s_cmp_lg_u64 s[46:47], 0
    s_cselect_b32 s65, 8, 0
    s_or_b32 s64, s64, s65
    s_cmp_lg_u64 s[48:49], 0
    s_cselect_b32 s65, 16, 0
    s_or_b32 s64, s64, s65
    s_cmp_lg_u64 s[50:51], 0
    s_cselect_b32 s65, 32, 0
    s_or_b32 s64, s64, s65
    s_cmp_lg_u64 s[52:53], 0
    s_cselect_b32 s65, 64, 0
    s_or_b32 s64, s64, s65
    s_cmp_lg_u64 s[54:55], 0
    s_cselect_b32 s65, 128, 0
    s_or_b32 s64, s64, s65
    s_waitcnt vmcnt(0) lgkmcnt(0)
    s_mov_b32 s34, 0x3e0293ee
    v_mbcnt_lo_u32_b32 v0, -1, 0
    v_mbcnt_hi_u32_b32 v0, -1, v0
    v_lshrrev_b32 v1, 5, v0
    v_and_b32 v2, 31, v0
    v_lshlrev_b32 v2, 8, v2
    v_lshl_add_u32 v244, v1, 4, v2
    v_lshlrev_b32 v1, 10, v1
    v_bfe_u32 v2, v0, 2, 2
    v_lshl_add_u32 v1, v2, 6, v1
    v_bfe_u32 v2, v0, 4, 1
    v_lshl_add_u32 v1, v2, 5, v1
    v_and_b32 v2, 1, v0
    v_lshl_add_u32 v1, v2, 4, v1
    v_bfe_u32 v2, v0, 1, 1
    v_lshl_add_u32 v1, v2, 3, v1
    v_add_u32 v241, s33, v1
    s_mov_b32 s65, 0
L_unit:
    s_bitcmp1_b32 s64, s65
    s_cbranch_scc0 L_next
    s_lshr_b32 s66, s65, 1
    s_lshl_b32 s67, s66, 24
    s_add_u32 s67, s67, s28
    s_and_b32 s68, s65, 1
    s_lshl_b32 s68, s68, 13
    s_xor_b32 s67, s67, s68
    s_lshl_b32 s66, s66, 23
    s_add_u32 s66, s66, s30
    buffer_load_dwordx4 v[0:3], v244, s[8:11], s67 offen offset:0
    buffer_load_dwordx4 v[4:7], v244, s[8:11], s67 offen offset:32
    buffer_load_dwordx4 v[8:11], v244, s[8:11], s67 offen offset:64
    buffer_load_dwordx4 v[12:15], v244, s[8:11], s67 offen offset:96
    buffer_load_dwordx4 v[16:19], v244, s[8:11], s67 offen offset:128
    buffer_load_dwordx4 v[20:23], v244, s[8:11], s67 offen offset:160
    buffer_load_dwordx4 v[24:27], v244, s[8:11], s67 offen offset:192
    buffer_load_dwordx4 v[28:31], v244, s[8:11], s67 offen offset:224
    v_mov_b32 v80, 0xff800000
    s_mov_b32 s68, s66
    s_mov_b32 s69, 0
L_p1:
    buffer_load_dwordx4 v[32:35], v244, s[12:15], s68 offen offset:0
    buffer_load_dwordx4 v[36:39], v244, s[12:15], s68 offen offset:32
    buffer_load_dwordx4 v[40:43], v244, s[12:15], s68 offen offset:64
    buffer_load_dwordx4 v[44:47], v244, s[12:15], s68 offen offset:96
    buffer_load_dwordx4 v[48:51], v244, s[12:15], s68 offen offset:128
    buffer_load_dwordx4 v[52:55], v244, s[12:15], s68 offen offset:160
    buffer_load_dwordx4 v[56:59], v244, s[12:15], s68 offen offset:192
    buffer_load_dwordx4 v[60:63], v244, s[12:15], s68 offen offset:224
    s_waitcnt vmcnt(0)
    v_mfma_f32_32x32x16_bf16 v[64:79], v[32:35], v[0:3], 0
    v_mfma_f32_32x32x16_bf16 v[64:79], v[36:39], v[4:7], v[64:79]
    v_mfma_f32_32x32x16_bf16 v[64:79], v[40:43], v[8:11], v[64:79]
    v_mfma_f32_32x32x16_bf16 v[64:79], v[44:47], v[12:15], v[64:79]
    v_mfma_f32_32x32x16_bf16 v[64:79], v[48:51], v[16:19], v[64:79]
    v_mfma_f32_32x32x16_bf16 v[64:79], v[52:55], v[20:23], v[64:79]
    v_mfma_f32_32x32x16_bf16 v[64:79], v[56:59], v[24:27], v[64:79]
    v_mfma_f32_32x32x16_bf16 v[64:79], v[60:63], v[28:31], v[64:79]
    s_nop 15
    v_max3_f32 v80, v80, v64, v65
    v_max3_f32 v80, v80, v66, v67
    v_max3_f32 v80, v80, v68, v69
    v_max3_f32 v80, v80, v70, v71
    v_max3_f32 v80, v80, v72, v73
    v_max3_f32 v80, v80, v74, v75
    v_max3_f32 v80, v80, v76, v77
    v_max3_f32 v80, v80, v78, v79
    s_add_u32 s68, s68, 8192
    s_add_u32 s69, s69, 1
    s_cmp_lt_u32 s69, 16
    s_cbranch_scc1 L_p1
    v_mov_b32 v81, v80
    s_nop 1
    v_permlane32_swap_b32 v80, v81
    s_nop 1
    v_max_f32 v80, v80, v81
    v_mov_b32 v82, 0
    v_mov_b32 v128, 0
    v_mov_b32 v129, 0
    v_mov_b32 v130, 0
    v_mov_b32 v131, 0
    v_mov_b32 v132, 0
    v_mov_b32 v133, 0
    v_mov_b32 v134, 0
    v_mov_b32 v135, 0
    v_mov_b32 v136, 0
    v_mov_b32 v137, 0
    v_mov_b32 v138, 0
    v_mov_b32 v139, 0
    v_mov_b32 v140, 0
    v_mov_b32 v141, 0
    v_mov_b32 v142, 0
    v_mov_b32 v143, 0
    v_mov_b32 v144, 0
    v_mov_b32 v145, 0
    v_mov_b32 v146, 0
    v_mov_b32 v147, 0
    v_mov_b32 v148, 0
    v_mov_b32 v149, 0
    v_mov_b32 v150, 0
    v_mov_b32 v151, 0
    v_mov_b32 v152, 0
    v_mov_b32 v153, 0
    v_mov_b32 v154, 0
    v_mov_b32 v155, 0
    v_mov_b32 v156, 0
    v_mov_b32 v157, 0
    v_mov_b32 v158, 0
    v_mov_b32 v159, 0
    v_mov_b32 v160, 0
    v_mov_b32 v161, 0
    v_mov_b32 v162, 0
    v_mov_b32 v163, 0
    v_mov_b32 v164, 0
    v_mov_b32 v165, 0
    v_mov_b32 v166, 0
    v_mov_b32 v167, 0
    v_mov_b32 v168, 0
    v_mov_b32 v169, 0
    v_mov_b32 v170, 0
    v_mov_b32 v171, 0
    v_mov_b32 v172, 0
    v_mov_b32 v173, 0
    v_mov_b32 v174, 0
    v_mov_b32 v175, 0
    v_mov_b32 v176, 0
    v_mov_b32 v177, 0
    v_mov_b32 v178, 0
    v_mov_b32 v179, 0
    v_mov_b32 v180, 0
    v_mov_b32 v181, 0
    v_mov_b32 v182, 0
    v_mov_b32 v183, 0
    v_mov_b32 v184, 0
    v_mov_b32 v185, 0
    v_mov_b32 v186, 0
    v_mov_b32 v187, 0
    v_mov_b32 v188, 0
    v_mov_b32 v189, 0
    v_mov_b32 v190, 0
    v_mov_b32 v191, 0
    s_mov_b32 s68, s66
    s_mov_b32 s69, 0
L_p2:
    buffer_load_dwordx4 v[32:35], v244, s[12:15], s68 offen offset:0
    buffer_load_dwordx4 v[36:39], v244, s[12:15], s68 offen offset:32
    buffer_load_dwordx4 v[40:43], v244, s[12:15], s68 offen offset:64
    buffer_load_dwordx4 v[44:47], v244, s[12:15], s68 offen offset:96
    buffer_load_dwordx4 v[48:51], v244, s[12:15], s68 offen offset:128
    buffer_load_dwordx4 v[52:55], v244, s[12:15], s68 offen offset:160
    buffer_load_dwordx4 v[56:59], v244, s[12:15], s68 offen offset:192
    buffer_load_dwordx4 v[60:63], v244, s[12:15], s68 offen offset:224
    s_mov_b32 m0, s33
    s_add_u32 s62, s68, 4096
    buffer_load_dwordx4 v243, s[16:19], s68 offen offset:0 lds
    buffer_load_dwordx4 v243, s[16:19], s68 offen offset:1024 lds
    buffer_load_dwordx4 v243, s[16:19], s68 offen offset:2048 lds
    buffer_load_dwordx4 v243, s[16:19], s68 offen offset:3072 lds
    s_add_u32 m0, s33, 4096
    s_nop 0
    buffer_load_dwordx4 v243, s[16:19], s62 offen offset:0 lds
    buffer_load_dwordx4 v243, s[16:19], s62 offen offset:1024 lds
    buffer_load_dwordx4 v243, s[16:19], s62 offen offset:2048 lds
    buffer_load_dwordx4 v243, s[16:19], s62 offen offset:3072 lds
    s_waitcnt vmcnt(0)
    ds_read_b64_tr_b16 v[96:97], v241 offset:0
    ds_read_b64_tr_b16 v[98:99], v241 offset:2048
    ds_read_b64_tr_b16 v[100:101], v241 offset:256
    ds_read_b64_tr_b16 v[102:103], v241 offset:2304
    ds_read_b64_tr_b16 v[104:105], v241 offset:512
    ds_read_b64_tr_b16 v[106:107], v241 offset:2560
    ds_read_b64_tr_b16 v[108:109], v241 offset:768
    ds_read_b64_tr_b16 v[110:111], v241 offset:2816
    ds_read_b64_tr_b16 v[112:113], v241 offset:4096
    ds_read_b64_tr_b16 v[114:115], v241 offset:6144
    ds_read_b64_tr_b16 v[116:117], v241 offset:4352
    ds_read_b64_tr_b16 v[118:119], v241 offset:6400
    ds_read_b64_tr_b16 v[120:121], v241 offset:4608
    ds_read_b64_tr_b16 v[122:123], v241 offset:6656
    ds_read_b64_tr_b16 v[124:125], v241 offset:4864
    ds_read_b64_tr_b16 v[126:127], v241 offset:6912
    v_mfma_f32_32x32x16_bf16 v[64:79], v[32:35], v[0:3], 0
    v_mfma_f32_32x32x16_bf16 v[64:79], v[36:39], v[4:7], v[64:79]
    v_mfma_f32_32x32x16_bf16 v[64:79], v[40:43], v[8:11], v[64:79]
    v_mfma_f32_32x32x16_bf16 v[64:79], v[44:47], v[12:15], v[64:79]
    v_mfma_f32_32x32x16_bf16 v[64:79], v[48:51], v[16:19], v[64:79]
    v_mfma_f32_32x32x16_bf16 v[64:79], v[52:55], v[20:23], v[64:79]
    v_mfma_f32_32x32x16_bf16 v[64:79], v[56:59], v[24:27], v[64:79]
    v_mfma_f32_32x32x16_bf16 v[64:79], v[60:63], v[28:31], v[64:79]
    s_nop 15
    v_sub_f32 v64, v64, v80
    v_sub_f32 v65, v65, v80
    v_sub_f32 v66, v66, v80
    v_sub_f32 v67, v67, v80
    v_sub_f32 v68, v68, v80
    v_sub_f32 v69, v69, v80
    v_sub_f32 v70, v70, v80
    v_sub_f32 v71, v71, v80
    v_sub_f32 v72, v72, v80
    v_sub_f32 v73, v73, v80
    v_sub_f32 v74, v74, v80
    v_sub_f32 v75, v75, v80
    v_sub_f32 v76, v76, v80
    v_sub_f32 v77, v77, v80
    v_sub_f32 v78, v78, v80
    v_sub_f32 v79, v79, v80
    v_mul_f32 v64, s34, v64
    v_mul_f32 v65, s34, v65
    v_mul_f32 v66, s34, v66
    v_mul_f32 v67, s34, v67
    v_mul_f32 v68, s34, v68
    v_mul_f32 v69, s34, v69
    v_mul_f32 v70, s34, v70
    v_mul_f32 v71, s34, v71
    v_mul_f32 v72, s34, v72
    v_mul_f32 v73, s34, v73
    v_mul_f32 v74, s34, v74
    v_mul_f32 v75, s34, v75
    v_mul_f32 v76, s34, v76
    v_mul_f32 v77, s34, v77
    v_mul_f32 v78, s34, v78
    v_mul_f32 v79, s34, v79
    v_exp_f32 v64, v64
    v_exp_f32 v65, v65
    v_exp_f32 v66, v66
    v_exp_f32 v67, v67
    v_exp_f32 v68, v68
    v_exp_f32 v69, v69
    v_exp_f32 v70, v70
    v_exp_f32 v71, v71
    v_exp_f32 v72, v72
    v_exp_f32 v73, v73
    v_exp_f32 v74, v74
    v_exp_f32 v75, v75
    v_exp_f32 v76, v76
    v_exp_f32 v77, v77
    v_exp_f32 v78, v78
    v_exp_f32 v79, v79
    s_nop 0
    v_add_f32 v82, v82, v64
    v_add_f32 v82, v82, v65
    v_add_f32 v82, v82, v66
    v_add_f32 v82, v82, v67
    v_add_f32 v82, v82, v68
    v_add_f32 v82, v82, v69
    v_add_f32 v82, v82, v70
    v_add_f32 v82, v82, v71
    v_add_f32 v82, v82, v72
    v_add_f32 v82, v82, v73
    v_add_f32 v82, v82, v74
    v_add_f32 v82, v82, v75
    v_add_f32 v82, v82, v76
    v_add_f32 v82, v82, v77
    v_add_f32 v82, v82, v78
    v_add_f32 v82, v82, v79
    v_cvt_pk_bf16_f32 v84, v64, v65
    v_cvt_pk_bf16_f32 v85, v66, v67
    v_cvt_pk_bf16_f32 v86, v68, v69
    v_cvt_pk_bf16_f32 v87, v70, v71
    v_cvt_pk_bf16_f32 v88, v72, v73
    v_cvt_pk_bf16_f32 v89, v74, v75
    v_cvt_pk_bf16_f32 v90, v76, v77
    v_cvt_pk_bf16_f32 v91, v78, v79
    s_waitcnt lgkmcnt(0)
    s_nop 1
    v_mfma_f32_32x32x16_bf16 v[128:143], v[96:99], v[84:87], v[128:143]
    v_mfma_f32_32x32x16_bf16 v[144:159], v[100:103], v[84:87], v[144:159]
    v_mfma_f32_32x32x16_bf16 v[160:175], v[104:107], v[84:87], v[160:175]
    v_mfma_f32_32x32x16_bf16 v[176:191], v[108:111], v[84:87], v[176:191]
    v_mfma_f32_32x32x16_bf16 v[128:143], v[112:115], v[88:91], v[128:143]
    v_mfma_f32_32x32x16_bf16 v[144:159], v[116:119], v[88:91], v[144:159]
    v_mfma_f32_32x32x16_bf16 v[160:175], v[120:123], v[88:91], v[160:175]
    v_mfma_f32_32x32x16_bf16 v[176:191], v[124:127], v[88:91], v[176:191]
    s_add_u32 s68, s68, 8192
    s_add_u32 s69, s69, 1
    s_cmp_lt_u32 s69, 16
    s_cbranch_scc1 L_p2
    v_mov_b32 v81, v82
    s_nop 15
    v_permlane32_swap_b32 v82, v81
    s_nop 1
    v_add_f32 v82, v82, v81
    v_rcp_f32 v82, v82
    s_nop 1
    v_mul_f32 v128, v82, v128
    v_mul_f32 v129, v82, v129
    v_mul_f32 v130, v82, v130
    v_mul_f32 v131, v82, v131
    v_mul_f32 v132, v82, v132
    v_mul_f32 v133, v82, v133
    v_mul_f32 v134, v82, v134
    v_mul_f32 v135, v82, v135
    v_mul_f32 v136, v82, v136
    v_mul_f32 v137, v82, v137
    v_mul_f32 v138, v82, v138
    v_mul_f32 v139, v82, v139
    v_mul_f32 v140, v82, v140
    v_mul_f32 v141, v82, v141
    v_mul_f32 v142, v82, v142
    v_mul_f32 v143, v82, v143
    v_mul_f32 v144, v82, v144
    v_mul_f32 v145, v82, v145
    v_mul_f32 v146, v82, v146
    v_mul_f32 v147, v82, v147
    v_mul_f32 v148, v82, v148
    v_mul_f32 v149, v82, v149
    v_mul_f32 v150, v82, v150
    v_mul_f32 v151, v82, v151
    v_mul_f32 v152, v82, v152
    v_mul_f32 v153, v82, v153
    v_mul_f32 v154, v82, v154
    v_mul_f32 v155, v82, v155
    v_mul_f32 v156, v82, v156
    v_mul_f32 v157, v82, v157
    v_mul_f32 v158, v82, v158
    v_mul_f32 v159, v82, v159
    v_mul_f32 v160, v82, v160
    v_mul_f32 v161, v82, v161
    v_mul_f32 v162, v82, v162
    v_mul_f32 v163, v82, v163
    v_mul_f32 v164, v82, v164
    v_mul_f32 v165, v82, v165
    v_mul_f32 v166, v82, v166
    v_mul_f32 v167, v82, v167
    v_mul_f32 v168, v82, v168
    v_mul_f32 v169, v82, v169
    v_mul_f32 v170, v82, v170
    v_mul_f32 v171, v82, v171
    v_mul_f32 v172, v82, v172
    v_mul_f32 v173, v82, v173
    v_mul_f32 v174, v82, v174
    v_mul_f32 v175, v82, v175
    v_mul_f32 v176, v82, v176
    v_mul_f32 v177, v82, v177
    v_mul_f32 v178, v82, v178
    v_mul_f32 v179, v82, v179
    v_mul_f32 v180, v82, v180
    v_mul_f32 v181, v82, v181
    v_mul_f32 v182, v82, v182
    v_mul_f32 v183, v82, v183
    v_mul_f32 v184, v82, v184
    v_mul_f32 v185, v82, v185
    v_mul_f32 v186, v82, v186
    v_mul_f32 v187, v82, v187
    v_mul_f32 v188, v82, v188
    v_mul_f32 v189, v82, v189
    v_mul_f32 v190, v82, v190
    v_mul_f32 v191, v82, v191
    v_cvt_pk_bf16_f32 v128, v128, v129
    v_cvt_pk_bf16_f32 v129, v130, v131
    v_cvt_pk_bf16_f32 v130, v132, v133
    v_cvt_pk_bf16_f32 v131, v134, v135
    buffer_store_dwordx4 v[128:131], v244, s[20:23], s67 offen offset:0
    v_cvt_pk_bf16_f32 v136, v136, v137
    v_cvt_pk_bf16_f32 v137, v138, v139
    v_cvt_pk_bf16_f32 v138, v140, v141
    v_cvt_pk_bf16_f32 v139, v142, v143
    buffer_store_dwordx4 v[136:139], v244, s[20:23], s67 offen offset:32
    v_cvt_pk_bf16_f32 v144, v144, v145
    v_cvt_pk_bf16_f32 v145, v146, v147
    v_cvt_pk_bf16_f32 v146, v148, v149
    v_cvt_pk_bf16_f32 v147, v150, v151
    buffer_store_dwordx4 v[144:147], v244, s[20:23], s67 offen offset:64
    v_cvt_pk_bf16_f32 v152, v152, v153
    v_cvt_pk_bf16_f32 v153, v154, v155
    v_cvt_pk_bf16_f32 v154, v156, v157
    v_cvt_pk_bf16_f32 v155, v158, v159
    buffer_store_dwordx4 v[152:155], v244, s[20:23], s67 offen offset:96
    v_cvt_pk_bf16_f32 v160, v160, v161
    v_cvt_pk_bf16_f32 v161, v162, v163
    v_cvt_pk_bf16_f32 v162, v164, v165
    v_cvt_pk_bf16_f32 v163, v166, v167
    buffer_store_dwordx4 v[160:163], v244, s[20:23], s67 offen offset:128
    v_cvt_pk_bf16_f32 v168, v168, v169
    v_cvt_pk_bf16_f32 v169, v170, v171
    v_cvt_pk_bf16_f32 v170, v172, v173
    v_cvt_pk_bf16_f32 v171, v174, v175
    buffer_store_dwordx4 v[168:171], v244, s[20:23], s67 offen offset:160
    v_cvt_pk_bf16_f32 v176, v176, v177
    v_cvt_pk_bf16_f32 v177, v178, v179
    v_cvt_pk_bf16_f32 v178, v180, v181
    v_cvt_pk_bf16_f32 v179, v182, v183
    buffer_store_dwordx4 v[176:179], v244, s[20:23], s67 offen offset:192
    v_cvt_pk_bf16_f32 v184, v184, v185
    v_cvt_pk_bf16_f32 v185, v186, v187
    v_cvt_pk_bf16_f32 v186, v188, v189
    v_cvt_pk_bf16_f32 v187, v190, v191
    buffer_store_dwordx4 v[184:187], v244, s[20:23], s67 offen offset:224
    s_waitcnt vmcnt(0)
L_next:
    s_add_u32 s65, s65, 1
    s_cmp_lt_u32 s65, 8
    s_cbranch_scc1 L_unit
L_end:
    s_endpgm
.section .rodata,"a"
.p2align 6
.amdhsa_kernel standalone__mha_softmax__near_ridge_kernel
  .amdhsa_next_free_vgpr 512
  .amdhsa_next_free_sgpr 96
  .amdhsa_accum_offset 256
  .amdhsa_group_segment_fixed_size 0
  .amdhsa_float_denorm_mode_32 3
  .amdhsa_kernarg_size 48
  .amdhsa_user_sgpr_count 2
  .amdhsa_user_sgpr_kernarg_segment_ptr 1
  .amdhsa_system_sgpr_workgroup_id_x 1
.end_amdhsa_kernel
```
